```python
import torch

def _softmax(x, axis=-1):
    return torch.softmax(x, dim=axis)
def _gelu(x):
    return torch.nn.functional.gelu(x, approximate="tanh")
def _silu(x):
    return torch.nn.functional.silu(x)
def _sigmoid(x):
    return torch.sigmoid(x)
def _layernorm(x, axis=-1, eps=1e-5):
    m = x.mean(dim=axis, keepdim=True)
    v = x.var(dim=axis, keepdim=True, unbiased=False)
    return (x - m) / torch.sqrt(v + eps)
def _scatter_add(tgt, idx, src, axis=0):
    return tgt.clone().index_add_(axis, idx, src)
def _segment_sum(src, seg, n):
    out = torch.zeros((n,) + src.shape[1:], dtype=src.dtype)
    return out.index_add_(0, seg, src)
def _pad(x, pw):
    flat = tuple(v for pair in reversed(pw) for v in pair)
    return torch.nn.functional.pad(x, flat)

kernel_name = 'parallel_sum__ssm_conv_s5__glu_gated_glu__prompt'

def setup_inputs():

    _w = (lambda a: (lambda t: t.to(torch.bfloat16) if t.is_floating_point() else t)(torch.as_tensor(a)))
    def _A_setup():
        B, S, D = 1, 2048, 640
        P = D
        Lambda_re = -0.5 * (lambda _x: torch.exp(torch.as_tensor(_x)))((lambda *s: torch.randn(*s, dtype=torch.bfloat16) * 0.8)(P))
        Lambda_im = (lambda *s: torch.randn(*s, dtype=torch.bfloat16) * 0.8)(P) * 1.0
        B_re = (lambda *s: torch.randn(*s, dtype=torch.bfloat16) * 0.8)(P, D) * (D ** -0.5)
        B_im = (lambda *s: torch.randn(*s, dtype=torch.bfloat16) * 0.8)(P, D) * (D ** -0.5)
        C_re = (lambda *s: torch.randn(*s, dtype=torch.bfloat16) * 0.8)(D, P) * (P ** -0.5)
        C_im = (lambda *s: torch.randn(*s, dtype=torch.bfloat16) * 0.8)(D, P) * (P ** -0.5)
        log_dt = (lambda *s: torch.randn(*s, dtype=torch.bfloat16) * 0.8)(P) * 0.3 - 2.0
        Dskip = (lambda *s: torch.randn(*s, dtype=torch.bfloat16) * 0.8)(D)
        return {
            "x": _w((lambda *s: torch.randn(*s, dtype=torch.bfloat16) * 0.05)(B, S, D)),
            "Lambda_re": _w(Lambda_re),
            "Lambda_im": _w(Lambda_im),
            "B_re": _w(B_re),
            "B_im": _w(B_im),
            "C_re": _w(C_re),
            "C_im": _w(C_im),
            "log_dt": _w(log_dt),
            "Dskip": _w(Dskip),
        }
    _A_in = _A_setup()

    def _B_setup():
        B, S, D, F = 1, 2048, 640, 1728
        return {
            "x": _w((lambda *s: torch.randn(*s, dtype=torch.bfloat16) * 0.05)(B, S, D)),
            "w_gate": _w((lambda *s: torch.randn(*s, dtype=torch.bfloat16) * 0.05)(D, F)),
            "w_up": _w((lambda *s: torch.randn(*s, dtype=torch.bfloat16) * 0.05)(D, F)),
            "w_down": _w((lambda *s: torch.randn(*s, dtype=torch.bfloat16) * 0.05)(F, D)),
        }
    _B_in = _B_setup()

    return {
        "A_x": _A_in["x"],
        "A_Lambda_re": _A_in["Lambda_re"],
        "A_Lambda_im": _A_in["Lambda_im"],
        "A_B_re": _A_in["B_re"],
        "A_B_im": _A_in["B_im"],
        "A_C_re": _A_in["C_re"],
        "A_C_im": _A_in["C_im"],
        "A_log_dt": _A_in["log_dt"],
        "A_Dskip": _A_in["Dskip"],
        "B_x": _B_in["x"],
        "B_w_gate": _B_in["w_gate"],
        "B_w_up": _B_in["w_up"],
        "B_w_down": _B_in["w_down"],
    }

def reference(A_x, A_Lambda_re, A_Lambda_im, A_B_re, A_B_im, A_C_re, A_C_im, A_log_dt, A_Dskip, B_x, B_w_gate, B_w_up, B_w_down):
    def _A_ref(x, Lambda_re, Lambda_im, B_re, B_im, C_re, C_im, log_dt, Dskip):
        Bsz, L, H = x.shape
        Lam = Lambda_re + 1j * Lambda_im
        Bmat = B_re + 1j * B_im
        Cmat = C_re + 1j * C_im
        dt = torch.exp(log_dt)
        Lam_bar = torch.exp(dt * Lam)
        B_bar = ((Lam_bar - 1.0) / Lam)[:, None] * Bmat
        Bu = torch.einsum("bld,pd->blp", x + 0j, B_bar)
        h = torch.zeros_like(Bu[:, 0, :])
        hs = []
        for t in range(L):
            h = Lam_bar[None, :] * h + Bu[:, t, :]
            hs.append(h)
        hseq = torch.stack(hs, 1)
        y = 2.0 * torch.einsum("blp,dp->bld", hseq, Cmat).real + x * Dskip[None, None, :]
        return y

    def _B_ref(x, w_gate, w_up, w_down):
        g = torch.einsum("bsd,df->bsf", x, w_gate)
        u = torch.einsum("bsd,df->bsf", x, w_up)
        h = _sigmoid(g) * u
        return torch.einsum("bsf,fd->bsd", h, w_down)

    x = A_x
    xn = _layernorm(x, axis=-1)
    return x + _A_ref(xn, A_Lambda_re, A_Lambda_im, A_B_re, A_B_im, A_C_re, A_C_im, A_log_dt, A_Dskip) + _B_ref(xn, B_w_gate, B_w_up, B_w_down)
```

```asm
; @launch grid=(256,1,1) block=(256,1,1) lds=163840
.amdgcn_target "amdgcn-amd-amdhsa--gfx950"

.text
.globl parallel_sum__ssm_conv_s5__glu_gated_glu__prompt_kernel
.p2align 8
.type parallel_sum__ssm_conv_s5__glu_gated_glu__prompt_kernel,@function
parallel_sum__ssm_conv_s5__glu_gated_glu__prompt_kernel:
    s_cmp_ge_u32 s2, 256
    s_cbranch_scc1 L_end
    s_load_dwordx2 s[40:41], s[0:1], 0
    s_load_dwordx16 s[8:23], s[0:1], 0
    s_load_dwordx16 s[24:39], s[0:1], 64
    s_getpc_b64 s[84:85]
L_pf:
    s_mov_b32 s86, L_end-L_pf
    s_mov_b32 s87, 0x20000
    s_lshr_b32 s74, s2, 3
    s_mul_i32 s73, s74, 3072
    v_lshlrev_b32 v1, 7, v0
    v_cmp_gt_u32 vcc, 24, v0
    v_mov_b32 v2, 134217728
    v_add_u32 v1, s73, v1
    v_cndmask_b32 v1, v2, v1, vcc
    buffer_load_dword a255, v1, s[84:87], 0 offen
    v_and_b32 v233, 63, v0
    v_lshrrev_b32 v1, 6, v0
    v_lshlrev_b32 v238, 4, v233
    v_readfirstlane_b32 s64, v1
    v_lshrrev_b32 v7, 5, v233
    v_lshrrev_b32 v2, 3, v233
    v_and_b32 v3, 7, v233
    s_mov_b32 s79, 0
    s_mul_i32 s71, s64, 5120
    s_lshl_b32 s73, s64, 2
    v_lshrrev_b32 v4, 1, v2
    v_add_u32 v4, s73, v4
    v_and_b32 v4, 7, v4
    v_xor_b32 v4, v4, v3
    v_lshlrev_b32 v4, 4, v4
    s_and_b32 s73, s2, 3
    s_bfe_u32 s75, s2, 0x10002
    s_and_b32 s77, s2, 2
    s_lshl_b32 s77, s77, 1
    s_add_u32 s77, s77, 8
    s_cmp_lt_u32 s74, s77
    s_cbranch_scc1 L_ssmx
    s_sub_u32 s74, s74, s77
    s_lshl_b32 s76, s2, 2
    s_lshr_b32 s73, 572531203, s76
    s_and_b32 s73, s73, 15
    s_mul_i32 s73, s73, 7
    s_sub_u32 s73, s74, s73
    s_mul_i32 s66, s74, 37
    s_lshr_b32 s66, s66, 8
    s_mul_i32 s65, s66, 7
    s_sub_u32 s65, s74, s65
    s_sub_u32 s65, s65, s75
    s_lshr_b32 s77, 3111146240, s76
    s_add_u32 s66, s66, s77
    s_mul_i32 s78, s73, 43
    s_lshr_b32 s78, s78, 8
    s_mul_i32 s68, s78, 6
    s_sub_u32 s68, s73, s68
    s_lshr_b32 s77, 1698745213, s76
    s_add_u32 s78, s78, s77
    s_cmp_lt_i32 s73, 0
    s_cselect_b32 s66, s66, s78
    s_cselect_b32 s65, s65, s68
    s_and_b32 s66, s66, 15
    s_mul_i32 s77, s75, 7
    s_add_u32 s65, s65, s77
    s_lshr_b32 s77, 4283432949, s76
    s_and_b32 s77, s77, 15
    s_add_u32 s77, s77, 16
    s_mul_i32 s78, s75, 3
    s_add_u32 s68, s68, s78
    s_lshl_b32 s78, s68, 1
    s_cmp_ge_u32 s74, s77
    s_cselect_b32 s66, 13, s66
    s_cselect_b32 s65, s78, s65
    s_cselect_b32 s77, s68, 6
    s_mul_i32 s73, s65, 86
    s_lshr_b32 s73, s73, 8
    s_mul_i32 s73, s73, 3
    s_sub_u32 s73, s65, s73
    s_bfe_u32 s74, s2, 0x10002
    s_lshl_b32 s74, s74, 1
    s_add_u32 s73, s73, s74
    s_lshl_b32 s3, s73, 8
    s_cmp_eq_u32 s77, 5
    s_cselect_b32 s74, 2, s77
    s_lshl_b32 s74, s74, 8
    s_cmp_lt_u32 s77, 6
    s_cselect_b32 s3, s74, s3
    s_mul_i32 s74, s65, 160
    s_lshl_b32 s73, s64, 3
    v_mov_b32 v8, v2
    s_mov_b32 s69, 39936
    s_mov_b32 s70, 163840
    s_branch L_x
L_ssmx:
    s_lshl_b32 s65, s73, 2
    s_add_u32 s65, s65, s74
    s_cmp_ge_u32 s74, 8
    s_cselect_b32 s66, 4, s73
    s_cselect_b32 s65, s65, s74
    s_and_b32 s65, s65, 7
    s_lshl_b32 s75, s75, 3
    s_add_u32 s65, s65, s75
    s_mul_i32 s73, s65, 86
    s_lshr_b32 s73, s73, 8
    s_mul_i32 s73, s73, 3
    s_sub_u32 s73, s65, s73
    s_bfe_u32 s74, s2, 0x10002
    s_lshl_b32 s74, s74, 1
    s_add_u32 s73, s73, s74
    s_add_u32 s73, s73, s66
    s_mul_i32 s74, s73, 52
    s_lshr_b32 s74, s74, 8
    s_mul_i32 s74, s74, 5
    s_sub_u32 s73, s73, s74
    s_lshl_b32 s3, s73, 8
    s_lshl_b32 s74, s65, 7
    s_lshl_b32 s73, s64, 1
    s_mov_b32 s69, 9216
    s_mov_b32 s70, 134217728
    s_mov_b32 s77, 7
    v_and_b32 v9, 1, v2
    v_lshl_add_u32 v8, v7, 1, v9
    v_bfe_u32 v10, v2, 1, 1
    v_lshl_add_u32 v8, v8, 5, v10
L_x:
    s_add_u32 s74, s74, s73
    v_add_u32 v8, s74, v8
    v_mul_u32_u24 v8, 1280, v8
    v_add_u32 v224, v8, v4
    v_add_u32 v228, s70, v224
    v_add_u32 v225, s69, v224
    v_add_u32 v226, s69, v225
    v_add_u32 v227, s69, v226
    s_mov_b32 s42, 2621440
    s_mov_b32 s43, 0x20000
    s_mov_b32 m0, s71
    s_waitcnt lgkmcnt(0)
    buffer_load_dwordx4 v224, s[40:43], s3 offen offset:0 lds
    buffer_load_dwordx4 v225, s[40:43], s3 offen offset:1024 lds
    buffer_load_dwordx4 v226, s[40:43], s3 offen offset:2048 lds
    buffer_load_dwordx4 v227, s[40:43], s3 offen offset:3072 lds
    s_add_u32 m0, s71, 4096
    s_cmp_eq_u32 s77, 7
    buffer_load_dwordx4 v228, s[40:43], s3 offen lds
    s_cbranch_scc0 L_glup
    s_memrealtime s[98:99]
    s_lshl_b32 s78, s66, 2
    s_add_u32 s78, s78, s64
    s_lshl_b32 s77, s78, 5
    v_add_u32 v8, s77, v2
    v_mul_u32_u24 v8, 1280, v8
    v_lshrrev_b32 v9, 1, v2
    v_xor_b32 v9, v9, v3
    v_lshl_add_u32 v229, v9, 4, v8
    v_xor_b32_e64 v230, 64, v229
    v_add_u32 v230, 9216, v230
    v_add_u32 v231, 18432, v229
    v_add_u32 v232, 18432, v230
    s_mul_i32 s72, s64, 24576
    s_add_u32 s72, s72, 61440
    s_mov_b32 s44, s14
    s_mov_b32 s45, s15
    s_mov_b32 s46, 819200
    s_mov_b32 s47, 0x20000
    s_mov_b32 s48, s16
    s_mov_b32 s49, s17
    s_mov_b32 s50, 819200
    s_mov_b32 s51, 0x20000
    s_add_u32 m0, s72, 0
    s_add_u32 s68, s3, 0
    buffer_load_dwordx4 v229, s[44:47], s68 offen offset:0 lds
    buffer_load_dwordx4 v230, s[44:47], s68 offen offset:1024 lds
    buffer_load_dwordx4 v231, s[44:47], s68 offen offset:2048 lds
    buffer_load_dwordx4 v232, s[44:47], s68 offen offset:3072 lds
    s_add_u32 m0, s72, 4096
    s_nop 0
    buffer_load_dwordx4 v229, s[48:51], s68 offen offset:0 lds
    s_branch L_ssm2
L_glup:
    v_bfe_u32 v8, v233, 2, 3
    v_mul_u32_u24 v8, 3456, v8
    v_lshl_add_u32 v8, v7, 6, v8
    v_and_b32 v10, 0x30, v238
    s_lshr_b32 s73, s64, 1
    s_and_b32 s75, s64, 1
    s_lshl_b32 s76, s75, 13
    s_cmp_lt_u32 s77, 6
    s_cbranch_scc1 L_gldp
    s_lshl_b32 s74, s66, 1
    s_add_u32 s74, s74, s73
    s_lshl_b32 s77, s74, 7
    s_cmp_ge_u32 s74, 27
    s_cselect_b32 s77, 134217728, s77
    v_add3_u32 v229, v8, v10, s77
    s_mul_i32 s77, s73, 49152
    s_add_u32 s77, s77, 61440
    s_add_u32 s72, s76, s77
    v_add_u32 v230, 26624, v229
    v_add_u32 v231, 53248, v229
    v_add_u32 v232, 79872, v229
    s_bitcmp1_b32 s64, 0
    s_cselect_b32 s44, s30, s28
    s_cselect_b32 s45, s31, s29
    s_mov_b32 s46, 2211840
    s_mov_b32 s47, 0x20000
    s_mul_i32 s26, s3, 1728
    s_add_u32 m0, s72, 0
    s_add_u32 s68, s26, 0
    buffer_load_dwordx4 v229, s[44:47], s68 offen offset:0 lds
    buffer_load_dwordx4 v230, s[44:47], s68 offen offset:1024 lds
    buffer_load_dwordx4 v231, s[44:47], s68 offen offset:2048 lds
    buffer_load_dwordx4 v232, s[44:47], s68 offen offset:3072 lds
    s_mov_b32 s60, s36
    s_mov_b32 s61, s37
    s_mov_b32 s62, 256
    s_mov_b32 s63, 0x20000
    s_add_u32 s52, s38, 0
    s_addc_u32 s53, s39, 0
    s_mov_b32 s54, 12320768
    s_mov_b32 s55, 0x20000
    s_add_u32 s56, s38, 16777216
    s_addc_u32 s57, s39, 0
    s_mov_b32 s58, 5242880
    s_mov_b32 s59, 0x20000
    s_lshl_b32 s73, s2, 4
    s_add_u32 s73, s73, 4259840
    s_and_b32 s74, s2, 7
    s_or_b32 s74, s74, s64
    s_cselect_b32 s73, 134217728, s73
    buffer_load_dword a255, off, s[56:59], s73
    v_bfe_u32 v5, v233, 3, 2
    v_mul_u32_u24 v5, 5120, v5
    v_lshl_add_u32 v5, v3, 7, v5
    v_bfe_u32 v6, v233, 1, 3
    v_xor_b32 v6, v6, v7
    v_xor_b32 v8, 0, v6
    v_lshl_add_u32 v216, v8, 4, v5
    v_xor_b32 v8, 2, v6
    v_lshl_add_u32 v217, v8, 4, v5
    v_xor_b32 v8, 4, v6
    v_lshl_add_u32 v218, v8, 4, v5
    v_xor_b32_e64 v8, 6, v6
    v_lshl_add_u32 v219, v8, 4, v5
    s_add_u32 m0, s72, 4096
    s_add_u32 s68, s26, 110592
    buffer_load_dwordx4 v229, s[44:47], s68 offen offset:0 lds
    buffer_load_dwordx4 v230, s[44:47], s68 offen offset:1024 lds
    buffer_load_dwordx4 v231, s[44:47], s68 offen offset:2048 lds
    buffer_load_dwordx4 v232, s[44:47], s68 offen offset:3072 lds
    s_lshr_b32 s73, 391, s65
    s_lshl_b32 s31, s3, 1
    s_bitcmp1_b32 s73, 0
    s_cselect_b32 s31, s31, 134217728
    s_lshl_b32 s78, s66, 2
    s_add_u32 s78, s78, s64
    s_and_b32 s75, s64, 1
    s_lshl_b32 s75, s75, 9
    s_add_u32 s75, s75, s77
    v_bfe_u32 v8, v233, 2, 2
    v_lshlrev_b32 v8, 6, v8
    v_lshl_add_u32 v8, v7, 10, v8
    v_and_b32_e64 v10, 1, v233
    v_lshl_add_u32 v8, v10, 5, v8
    v_bfe_u32 v10, v233, 4, 1
    v_lshl_add_u32 v8, v10, 4, v8
    v_bfe_u32 v10, v233, 1, 1
    v_lshl_add_u32 v8, v10, 3, v8
    v_add_u32 v220, s75, v8
    s_lshl_b32 s67, s65, 2
    s_add_u32 s67, s67, s64
    s_lshl_b32 s67, s67, 4
    s_add_u32 s67, s67, s66
    s_lshl_b32 s67, s67, 5
    s_add_u32 s67, s67, 5046272
    s_mov_b32 s6, s72
    s_mov_b32 s48, s24
    s_mov_b32 s49, s25
    s_mov_b32 s50, 1280
    s_mov_b32 s51, 0x20000
    s_lshr_b32 s73, s2, 3
    s_xor_b32 s73, s73, 12
    s_or_b32 s73, s73, s64
    s_lshl_b32 s73, s73, 13
    v_lshl_add_u32 v14, v233, 7, s73
    buffer_load_dword a255, v14, s[48:51], 0 offen
    s_and_b32 s73, s2, 6
    s_lshl_b32 s73, s73, 2
    s_lshr_b32 s74, s2, 5
    s_add_u32 s4, s73, s74
    s_and_b32 s73, s2, 1
    s_lshl_b32 s73, s73, 2
    s_bfe_u32 s5, s2, 0x20003
    s_add_u32 s5, s5, s73
    s_mul_i32 s73, s4, 94
    s_add_u32 s69, s73, s64
    s_lshl_b32 s69, s69, 12
    s_and_b32 s74, s64, 2
    s_add_u32 s74, s74, 54
    s_lshl_b32 s74, s74, 12
    s_add_u32 s99, s69, s74
    s_mul_i32 s70, s5, 481280
    s_mul_i32 s73, s64, 5120
    s_add_u32 s70, s70, s73
    s_cmp_ge_u32 s64, 2
    s_cselect_b32 s7, 134217728, 0
    s_lshl_b32 s29, s64, 10
    s_and_b32 s74, s64, 2
    s_add_u32 s74, s74, 54
    s_mul_i32 s74, s74, 5120
    s_add_u32 s9, s70, s74
    s_bitcmp1_b32 s64, 0
    s_cselect_b32 s92, s20, s18
    s_cselect_b32 s93, s21, s19
    s_mov_b32 s94, 819200
    s_mov_b32 s95, 0x20000
    s_mul_i32 s98, s5, 102400
    s_lshr_b32 s73, s64, 1
    s_lshl_b32 s73, s73, 7
    s_add_u32 s98, s98, s73
    s_mov_b32 s12, 0
    s_add_u32 s13, s12, 256
    s_cmp_eq_u32 s13, 1280
    s_cselect_b32 s13, 0, s13
    s_add_u32 s14, s13, 256
    s_cmp_eq_u32 s14, 1280
    s_cselect_b32 s14, 0, s14
    s_add_u32 s15, s14, 256
    s_cmp_eq_u32 s15, 1280
    s_cselect_b32 s15, 0, s15
    s_add_u32 s30, s15, 256
    s_cmp_eq_u32 s30, 1280
    s_cselect_b32 s30, 0, s30
    s_add_u32 s73, s72, 32768
    v_mul_u32_u24 v14, 1280, v2
    v_lshrrev_b32 v15, 1, v2
    v_xor_b32 v15, v15, v3
    v_lshl_add_u32 v250, v15, 4, v14
    v_xor_b32 v251, 64, v250
    v_add_u32 v251, 9216, v251
    v_bfe_u32 v14, v233, 1, 3
    v_lshrrev_b32 v15, 4, v233
    v_xor_b32 v14, v14, v15
    v_and_b32 v15, 15, v233
    v_lshl_add_u32 v15, v15, 7, s73
    v_lshl_add_u32 v252, v14, 4, v15
    v_xor_b32 v253, 64, v252
    s_mov_b32 s88, s32
    s_mov_b32 s89, s33
    s_mov_b32 s90, 2211840
    s_mov_b32 s91, 0x20000
    v_mul_u32_u24 v17, 1280, v2
    v_lshl_add_u32 v249, v3, 4, v17
    s_mul_i32 s27, s64, 12
    s_add_u32 s27, s27, s65
    s_mul_i32 s27, s27, 13
    s_add_u32 s27, s27, s66
    s_add_u32 s27, s27, 0
    s_mul_i32 s73, s64, 312
    s_add_u32 s73, s73, 155
    s_sub_u32 s27, s73, s27
    s_cmp_ge_u32 s27, 484
    s_cselect_b32 s27, 600, s27
    s_add_u32 s73, s78, 484
    s_cmp_eq_u32 s65, 12
    s_cselect_b32 s27, s73, s27
    s_mul_i32 s100, s27, 6554
    s_lshr_b32 s100, s100, 16
    s_mul_i32 s101, s100, 10
    s_sub_u32 s101, s27, s101
    s_lshl_b32 s76, s101, 7
    s_mul_i32 s97, s100, 40960
    s_add_u32 s97, s97, s76
    s_lshl_b32 s73, s101, 2
    v_lshrrev_b32 v15, 4, v233
    v_add_u32 v15, s73, v15
    v_mul_u32_u24 v248, 13, v15
    v_lshrrev_b32 v248, 6, v248
    v_mul_u32_u24 v248, 476160, v248
    v_lshl_add_u32 v248, v15, 10, v248
    v_and_b32 v15, 0xf0, v238
    v_add_u32 v248, v248, v15
    s_mul_i32 s96, s100, 5120
    s_cmp_ge_u32 s100, 54
    s_cselect_b32 s96, 134217728, s96
    v_bfe_u32 v247, v233, 2, 2
    v_lshlrev_b32 v247, 7, v247
    v_lshrrev_b32 v15, 4, v233
    v_lshl_add_u32 v247, v15, 5, v247
    v_and_b32 v16, 3, v233
    v_lshlrev_b32 v16, 3, v16
    v_add3_u32 v247, v247, v16, s71
    s_add_u32 m0, s71, 24576
    s_add_u32 s3, s3, 128
    s_cmp_eq_u32 s3, 1280
    s_cselect_b32 s3, 0, s3
    s_mul_i32 s26, s3, 1728
    s_add_u32 s68, s3, 0
    buffer_load_dwordx4 v228, s[40:43], s68 offen lds
    s_add_u32 m0, s71, 20480
    s_nop 0
    buffer_load_dwordx4 v224, s[40:43], s68 offen offset:0 lds
    buffer_load_dwordx4 v225, s[40:43], s68 offen offset:1024 lds
    buffer_load_dwordx4 v226, s[40:43], s68 offen offset:2048 lds
    buffer_load_dwordx4 v227, s[40:43], s68 offen offset:3072 lds
    s_add_u32 m0, s72, 16384
    s_add_u32 s68, s26, 0
    buffer_load_dwordx4 v229, s[44:47], s68 offen offset:0 lds
    buffer_load_dwordx4 v230, s[44:47], s68 offen offset:1024 lds
    buffer_load_dwordx4 v231, s[44:47], s68 offen offset:2048 lds
    s_waitcnt vmcnt(9)
    s_barrier
    s_cmp_eq_u32 s65, 12
    s_cbranch_scc1 L_g12
    s_branch L_glu
L_gldp:
    s_mul_i32 s74, s73, 110592
    s_add_u32 s74, s74, 3328
    v_add3_u32 v229, v8, v10, s74
    s_lshl_b32 s74, s73, 12
    s_add_u32 s72, s76, s74
    s_add_u32 s72, s72, 122880
    s_add_u32 s65, s65, s73
    s_add_u32 s78, s75, 52
    v_add_u32 v230, 26624, v229
    v_add_u32 v231, 53248, v229
    v_add_u32 v232, 79872, v229
    s_bitcmp1_b32 s64, 0
    s_cselect_b32 s44, s30, s28
    s_cselect_b32 s45, s31, s29
    s_mov_b32 s46, 2211840
    s_mov_b32 s47, 0x20000
    s_mul_i32 s26, s3, 1728
    s_add_u32 m0, s72, 0
    s_add_u32 s68, s26, 0
    buffer_load_dwordx4 v229, s[44:47], s68 offen offset:0 lds
    buffer_load_dwordx4 v230, s[44:47], s68 offen offset:1024 lds
    buffer_load_dwordx4 v231, s[44:47], s68 offen offset:2048 lds
    buffer_load_dwordx4 v232, s[44:47], s68 offen offset:3072 lds
    s_mov_b32 s60, s36
    s_mov_b32 s61, s37
    s_mov_b32 s62, 256
    s_mov_b32 s63, 0x20000
    s_add_u32 s52, s38, 0
    s_addc_u32 s53, s39, 0
    s_mov_b32 s54, 12320768
    s_mov_b32 s55, 0x20000
    s_add_u32 s56, s38, 16777216
    s_addc_u32 s57, s39, 0
    s_mov_b32 s58, 5242880
    s_mov_b32 s59, 0x20000
    s_lshl_b32 s73, s2, 4
    s_add_u32 s73, s73, 4259840
    s_and_b32 s74, s2, 7
    s_or_b32 s74, s74, s64
    s_cselect_b32 s73, 134217728, s73
    buffer_load_dword a255, off, s[56:59], s73
    v_bfe_u32 v5, v233, 3, 2
    v_mul_u32_u24 v5, 5120, v5
    v_lshl_add_u32 v5, v3, 7, v5
    s_lshr_b32 s73, s64, 1
    s_mul_i32 s73, s73, 61440
    v_add_u32 v5, s73, v5
    v_bfe_u32 v6, v233, 1, 3
    v_xor_b32 v6, v6, v7
    v_xor_b32 v8, 0, v6
    v_lshl_add_u32 v216, v8, 4, v5
    v_xor_b32 v8, 2, v6
    v_lshl_add_u32 v217, v8, 4, v5
    v_xor_b32 v8, 4, v6
    v_lshl_add_u32 v218, v8, 4, v5
    v_xor_b32_e64 v8, 6, v6
    v_lshl_add_u32 v219, v8, 4, v5
    s_add_u32 m0, s71, 65536
    s_add_u32 s68, s3, 204800
    buffer_load_dwordx4 v228, s[40:43], s68 offen lds
    s_add_u32 m0, s71, 61440
    s_nop 0
    buffer_load_dwordx4 v224, s[40:43], s68 offen offset:0 lds
    buffer_load_dwordx4 v225, s[40:43], s68 offen offset:1024 lds
    buffer_load_dwordx4 v226, s[40:43], s68 offen offset:2048 lds
    buffer_load_dwordx4 v227, s[40:43], s68 offen offset:3072 lds
    s_lshl_b32 s31, s3, 1
    s_cmp_eq_u32 s77, 5
    s_cselect_b32 s31, 134217728, s31
    s_cmp_ge_u32 s64, 2
    s_cselect_b32 s31, 134217728, s31
    s_and_b32 s75, s64, 1
    s_lshl_b32 s75, s75, 9
    s_add_u32 s75, s75, 122880
    v_bfe_u32 v8, v233, 2, 2
    v_lshlrev_b32 v8, 6, v8
    v_lshl_add_u32 v8, v7, 10, v8
    v_and_b32 v10, 1, v233
    v_lshl_add_u32 v8, v10, 5, v8
    v_bfe_u32 v10, v233, 4, 1
    v_lshl_add_u32 v8, v10, 4, v8
    v_bfe_u32 v10, v233, 1, 1
    v_lshl_add_u32 v8, v10, 3, v8
    v_add_u32 v220, s75, v8
    s_and_b32 s73, s64, 1
    s_lshl_b32 s67, s65, 2
    s_add_u32 s67, s67, s73
    s_lshl_b32 s67, s67, 4
    s_add_u32 s67, s67, s66
    s_lshl_b32 s67, s67, 5
    s_add_u32 s67, s67, 5046272
    s_lshl_b32 s73, s73, 13
    s_lshr_b32 s74, s64, 1
    s_mul_i32 s74, s74, 49152
    s_add_u32 s6, s73, s74
    s_add_u32 s6, s6, 61440
    s_and_b32 s73, s2, 6
    s_lshl_b32 s73, s73, 2
    s_lshr_b32 s74, s2, 5
    s_add_u32 s4, s73, s74
    s_and_b32 s73, s2, 1
    s_lshl_b32 s73, s73, 2
    s_bfe_u32 s5, s2, 0x20003
    s_add_u32 s5, s5, s73
    s_mul_i32 s73, s4, 94
    s_add_u32 s69, s73, s64
    s_lshl_b32 s69, s69, 12
    s_and_b32 s74, s64, 2
    s_add_u32 s74, s74, 54
    s_lshl_b32 s74, s74, 12
    s_add_u32 s99, s69, s74
    s_mul_i32 s70, s5, 481280
    s_mul_i32 s73, s64, 5120
    s_add_u32 s70, s70, s73
    s_cmp_ge_u32 s64, 2
    s_cselect_b32 s7, 134217728, 0
    s_lshl_b32 s29, s64, 10
    s_and_b32 s74, s64, 2
    s_add_u32 s74, s74, 54
    s_mul_i32 s74, s74, 5120
    s_add_u32 s9, s70, s74
    s_bitcmp1_b32 s64, 0
    s_cselect_b32 s92, s20, s18
    s_cselect_b32 s93, s21, s19
    s_mov_b32 s94, 819200
    s_mov_b32 s95, 0x20000
    s_mul_i32 s98, s5, 102400
    s_lshr_b32 s73, s64, 1
    s_lshl_b32 s73, s73, 7
    s_add_u32 s98, s98, s73
    s_mov_b32 s12, 0
    s_add_u32 s13, s12, 256
    s_cmp_eq_u32 s13, 1280
    s_cselect_b32 s13, 0, s13
    s_add_u32 s14, s13, 256
    s_cmp_eq_u32 s14, 1280
    s_cselect_b32 s14, 0, s14
    s_add_u32 s15, s14, 256
    s_cmp_eq_u32 s15, 1280
    s_cselect_b32 s15, 0, s15
    s_add_u32 s30, s15, 256
    s_cmp_eq_u32 s30, 1280
    s_cselect_b32 s30, 0, s30
    s_add_u32 s73, s71, 40960
    v_mul_u32_u24 v14, 1280, v2
    v_lshrrev_b32 v15, 1, v2
    v_xor_b32 v15, v15, v3
    v_lshl_add_u32 v250, v15, 4, v14
    v_xor_b32 v251, 64, v250
    v_add_u32 v251, 9216, v251
    v_bfe_u32 v14, v233, 1, 3
    v_lshrrev_b32 v15, 4, v233
    v_xor_b32 v14, v14, v15
    v_and_b32 v15, 15, v233
    v_lshl_add_u32 v15, v15, 7, s73
    v_lshl_add_u32 v252, v14, 4, v15
    v_xor_b32 v253, 64, v252
    s_add_u32 m0, s71, 86016
    s_add_u32 s3, s3, 128
    s_cmp_eq_u32 s3, 1280
    s_cselect_b32 s3, 0, s3
    s_mul_i32 s26, s3, 1728
    s_add_u32 s68, s3, 204800
    buffer_load_dwordx4 v228, s[40:43], s68 offen lds
    s_add_u32 m0, s71, 81920
    s_nop 0
    buffer_load_dwordx4 v224, s[40:43], s68 offen offset:0 lds
    buffer_load_dwordx4 v225, s[40:43], s68 offen offset:1024 lds
    buffer_load_dwordx4 v226, s[40:43], s68 offen offset:2048 lds
    buffer_load_dwordx4 v227, s[40:43], s68 offen offset:3072 lds
    s_add_u32 m0, s72, 16384
    s_add_u32 s68, s26, 0
    buffer_load_dwordx4 v229, s[44:47], s68 offen offset:0 lds
    buffer_load_dwordx4 v230, s[44:47], s68 offen offset:1024 lds
    buffer_load_dwordx4 v231, s[44:47], s68 offen offset:2048 lds
    s_waitcnt vmcnt(8)
    s_barrier
    ds_read_b64_tr_b16 v[200:201], v220 offset:0
    ds_read_b64_tr_b16 v[202:203], v220 offset:256
    ds_read_b64_tr_b16 v[204:205], v220 offset:8192
    ds_read_b64_tr_b16 v[206:207], v220 offset:8448
    ds_read_b128 v[160:163], v216 offset:0
    ds_read_b128 v[164:167], v216 offset:1024
    ds_read_b128 v[168:171], v216 offset:2048
    ds_read_b128 v[172:175], v216 offset:3072
    ds_read_b128 v[176:179], v216 offset:4096
    s_waitcnt lgkmcnt(0)
    v_mfma_f32_32x32x16_bf16 v[0:15], v[200:203], v[160:163], 0
    ds_read_b64_tr_b16 v[208:209], v220 offset:2048
    ds_read_b64_tr_b16 v[210:211], v220 offset:2304
    v_accvgpr_write_b32 a232, 0
    v_mfma_f32_32x32x16_bf16 v[16:31], v[204:207], v[160:163], 0
    ds_read_b64_tr_b16 v[212:213], v220 offset:10240
    v_accvgpr_write_b32 a233, 0
    v_mfma_f32_32x32x16_bf16 v[32:47], v[200:203], v[164:167], 0
    ds_read_b64_tr_b16 v[214:215], v220 offset:10496
    ds_read_b128 v[180:183], v217 offset:0
    s_add_u32 m0, s71, 40960
    s_add_u32 s68, s98, s12
    s_add_u32 s68, s68, 0
    buffer_load_dwordx4 v250, s[92:95], s68 offen offset:0 lds
    v_mfma_f32_32x32x16_bf16 v[48:63], v[204:207], v[164:167], 0
    ds_read_b128 v[184:187], v217 offset:1024
    buffer_load_dwordx4 v251, s[92:95], s68 offen offset:1024 lds
    v_mfma_f32_32x32x16_bf16 v[64:79], v[200:203], v[168:171], 0
    ds_read_b128 v[188:191], v217 offset:2048
    ds_read_b128 v[192:195], v217 offset:3072
    s_add_u32 m0, s72, 16384
    s_add_u32 s68, s26, 0
    buffer_load_dwordx4 v232, s[44:47], s68 offen offset:3072 lds
    v_mfma_f32_32x32x16_bf16 v[80:95], v[204:207], v[168:171], 0
    ds_read_b128 v[196:199], v217 offset:4096
    s_add_u32 m0, s71, 24576
    s_add_u32 s68, s3, 0
    buffer_load_dwordx4 v228, s[40:43], s68 offen lds
    v_mfma_f32_32x32x16_bf16 v[96:111], v[200:203], v[172:175], 0
    s_add_u32 m0, s71, 20480
    s_nop 0
    buffer_load_dwordx4 v224, s[40:43], s68 offen offset:0 lds
    v_mfma_f32_32x32x16_bf16 v[112:127], v[204:207], v[172:175], 0
    buffer_load_dwordx4 v225, s[40:43], s68 offen offset:1024 lds
    v_mfma_f32_32x32x16_bf16 v[128:143], v[200:203], v[176:179], 0
    buffer_load_dwordx4 v226, s[40:43], s68 offen offset:2048 lds
    v_mfma_f32_32x32x16_bf16 v[144:159], v[204:207], v[176:179], 0
    v_accvgpr_write_b32 a234, 0
    v_accvgpr_write_b32 a235, 0
    s_waitcnt lgkmcnt(0)
    v_mfma_f32_32x32x16_bf16 v[0:15], v[208:211], v[180:183], v[0:15]
    ds_read_b64_tr_b16 v[200:201], v220 offset:4096
    ds_read_b64_tr_b16 v[202:203], v220 offset:4352
    v_mfma_f32_32x32x16_bf16 v[16:31], v[212:215], v[180:183], v[16:31]
    ds_read_b64_tr_b16 v[204:205], v220 offset:12288
    v_mfma_f32_32x32x16_bf16 v[32:47], v[208:211], v[184:187], v[32:47]
    ds_read_b64_tr_b16 v[206:207], v220 offset:12544
    ds_read_b128 v[160:163], v218 offset:0
    v_mfma_f32_32x32x16_bf16 v[48:63], v[212:215], v[184:187], v[48:63]
    ds_read_b128 v[164:167], v218 offset:1024
    s_add_u32 m0, s71, 43008
    s_add_u32 s68, s98, s12
    s_add_u32 s68, s68, 20480
    buffer_load_dwordx4 v250, s[92:95], s68 offen offset:0 lds
    v_mfma_f32_32x32x16_bf16 v[64:79], v[208:211], v[188:191], v[64:79]
    ds_read_b128 v[168:171], v218 offset:2048
    ds_read_b128 v[172:175], v218 offset:3072
    v_mfma_f32_32x32x16_bf16 v[80:95], v[212:215], v[188:191], v[80:95]
    ds_read_b128 v[176:179], v218 offset:4096
    buffer_load_dwordx4 v251, s[92:95], s68 offen offset:1024 lds
    v_mfma_f32_32x32x16_bf16 v[96:111], v[208:211], v[192:195], v[96:111]
    v_mfma_f32_32x32x16_bf16 v[112:127], v[212:215], v[192:195], v[112:127]
    s_add_u32 m0, s71, 20480
    s_add_u32 s68, s3, 0
    buffer_load_dwordx4 v227, s[40:43], s68 offen offset:3072 lds
    v_mfma_f32_32x32x16_bf16 v[128:143], v[208:211], v[196:199], v[128:143]
    v_mfma_f32_32x32x16_bf16 v[144:159], v[212:215], v[196:199], v[144:159]
    s_waitcnt lgkmcnt(0)
    v_mfma_f32_32x32x16_bf16 v[0:15], v[200:203], v[160:163], v[0:15]
    ds_read_b64_tr_b16 v[208:209], v220 offset:6144
    ds_read_b64_tr_b16 v[210:211], v220 offset:6400
    v_mfma_f32_32x32x16_bf16 v[16:31], v[204:207], v[160:163], v[16:31]
    ds_read_b64_tr_b16 v[212:213], v220 offset:14336
    v_mfma_f32_32x32x16_bf16 v[32:47], v[200:203], v[164:167], v[32:47]
    ds_read_b64_tr_b16 v[214:215], v220 offset:14592
    ds_read_b128 v[180:183], v219 offset:0
    v_mfma_f32_32x32x16_bf16 v[48:63], v[204:207], v[164:167], v[48:63]
    ds_read_b128 v[184:187], v219 offset:1024
    v_mfma_f32_32x32x16_bf16 v[64:79], v[200:203], v[168:171], v[64:79]
    ds_read_b128 v[188:191], v219 offset:2048
    ds_read_b128 v[192:195], v219 offset:3072
    s_add_u32 m0, s71, 102400
    s_add_u32 s68, s98, s12
    s_add_u32 s68, s68, 40960
    buffer_load_dwordx4 v250, s[92:95], s68 offen offset:0 lds
    v_mfma_f32_32x32x16_bf16 v[80:95], v[204:207], v[168:171], v[80:95]
    ds_read_b128 v[196:199], v219 offset:4096
    v_mfma_f32_32x32x16_bf16 v[96:111], v[200:203], v[172:175], v[96:111]
    v_mfma_f32_32x32x16_bf16 v[112:127], v[204:207], v[172:175], v[112:127]
    s_waitcnt vmcnt(9)
    ds_read_b128 a[0:3], v252 offset:0
    buffer_load_dwordx4 v251, s[92:95], s68 offen offset:1024 lds
    v_mfma_f32_32x32x16_bf16 v[128:143], v[200:203], v[176:179], v[128:143]
    ds_read_b128 a[20:23], v253 offset:0
    v_mfma_f32_32x32x16_bf16 v[144:159], v[204:207], v[176:179], v[144:159]
    s_waitcnt lgkmcnt(2)
    v_mfma_f32_32x32x16_bf16 v[0:15], v[208:211], v[180:183], v[0:15]
    s_waitcnt vmcnt(2)
    s_barrier
    ds_read_b64_tr_b16 v[200:201], v220 offset:16384
    ds_read_b64_tr_b16 v[202:203], v220 offset:16640
    v_mfma_f32_32x32x16_bf16 v[16:31], v[212:215], v[180:183], v[16:31]
    ds_read_b64_tr_b16 v[204:205], v220 offset:24576
    s_and_b32 s74, s67, 0x7f
    s_cselect_b32 s74, 134217728, s67
    v_mfma_f32_32x32x16_bf16 v[32:47], v[208:211], v[184:187], v[32:47]
    ds_read_b64_tr_b16 v[206:207], v220 offset:24832
    ds_read_b128 v[160:163], v216 offset:20480
    s_add_u32 m0, s71, 104448
    s_add_u32 s68, s98, s12
    s_add_u32 s68, s68, 61440
    buffer_load_dwordx4 v250, s[92:95], s68 offen offset:0 lds
    v_mfma_f32_32x32x16_bf16 v[48:63], v[212:215], v[184:187], v[48:63]
    ds_read_b128 v[164:167], v216 offset:21504
    buffer_load_dwordx4 v251, s[92:95], s68 offen offset:1024 lds
    v_mfma_f32_32x32x16_bf16 v[64:79], v[208:211], v[188:191], v[64:79]
    ds_read_b128 v[168:171], v216 offset:22528
    ds_read_b128 v[172:175], v216 offset:23552
    s_add_u32 m0, s71, 65536
    s_add_u32 s3, s3, 128
    s_cmp_eq_u32 s3, 1280
    s_cselect_b32 s3, 0, s3
    s_mul_i32 s26, s3, 1728
    s_add_u32 s68, s3, 204800
    buffer_load_dwordx4 v228, s[40:43], s68 offen lds
    v_mfma_f32_32x32x16_bf16 v[80:95], v[212:215], v[188:191], v[80:95]
    ds_read_b128 v[176:179], v216 offset:24576
    s_add_u32 m0, s71, 61440
    s_nop 0
    buffer_load_dwordx4 v224, s[40:43], s68 offen offset:0 lds
    v_mfma_f32_32x32x16_bf16 v[96:111], v[208:211], v[192:195], v[96:111]
    buffer_load_dwordx4 v225, s[40:43], s68 offen offset:1024 lds
    v_mfma_f32_32x32x16_bf16 v[112:127], v[212:215], v[192:195], v[112:127]
    ds_read_b128 a[4:7], v252 offset:2048
    buffer_load_dwordx4 v226, s[40:43], s68 offen offset:2048 lds
    v_mfma_f32_32x32x16_bf16 v[128:143], v[208:211], v[196:199], v[128:143]
    ds_read_b128 a[24:27], v253 offset:2048
    buffer_load_dwordx4 v227, s[40:43], s68 offen offset:3072 lds
    v_mfma_f32_32x32x16_bf16 v[144:159], v[212:215], v[196:199], v[144:159]
    s_mov_b64 exec, 0xff
    buffer_store_dwordx4 a[232:235], v238, s[56:59], s74 offen sc1
    s_mov_b64 exec, -1
    s_waitcnt lgkmcnt(2)
    v_mfma_f32_32x32x16_bf16 v[0:15], v[200:203], v[160:163], v[0:15]
    ds_read_b64_tr_b16 v[208:209], v220 offset:18432
    ds_read_b64_tr_b16 v[210:211], v220 offset:18688
    v_mfma_f32_32x32x16_bf16 v[16:31], v[204:207], v[160:163], v[16:31]
    ds_read_b64_tr_b16 v[212:213], v220 offset:26624
    v_mfma_f32_32x32x16_bf16 v[32:47], v[200:203], v[164:167], v[32:47]
    ds_read_b64_tr_b16 v[214:215], v220 offset:26880
    ds_read_b128 v[180:183], v217 offset:20480
    s_add_u32 m0, s71, 40960
    s_add_u32 s68, s98, s12
    s_add_u32 s68, s68, 81920
    buffer_load_dwordx4 v250, s[92:95], s68 offen offset:0 lds
    v_mfma_f32_32x32x16_bf16 v[48:63], v[204:207], v[164:167], v[48:63]
    ds_read_b128 v[184:187], v217 offset:21504
    buffer_load_dwordx4 v251, s[92:95], s68 offen offset:1024 lds
    v_mfma_f32_32x32x16_bf16 v[64:79], v[200:203], v[168:171], v[64:79]
    ds_read_b128 v[188:191], v217 offset:22528
    ds_read_b128 v[192:195], v217 offset:23552
    s_add_u32 m0, s72, 0
    s_add_u32 s68, s26, 0
    buffer_load_dwordx4 v229, s[44:47], s68 offen offset:0 lds
    v_mfma_f32_32x32x16_bf16 v[80:95], v[204:207], v[168:171], v[80:95]
    ds_read_b128 v[196:199], v217 offset:24576
    v_mfma_f32_32x32x16_bf16 v[96:111], v[200:203], v[172:175], v[96:111]
    buffer_load_dwordx4 v230, s[44:47], s68 offen offset:1024 lds
    v_mfma_f32_32x32x16_bf16 v[112:127], v[204:207], v[172:175], v[112:127]
    s_waitcnt vmcnt(12)
    ds_read_b128 a[8:11], v252 offset:61440
    buffer_load_dwordx4 v231, s[44:47], s68 offen offset:2048 lds
    v_mfma_f32_32x32x16_bf16 v[128:143], v[200:203], v[176:179], v[128:143]
    ds_read_b128 a[28:31], v253 offset:61440
    buffer_load_dwordx4 v232, s[44:47], s68 offen offset:3072 lds
    v_mfma_f32_32x32x16_bf16 v[144:159], v[204:207], v[176:179], v[144:159]
    s_waitcnt lgkmcnt(2)
    v_mfma_f32_32x32x16_bf16 v[0:15], v[208:211], v[180:183], v[0:15]
    ds_read_b64_tr_b16 v[200:201], v220 offset:20480
    ds_read_b64_tr_b16 v[202:203], v220 offset:20736
    v_mfma_f32_32x32x16_bf16 v[16:31], v[212:215], v[180:183], v[16:31]
    ds_read_b64_tr_b16 v[204:205], v220 offset:28672
    s_add_u32 m0, s71, 4096
    s_add_u32 s68, s3, 0
    buffer_load_dwordx4 v228, s[40:43], s68 offen lds
    v_mfma_f32_32x32x16_bf16 v[32:47], v[208:211], v[184:187], v[32:47]
    ds_read_b64_tr_b16 v[206:207], v220 offset:28928
    ds_read_b128 v[160:163], v218 offset:20480
    v_mfma_f32_32x32x16_bf16 v[48:63], v[212:215], v[184:187], v[48:63]
    ds_read_b128 v[164:167], v218 offset:21504
    s_add_u32 m0, s71, 0
    s_nop 0
    buffer_load_dwordx4 v224, s[40:43], s68 offen offset:0 lds
    v_mfma_f32_32x32x16_bf16 v[64:79], v[208:211], v[188:191], v[64:79]
    ds_read_b128 v[168:171], v218 offset:22528
    ds_read_b128 v[172:175], v218 offset:23552
    v_mfma_f32_32x32x16_bf16 v[80:95], v[212:215], v[188:191], v[80:95]
    ds_read_b128 v[176:179], v218 offset:24576
    buffer_load_dwordx4 v225, s[40:43], s68 offen offset:1024 lds
    v_mfma_f32_32x32x16_bf16 v[96:111], v[208:211], v[192:195], v[96:111]
    buffer_load_dword v243, off, s[60:63], 0 sc1
    v_mfma_f32_32x32x16_bf16 v[112:127], v[212:215], v[192:195], v[112:127]
    s_waitcnt vmcnt(16)
    ds_read_b128 a[12:15], v252 offset:63488
    ds_read_b128 a[32:35], v253 offset:63488
    buffer_load_dwordx4 v226, s[40:43], s68 offen offset:2048 lds
    v_mfma_f32_32x32x16_bf16 v[128:143], v[208:211], v[196:199], v[128:143]
    s_waitcnt vmcnt(9)
    ds_read_b128 a[16:19], v252 offset:0
    ds_read_b128 a[36:39], v253 offset:0
    v_mfma_f32_32x32x16_bf16 v[144:159], v[212:215], v[196:199], v[144:159]
    s_waitcnt lgkmcnt(4)
    v_mfma_f32_32x32x16_bf16 v[0:15], v[200:203], v[160:163], v[0:15]
    ds_read_b64_tr_b16 v[208:209], v220 offset:22528
    ds_read_b64_tr_b16 v[210:211], v220 offset:22784
    v_mfma_f32_32x32x16_bf16 v[16:31], v[204:207], v[160:163], v[16:31]
    ds_read_b64_tr_b16 v[212:213], v220 offset:30720
    buffer_load_dwordx4 v227, s[40:43], s68 offen offset:3072 lds
    v_mfma_f32_32x32x16_bf16 v[32:47], v[200:203], v[164:167], v[32:47]
    ds_read_b64_tr_b16 v[214:215], v220 offset:30976
    ds_read_b128 v[180:183], v219 offset:20480
    v_mfma_f32_32x32x16_bf16 v[48:63], v[204:207], v[164:167], v[48:63]
    ds_read_b128 v[184:187], v219 offset:21504
    v_mfma_f32_32x32x16_bf16 v[64:79], v[200:203], v[168:171], v[64:79]
    ds_read_b128 v[188:191], v219 offset:22528
    ds_read_b128 v[192:195], v219 offset:23552
    v_mfma_f32_32x32x16_bf16 v[80:95], v[204:207], v[168:171], v[80:95]
    ds_read_b128 v[196:199], v219 offset:24576
    v_mfma_f32_32x32x16_bf16 v[96:111], v[200:203], v[172:175], v[96:111]
    v_mfma_f32_32x32x16_bf16 v[112:127], v[204:207], v[172:175], v[112:127]
    v_mfma_f32_32x32x16_bf16 v[128:143], v[200:203], v[176:179], v[128:143]
    v_mfma_f32_32x32x16_bf16 v[144:159], v[204:207], v[176:179], v[144:159]
    s_waitcnt lgkmcnt(0)
    v_mfma_f32_32x32x16_bf16 v[0:15], v[208:211], v[180:183], v[0:15]
    s_waitcnt vmcnt(0)
    s_barrier
    ds_read_b64_tr_b16 v[200:201], v220 offset:0
    ds_read_b64_tr_b16 v[202:203], v220 offset:256
    v_mfma_f32_32x32x16_bf16 v[16:31], v[212:215], v[180:183], v[16:31]
    ds_read_b64_tr_b16 v[204:205], v220 offset:8192
    s_add_u32 m0, s71, 86016
    s_add_u32 s3, s3, 128
    s_cmp_eq_u32 s3, 1280
    s_cselect_b32 s3, 0, s3
    s_mul_i32 s26, s3, 1728
    s_add_u32 s68, s3, 204800
    buffer_load_dwordx4 v228, s[40:43], s68 offen lds
    v_mfma_f32_32x32x16_bf16 v[32:47], v[208:211], v[184:187], v[32:47]
    ds_read_b64_tr_b16 v[206:207], v220 offset:8448
    ds_read_b128 v[160:163], v216 offset:0
    s_add_u32 m0, s71, 81920
    s_nop 0
    buffer_load_dwordx4 v224, s[40:43], s68 offen offset:0 lds
    v_mfma_f32_32x32x16_bf16 v[48:63], v[212:215], v[184:187], v[48:63]
    ds_read_b128 v[164:167], v216 offset:1024
    v_mfma_f32_32x32x16_bf16 v[64:79], v[208:211], v[188:191], v[64:79]
    ds_read_b128 v[168:171], v216 offset:2048
    ds_read_b128 v[172:175], v216 offset:3072
    buffer_load_dwordx4 v225, s[40:43], s68 offen offset:1024 lds
    v_mfma_f32_32x32x16_bf16 v[80:95], v[212:215], v[188:191], v[80:95]
    ds_read_b128 v[176:179], v216 offset:4096
    v_mfma_f32_32x32x16_bf16 v[96:111], v[208:211], v[192:195], v[96:111]
    buffer_load_dwordx4 v226, s[40:43], s68 offen offset:2048 lds
    v_mfma_f32_32x32x16_bf16 v[112:127], v[212:215], v[192:195], v[112:127]
    v_mfma_f32_32x32x16_bf16 v[128:143], v[208:211], v[196:199], v[128:143]
    buffer_load_dwordx4 v227, s[40:43], s68 offen offset:3072 lds
    v_mfma_f32_32x32x16_bf16 v[144:159], v[212:215], v[196:199], v[144:159]
    s_waitcnt lgkmcnt(0)
    v_mfma_f32_32x32x16_bf16 v[0:15], v[200:203], v[160:163], v[0:15]
    ds_read_b64_tr_b16 v[208:209], v220 offset:2048
    ds_read_b64_tr_b16 v[210:211], v220 offset:2304
    v_lshlrev_b32 v234, 16, v200
    v_and_b32 v237, 0xffff0000, v200
    v_add_f32 v234, v234, v237
    v_mfma_f32_32x32x16_bf16 v[16:31], v[204:207], v[160:163], v[16:31]
    ds_read_b64_tr_b16 v[212:213], v220 offset:10240
    s_add_u32 m0, s72, 16384
    s_add_u32 s68, s26, 0
    buffer_load_dwordx4 v229, s[44:47], s68 offen offset:0 lds
    v_lshlrev_b32 v235, 16, v204
    v_and_b32 v237, 0xffff0000, v204
    v_mfma_f32_32x32x16_bf16 v[32:47], v[200:203], v[164:167], v[32:47]
    ds_read_b64_tr_b16 v[214:215], v220 offset:10496
    ds_read_b128 v[180:183], v217 offset:0
    v_add_f32 v235, v235, v237
    v_lshlrev_b32 v236, 16, v201
    v_mfma_f32_32x32x16_bf16 v[48:63], v[204:207], v[164:167], v[48:63]
    ds_read_b128 v[184:187], v217 offset:1024
    buffer_load_dwordx4 v230, s[44:47], s68 offen offset:1024 lds
    v_and_b32 v237, 0xffff0000, v201
    v_add_f32 v234, v234, v236
    v_mfma_f32_32x32x16_bf16 v[64:79], v[200:203], v[168:171], v[64:79]
    ds_read_b128 v[188:191], v217 offset:2048
    ds_read_b128 v[192:195], v217 offset:3072
    v_add_f32 v234, v234, v237
    v_lshlrev_b32 v236, 16, v205
    v_and_b32 v237, 0xffff0000, v205
    v_mfma_f32_32x32x16_bf16 v[80:95], v[204:207], v[168:171], v[80:95]
    ds_read_b128 v[196:199], v217 offset:4096
    buffer_load_dwordx4 v231, s[44:47], s68 offen offset:2048 lds
    v_add_f32 v235, v235, v236
    v_add_f32 v235, v235, v237
    v_mfma_f32_32x32x16_bf16 v[96:111], v[200:203], v[172:175], v[96:111]
    v_lshlrev_b32 v236, 16, v202
    v_and_b32 v237, 0xffff0000, v202
    v_add_f32 v234, v234, v236
    v_add_f32 v234, v234, v237
    v_lshlrev_b32 v236, 16, v206
    v_mfma_f32_32x32x16_bf16 v[112:127], v[204:207], v[172:175], v[112:127]
    buffer_load_dwordx4 v232, s[44:47], s68 offen offset:3072 lds
    v_and_b32 v237, 0xffff0000, v206
    v_add_f32 v235, v235, v236
    v_mfma_f32_32x32x16_bf16 v[128:143], v[200:203], v[176:179], v[128:143]
    v_add_f32 v235, v235, v237
    v_lshlrev_b32 v236, 16, v203
    v_and_b32 v237, 0xffff0000, v203
    v_add_f32 v234, v234, v236
    v_add_f32 v234, v234, v237
    v_mfma_f32_32x32x16_bf16 v[144:159], v[204:207], v[176:179], v[144:159]
    v_cmp_eq_u32 vcc, 0, v243
    s_cbranch_vccnz L_slow_non_gld
L_go_non_gld:
    v_readfirstlane_b32 s83, v243
    v_lshlrev_b32 v236, 16, v207
    v_and_b32 v237, 0xffff0000, v207
    v_add_f32 v235, v235, v236
    v_add_f32 v235, v235, v237
    s_waitcnt lgkmcnt(0)
    v_mfma_f32_32x32x16_bf16 v[0:15], v[208:211], v[180:183], v[0:15]
    ds_read_b64_tr_b16 v[200:201], v220 offset:4096
    ds_read_b64_tr_b16 v[202:203], v220 offset:4352
    v_lshlrev_b32 v236, 16, v208
    v_and_b32 v237, 0xffff0000, v208
    v_add_f32 v234, v234, v236
    v_mfma_f32_32x32x16_bf16 v[16:31], v[212:215], v[180:183], v[16:31]
    ds_read_b64_tr_b16 v[204:205], v220 offset:12288
    s_add_u32 m0, s71, 24576
    s_add_u32 s68, s3, 0
    buffer_load_dwordx4 v228, s[40:43], s68 offen lds
    v_add_f32 v234, v234, v237
    v_lshlrev_b32 v236, 16, v212
    v_and_b32 v237, 0xffff0000, v212
    v_mfma_f32_32x32x16_bf16 v[32:47], v[208:211], v[184:187], v[32:47]
    ds_read_b64_tr_b16 v[206:207], v220 offset:12544
    ds_read_b128 v[160:163], v218 offset:0
    v_add_f32 v235, v235, v236
    v_add_f32 v235, v235, v237
    v_lshlrev_b32 v236, 16, v209
    v_and_b32 v237, 0xffff0000, v209
    v_mfma_f32_32x32x16_bf16 v[48:63], v[212:215], v[184:187], v[48:63]
    ds_read_b128 v[164:167], v218 offset:1024
    s_add_u32 m0, s71, 20480
    s_nop 0
    buffer_load_dwordx4 v224, s[40:43], s68 offen offset:0 lds
    v_add_f32 v234, v234, v236
    v_add_f32 v234, v234, v237
    v_lshlrev_b32 v236, 16, v213
    v_mfma_f32_32x32x16_bf16 v[64:79], v[208:211], v[188:191], v[64:79]
    ds_read_b128 v[168:171], v218 offset:2048
    ds_read_b128 v[172:175], v218 offset:3072
    s_barrier
    v_and_b32 v237, 0xffff0000, v213
    v_add_f32 v235, v235, v236
    v_add_f32 v235, v235, v237
    v_mfma_f32_32x32x16_bf16 v[80:95], v[212:215], v[188:191], v[80:95]
    ds_read_b128 v[176:179], v218 offset:4096
    buffer_load_dwordx4 v225, s[40:43], s68 offen offset:1024 lds
    v_lshlrev_b32 v236, 16, v210
    v_and_b32 v237, 0xffff0000, v210
    v_mfma_f32_32x32x16_bf16 v[96:111], v[208:211], v[192:195], v[96:111]
    s_lshl_b32 s73, s2, 4
    s_add_u32 s73, s73, 4259840
    v_add_f32 v234, v234, v236
    v_add_f32 v234, v234, v237
    v_lshlrev_b32 v236, 16, v214
    v_and_b32 v237, 0xffff0000, v214
    v_mfma_f32_32x32x16_bf16 v[112:127], v[212:215], v[192:195], v[112:127]
    buffer_load_dwordx4 v226, s[40:43], s68 offen offset:2048 lds
    v_add_f32 v235, v235, v236
    v_add_f32 v235, v235, v237
    v_lshlrev_b32 v236, 16, v211
    v_and_b32 v237, 0xffff0000, v211
    v_mfma_f32_32x32x16_bf16 v[128:143], v[208:211], v[196:199], v[128:143]
    s_cmp_eq_u32 s64, 0
    s_cselect_b32 s73, s73, 134217728
    v_mov_b32 v241, s83
    v_add_f32 v234, v234, v236
    v_add_f32 v234, v234, v237
    v_lshlrev_b32 v236, 16, v215
    v_mfma_f32_32x32x16_bf16 v[144:159], v[212:215], v[196:199], v[144:159]
    s_mov_b64 exec, 1
    buffer_store_dword v241, off, s[56:59], s73 sc1
    s_mov_b64 exec, -1
    v_and_b32 v237, 0xffff0000, v215
    v_add_f32 v235, v235, v236
    v_add_f32 v235, v235, v237
    s_waitcnt lgkmcnt(0)
    v_mfma_f32_32x32x16_bf16 v[0:15], v[200:203], v[160:163], v[0:15]
    ds_read_b64_tr_b16 v[208:209], v220 offset:6144
    ds_read_b64_tr_b16 v[210:211], v220 offset:6400
    v_lshlrev_b32 v236, 16, v200
    v_and_b32 v237, 0xffff0000, v200
    v_add_f32 v234, v234, v236
    v_mfma_f32_32x32x16_bf16 v[16:31], v[204:207], v[160:163], v[16:31]
    ds_read_b64_tr_b16 v[212:213], v220 offset:14336
    buffer_load_dwordx4 v227, s[40:43], s68 offen offset:3072 lds
    v_add_f32 v234, v234, v237
    v_lshlrev_b32 v236, 16, v204
    v_mfma_f32_32x32x16_bf16 v[32:47], v[200:203], v[164:167], v[32:47]
    ds_read_b64_tr_b16 v[214:215], v220 offset:14592
    ds_read_b128 v[180:183], v219 offset:0
    v_and_b32 v237, 0xffff0000, v204
    v_add_f32 v235, v235, v236
    v_add_f32_e64 v235, v235, v237
    v_mfma_f32_32x32x16_bf16 v[48:63], v[204:207], v[164:167], v[48:63]
    ds_read_b128 v[184:187], v219 offset:1024
    s_add_u32 m0, s71, 106496
    s_add_u32 s3, s3, 128
    s_cmp_eq_u32 s3, 1280
    s_cselect_b32 s3, 0, s3
    s_mul_i32 s26, s3, 1728
    s_add_u32 s68, s3, 204800
    buffer_load_dwordx4 v228, s[40:43], s68 offen lds
    v_lshlrev_b32 v236, 16, v201
    v_and_b32 v237, 0xffff0000, v201
    v_mfma_f32_32x32x16_bf16 v[64:79], v[200:203], v[168:171], v[64:79]
    ds_read_b128 v[188:191], v219 offset:2048
    ds_read_b128 v[192:195], v219 offset:3072
    v_add_f32 v234, v234, v236
    v_add_f32 v234, v234, v237
    v_lshlrev_b32 v236, 16, v205
    v_mfma_f32_32x32x16_bf16 v[80:95], v[204:207], v[168:171], v[80:95]
    ds_read_b128 v[196:199], v219 offset:4096
    s_add_u32 m0, s71, 102400
    s_nop 0
    buffer_load_dwordx4 v224, s[40:43], s68 offen offset:0 lds
    v_and_b32 v237, 0xffff0000, v205
    v_mfma_f32_32x32x16_bf16 v[96:111], v[200:203], v[172:175], v[96:111]
    v_add_f32 v235, v235, v236
    v_add_f32 v235, v235, v237
    v_lshlrev_b32 v236, 16, v202
    v_and_b32 v237, 0xffff0000, v202
    v_add_f32 v234, v234, v236
    v_mfma_f32_32x32x16_bf16 v[112:127], v[204:207], v[172:175], v[112:127]
    buffer_load_dwordx4 v225, s[40:43], s68 offen offset:1024 lds
    v_add_f32 v234, v234, v237
    v_lshlrev_b32 v236, 16, v206
    v_and_b32 v237, 0xffff0000, v206
    v_mfma_f32_32x32x16_bf16 v[128:143], v[200:203], v[176:179], v[128:143]
    v_add_f32 v235, v235, v236
    v_add_f32 v235, v235, v237
    v_lshlrev_b32 v236, 16, v203
    v_and_b32 v237, 0xffff0000, v203
    v_add_f32 v234, v234, v236
    v_mfma_f32_32x32x16_bf16 v[144:159], v[204:207], v[176:179], v[144:159]
    v_add_f32 v234, v234, v237
    v_lshlrev_b32 v236, 16, v207
    v_and_b32 v237, 0xffff0000, v207
    v_add_f32 v235, v235, v236
    v_add_f32 v235, v235, v237
    s_waitcnt lgkmcnt(0)
    v_mfma_f32_32x32x16_bf16 v[0:15], v[208:211], v[180:183], v[0:15]
    s_waitcnt vmcnt(3)
    s_barrier
    ds_read_b64_tr_b16 v[200:201], v220 offset:16384
    ds_read_b64_tr_b16 v[202:203], v220 offset:16640
    v_lshlrev_b32 v236, 16, v208
    v_and_b32 v237, 0xffff0000, v208
    v_mfma_f32_32x32x16_bf16 v[16:31], v[212:215], v[180:183], v[16:31]
    ds_read_b64_tr_b16 v[204:205], v220 offset:24576
    buffer_load_dwordx4 v226, s[40:43], s68 offen offset:2048 lds
    v_add_f32 v234, v234, v236
    v_add_f32 v234, v234, v237
    v_mfma_f32_32x32x16_bf16 v[32:47], v[208:211], v[184:187], v[32:47]
    ds_read_b64_tr_b16 v[206:207], v220 offset:24832
    ds_read_b128 v[160:163], v216 offset:20480
    v_lshlrev_b32 v236, 16, v212
    v_and_b32 v237, 0xffff0000, v212
    v_add_f32 v235, v235, v236
    v_mfma_f32_32x32x16_bf16 v[48:63], v[212:215], v[184:187], v[48:63]
    ds_read_b128 v[164:167], v216 offset:21504
    buffer_load_dwordx4 v227, s[40:43], s68 offen offset:3072 lds
    v_add_f32 v235, v235, v237
    v_lshlrev_b32 v236, 16, v209
    v_mfma_f32_32x32x16_bf16 v[64:79], v[208:211], v[188:191], v[64:79]
    ds_read_b128 v[168:171], v216 offset:22528
    ds_read_b128 v[172:175], v216 offset:23552
    v_and_b32 v237, 0xffff0000, v209
    v_add_f32 v234, v234, v236
    v_add_f32 v234, v234, v237
    v_mfma_f32_32x32x16_bf16 v[80:95], v[212:215], v[188:191], v[80:95]
    ds_read_b128 v[176:179], v216 offset:24576
    s_add_u32 m0, s72, 0
    s_add_u32 s68, s26, 0
    buffer_load_dwordx4 v229, s[44:47], s68 offen offset:0 lds
    v_lshlrev_b32 v236, 16, v213
    v_and_b32 v237, 0xffff0000, v213
    v_mfma_f32_32x32x16_bf16 v[96:111], v[208:211], v[192:195], v[96:111]
    v_add_f32 v235, v235, v236
    v_add_f32 v235, v235, v237
    v_lshlrev_b32 v236, 16, v210
    v_and_b32 v237, 0xffff0000, v210
    v_add_f32 v234, v234, v236
    v_mfma_f32_32x32x16_bf16 v[112:127], v[212:215], v[192:195], v[112:127]
    buffer_load_dwordx4 v230, s[44:47], s68 offen offset:1024 lds
    v_add_f32 v234, v234, v237
    v_lshlrev_b32 v236, 16, v214
    v_and_b32 v237, 0xffff0000, v214
    v_mfma_f32_32x32x16_bf16 v[128:143], v[208:211], v[196:199], v[128:143]
    v_add_f32 v235, v235, v236
    v_add_f32 v235, v235, v237
    v_lshlrev_b32 v236, 16, v211
    v_and_b32 v237, 0xffff0000, v211
    v_add_f32 v234, v234, v236
    v_mfma_f32_32x32x16_bf16 v[144:159], v[212:215], v[196:199], v[144:159]
    v_add_f32 v234, v234, v237
    v_lshlrev_b32 v236, 16, v215
    v_and_b32 v237, 0xffff0000, v215
    v_add_f32 v235, v235, v236
    v_add_f32 v235, v235, v237
    s_waitcnt lgkmcnt(0)
    v_mfma_f32_32x32x16_bf16 v[0:15], v[200:203], v[160:163], v[0:15]
    ds_read_b64_tr_b16 v[208:209], v220 offset:18432
    ds_read_b64_tr_b16 v[210:211], v220 offset:18688
    v_lshlrev_b32 v236, 16, v200
    v_and_b32 v237, 0xffff0000, v200
    v_add_f32 v234, v234, v236
    v_mfma_f32_32x32x16_bf16 v[16:31], v[204:207], v[160:163], v[16:31]
    ds_read_b64_tr_b16 v[212:213], v220 offset:26624
    buffer_load_dwordx4 v231, s[44:47], s68 offen offset:2048 lds
    v_add_f32 v234, v234, v237
    v_mfma_f32_32x32x16_bf16 v[32:47], v[200:203], v[164:167], v[32:47]
    ds_read_b64_tr_b16 v[214:215], v220 offset:26880
    ds_read_b128 v[180:183], v217 offset:20480
    v_lshlrev_b32 v236, 16, v204
    v_and_b32 v237, 0xffff0000, v204
    v_add_f32 v235, v235, v236
    v_mfma_f32_32x32x16_bf16 v[48:63], v[204:207], v[164:167], v[48:63]
    ds_read_b128 v[184:187], v217 offset:21504
    v_add_f32 v235, v235, v237
    v_lshlrev_b32 v236, 16, v201
    v_and_b32 v237, 0xffff0000, v201
    v_add_f32 v234, v234, v236
    v_mfma_f32_32x32x16_bf16 v[64:79], v[200:203], v[168:171], v[64:79]
    ds_read_b128 v[188:191], v217 offset:22528
    ds_read_b128 v[192:195], v217 offset:23552
    buffer_load_dwordx4 v232, s[44:47], s68 offen offset:3072 lds
    v_add_f32 v234, v234, v237
    v_mfma_f32_32x32x16_bf16 v[80:95], v[204:207], v[168:171], v[80:95]
    ds_read_b128 v[196:199], v217 offset:24576
    v_lshlrev_b32 v236, 16, v205
    v_and_b32 v237, 0xffff0000, v205
    v_add_f32 v235, v235, v236
    v_mfma_f32_32x32x16_bf16 v[96:111], v[200:203], v[172:175], v[96:111]
    v_add_f32 v235, v235, v237
    v_lshlrev_b32 v236, 16, v202
    v_and_b32 v237, 0xffff0000, v202
    v_add_f32 v234, v234, v236
    v_add_f32 v234, v234, v237
    v_mfma_f32_32x32x16_bf16 v[112:127], v[204:207], v[172:175], v[112:127]
    s_add_u32 m0, s71, 45056
    s_add_u32 s68, s3, 0
    buffer_load_dwordx4 v228, s[40:43], s68 offen lds
    v_lshlrev_b32 v236, 16, v206
    v_and_b32 v237, 0xffff0000, v206
    v_add_f32 v235, v235, v236
    v_mfma_f32_32x32x16_bf16 v[128:143], v[200:203], v[176:179], v[128:143]
    v_add_f32 v235, v235, v237
    v_lshlrev_b32 v236, 16, v203
    v_and_b32 v237, 0xffff0000, v203
    v_add_f32 v234, v234, v236
    v_mfma_f32_32x32x16_bf16 v[144:159], v[204:207], v[176:179], v[144:159]
    v_add_f32 v234, v234, v237
    v_lshlrev_b32 v236, 16, v207
    v_and_b32 v237, 0xffff0000, v207
    v_add_f32 v235, v235, v236
    v_add_f32 v235, v235, v237
    s_waitcnt lgkmcnt(0)
    v_mfma_f32_32x32x16_bf16 v[0:15], v[208:211], v[180:183], v[0:15]
    ds_read_b64_tr_b16 v[200:201], v220 offset:20480
    ds_read_b64_tr_b16 v[202:203], v220 offset:20736
    s_lshr_b32 s73, s2, 3
    v_lshlrev_b32 v236, 16, v208
    v_and_b32 v237, 0xffff0000, v208
    v_add_f32 v234, v234, v236
    v_mfma_f32_32x32x16_bf16 v[16:31], v[212:215], v[180:183], v[16:31]
    ds_read_b64_tr_b16 v[204:205], v220 offset:28672
    s_add_u32 m0, s71, 40960
    s_nop 0
    buffer_load_dwordx4 v224, s[40:43], s68 offen offset:0 lds
    v_add_f32 v234, v234, v237
    v_lshlrev_b32 v236, 16, v212
    v_and_b32 v237, 0xffff0000, v212
    v_mfma_f32_32x32x16_bf16 v[32:47], v[208:211], v[184:187], v[32:47]
    ds_read_b64_tr_b16 v[206:207], v220 offset:28928
    ds_read_b128 v[160:163], v218 offset:20480
    v_add_f32 v235, v235, v236
    v_add_f32 v235, v235, v237
    v_lshlrev_b32 v236, 16, v209
    v_mfma_f32_32x32x16_bf16 v[48:63], v[212:215], v[184:187], v[48:63]
    ds_read_b128 v[164:167], v218 offset:21504
    buffer_load_dwordx4 v225, s[40:43], s68 offen offset:1024 lds
    v_and_b32 v237, 0xffff0000, v209
    v_add_f32 v234, v234, v236
    v_add_f32 v234, v234, v237
    v_mfma_f32_32x32x16_bf16 v[64:79], v[208:211], v[188:191], v[64:79]
    ds_read_b128 v[168:171], v218 offset:22528
    ds_read_b128 v[172:175], v218 offset:23552
    v_lshlrev_b32 v236, 16, v213
    v_and_b32 v237, 0xffff0000, v213
    v_add_f32 v235, v235, v236
    v_add_f32 v235, v235, v237
    v_mfma_f32_32x32x16_bf16 v[80:95], v[212:215], v[188:191], v[80:95]
    ds_read_b128 v[176:179], v218 offset:24576
    buffer_load_dwordx4 v226, s[40:43], s68 offen offset:2048 lds
    v_lshlrev_b32 v236, 16, v210
    v_and_b32 v237, 0xffff0000, v210
    v_add_f32 v234, v234, v236
    v_mfma_f32_32x32x16_bf16 v[96:111], v[208:211], v[192:195], v[96:111]
    s_mul_i32 s73, s73, 3072
    s_cmp_eq_u32 s64, 0
    s_cselect_b32 s73, s73, 134217728
    v_add_f32 v234, v234, v237
    v_lshlrev_b32 v236, 16, v214
    v_and_b32 v237, 0xffff0000, v214
    v_mfma_f32_32x32x16_bf16 v[112:127], v[212:215], v[192:195], v[112:127]
    buffer_load_dwordx4 v227, s[40:43], s68 offen offset:3072 lds
    v_add_f32 v235, v235, v236
    v_add_f32 v235, v235, v237
    v_lshlrev_b32 v236, 16, v211
    v_mfma_f32_32x32x16_bf16 v[128:143], v[208:211], v[196:199], v[128:143]
    v_lshl_add_u32 v243, v233, 7, s73
    v_and_b32 v237, 0xffff0000, v211
    v_add_f32 v234, v234, v236
    v_add_f32 v234, v234, v237
    v_lshlrev_b32 v236, 16, v215
    v_and_b32 v237, 0xffff0000, v215
    v_mfma_f32_32x32x16_bf16 v[144:159], v[212:215], v[196:199], v[144:159]
    s_mov_b32 exec_lo, 16777215
    s_mov_b32 exec_hi, 0
    buffer_load_dword a255, v243, s[84:87], 0 offen
    s_mov_b64 exec, -1
    v_add_f32 v235, v235, v236
    v_add_f32 v235, v235, v237
    s_waitcnt lgkmcnt(0)
    v_mfma_f32_32x32x16_bf16 v[0:15], v[200:203], v[160:163], v[0:15]
    ds_read_b64_tr_b16 v[208:209], v220 offset:22528
    ds_read_b64_tr_b16 v[210:211], v220 offset:22784
    v_lshlrev_b32 v236, 16, v200
    v_and_b32 v237, 0xffff0000, v200
    v_add_f32 v234, v234, v236
    v_mfma_f32_32x32x16_bf16 v[16:31], v[204:207], v[160:163], v[16:31]
    ds_read_b64_tr_b16 v[212:213], v220 offset:30720
    s_add_u32 m0, s71, 65536
    s_add_u32 s3, s3, 128
    s_cmp_eq_u32 s3, 1280
    s_cselect_b32 s3, 0, s3
    s_mul_i32 s26, s3, 1728
    s_add_u32 s68, s3, 204800
    buffer_load_dwordx4 v228, s[40:43], s68 offen lds
    v_add_f32 v234, v234, v237
    v_lshlrev_b32 v236, 16, v204
    v_mfma_f32_32x32x16_bf16 v[32:47], v[200:203], v[164:167], v[32:47]
    ds_read_b64_tr_b16 v[214:215], v220 offset:30976
    ds_read_b128 v[180:183], v219 offset:20480
    v_and_b32 v237, 0xffff0000, v204
    v_add_f32 v235, v235, v236
    v_add_f32 v235, v235, v237
    v_mfma_f32_32x32x16_bf16 v[48:63], v[204:207], v[164:167], v[48:63]
    ds_read_b128 v[184:187], v219 offset:21504
    s_add_u32 m0, s71, 61440
    s_nop 0
    buffer_load_dwordx4 v224, s[40:43], s68 offen offset:0 lds
    v_lshlrev_b32 v236, 16, v201
    v_and_b32 v237, 0xffff0000, v201
    v_mfma_f32_32x32x16_bf16 v[64:79], v[200:203], v[168:171], v[64:79]
    ds_read_b128 v[188:191], v219 offset:22528
    ds_read_b128 v[192:195], v219 offset:23552
    v_add_f32 v234, v234, v236
    v_add_f32 v234, v234, v237
    v_lshlrev_b32 v236, 16, v205
    v_mfma_f32_32x32x16_bf16 v[80:95], v[204:207], v[168:171], v[80:95]
    ds_read_b128 v[196:199], v219 offset:24576
    buffer_load_dwordx4 v225, s[40:43], s68 offen offset:1024 lds
    v_and_b32 v237, 0xffff0000, v205
    v_mfma_f32_32x32x16_bf16 v[96:111], v[200:203], v[172:175], v[96:111]
    v_add_f32 v235, v235, v236
    v_add_f32 v235, v235, v237
    v_lshlrev_b32 v236, 16, v202
    v_and_b32 v237, 0xffff0000, v202
    v_add_f32 v234, v234, v236
    v_mfma_f32_32x32x16_bf16 v[112:127], v[204:207], v[172:175], v[112:127]
    buffer_load_dwordx4 v226, s[40:43], s68 offen offset:2048 lds
    v_add_f32 v234, v234, v237
    v_lshlrev_b32 v236, 16, v206
    v_and_b32 v237, 0xffff0000, v206
    v_mfma_f32_32x32x16_bf16 v[128:143], v[200:203], v[176:179], v[128:143]
    v_add_f32 v235, v235, v236
    v_add_f32 v235, v235, v237
    v_lshlrev_b32 v236, 16, v203
    v_and_b32 v237, 0xffff0000, v203
    v_add_f32 v234, v234, v236
    v_mfma_f32_32x32x16_bf16 v[144:159], v[204:207], v[176:179], v[144:159]
    v_add_f32 v234, v234, v237
    v_lshlrev_b32 v236, 16, v207
    v_and_b32 v237, 0xffff0000, v207
    v_add_f32 v235, v235, v236
    v_add_f32 v235, v235, v237
    s_waitcnt lgkmcnt(0)
    v_mfma_f32_32x32x16_bf16 v[0:15], v[208:211], v[180:183], v[0:15]
    s_waitcnt vmcnt(5)
    s_barrier
    ds_read_b64_tr_b16 v[200:201], v220 offset:0
    ds_read_b64_tr_b16 v[202:203], v220 offset:256
    v_lshlrev_b32 v236, 16, v208
    v_and_b32 v237, 0xffff0000, v208
    v_mfma_f32_32x32x16_bf16 v[16:31], v[212:215], v[180:183], v[16:31]
    ds_read_b64_tr_b16 v[204:205], v220 offset:8192
    buffer_load_dwordx4 v227, s[40:43], s68 offen offset:3072 lds
    v_add_f32 v234, v234, v236
    v_add_f32 v234, v234, v237
    v_mfma_f32_32x32x16_bf16 v[32:47], v[208:211], v[184:187], v[32:47]
    ds_read_b64_tr_b16 v[206:207], v220 offset:8448
    ds_read_b128 v[160:163], v216 offset:40960
    v_lshlrev_b32 v236, 16, v212
    v_and_b32 v237, 0xffff0000, v212
    v_add_f32 v235, v235, v236
    v_mfma_f32_32x32x16_bf16 v[48:63], v[212:215], v[184:187], v[48:63]
    ds_read_b128 v[164:167], v216 offset:41984
    s_add_u32 m0, s72, 16384
    s_add_u32 s68, s26, 0
    buffer_load_dwordx4 v229, s[44:47], s68 offen offset:0 lds
    v_add_f32 v235, v235, v237
    v_lshlrev_b32 v236, 16, v209
    v_mfma_f32_32x32x16_bf16 v[64:79], v[208:211], v[188:191], v[64:79]
    ds_read_b128 v[168:171], v216 offset:43008
    ds_read_b128 v[172:175], v216 offset:44032
    v_and_b32 v237, 0xffff0000, v209
    v_add_f32 v234, v234, v236
    v_add_f32 v234, v234, v237
    v_mfma_f32_32x32x16_bf16 v[80:95], v[212:215], v[188:191], v[80:95]
    ds_read_b128 v[176:179], v216 offset:45056
    buffer_load_dwordx4 v230, s[44:47], s68 offen offset:1024 lds
    v_lshlrev_b32 v236, 16, v213
    v_and_b32 v237, 0xffff0000, v213
    v_mfma_f32_32x32x16_bf16 v[96:111], v[208:211], v[192:195], v[96:111]
    v_add_f32 v235, v235, v236
    v_add_f32 v235, v235, v237
    v_lshlrev_b32 v236, 16, v210
    v_and_b32 v237, 0xffff0000, v210
    v_add_f32 v234, v234, v236
    v_mfma_f32_32x32x16_bf16 v[112:127], v[212:215], v[192:195], v[112:127]
    buffer_load_dwordx4 v231, s[44:47], s68 offen offset:2048 lds
    v_add_f32 v234, v234, v237
    v_lshlrev_b32 v236, 16, v214
    v_and_b32 v237, 0xffff0000, v214
    v_mfma_f32_32x32x16_bf16 v[128:143], v[208:211], v[196:199], v[128:143]
    v_add_f32 v235, v235, v236
    v_add_f32 v235, v235, v237
    v_lshlrev_b32 v236, 16, v211
    v_and_b32 v237, 0xffff0000, v211
    v_add_f32 v234, v234, v236
    v_mfma_f32_32x32x16_bf16 v[144:159], v[212:215], v[196:199], v[144:159]
    v_add_f32 v234, v234, v237
    v_lshlrev_b32 v236, 16, v215
    v_and_b32 v237, 0xffff0000, v215
    v_add_f32 v235, v235, v236
    v_add_f32 v235, v235, v237
    s_waitcnt lgkmcnt(0)
    v_mfma_f32_32x32x16_bf16 v[0:15], v[200:203], v[160:163], v[0:15]
    ds_read_b64_tr_b16 v[208:209], v220 offset:2048
    ds_read_b64_tr_b16 v[210:211], v220 offset:2304
    s_lshl_b32 s73, s64, 10
    v_mfma_f32_32x32x16_bf16 v[16:31], v[204:207], v[160:163], v[16:31]
    ds_read_b64_tr_b16 v[212:213], v220 offset:10240
    buffer_load_dwordx4 v232, s[44:47], s68 offen offset:3072 lds
    v_mfma_f32_32x32x16_bf16 v[32:47], v[200:203], v[164:167], v[32:47]
    ds_read_b64_tr_b16 v[214:215], v220 offset:10496
    ds_read_b128 v[180:183], v217 offset:40960
    s_add_u32 s73, s73, 4259840
    v_mfma_f32_32x32x16_bf16 v[48:63], v[204:207], v[164:167], v[48:63]
    ds_read_b128 v[184:187], v217 offset:41984
    s_add_u32 m0, s71, 4096
    s_add_u32 s68, s3, 0
    buffer_load_dwordx4 v228, s[40:43], s68 offen lds
    v_mfma_f32_32x32x16_bf16 v[64:79], v[200:203], v[168:171], v[64:79]
    ds_read_b128 v[188:191], v217 offset:43008
    ds_read_b128 v[192:195], v217 offset:44032
    v_lshlrev_b32 v243, 4, v233
    v_mfma_f32_32x32x16_bf16 v[80:95], v[204:207], v[168:171], v[80:95]
    ds_read_b128 v[196:199], v217 offset:45056
    s_add_u32 m0, s71, 0
    s_nop 0
    buffer_load_dwordx4 v224, s[40:43], s68 offen offset:0 lds
    v_mfma_f32_32x32x16_bf16 v[96:111], v[200:203], v[172:175], v[96:111]
    buffer_load_dword v243, v243, s[56:59], s73 offen sc1
    v_permlane32_swap_b32 v234, v235
    v_mfma_f32_32x32x16_bf16 v[112:127], v[204:207], v[172:175], v[112:127]
    buffer_load_dwordx4 v225, s[40:43], s68 offen offset:1024 lds
    v_lshrrev_b32 v236, 1, v238
    v_mfma_f32_32x32x16_bf16 v[128:143], v[200:203], v[176:179], v[128:143]
    s_mul_i32 s101, s78, 2560
    s_add_u32 s101, s101, 4390912
    v_add_f32 v234, v234, v235
    v_mfma_f32_32x32x16_bf16 v[144:159], v[204:207], v[176:179], v[144:159]
    v_mov_b32 v235, s83
    s_add_u32 s73, s101, s31
    buffer_store_dwordx2 v[234:235], v236, s[56:59], s73 offen sc1
    s_waitcnt lgkmcnt(0)
    v_mfma_f32_32x32x16_bf16 v[0:15], v[208:211], v[180:183], v[0:15]
    ds_read_b64_tr_b16 v[200:201], v220 offset:4096
    ds_read_b64_tr_b16 v[202:203], v220 offset:4352
    v_mfma_f32_32x32x16_bf16 v[16:31], v[212:215], v[180:183], v[16:31]
    ds_read_b64_tr_b16 v[204:205], v220 offset:12288
    buffer_load_dwordx4 v226, s[40:43], s68 offen offset:2048 lds
    v_mfma_f32_32x32x16_bf16 v[32:47], v[208:211], v[184:187], v[32:47]
    ds_read_b64_tr_b16 v[206:207], v220 offset:12544
    ds_read_b128 v[160:163], v218 offset:40960
    v_mfma_f32_32x32x16_bf16 v[48:63], v[212:215], v[184:187], v[48:63]
    ds_read_b128 v[164:167], v218 offset:41984
    buffer_load_dwordx4 v227, s[40:43], s68 offen offset:3072 lds
    v_mfma_f32_32x32x16_bf16 v[64:79], v[208:211], v[188:191], v[64:79]
    ds_read_b128 v[168:171], v218 offset:43008
    ds_read_b128 v[172:175], v218 offset:44032
    v_mfma_f32_32x32x16_bf16 v[80:95], v[212:215], v[188:191], v[80:95]
    ds_read_b128 v[176:179], v218 offset:45056
    s_add_u32 m0, s71, 86016
    s_add_u32 s3, s3, 128
    s_cmp_eq_u32 s3, 1280
    s_cselect_b32 s3, 0, s3
    s_mul_i32 s26, s3, 1728
    s_add_u32 s68, s3, 204800
    buffer_load_dwordx4 v228, s[40:43], s68 offen lds
    v_mfma_f32_32x32x16_bf16 v[96:111], v[208:211], v[192:195], v[96:111]
    v_mfma_f32_32x32x16_bf16 v[112:127], v[212:215], v[192:195], v[112:127]
    s_add_u32 m0, s71, 81920
    s_nop 0
    buffer_load_dwordx4 v224, s[40:43], s68 offen offset:0 lds
    v_mfma_f32_32x32x16_bf16 v[128:143], v[208:211], v[196:199], v[128:143]
    v_mfma_f32_32x32x16_bf16 v[144:159], v[212:215], v[196:199], v[144:159]
    s_waitcnt lgkmcnt(0)
    v_mfma_f32_32x32x16_bf16 v[0:15], v[200:203], v[160:163], v[0:15]
    ds_read_b64_tr_b16 v[208:209], v220 offset:6144
    ds_read_b64_tr_b16 v[210:211], v220 offset:6400
    v_mfma_f32_32x32x16_bf16 v[16:31], v[204:207], v[160:163], v[16:31]
    ds_read_b64_tr_b16 v[212:213], v220 offset:14336
    buffer_load_dwordx4 v225, s[40:43], s68 offen offset:1024 lds
    v_mfma_f32_32x32x16_bf16 v[32:47], v[200:203], v[164:167], v[32:47]
    ds_read_b64_tr_b16 v[214:215], v220 offset:14592
    ds_read_b128 v[180:183], v219 offset:40960
    v_mfma_f32_32x32x16_bf16 v[48:63], v[204:207], v[164:167], v[48:63]
    ds_read_b128 v[184:187], v219 offset:41984
    v_mfma_f32_32x32x16_bf16 v[64:79], v[200:203], v[168:171], v[64:79]
    ds_read_b128 v[188:191], v219 offset:43008
    ds_read_b128 v[192:195], v219 offset:44032
    buffer_load_dwordx4 v226, s[40:43], s68 offen offset:2048 lds
    v_mfma_f32_32x32x16_bf16 v[80:95], v[204:207], v[168:171], v[80:95]
    ds_read_b128 v[196:199], v219 offset:45056
    v_mfma_f32_32x32x16_bf16 v[96:111], v[200:203], v[172:175], v[96:111]
    v_mfma_f32_32x32x16_bf16 v[112:127], v[204:207], v[172:175], v[112:127]
    buffer_load_dwordx4 v227, s[40:43], s68 offen offset:3072 lds
    v_mfma_f32_32x32x16_bf16 v[128:143], v[200:203], v[176:179], v[128:143]
    v_mfma_f32_32x32x16_bf16 v[144:159], v[204:207], v[176:179], v[144:159]
    s_waitcnt vmcnt(9)
    v_cmp_ne_u32 vcc, s83, v243
    s_cbranch_vccnz L_slow_f1_gld
L_go_f1_gld:
    s_barrier
    s_waitcnt lgkmcnt(0)
    v_mfma_f32_32x32x16_bf16 v[0:15], v[208:211], v[180:183], v[0:15]
    s_waitcnt vmcnt(5)
    s_barrier
    ds_read_b64_tr_b16 v[200:201], v220 offset:16384
    ds_read_b64_tr_b16 v[202:203], v220 offset:16640
    v_mfma_f32_32x32x16_bf16 v[16:31], v[212:215], v[180:183], v[16:31]
    ds_read_b64_tr_b16 v[204:205], v220 offset:24576
    s_add_u32 m0, s72, 0
    s_add_u32 s68, s26, 0
    buffer_load_dwordx4 v229, s[44:47], s68 offen offset:0 lds
    v_mfma_f32_32x32x16_bf16 v[32:47], v[208:211], v[184:187], v[32:47]
    ds_read_b64_tr_b16 v[206:207], v220 offset:24832
    ds_read_b128 v[160:163], v216 offset:0
    buffer_load_dwordx4 v230, s[44:47], s68 offen offset:1024 lds
    v_mfma_f32_32x32x16_bf16 v[48:63], v[212:215], v[184:187], v[48:63]
    ds_read_b128 v[164:167], v216 offset:1024
    v_mfma_f32_32x32x16_bf16 v[64:79], v[208:211], v[188:191], v[64:79]
    ds_read_b128 v[168:171], v216 offset:2048
    ds_read_b128 v[172:175], v216 offset:3072
    buffer_load_dwordx4 v231, s[44:47], s68 offen offset:2048 lds
    v_mfma_f32_32x32x16_bf16 v[80:95], v[212:215], v[188:191], v[80:95]
    ds_read_b128 v[176:179], v216 offset:4096
    v_mfma_f32_32x32x16_bf16 v[96:111], v[208:211], v[192:195], v[96:111]
    buffer_load_dwordx4 v232, s[44:47], s68 offen offset:3072 lds
    v_mfma_f32_32x32x16_bf16 v[112:127], v[212:215], v[192:195], v[112:127]
    v_mfma_f32_32x32x16_bf16 v[128:143], v[208:211], v[196:199], v[128:143]
    s_add_u32 m0, s71, 24576
    s_add_u32 s68, s3, 0
    buffer_load_dwordx4 v228, s[40:43], s68 offen lds
    v_mfma_f32_32x32x16_bf16 v[144:159], v[212:215], v[196:199], v[144:159]
    s_waitcnt lgkmcnt(0)
    v_mfma_f32_32x32x16_bf16 v[0:15], v[200:203], v[160:163], v[0:15]
    ds_read_b64_tr_b16 v[208:209], v220 offset:18432
    ds_read_b64_tr_b16 v[210:211], v220 offset:18688
    v_mfma_f32_32x32x16_bf16 v[16:31], v[204:207], v[160:163], v[16:31]
    ds_read_b64_tr_b16 v[212:213], v220 offset:26624
    s_add_u32 m0, s71, 20480
    s_nop 0
    buffer_load_dwordx4 v224, s[40:43], s68 offen offset:0 lds
    v_mfma_f32_32x32x16_bf16 v[32:47], v[200:203], v[164:167], v[32:47]
    ds_read_b64_tr_b16 v[214:215], v220 offset:26880
    ds_read_b128 v[180:183], v217 offset:0
    buffer_load_dwordx4 v225, s[40:43], s68 offen offset:1024 lds
    v_mfma_f32_32x32x16_bf16 v[48:63], v[204:207], v[164:167], v[48:63]
    ds_read_b128 v[184:187], v217 offset:1024
    v_mfma_f32_32x32x16_bf16 v[64:79], v[200:203], v[168:171], v[64:79]
    ds_read_b128 v[188:191], v217 offset:2048
    ds_read_b128 v[192:195], v217 offset:3072
    buffer_load_dwordx4 v226, s[40:43], s68 offen offset:2048 lds
    v_mfma_f32_32x32x16_bf16 v[80:95], v[204:207], v[168:171], v[80:95]
    ds_read_b128 v[196:199], v217 offset:4096
    v_mfma_f32_32x32x16_bf16 v[96:111], v[200:203], v[172:175], v[96:111]
    buffer_load_dwordx4 v227, s[40:43], s68 offen offset:3072 lds
    v_mfma_f32_32x32x16_bf16 v[112:127], v[204:207], v[172:175], v[112:127]
    v_mfma_f32_32x32x16_bf16 v[128:143], v[200:203], v[176:179], v[128:143]
    s_mul_i32 s100, s13, 160
    s_add_u32 s100, s100, s9
    buffer_load_dwordx4 a[40:43], v238, s[56:59], s100 offen offset:0 sc1
    v_mfma_f32_32x32x16_bf16 v[144:159], v[204:207], v[176:179], v[144:159]
    s_waitcnt lgkmcnt(0)
    v_mfma_f32_32x32x16_bf16 v[0:15], v[208:211], v[180:183], v[0:15]
    ds_read_b64_tr_b16 v[200:201], v220 offset:20480
    ds_read_b64_tr_b16 v[202:203], v220 offset:20736
    v_mfma_f32_32x32x16_bf16 v[16:31], v[212:215], v[180:183], v[16:31]
    ds_read_b64_tr_b16 v[204:205], v220 offset:28672
    s_add_u32 m0, s71, 106496
    s_add_u32 s3, s3, 128
    s_cmp_eq_u32 s3, 1280
    s_cselect_b32 s3, 0, s3
    s_mul_i32 s26, s3, 1728
    s_add_u32 s68, s3, 204800
    buffer_load_dwordx4 v228, s[40:43], s68 offen lds
    v_mfma_f32_32x32x16_bf16 v[32:47], v[208:211], v[184:187], v[32:47]
    ds_read_b64_tr_b16 v[206:207], v220 offset:28928
    ds_read_b128 v[160:163], v218 offset:0
    s_add_u32 m0, s71, 102400
    s_nop 0
    buffer_load_dwordx4 v224, s[40:43], s68 offen offset:0 lds
    v_mfma_f32_32x32x16_bf16 v[48:63], v[212:215], v[184:187], v[48:63]
    ds_read_b128 v[164:167], v218 offset:1024
    v_mfma_f32_32x32x16_bf16 v[64:79], v[208:211], v[188:191], v[64:79]
    ds_read_b128 v[168:171], v218 offset:2048
    ds_read_b128 v[172:175], v218 offset:3072
    buffer_load_dwordx4 v225, s[40:43], s68 offen offset:1024 lds
    v_mfma_f32_32x32x16_bf16 v[80:95], v[212:215], v[188:191], v[80:95]
    ds_read_b128 v[176:179], v218 offset:4096
    v_mfma_f32_32x32x16_bf16 v[96:111], v[208:211], v[192:195], v[96:111]
    buffer_load_dwordx4 v226, s[40:43], s68 offen offset:2048 lds
    v_mfma_f32_32x32x16_bf16 v[112:127], v[212:215], v[192:195], v[112:127]
    v_mfma_f32_32x32x16_bf16 v[128:143], v[208:211], v[196:199], v[128:143]
    buffer_load_dwordx4 a[44:47], v238, s[56:59], s100 offen offset:1024 sc1
    v_mfma_f32_32x32x16_bf16 v[144:159], v[212:215], v[196:199], v[144:159]
    s_waitcnt lgkmcnt(0)
    v_mfma_f32_32x32x16_bf16 v[0:15], v[200:203], v[160:163], v[0:15]
    ds_read_b64_tr_b16 v[208:209], v220 offset:22528
    ds_read_b64_tr_b16 v[210:211], v220 offset:22784
    v_mfma_f32_32x32x16_bf16 v[16:31], v[204:207], v[160:163], v[16:31]
    ds_read_b64_tr_b16 v[212:213], v220 offset:30720
    buffer_load_dwordx4 v227, s[40:43], s68 offen offset:3072 lds
    v_mfma_f32_32x32x16_bf16 v[32:47], v[200:203], v[164:167], v[32:47]
    ds_read_b64_tr_b16 v[214:215], v220 offset:30976
    ds_read_b128 v[180:183], v219 offset:0
    buffer_load_dwordx4 a[48:51], v238, s[56:59], s100 offen offset:2048 sc1
    v_mfma_f32_32x32x16_bf16 v[48:63], v[204:207], v[164:167], v[48:63]
    ds_read_b128 v[184:187], v219 offset:1024
    v_mfma_f32_32x32x16_bf16 v[64:79], v[200:203], v[168:171], v[64:79]
    ds_read_b128 v[188:191], v219 offset:2048
    ds_read_b128 v[192:195], v219 offset:3072
    buffer_load_dwordx4 a[52:55], v238, s[56:59], s100 offen offset:3072 sc1
    v_mfma_f32_32x32x16_bf16 v[80:95], v[204:207], v[168:171], v[80:95]
    ds_read_b128 v[196:199], v219 offset:4096
    v_mfma_f32_32x32x16_bf16 v[96:111], v[200:203], v[172:175], v[96:111]
    s_add_u32 s100, s100, 4096
    buffer_load_dwordx4 a[56:59], v238, s[56:59], s100 offen offset:0 sc1
    v_mfma_f32_32x32x16_bf16 v[112:127], v[204:207], v[172:175], v[112:127]
    v_mfma_f32_32x32x16_bf16 v[128:143], v[200:203], v[176:179], v[128:143]
    s_mul_i32 s100, s13, 160
    s_add_u32 s100, s100, s9
    s_add_u32 s100, s100, 10240
    buffer_load_dwordx4 a[60:63], v238, s[56:59], s100 offen offset:0 sc1
    v_mfma_f32_32x32x16_bf16 v[144:159], v[204:207], v[176:179], v[144:159]
    s_waitcnt lgkmcnt(0)
    v_mfma_f32_32x32x16_bf16 v[0:15], v[208:211], v[180:183], v[0:15]
    s_waitcnt vmcnt(11)
    s_barrier
    ds_read_b64_tr_b16 v[200:201], v220 offset:0
    ds_read_b64_tr_b16 v[202:203], v220 offset:256
    v_mfma_f32_32x32x16_bf16 v[16:31], v[212:215], v[180:183], v[16:31]
    ds_read_b64_tr_b16 v[204:205], v220 offset:8192
    s_add_u32 m0, s72, 16384
    s_add_u32 s68, s26, 0
    buffer_load_dwordx4 v229, s[44:47], s68 offen offset:0 lds
    v_mfma_f32_32x32x16_bf16 v[32:47], v[208:211], v[184:187], v[32:47]
    ds_read_b64_tr_b16 v[206:207], v220 offset:8448
    ds_read_b128 v[160:163], v216 offset:20480
    buffer_load_dwordx4 v230, s[44:47], s68 offen offset:1024 lds
    v_mfma_f32_32x32x16_bf16 v[48:63], v[212:215], v[184:187], v[48:63]
    ds_read_b128 v[164:167], v216 offset:21504
    v_mfma_f32_32x32x16_bf16 v[64:79], v[208:211], v[188:191], v[64:79]
    ds_read_b128 v[168:171], v216 offset:22528
    ds_read_b128 v[172:175], v216 offset:23552
    buffer_load_dwordx4 v231, s[44:47], s68 offen offset:2048 lds
    v_mfma_f32_32x32x16_bf16 v[80:95], v[212:215], v[188:191], v[80:95]
    ds_read_b128 v[176:179], v216 offset:24576
    v_mfma_f32_32x32x16_bf16 v[96:111], v[208:211], v[192:195], v[96:111]
    buffer_load_dwordx4 v232, s[44:47], s68 offen offset:3072 lds
    v_mfma_f32_32x32x16_bf16 v[112:127], v[212:215], v[192:195], v[112:127]
    v_mfma_f32_32x32x16_bf16 v[128:143], v[208:211], v[196:199], v[128:143]
    s_add_u32 m0, s71, 45056
    s_add_u32 s68, s3, 0
    buffer_load_dwordx4 v228, s[40:43], s68 offen lds
    v_mfma_f32_32x32x16_bf16 v[144:159], v[212:215], v[196:199], v[144:159]
    s_waitcnt lgkmcnt(0)
    v_mfma_f32_32x32x16_bf16 v[0:15], v[200:203], v[160:163], v[0:15]
    ds_read_b64_tr_b16 v[208:209], v220 offset:2048
    ds_read_b64_tr_b16 v[210:211], v220 offset:2304
    v_mfma_f32_32x32x16_bf16 v[16:31], v[204:207], v[160:163], v[16:31]
    ds_read_b64_tr_b16 v[212:213], v220 offset:10240
    s_add_u32 m0, s71, 40960
    s_nop 0
    buffer_load_dwordx4 v224, s[40:43], s68 offen offset:0 lds
    v_mfma_f32_32x32x16_bf16 v[32:47], v[200:203], v[164:167], v[32:47]
    ds_read_b64_tr_b16 v[214:215], v220 offset:10496
    ds_read_b128 v[180:183], v217 offset:20480
    v_mfma_f32_32x32x16_bf16 v[48:63], v[204:207], v[164:167], v[48:63]
    ds_read_b128 v[184:187], v217 offset:21504
    buffer_load_dwordx4 v225, s[40:43], s68 offen offset:1024 lds
    v_mfma_f32_32x32x16_bf16 v[64:79], v[200:203], v[168:171], v[64:79]
    ds_read_b128 v[188:191], v217 offset:22528
    ds_read_b128 v[192:195], v217 offset:23552
    v_mfma_f32_32x32x16_bf16 v[80:95], v[204:207], v[168:171], v[80:95]
    ds_read_b128 v[196:199], v217 offset:24576
    buffer_load_dwordx4 v226, s[40:43], s68 offen offset:2048 lds
    v_mfma_f32_32x32x16_bf16 v[96:111], v[200:203], v[172:175], v[96:111]
    v_mfma_f32_32x32x16_bf16 v[112:127], v[204:207], v[172:175], v[112:127]
    buffer_load_dwordx4 v227, s[40:43], s68 offen offset:3072 lds
    v_mfma_f32_32x32x16_bf16 v[128:143], v[200:203], v[176:179], v[128:143]
    buffer_load_dwordx2 a[240:241], v236, s[56:59], s101 offen offset:0 sc1
    v_mfma_f32_32x32x16_bf16 v[144:159], v[204:207], v[176:179], v[144:159]
    buffer_load_dwordx2 a[242:243], v236, s[56:59], s101 offen offset:512 sc1
    buffer_load_dwordx2 a[244:245], v236, s[56:59], s101 offen offset:1024 sc1
    s_waitcnt lgkmcnt(0)
    v_mfma_f32_32x32x16_bf16 v[0:15], v[208:211], v[180:183], v[0:15]
    ds_read_b64_tr_b16 v[200:201], v220 offset:4096
    ds_read_b64_tr_b16 v[202:203], v220 offset:4352
    v_mfma_f32_32x32x16_bf16 v[16:31], v[212:215], v[180:183], v[16:31]
    ds_read_b64_tr_b16 v[204:205], v220 offset:12288
    s_add_u32 m0, s71, 65536
    s_add_u32 s3, s3, 128
    s_cmp_eq_u32 s3, 1280
    s_cselect_b32 s3, 0, s3
    s_mul_i32 s26, s3, 1728
    s_add_u32 s68, s3, 204800
    buffer_load_dwordx4 v228, s[40:43], s68 offen lds
    v_mfma_f32_32x32x16_bf16 v[32:47], v[208:211], v[184:187], v[32:47]
    ds_read_b64_tr_b16 v[206:207], v220 offset:12544
    ds_read_b128 v[160:163], v218 offset:20480
    v_mfma_f32_32x32x16_bf16 v[48:63], v[212:215], v[184:187], v[48:63]
    ds_read_b128 v[164:167], v218 offset:21504
    s_add_u32 m0, s71, 61440
    s_nop 0
    buffer_load_dwordx4 v224, s[40:43], s68 offen offset:0 lds
    v_mfma_f32_32x32x16_bf16 v[64:79], v[208:211], v[188:191], v[64:79]
    ds_read_b128 v[168:171], v218 offset:22528
    ds_read_b128 v[172:175], v218 offset:23552
    v_mfma_f32_32x32x16_bf16 v[80:95], v[212:215], v[188:191], v[80:95]
    ds_read_b128 v[176:179], v218 offset:24576
    buffer_load_dwordx4 v225, s[40:43], s68 offen offset:1024 lds
    v_mfma_f32_32x32x16_bf16 v[96:111], v[208:211], v[192:195], v[96:111]
    v_mfma_f32_32x32x16_bf16 v[112:127], v[212:215], v[192:195], v[112:127]
    buffer_load_dwordx4 v226, s[40:43], s68 offen offset:2048 lds
    v_mfma_f32_32x32x16_bf16 v[128:143], v[208:211], v[196:199], v[128:143]
    v_mfma_f32_32x32x16_bf16 v[144:159], v[212:215], v[196:199], v[144:159]
    buffer_load_dwordx2 a[246:247], v236, s[56:59], s101 offen offset:1536 sc1
    buffer_load_dwordx2 a[248:249], v236, s[56:59], s101 offen offset:2048 sc1
    s_waitcnt lgkmcnt(0)
    v_mfma_f32_32x32x16_bf16 v[0:15], v[200:203], v[160:163], v[0:15]
    ds_read_b64_tr_b16 v[208:209], v220 offset:6144
    ds_read_b64_tr_b16 v[210:211], v220 offset:6400
    v_mfma_f32_32x32x16_bf16 v[16:31], v[204:207], v[160:163], v[16:31]
    ds_read_b64_tr_b16 v[212:213], v220 offset:14336
    buffer_load_dwordx4 v227, s[40:43], s68 offen offset:3072 lds
    v_mfma_f32_32x32x16_bf16 v[32:47], v[200:203], v[164:167], v[32:47]
    ds_read_b64_tr_b16 v[214:215], v220 offset:14592
    ds_read_b128 v[180:183], v219 offset:20480
    v_mfma_f32_32x32x16_bf16 v[48:63], v[204:207], v[164:167], v[48:63]
    ds_read_b128 v[184:187], v219 offset:21504
    v_mfma_f32_32x32x16_bf16 v[64:79], v[200:203], v[168:171], v[64:79]
    ds_read_b128 v[188:191], v219 offset:22528
    ds_read_b128 v[192:195], v219 offset:23552
    v_mfma_f32_32x32x16_bf16 v[80:95], v[204:207], v[168:171], v[80:95]
    ds_read_b128 v[196:199], v219 offset:24576
    buffer_load_dwordx4 a[64:67], v238, s[56:59], s100 offen offset:1024 sc1
    v_mfma_f32_32x32x16_bf16 v[96:111], v[200:203], v[172:175], v[96:111]
    v_mfma_f32_32x32x16_bf16 v[112:127], v[204:207], v[172:175], v[112:127]
    v_mfma_f32_32x32x16_bf16 v[128:143], v[200:203], v[176:179], v[128:143]
    v_mfma_f32_32x32x16_bf16 v[144:159], v[204:207], v[176:179], v[144:159]
    s_waitcnt lgkmcnt(0)
    v_mfma_f32_32x32x16_bf16 v[0:15], v[208:211], v[180:183], v[0:15]
    s_waitcnt vmcnt(11)
    s_barrier
    ds_read_b64_tr_b16 v[200:201], v220 offset:16384
    ds_read_b64_tr_b16 v[202:203], v220 offset:16640
    v_mfma_f32_32x32x16_bf16 v[16:31], v[212:215], v[180:183], v[16:31]
    ds_read_b64_tr_b16 v[204:205], v220 offset:24576
    s_add_u32 m0, s72, 0
    s_add_u32 s68, s26, 0
    buffer_load_dwordx4 v229, s[44:47], s68 offen offset:0 lds
    v_mfma_f32_32x32x16_bf16 v[32:47], v[208:211], v[184:187], v[32:47]
    ds_read_b64_tr_b16 v[206:207], v220 offset:24832
    ds_read_b128 v[160:163], v216 offset:40960
    buffer_load_dwordx4 v230, s[44:47], s68 offen offset:1024 lds
    v_mfma_f32_32x32x16_bf16 v[48:63], v[212:215], v[184:187], v[48:63]
    ds_read_b128 v[164:167], v216 offset:41984
    v_mfma_f32_32x32x16_bf16 v[64:79], v[208:211], v[188:191], v[64:79]
    ds_read_b128 v[168:171], v216 offset:43008
    ds_read_b128 v[172:175], v216 offset:44032
    buffer_load_dwordx4 v231, s[44:47], s68 offen offset:2048 lds
    v_mfma_f32_32x32x16_bf16 v[80:95], v[212:215], v[188:191], v[80:95]
    ds_read_b128 v[176:179], v216 offset:45056
    v_mfma_f32_32x32x16_bf16 v[96:111], v[208:211], v[192:195], v[96:111]
    buffer_load_dwordx4 v232, s[44:47], s68 offen offset:3072 lds
    v_mfma_f32_32x32x16_bf16 v[112:127], v[212:215], v[192:195], v[112:127]
    v_mfma_f32_32x32x16_bf16 v[128:143], v[208:211], v[196:199], v[128:143]
    s_add_u32 m0, s71, 4096
    s_add_u32 s68, s3, 0
    buffer_load_dwordx4 v228, s[40:43], s68 offen lds
    v_mfma_f32_32x32x16_bf16 v[144:159], v[212:215], v[196:199], v[144:159]
    s_waitcnt lgkmcnt(0)
    v_mfma_f32_32x32x16_bf16 v[0:15], v[200:203], v[160:163], v[0:15]
    ds_read_b64_tr_b16 v[208:209], v220 offset:18432
    ds_read_b64_tr_b16 v[210:211], v220 offset:18688
    s_waitcnt vmcnt(7)
    v_accvgpr_read_b32 v234, a241
    v_mfma_f32_32x32x16_bf16 v[16:31], v[204:207], v[160:163], v[16:31]
    ds_read_b64_tr_b16 v[212:213], v220 offset:26624
    s_add_u32 m0, s71, 0
    s_nop 0
    buffer_load_dwordx4 v224, s[40:43], s68 offen offset:0 lds
    v_mfma_f32_32x32x16_bf16 v[32:47], v[200:203], v[164:167], v[32:47]
    ds_read_b64_tr_b16 v[214:215], v220 offset:26880
    ds_read_b128 v[180:183], v217 offset:40960
    buffer_load_dwordx4 v225, s[40:43], s68 offen offset:1024 lds
    v_mfma_f32_32x32x16_bf16 v[48:63], v[204:207], v[164:167], v[48:63]
    ds_read_b128 v[184:187], v217 offset:41984
    v_xor_b32_e64 v234, s83, v234
    v_accvgpr_read_b32 v235, a243
    v_mfma_f32_32x32x16_bf16 v[64:79], v[200:203], v[168:171], v[64:79]
    ds_read_b128 v[188:191], v217 offset:43008
    ds_read_b128 v[192:195], v217 offset:44032
    buffer_load_dwordx4 v226, s[40:43], s68 offen offset:2048 lds
    v_mfma_f32_32x32x16_bf16 v[80:95], v[204:207], v[168:171], v[80:95]
    ds_read_b128 v[196:199], v217 offset:45056
    v_xor_b32 v235, s83, v235
    v_or_b32 v234, v234, v235
    v_mfma_f32_32x32x16_bf16 v[96:111], v[200:203], v[172:175], v[96:111]
    buffer_load_dwordx4 v227, s[40:43], s68 offen offset:3072 lds
    v_accvgpr_read_b32 v235, a245
    v_xor_b32 v235, s83, v235
    v_mfma_f32_32x32x16_bf16 v[112:127], v[204:207], v[172:175], v[112:127]
    v_or_b32 v234, v234, v235
    v_accvgpr_read_b32 v235, a247
    v_xor_b32 v235, s83, v235
    v_mfma_f32_32x32x16_bf16 v[128:143], v[200:203], v[176:179], v[128:143]
    buffer_load_dwordx4 a[68:71], v238, s[56:59], s100 offen offset:2048 sc1
    v_or_b32 v234, v234, v235
    v_accvgpr_read_b32 v235, a249
    v_xor_b32 v235, s83, v235
    v_mfma_f32_32x32x16_bf16 v[144:159], v[204:207], v[176:179], v[144:159]
    v_or_b32 v234, v234, v235
    v_cmp_ne_u32 vcc, 0, v234
    s_cbranch_vccnz L_slow_sum_gld
L_go_sum_gld:
    s_waitcnt lgkmcnt(0)
    v_mfma_f32_32x32x16_bf16 v[0:15], v[208:211], v[180:183], v[0:15]
    ds_read_b64_tr_b16 v[200:201], v220 offset:20480
    ds_read_b64_tr_b16 v[202:203], v220 offset:20736
    s_lshr_b32 s73, s2, 3
    s_mul_i32 s73, s73, 3072
    v_mfma_f32_32x32x16_bf16 v[16:31], v[212:215], v[180:183], v[16:31]
    ds_read_b64_tr_b16 v[204:205], v220 offset:28672
    s_add_u32 m0, s71, 86016
    s_add_u32 s3, s3, 128
    s_cmp_eq_u32 s3, 1280
    s_cselect_b32 s3, 0, s3
    s_mul_i32 s26, s3, 1728
    s_add_u32 s68, s3, 204800
    buffer_load_dwordx4 v228, s[40:43], s68 offen lds
    v_mfma_f32_32x32x16_bf16 v[32:47], v[208:211], v[184:187], v[32:47]
    ds_read_b64_tr_b16 v[206:207], v220 offset:28928
    ds_read_b128 v[160:163], v218 offset:40960
    s_cmp_eq_u32 s64, 0
    s_cselect_b32 s73, s73, 134217728
    v_mfma_f32_32x32x16_bf16 v[48:63], v[212:215], v[184:187], v[48:63]
    ds_read_b128 v[164:167], v218 offset:41984
    s_add_u32 m0, s71, 81920
    s_nop 0
    buffer_load_dwordx4 v224, s[40:43], s68 offen offset:0 lds
    v_mfma_f32_32x32x16_bf16 v[64:79], v[208:211], v[188:191], v[64:79]
    ds_read_b128 v[168:171], v218 offset:43008
    ds_read_b128 v[172:175], v218 offset:44032
    v_lshl_add_u32 v243, v233, 7, s73
    v_mfma_f32_32x32x16_bf16 v[80:95], v[212:215], v[188:191], v[80:95]
    ds_read_b128 v[176:179], v218 offset:45056
    buffer_load_dwordx4 v225, s[40:43], s68 offen offset:1024 lds
    v_mfma_f32_32x32x16_bf16 v[96:111], v[208:211], v[192:195], v[96:111]
    s_mov_b32 exec_lo, 16777215
    s_mov_b32 exec_hi, 0
    buffer_load_dword a255, v243, s[84:87], 0 offen
    s_mov_b64 exec, -1
    v_accvgpr_read_b32 v254, a240
    v_mfma_f32_32x32x16_bf16 v[112:127], v[212:215], v[192:195], v[112:127]
    buffer_load_dwordx4 v226, s[40:43], s68 offen offset:2048 lds
    v_accvgpr_read_b32 v234, a242
    v_mfma_f32_32x32x16_bf16 v[128:143], v[208:211], v[196:199], v[128:143]
    v_add_f32 v254, v254, v234
    v_accvgpr_read_b32 v234, a244
    v_add_f32 v254, v254, v234
    v_accvgpr_read_b32 v234, a246
    v_mfma_f32_32x32x16_bf16 v[144:159], v[212:215], v[196:199], v[144:159]
    v_add_f32 v254, v254, v234
    v_accvgpr_read_b32 v234, a248
    v_add_f32 v254, v254, v234
    s_waitcnt lgkmcnt(0)
    v_mfma_f32_32x32x16_bf16 v[0:15], v[200:203], v[160:163], v[0:15]
    ds_read_b64_tr_b16 v[208:209], v220 offset:22528
    ds_read_b64_tr_b16 v[210:211], v220 offset:22784
    s_lshl_b32 s75, s78, 12
    v_mfma_f32_32x32x16_bf16 v[16:31], v[204:207], v[160:163], v[16:31]
    ds_read_b64_tr_b16 v[212:213], v220 offset:30720
    buffer_load_dwordx4 v227, s[40:43], s68 offen offset:3072 lds
    s_cmp_ge_u32 s78, 54
    s_cselect_b32 s21, 134217728, s75
    v_mfma_f32_32x32x16_bf16 v[32:47], v[200:203], v[164:167], v[32:47]
    ds_read_b64_tr_b16 v[214:215], v220 offset:30976
    ds_read_b128 v[180:183], v219 offset:40960
    buffer_load_dwordx4 a[72:75], v238, s[56:59], s100 offen offset:3072 sc1
    v_mfma_f32_32x32x16_bf16 v[48:63], v[204:207], v[164:167], v[48:63]
    ds_read_b128 v[184:187], v219 offset:41984
    s_mul_i32 s73, s65, 5
    s_add_u32 s73, s73, 0
    v_mfma_f32_32x32x16_bf16 v[64:79], v[200:203], v[168:171], v[64:79]
    ds_read_b128 v[188:191], v219 offset:43008
    ds_read_b128 v[192:195], v219 offset:44032
    s_add_u32 s100, s100, 4096
    buffer_load_dwordx4 a[76:79], v238, s[56:59], s100 offen offset:0 sc1
    v_mfma_f32_32x32x16_bf16 v[80:95], v[204:207], v[168:171], v[80:95]
    ds_read_b128 v[196:199], v219 offset:45056
    s_lshr_b32 s74, s73, 1
    s_mul_i32 s74, s74, 380928
    v_mfma_f32_32x32x16_bf16 v[96:111], v[200:203], v[172:175], v[96:111]
    s_mul_i32 s100, s14, 160
    s_add_u32 s100, s100, s9
    buffer_load_dwordx4 a[80:83], v238, s[56:59], s100 offen offset:0 sc1
    s_lshl_b32 s73, s73, 11
    v_mfma_f32_32x32x16_bf16 v[112:127], v[204:207], v[172:175], v[112:127]
    s_add_u32 s74, s74, s73
    s_add_u32 s16, s74, s21
    s_mul_i32 s73, s65, 5
    v_mfma_f32_32x32x16_bf16 v[128:143], v[200:203], v[176:179], v[128:143]
    buffer_load_dwordx4 a[84:87], v238, s[56:59], s100 offen offset:1024 sc1
    s_add_u32 s73, s73, 1
    s_lshr_b32 s74, s73, 1
    s_mul_i32 s74, s74, 380928
    v_mfma_f32_32x32x16_bf16 v[144:159], v[204:207], v[176:179], v[144:159]
    s_lshl_b32 s73, s73, 11
    s_add_u32 s74, s74, s73
    s_add_u32 s17, s74, s21
    s_waitcnt lgkmcnt(0)
    v_mfma_f32_32x32x16_bf16 v[0:15], v[208:211], v[180:183], v[0:15]
    s_waitcnt vmcnt(11)
    s_barrier
    ds_read_b64_tr_b16 v[200:201], v220 offset:0
    ds_read_b64_tr_b16 v[202:203], v220 offset:256
    s_mul_i32 s73, s65, 5
    v_mfma_f32_32x32x16_bf16 v[16:31], v[212:215], v[180:183], v[16:31]
    ds_read_b64_tr_b16 v[204:205], v220 offset:8192
    s_add_u32 m0, s72, 16384
    s_add_u32 s68, s26, 0
    buffer_load_dwordx4 v229, s[44:47], s68 offen offset:0 lds
    s_add_u32 s73, s73, 2
    v_mfma_f32_32x32x16_bf16 v[32:47], v[208:211], v[184:187], v[32:47]
    ds_read_b64_tr_b16 v[206:207], v220 offset:8448
    ds_read_b128 v[160:163], v216 offset:0
    buffer_load_dwordx4 v230, s[44:47], s68 offen offset:1024 lds
    v_mfma_f32_32x32x16_bf16 v[48:63], v[212:215], v[184:187], v[48:63]
    ds_read_b128 v[164:167], v216 offset:1024
    s_lshr_b32 s74, s73, 1
    s_mul_i32 s74, s74, 380928
    s_lshl_b32 s73, s73, 11
    v_mfma_f32_32x32x16_bf16 v[64:79], v[208:211], v[188:191], v[64:79]
    ds_read_b128 v[168:171], v216 offset:2048
    ds_read_b128 v[172:175], v216 offset:3072
    buffer_load_dwordx4 v231, s[44:47], s68 offen offset:2048 lds
    s_add_u32 s74, s74, s73
    v_mfma_f32_32x32x16_bf16 v[80:95], v[212:215], v[188:191], v[80:95]
    ds_read_b128 v[176:179], v216 offset:4096
    s_add_u32 s18, s74, s21
    s_mul_i32 s73, s65, 5
    s_add_u32 s73, s73, 3
    v_mfma_f32_32x32x16_bf16 v[96:111], v[208:211], v[192:195], v[96:111]
    buffer_load_dwordx4 v232, s[44:47], s68 offen offset:3072 lds
    s_lshr_b32 s74, s73, 1
    s_mul_i32 s74, s74, 380928
    v_mfma_f32_32x32x16_bf16 v[112:127], v[212:215], v[192:195], v[112:127]
    s_lshl_b32 s73, s73, 11
    s_add_u32 s74, s74, s73
    s_add_u32 s19, s74, s21
    s_mul_i32 s73, s65, 5
    v_mfma_f32_32x32x16_bf16 v[128:143], v[208:211], v[196:199], v[128:143]
    s_add_u32 m0, s71, 24576
    s_add_u32 s68, s3, 0
    buffer_load_dwordx4 v228, s[40:43], s68 offen lds
    s_add_u32 s73, s73, 4
    s_lshr_b32 s74, s73, 1
    v_mfma_f32_32x32x16_bf16 v[144:159], v[212:215], v[196:199], v[144:159]
    s_mul_i32 s74, s74, 380928
    s_lshl_b32 s73, s73, 11
    s_add_u32 s74, s74, s73
    s_add_u32 s20, s74, s21
    s_waitcnt lgkmcnt(0)
    v_mfma_f32_32x32x16_bf16 v[0:15], v[200:203], v[160:163], v[0:15]
    ds_read_b64_tr_b16 v[208:209], v220 offset:2048
    ds_read_b64_tr_b16 v[210:211], v220 offset:2304
    v_mfma_f32_32x32x16_bf16 v[16:31], v[204:207], v[160:163], v[16:31]
    ds_read_b64_tr_b16 v[212:213], v220 offset:10240
    s_add_u32 m0, s71, 20480
    s_nop 0
    buffer_load_dwordx4 v224, s[40:43], s68 offen offset:0 lds
    v_mfma_f32_32x32x16_bf16 v[32:47], v[200:203], v[164:167], v[32:47]
    ds_read_b64_tr_b16 v[214:215], v220 offset:10496
    ds_read_b128 v[180:183], v217 offset:0
    buffer_load_dwordx4 v225, s[40:43], s68 offen offset:1024 lds
    v_mfma_f32_32x32x16_bf16 v[48:63], v[204:207], v[164:167], v[48:63]
    ds_read_b128 v[184:187], v217 offset:1024
    v_mfma_f32_32x32x16_bf16 v[64:79], v[200:203], v[168:171], v[64:79]
    ds_read_b128 v[188:191], v217 offset:2048
    ds_read_b128 v[192:195], v217 offset:3072
    buffer_load_dwordx4 v226, s[40:43], s68 offen offset:2048 lds
    v_mfma_f32_32x32x16_bf16 v[80:95], v[204:207], v[168:171], v[80:95]
    ds_read_b128 v[196:199], v217 offset:4096
    v_mfma_f32_32x32x16_bf16 v[96:111], v[200:203], v[172:175], v[96:111]
    buffer_load_dwordx4 v227, s[40:43], s68 offen offset:3072 lds
    v_mfma_f32_32x32x16_bf16 v[112:127], v[204:207], v[172:175], v[112:127]
    v_mfma_f32_32x32x16_bf16 v[128:143], v[200:203], v[176:179], v[128:143]
    buffer_load_dwordx4 a[88:91], v238, s[56:59], s100 offen offset:2048 sc1
    v_mfma_f32_32x32x16_bf16 v[144:159], v[204:207], v[176:179], v[144:159]
    s_waitcnt lgkmcnt(0)
    v_mfma_f32_32x32x16_bf16 v[0:15], v[208:211], v[180:183], v[0:15]
    ds_read_b64_tr_b16 v[200:201], v220 offset:4096
    ds_read_b64_tr_b16 v[202:203], v220 offset:4352
    v_mfma_f32_32x32x16_bf16 v[16:31], v[212:215], v[180:183], v[16:31]
    ds_read_b64_tr_b16 v[204:205], v220 offset:12288
    buffer_load_dwordx4 a[92:95], v238, s[56:59], s100 offen offset:3072 sc1
    v_mfma_f32_32x32x16_bf16 v[32:47], v[208:211], v[184:187], v[32:47]
    ds_read_b64_tr_b16 v[206:207], v220 offset:12544
    ds_read_b128 v[160:163], v218 offset:0
    v_mfma_f32_32x32x16_bf16 v[48:63], v[212:215], v[184:187], v[48:63]
    ds_read_b128 v[164:167], v218 offset:1024
    s_mul_i32 s27, s65, 1280
    v_mfma_f32_32x32x16_bf16 v[64:79], v[208:211], v[188:191], v[64:79]
    ds_read_b128 v[168:171], v218 offset:2048
    ds_read_b128 v[172:175], v218 offset:3072
    v_mfma_f32_32x32x16_bf16 v[80:95], v[212:215], v[188:191], v[80:95]
    ds_read_b128 v[176:179], v218 offset:4096
    s_add_u32 s100, s100, 4096
    buffer_load_dwordx4 a[96:99], v238, s[56:59], s100 offen offset:0 sc1
    v_mfma_f32_32x32x16_bf16 v[96:111], v[208:211], v[192:195], v[96:111]
    v_mfma_f32_32x32x16_bf16 v[112:127], v[212:215], v[192:195], v[112:127]
    s_add_u32 s27, s27, 4194304
    v_lshrrev_b32 v240, 1, v238
    v_mfma_f32_32x32x16_bf16 v[128:143], v[208:211], v[196:199], v[128:143]
    v_and_b32 v239, 0xf8, v240
    buffer_load_dwordx2 v[244:245], v239, s[56:59], s27 offen offset:0 sc1
    v_mfma_f32_32x32x16_bf16 v[144:159], v[212:215], v[196:199], v[144:159]
    buffer_load_dwordx2 v[246:247], v239, s[56:59], s27 offen offset:256 sc1
    buffer_load_dwordx2 v[248:249], v239, s[56:59], s27 offen offset:512 sc1
    s_waitcnt lgkmcnt(0)
    v_mfma_f32_32x32x16_bf16 v[0:15], v[200:203], v[160:163], v[0:15]
    ds_read_b64_tr_b16 v[208:209], v220 offset:6144
    ds_read_b64_tr_b16 v[210:211], v220 offset:6400
    v_mfma_f32_32x32x16_bf16 v[16:31], v[204:207], v[160:163], v[16:31]
    ds_read_b64_tr_b16 v[212:213], v220 offset:14336
    s_mul_i32 s100, s14, 160
    s_add_u32 s100, s100, s9
    s_add_u32 s100, s100, 10240
    buffer_load_dwordx4 a[100:103], v238, s[56:59], s100 offen offset:0 sc1
    v_mfma_f32_32x32x16_bf16 v[32:47], v[200:203], v[164:167], v[32:47]
    ds_read_b64_tr_b16 v[214:215], v220 offset:14592
    ds_read_b128 v[180:183], v219 offset:0
    v_mfma_f32_32x32x16_bf16 v[48:63], v[204:207], v[164:167], v[48:63]
    ds_read_b128 v[184:187], v219 offset:1024
    v_mfma_f32_32x32x16_bf16 v[64:79], v[200:203], v[168:171], v[64:79]
    ds_read_b128 v[188:191], v219 offset:2048
    ds_read_b128 v[192:195], v219 offset:3072
    buffer_load_dwordx4 a[104:107], v238, s[56:59], s100 offen offset:1024 sc1
    v_mfma_f32_32x32x16_bf16 v[80:95], v[204:207], v[168:171], v[80:95]
    ds_read_b128 v[196:199], v219 offset:4096
    v_mfma_f32_32x32x16_bf16 v[96:111], v[200:203], v[172:175], v[96:111]
    v_mfma_f32_32x32x16_bf16 v[112:127], v[204:207], v[172:175], v[112:127]
    buffer_load_dwordx4 a[108:111], v238, s[56:59], s100 offen offset:2048 sc1
    v_mfma_f32_32x32x16_bf16 v[128:143], v[200:203], v[176:179], v[128:143]
    v_mfma_f32_32x32x16_bf16 v[144:159], v[204:207], v[176:179], v[144:159]
    buffer_load_dwordx2 v[250:251], v239, s[56:59], s27 offen offset:768 sc1
    buffer_load_dwordx2 v[252:253], v239, s[56:59], s27 offen offset:1024 sc1
    s_waitcnt lgkmcnt(0)
    v_mfma_f32_32x32x16_bf16 v[0:15], v[208:211], v[180:183], v[0:15]
    s_waitcnt vmcnt(11)
    s_barrier
    ds_read_b64_tr_b16 v[200:201], v220 offset:16384
    ds_read_b64_tr_b16 v[202:203], v220 offset:16640
    v_mfma_f32_32x32x16_bf16 v[16:31], v[212:215], v[180:183], v[16:31]
    ds_read_b64_tr_b16 v[204:205], v220 offset:24576
    buffer_load_dwordx4 a[112:115], v238, s[56:59], s100 offen offset:3072 sc1
    v_mfma_f32_32x32x16_bf16 v[32:47], v[208:211], v[184:187], v[32:47]
    ds_read_b64_tr_b16 v[206:207], v220 offset:24832
    ds_read_b128 v[160:163], v216 offset:20480
    s_add_u32 s100, s100, 4096
    buffer_load_dwordx4 a[116:119], v238, s[56:59], s100 offen offset:0 sc1
    v_mfma_f32_32x32x16_bf16 v[48:63], v[212:215], v[184:187], v[48:63]
    ds_read_b128 v[164:167], v216 offset:21504
    v_mfma_f32_32x32x16_bf16 v[64:79], v[208:211], v[188:191], v[64:79]
    ds_read_b128 v[168:171], v216 offset:22528
    ds_read_b128 v[172:175], v216 offset:23552
    s_mul_i32 s100, s15, 160
    s_add_u32 s100, s100, s9
    buffer_load_dwordx4 a[120:123], v238, s[56:59], s100 offen offset:0 sc1
    v_mfma_f32_32x32x16_bf16 v[80:95], v[212:215], v[188:191], v[80:95]
    ds_read_b128 v[176:179], v216 offset:24576
    v_mfma_f32_32x32x16_bf16 v[96:111], v[208:211], v[192:195], v[96:111]
    buffer_load_dwordx4 a[124:127], v238, s[56:59], s100 offen offset:1024 sc1
    v_mfma_f32_32x32x16_bf16 v[112:127], v[212:215], v[192:195], v[112:127]
    v_mfma_f32_32x32x16_bf16 v[128:143], v[208:211], v[196:199], v[128:143]
    buffer_load_dwordx4 a[128:131], v238, s[56:59], s100 offen offset:2048 sc1
    v_mfma_f32_32x32x16_bf16 v[144:159], v[212:215], v[196:199], v[144:159]
    s_waitcnt lgkmcnt(0)
    v_mfma_f32_32x32x16_bf16 v[0:15], v[200:203], v[160:163], v[0:15]
    ds_read_b64_tr_b16 v[208:209], v220 offset:18432
    ds_read_b64_tr_b16 v[210:211], v220 offset:18688
    s_lshl_b32 s73, s4, 1
    v_lshrrev_b32 v242, 5, v233
    v_add_u32 v242, s73, v242
    v_mfma_f32_32x32x16_bf16 v[16:31], v[204:207], v[160:163], v[16:31]
    ds_read_b64_tr_b16 v[212:213], v220 offset:26624
    buffer_load_dwordx4 a[132:135], v238, s[56:59], s100 offen offset:3072 sc1
    v_mul_u32_u24 v242, 205, v242
    v_lshrrev_b32_e64 v242, 10, v242
    v_mfma_f32_32x32x16_bf16 v[32:47], v[200:203], v[164:167], v[32:47]
    ds_read_b64_tr_b16 v[214:215], v220 offset:26880
    ds_read_b128 v[180:183], v217 offset:20480
    s_add_u32 s100, s100, 4096
    buffer_load_dwordx4 a[136:139], v238, s[56:59], s100 offen offset:0 sc1
    v_and_b32 v241, 15, v233
    v_mfma_f32_32x32x16_bf16 v[48:63], v[204:207], v[164:167], v[48:63]
    ds_read_b128 v[184:187], v217 offset:21504
    v_lshl_add_u32 v242, v242, 6, v241
    s_lshl_b32 s75, s64, 4
    v_add_u32 v242, s75, v242
    v_mfma_f32_32x32x16_bf16 v[64:79], v[200:203], v[168:171], v[64:79]
    ds_read_b128 v[188:191], v217 offset:22528
    ds_read_b128 v[192:195], v217 offset:23552
    s_mul_i32 s100, s15, 160
    s_add_u32 s100, s100, s9
    s_add_u32 s100, s100, 10240
    buffer_load_dwordx4 a[140:143], v238, s[56:59], s100 offen offset:0 sc1
    v_mfma_f32_32x32x16_bf16 v[80:95], v[204:207], v[168:171], v[80:95]
    ds_read_b128 v[196:199], v217 offset:24576
    v_and_b32 v243, 14, v241
    s_and_b32 s74, s64, 2
    v_mfma_f32_32x32x16_bf16 v[96:111], v[200:203], v[172:175], v[96:111]
    buffer_load_dwordx4 a[144:147], v238, s[56:59], s100 offen offset:1024 sc1
    s_lshr_b32 s73, s4, 1
    s_lshl_b32 s73, s73, 5
    s_add_u32 s74, s74, s73
    s_add_u32 s74, s74, 1024
    v_mfma_f32_32x32x16_bf16 v[112:127], v[204:207], v[172:175], v[112:127]
    v_add3_u32 v243, v243, v241, s74
    v_and_b32 v241, 16, v233
    v_cmp_eq_u32 vcc, 0, v241
    s_mov_b32 s28, 5046272
    v_mfma_f32_32x32x16_bf16 v[128:143], v[200:203], v[176:179], v[128:143]
    buffer_load_dwordx4 a[148:151], v238, s[56:59], s100 offen offset:2048 sc1
    s_nop 0
    v_cndmask_b32 v231, v243, v242, vcc
    v_lshlrev_b32 v231, 5, v231
    v_mfma_f32_32x32x16_bf16 v[144:159], v[204:207], v[176:179], v[144:159]
    s_cmp_ge_u32 s64, 2
    s_cselect_b32 s23, 0, 0x2000
    s_or_b32 s22, s23, 0x3ff0000
    s_mov_b32 s10, 0x1fff
    s_mov_b32 s11, 0x1fff
    s_waitcnt lgkmcnt(0)
    v_mfma_f32_32x32x16_bf16 v[0:15], v[208:211], v[180:183], v[0:15]
    ds_read_b64_tr_b16 v[200:201], v220 offset:20480
    ds_read_b64_tr_b16 v[202:203], v220 offset:20736
    s_waitcnt vmcnt(10)
    v_xor_b32 v241, s83, v245
    v_mfma_f32_32x32x16_bf16 v[16:31], v[212:215], v[180:183], v[16:31]
    ds_read_b64_tr_b16 v[204:205], v220 offset:28672
    buffer_load_dwordx4 a[152:155], v238, s[56:59], s100 offen offset:3072 sc1
    v_xor_b32 v242, s83, v247
    v_or_b32 v241, v241, v242
    v_xor_b32_e64 v242, s83, v249
    v_mfma_f32_32x32x16_bf16 v[32:47], v[208:211], v[184:187], v[32:47]
    ds_read_b64_tr_b16 v[206:207], v220 offset:28928
    ds_read_b128 v[160:163], v218 offset:20480
    s_add_u32 s100, s100, 4096
    buffer_load_dwordx4 a[156:159], v238, s[56:59], s100 offen offset:0 sc1
    v_mfma_f32_32x32x16_bf16 v[48:63], v[212:215], v[184:187], v[48:63]
    ds_read_b128 v[164:167], v218 offset:21504
    v_or_b32 v241, v241, v242
    v_xor_b32 v242, s83, v251
    v_or_b32 v241, v241, v242
    v_xor_b32 v242, s83, v253
    v_mfma_f32_32x32x16_bf16 v[64:79], v[208:211], v[188:191], v[64:79]
    ds_read_b128 v[168:171], v218 offset:22528
    ds_read_b128 v[172:175], v218 offset:23552
    s_mul_i32 s100, s30, 160
    s_add_u32 s100, s100, s9
    buffer_load_dwordx4 a[160:163], v238, s[56:59], s100 offen offset:0 sc1
    v_mfma_f32_32x32x16_bf16 v[80:95], v[212:215], v[188:191], v[80:95]
    ds_read_b128 v[176:179], v218 offset:24576
    v_or_b32 v241, v241, v242
    v_cmp_ne_u32 vcc, 0, v241
    s_cbranch_vccnz L_slow_epi_gld
L_go_epi_gld:
    v_mfma_f32_32x32x16_bf16 v[96:111], v[208:211], v[192:195], v[96:111]
    buffer_load_dwordx4 a[164:167], v238, s[56:59], s100 offen offset:1024 sc1
    s_lshl_b32 s73, s64, 10
    s_add_u32 s73, s73, 159744
    v_lshrrev_b32 v239, 2, v238
    v_mfma_f32_32x32x16_bf16 v[112:127], v[212:215], v[192:195], v[112:127]
    v_add_u32 v239, s73, v239
    v_lshrrev_b32 v240, 5, v233
    v_lshl_add_u32 v241, v240, 4, s73
    ds_write_b32 v239, v254
    v_mfma_f32_32x32x16_bf16 v[128:143], v[208:211], v[196:199], v[128:143]
    buffer_load_dwordx4 a[168:171], v238, s[56:59], s100 offen offset:2048 sc1
    v_and_b32 v228, 0xffff0000, v244
    v_lshlrev_b32 v244, 16, v244
    v_rcp_f32 v245, v228
    v_mfma_f32_32x32x16_bf16 v[144:159], v[212:215], v[196:199], v[144:159]
    v_and_b32 v229, 0xffff0000, v246
    v_lshlrev_b32 v246, 16, v246
    v_rcp_f32 v247, v229
    s_waitcnt lgkmcnt(1)
    v_mfma_f32_32x32x16_bf16 v[0:15], v[200:203], v[160:163], v[0:15]
    ds_read_b64_tr_b16 v[208:209], v220 offset:22528
    ds_read_b64_tr_b16 v[210:211], v220 offset:22784
    v_and_b32 v222, 0xffff0000, v248
    v_lshlrev_b32 v248, 16, v248
    v_mfma_f32_32x32x16_bf16 v[16:31], v[204:207], v[160:163], v[16:31]
    ds_read_b64_tr_b16 v[212:213], v220 offset:30720
    buffer_load_dwordx4 a[172:175], v238, s[56:59], s100 offen offset:3072 sc1
    v_rcp_f32_e64 v249, v222
    v_mfma_f32_32x32x16_bf16 v[32:47], v[200:203], v[164:167], v[32:47]
    ds_read_b64_tr_b16 v[214:215], v220 offset:30976
    ds_read_b128 v[180:183], v219 offset:20480
    s_add_u32 s100, s100, 4096
    buffer_load_dwordx4 a[176:179], v238, s[56:59], s100 offen offset:0 sc1
    v_mfma_f32_32x32x16_bf16 v[48:63], v[204:207], v[164:167], v[48:63]
    ds_read_b128 v[184:187], v219 offset:21504
    v_and_b32 v223, 0xffff0000, v250
    v_lshlrev_b32 v250, 16, v250
    v_mfma_f32_32x32x16_bf16 v[64:79], v[200:203], v[168:171], v[64:79]
    ds_read_b128 v[188:191], v219 offset:22528
    ds_read_b128 v[192:195], v219 offset:23552
    s_mul_i32 s100, s30, 160
    s_add_u32 s100, s100, s9
    s_add_u32 s100, s100, 10240
    buffer_load_dwordx4 a[180:183], v238, s[56:59], s100 offen offset:0 sc1
    v_mfma_f32_32x32x16_bf16 v[80:95], v[204:207], v[168:171], v[80:95]
    ds_read_b128 v[196:199], v219 offset:24576
    v_rcp_f32 v251, v223
    v_mfma_f32_32x32x16_bf16 v[96:111], v[200:203], v[172:175], v[96:111]
    buffer_load_dwordx4 a[184:187], v238, s[56:59], s100 offen offset:1024 sc1
    v_and_b32 v234, 0xffff0000, v252
    v_lshlrev_b32 v252, 16, v252
    v_mfma_f32_32x32x16_bf16 v[112:127], v[204:207], v[172:175], v[112:127]
    v_rcp_f32_e64 v253, v234
    v_and_b32 v242, 0xf0, v238
    v_lshl_add_u32 v242, v240, 9, v242
    v_mfma_f32_32x32x16_bf16 v[128:143], v[200:203], v[176:179], v[128:143]
    buffer_load_dwordx4 a[188:191], v238, s[56:59], s100 offen offset:2048 sc1
    v_bfe_u32 v243, v233, 4, 1
    v_lshl_add_u32 v221, v243, 10, v242
    v_mul_f32 v245, 0xbfb8aa3b, v245
    v_mfma_f32_32x32x16_bf16 v[144:159], v[204:207], v[176:179], v[144:159]
    v_mul_f32 v247, 0xbfb8aa3b, v247
    v_mul_f32 v249, 0xbfb8aa3b, v249
    v_mul_f32 v251, 0xbfb8aa3b, v251
    v_mul_f32 v253, 0xbfb8aa3b, v253
    s_waitcnt lgkmcnt(0)
    v_mfma_f32_32x32x16_bf16 v[0:15], v[208:211], v[180:183], v[0:15]
    ds_read_b128 v[160:163], v241 offset:0
    v_mfma_f32_32x32x16_bf16 v[16:31], v[212:215], v[180:183], v[16:31]
    buffer_load_dwordx4 a[192:195], v238, s[56:59], s100 offen offset:3072 sc1
    v_mfma_f32_32x32x16_bf16 v[32:47], v[208:211], v[184:187], v[32:47]
    s_add_u32 s100, s100, 4096
    buffer_load_dwordx4 a[196:199], v238, s[56:59], s100 offen offset:0 sc1
    v_mfma_f32_32x32x16_bf16 v[48:63], v[212:215], v[184:187], v[48:63]
    ds_read_b128 v[164:167], v241 offset:32
    v_mfma_f32_32x32x16_bf16 v[64:79], v[208:211], v[188:191], v[64:79]
    s_add_u32 s100, s70, 0
    buffer_load_dwordx4 a[200:203], v238, s[56:59], s100 offen offset:0 sc1
    v_mfma_f32_32x32x16_bf16 v[80:95], v[212:215], v[188:191], v[80:95]
    ds_read_b128 v[168:171], v241 offset:64
    ds_read_b128 v[172:175], v241 offset:96
    v_mfma_f32_32x32x16_bf16 v[96:111], v[208:211], v[192:195], v[96:111]
    buffer_load_dwordx4 a[204:207], v238, s[56:59], s100 offen offset:1024 sc1
    v_mfma_f32_32x32x16_bf16 v[112:127], v[212:215], v[192:195], v[112:127]
    ds_read_b128 v[176:179], v241 offset:128
    ds_read_b128 v[200:203], v241 offset:160
    v_mfma_f32_32x32x16_bf16 v[128:143], v[208:211], v[196:199], v[128:143]
    buffer_load_dwordx4 a[208:211], v238, s[56:59], s100 offen offset:2048 sc1
    v_mfma_f32_32x32x16_bf16 v[144:159], v[212:215], v[196:199], v[144:159]
    ds_read_b128 v[204:207], v241 offset:192
    ds_read_b128 v[224:227], v241 offset:224
    s_waitcnt lgkmcnt(0)
    s_barrier
    v_pk_fma_f32 v[0:1], v[160:161], v[244:245], v[0:1] op_sel_hi:[1,0,1]
    v_pk_fma_f32 v[2:3], v[162:163], v[244:245], v[2:3] op_sel_hi:[1,0,1]
    v_pk_fma_f32 v[4:5], v[164:165], v[244:245], v[4:5] op_sel_hi:[1,0,1]
    v_pk_fma_f32 v[6:7], v[166:167], v[244:245], v[6:7] op_sel_hi:[1,0,1]
    v_pk_mul_f32 v[0:1], v[0:1], v[244:245] op_sel:[0,1] op_sel_hi:[1,1]
    v_pk_mul_f32 v[2:3], v[2:3], v[244:245] op_sel:[0,1] op_sel_hi:[1,1]
    v_pk_mul_f32 v[4:5], v[4:5], v[244:245] op_sel:[0,1] op_sel_hi:[1,1]
    v_pk_mul_f32 v[6:7], v[6:7], v[244:245] op_sel:[0,1] op_sel_hi:[1,1]
    v_exp_f32 v0, v0
    v_exp_f32 v1, v1
    v_exp_f32 v2, v2
    v_exp_f32 v3, v3
    v_exp_f32 v4, v4
    v_exp_f32 v5, v5
    v_exp_f32 v6, v6
    v_exp_f32 v7, v7
    buffer_load_dwordx4 a[212:215], v238, s[56:59], s100 offen offset:3072 sc1
    v_pk_fma_f32 v[16:17], v[176:177], v[244:245], v[16:17] op_sel_hi:[1,0,1]
    v_pk_fma_f32 v[18:19], v[178:179], v[244:245], v[18:19] op_sel_hi:[1,0,1]
    v_pk_fma_f32 v[20:21], v[200:201], v[244:245], v[20:21] op_sel_hi:[1,0,1]
    v_pk_fma_f32 v[22:23], v[202:203], v[244:245], v[22:23] op_sel_hi:[1,0,1]
    v_pk_fma_f32 v[0:1], v[0:1], v[228:229], v[228:229] op_sel:[0,0,0] op_sel_hi:[1,0,0]
    v_pk_fma_f32 v[2:3], v[2:3], v[228:229], v[228:229] op_sel:[0,0,0] op_sel_hi:[1,0,0]
    v_pk_fma_f32 v[4:5], v[4:5], v[228:229], v[228:229] op_sel:[0,0,0] op_sel_hi:[1,0,0]
    v_pk_fma_f32 v[6:7], v[6:7], v[228:229], v[228:229] op_sel:[0,0,0] op_sel_hi:[1,0,0]
    v_rcp_f32 v0, v0
    v_rcp_f32 v1, v1
    v_rcp_f32 v2, v2
    v_rcp_f32 v3, v3
    v_rcp_f32 v4, v4
    v_rcp_f32 v5, v5
    v_rcp_f32 v6, v6
    v_rcp_f32 v7, v7
    s_add_u32 s100, s100, 4096
    buffer_load_dwordx4 a[216:219], v238, s[56:59], s100 offen offset:0 sc1
    v_pk_mul_f32 v[16:17], v[16:17], v[0:1]
    v_pk_mul_f32 v[18:19], v[18:19], v[2:3]
    v_pk_mul_f32 v[20:21], v[20:21], v[4:5]
    v_pk_mul_f32 v[22:23], v[22:23], v[6:7]
    v_cvt_pk_bf16_f32 v180, v16, v17
    v_cvt_pk_bf16_f32 v181, v18, v19
    v_cvt_pk_bf16_f32 v182, v20, v21
    v_cvt_pk_bf16_f32 v183, v22, v23
    buffer_store_dwordx4 v[180:183], v221, s[52:55], s16 offen offset:0 sc1
    v_pk_fma_f32 v[8:9], v[168:169], v[244:245], v[8:9] op_sel_hi:[1,0,1]
    v_pk_fma_f32 v[10:11], v[170:171], v[244:245], v[10:11] op_sel_hi:[1,0,1]
    v_pk_fma_f32 v[12:13], v[172:173], v[244:245], v[12:13] op_sel_hi:[1,0,1]
    v_pk_fma_f32 v[14:15], v[174:175], v[244:245], v[14:15] op_sel_hi:[1,0,1]
    v_pk_mul_f32 v[8:9], v[8:9], v[244:245] op_sel:[0,1] op_sel_hi:[1,1]
    v_pk_mul_f32 v[10:11], v[10:11], v[244:245] op_sel:[0,1] op_sel_hi:[1,1]
    v_pk_mul_f32 v[12:13], v[12:13], v[244:245] op_sel:[0,1] op_sel_hi:[1,1]
    v_pk_mul_f32 v[14:15], v[14:15], v[244:245] op_sel:[0,1] op_sel_hi:[1,1]
    v_exp_f32 v8, v8
    v_exp_f32 v9, v9
    v_exp_f32 v10, v10
    v_exp_f32 v11, v11
    v_exp_f32 v12, v12
    v_exp_f32 v13, v13
    v_exp_f32 v14, v14
    v_exp_f32 v15, v15
    s_add_u32 s100, s70, 20480
    buffer_load_dwordx4 a[220:223], v238, s[56:59], s100 offen offset:0 sc1
    v_pk_fma_f32 v[24:25], v[204:205], v[244:245], v[24:25] op_sel_hi:[1,0,1]
    v_pk_fma_f32 v[26:27], v[206:207], v[244:245], v[26:27] op_sel_hi:[1,0,1]
    v_pk_fma_f32 v[28:29], v[224:225], v[244:245], v[28:29] op_sel_hi:[1,0,1]
    v_pk_fma_f32 v[30:31], v[226:227], v[244:245], v[30:31] op_sel_hi:[1,0,1]
    v_pk_fma_f32 v[8:9], v[8:9], v[228:229], v[228:229] op_sel:[0,0,0] op_sel_hi:[1,0,0]
    v_pk_fma_f32 v[10:11], v[10:11], v[228:229], v[228:229] op_sel:[0,0,0] op_sel_hi:[1,0,0]
    v_pk_fma_f32 v[12:13], v[12:13], v[228:229], v[228:229] op_sel:[0,0,0] op_sel_hi:[1,0,0]
    v_pk_fma_f32 v[14:15], v[14:15], v[228:229], v[228:229] op_sel:[0,0,0] op_sel_hi:[1,0,0]
    v_rcp_f32 v8, v8
    v_rcp_f32 v9, v9
    v_rcp_f32 v10, v10
    v_rcp_f32 v11, v11
    v_rcp_f32 v12, v12
    v_rcp_f32 v13, v13
    v_rcp_f32 v14, v14
    v_rcp_f32 v15, v15
    buffer_load_dwordx4 a[224:227], v238, s[56:59], s100 offen offset:1024 sc1
    v_pk_mul_f32 v[24:25], v[24:25], v[8:9]
    v_pk_mul_f32 v[26:27], v[26:27], v[10:11]
    v_pk_mul_f32 v[28:29], v[28:29], v[12:13]
    v_pk_mul_f32 v[30:31], v[30:31], v[14:15]
    v_cvt_pk_bf16_f32 v184, v24, v25
    v_cvt_pk_bf16_f32 v185, v26, v27
    v_cvt_pk_bf16_f32 v186, v28, v29
    v_cvt_pk_bf16_f32 v187, v30, v31
    buffer_store_dwordx4 v[184:187], v221, s[52:55], s16 offen offset:256 sc1
    v_pk_fma_f32 v[32:33], v[160:161], v[246:247], v[32:33] op_sel_hi:[1,0,1]
    v_pk_fma_f32 v[34:35], v[162:163], v[246:247], v[34:35] op_sel_hi:[1,0,1]
    v_pk_fma_f32 v[36:37], v[164:165], v[246:247], v[36:37] op_sel_hi:[1,0,1]
    v_pk_fma_f32 v[38:39], v[166:167], v[246:247], v[38:39] op_sel_hi:[1,0,1]
    v_pk_mul_f32 v[32:33], v[32:33], v[246:247] op_sel:[0,1] op_sel_hi:[1,1]
    v_pk_mul_f32 v[34:35], v[34:35], v[246:247] op_sel:[0,1] op_sel_hi:[1,1]
    v_pk_mul_f32 v[36:37], v[36:37], v[246:247] op_sel:[0,1] op_sel_hi:[1,1]
    v_pk_mul_f32 v[38:39], v[38:39], v[246:247] op_sel:[0,1] op_sel_hi:[1,1]
    v_exp_f32 v32, v32
    v_exp_f32 v33, v33
    v_exp_f32 v34, v34
    v_exp_f32 v35, v35
    v_exp_f32 v36, v36
    v_exp_f32 v37, v37
    v_exp_f32 v38, v38
    v_exp_f32 v39, v39
    buffer_load_dwordx4 a[228:231], v238, s[56:59], s100 offen offset:2048 sc1
    v_pk_fma_f32 v[48:49], v[176:177], v[246:247], v[48:49] op_sel_hi:[1,0,1]
    v_pk_fma_f32 v[50:51], v[178:179], v[246:247], v[50:51] op_sel_hi:[1,0,1]
    v_pk_fma_f32 v[52:53], v[200:201], v[246:247], v[52:53] op_sel_hi:[1,0,1]
    v_pk_fma_f32 v[54:55], v[202:203], v[246:247], v[54:55] op_sel_hi:[1,0,1]
    v_pk_fma_f32 v[32:33], v[32:33], v[228:229], v[228:229] op_sel:[0,1,1] op_sel_hi:[1,1,1]
    v_pk_fma_f32 v[34:35], v[34:35], v[228:229], v[228:229] op_sel:[0,1,1] op_sel_hi:[1,1,1]
    v_pk_fma_f32 v[36:37], v[36:37], v[228:229], v[228:229] op_sel:[0,1,1] op_sel_hi:[1,1,1]
    v_pk_fma_f32 v[38:39], v[38:39], v[228:229], v[228:229] op_sel:[0,1,1] op_sel_hi:[1,1,1]
    v_rcp_f32 v32, v32
    v_rcp_f32 v33, v33
    v_rcp_f32 v34, v34
    v_rcp_f32 v35, v35
    v_rcp_f32 v36, v36
    v_rcp_f32 v37, v37
    v_rcp_f32 v38, v38
    v_rcp_f32 v39, v39
    buffer_load_dwordx4 a[232:235], v238, s[56:59], s100 offen offset:3072 sc1
    v_pk_mul_f32 v[48:49], v[48:49], v[32:33]
    v_pk_mul_f32 v[50:51], v[50:51], v[34:35]
    v_pk_mul_f32 v[52:53], v[52:53], v[36:37]
    v_pk_mul_f32 v[54:55], v[54:55], v[38:39]
    v_cvt_pk_bf16_f32 v188, v48, v49
    v_cvt_pk_bf16_f32 v189, v50, v51
    v_cvt_pk_bf16_f32 v190, v52, v53
    v_cvt_pk_bf16_f32 v191, v54, v55
    buffer_store_dwordx4 v[188:191], v221, s[52:55], s17 offen offset:0 sc1
    v_pk_fma_f32 v[40:41], v[168:169], v[246:247], v[40:41] op_sel_hi:[1,0,1]
    v_pk_fma_f32 v[42:43], v[170:171], v[246:247], v[42:43] op_sel_hi:[1,0,1]
    v_pk_fma_f32 v[44:45], v[172:173], v[246:247], v[44:45] op_sel_hi:[1,0,1]
    v_pk_fma_f32 v[46:47], v[174:175], v[246:247], v[46:47] op_sel_hi:[1,0,1]
    v_pk_mul_f32 v[40:41], v[40:41], v[246:247] op_sel:[0,1] op_sel_hi:[1,1]
    v_pk_mul_f32 v[42:43], v[42:43], v[246:247] op_sel:[0,1] op_sel_hi:[1,1]
    v_pk_mul_f32 v[44:45], v[44:45], v[246:247] op_sel:[0,1] op_sel_hi:[1,1]
    v_pk_mul_f32 v[46:47], v[46:47], v[246:247] op_sel:[0,1] op_sel_hi:[1,1]
    v_exp_f32 v40, v40
    v_exp_f32 v41, v41
    v_exp_f32 v42, v42
    v_exp_f32 v43, v43
    v_exp_f32 v44, v44
    v_exp_f32 v45, v45
    v_exp_f32 v46, v46
    v_exp_f32 v47, v47
    s_add_u32 s100, s100, 4096
    buffer_load_dwordx4 a[236:239], v238, s[56:59], s100 offen offset:0 sc1
    v_pk_fma_f32 v[56:57], v[204:205], v[246:247], v[56:57] op_sel_hi:[1,0,1]
    v_pk_fma_f32 v[58:59], v[206:207], v[246:247], v[58:59] op_sel_hi:[1,0,1]
    v_pk_fma_f32 v[60:61], v[224:225], v[246:247], v[60:61] op_sel_hi:[1,0,1]
    v_pk_fma_f32 v[62:63], v[226:227], v[246:247], v[62:63] op_sel_hi:[1,0,1]
    v_pk_fma_f32 v[40:41], v[40:41], v[228:229], v[228:229] op_sel:[0,1,1] op_sel_hi:[1,1,1]
    v_pk_fma_f32 v[42:43], v[42:43], v[228:229], v[228:229] op_sel:[0,1,1] op_sel_hi:[1,1,1]
    v_pk_fma_f32 v[44:45], v[44:45], v[228:229], v[228:229] op_sel:[0,1,1] op_sel_hi:[1,1,1]
    v_pk_fma_f32 v[46:47], v[46:47], v[228:229], v[228:229] op_sel:[0,1,1] op_sel_hi:[1,1,1]
    v_rcp_f32 v40, v40
    v_rcp_f32 v41, v41
    v_rcp_f32 v42, v42
    v_rcp_f32 v43, v43
    v_rcp_f32 v44, v44
    v_rcp_f32 v45, v45
    v_rcp_f32 v46, v46
    v_rcp_f32 v47, v47
    s_add_u32 m0, s6, 16384
    s_add_u32 s100, s70, 81920
    buffer_load_dwordx4 v238, s[56:59], s100 offen offset:0 sc1 lds
    v_pk_mul_f32 v[56:57], v[56:57], v[40:41]
    v_pk_mul_f32 v[58:59], v[58:59], v[42:43]
    v_pk_mul_f32 v[60:61], v[60:61], v[44:45]
    v_pk_mul_f32 v[62:63], v[62:63], v[46:47]
    v_cvt_pk_bf16_f32 v192, v56, v57
    v_cvt_pk_bf16_f32 v193, v58, v59
    v_cvt_pk_bf16_f32 v194, v60, v61
    v_cvt_pk_bf16_f32 v195, v62, v63
    buffer_store_dwordx4 v[192:195], v221, s[52:55], s17 offen offset:256 sc1
    v_pk_fma_f32 v[64:65], v[160:161], v[248:249], v[64:65] op_sel_hi:[1,0,1]
    v_pk_fma_f32 v[66:67], v[162:163], v[248:249], v[66:67] op_sel_hi:[1,0,1]
    v_pk_fma_f32 v[68:69], v[164:165], v[248:249], v[68:69] op_sel_hi:[1,0,1]
    v_pk_fma_f32 v[70:71], v[166:167], v[248:249], v[70:71] op_sel_hi:[1,0,1]
    v_pk_mul_f32 v[64:65], v[64:65], v[248:249] op_sel:[0,1] op_sel_hi:[1,1]
    v_pk_mul_f32 v[66:67], v[66:67], v[248:249] op_sel:[0,1] op_sel_hi:[1,1]
    v_pk_mul_f32 v[68:69], v[68:69], v[248:249] op_sel:[0,1] op_sel_hi:[1,1]
    v_pk_mul_f32 v[70:71], v[70:71], v[248:249] op_sel:[0,1] op_sel_hi:[1,1]
    v_exp_f32 v64, v64
    v_exp_f32 v65, v65
    v_exp_f32 v66, v66
    v_exp_f32 v67, v67
    v_exp_f32 v68, v68
    v_exp_f32 v69, v69
    v_exp_f32 v70, v70
    v_exp_f32 v71, v71
    buffer_load_dwordx4 v238, s[56:59], s100 offen offset:1024 sc1 lds
    v_pk_fma_f32 v[80:81], v[176:177], v[248:249], v[80:81] op_sel_hi:[1,0,1]
    v_pk_fma_f32 v[82:83], v[178:179], v[248:249], v[82:83] op_sel_hi:[1,0,1]
    v_pk_fma_f32 v[84:85], v[200:201], v[248:249], v[84:85] op_sel_hi:[1,0,1]
    v_pk_fma_f32 v[86:87], v[202:203], v[248:249], v[86:87] op_sel_hi:[1,0,1]
    v_pk_fma_f32 v[64:65], v[64:65], v[222:223], v[222:223] op_sel:[0,0,0] op_sel_hi:[1,0,0]
    v_pk_fma_f32 v[66:67], v[66:67], v[222:223], v[222:223] op_sel:[0,0,0] op_sel_hi:[1,0,0]
    v_pk_fma_f32 v[68:69], v[68:69], v[222:223], v[222:223] op_sel:[0,0,0] op_sel_hi:[1,0,0]
    v_pk_fma_f32 v[70:71], v[70:71], v[222:223], v[222:223] op_sel:[0,0,0] op_sel_hi:[1,0,0]
    v_rcp_f32 v64, v64
    v_rcp_f32 v65, v65
    v_rcp_f32 v66, v66
    v_rcp_f32 v67, v67
    v_rcp_f32 v68, v68
    v_rcp_f32 v69, v69
    v_rcp_f32 v70, v70
    v_rcp_f32 v71, v71
    buffer_load_dwordx4 v238, s[56:59], s100 offen offset:2048 sc1 lds
    v_pk_mul_f32 v[80:81], v[80:81], v[64:65]
    v_pk_mul_f32 v[82:83], v[82:83], v[66:67]
    v_pk_mul_f32 v[84:85], v[84:85], v[68:69]
    v_pk_mul_f32 v[86:87], v[86:87], v[70:71]
    v_cvt_pk_bf16_f32 v180, v80, v81
    v_cvt_pk_bf16_f32 v181, v82, v83
    v_cvt_pk_bf16_f32 v182, v84, v85
    v_cvt_pk_bf16_f32 v183, v86, v87
    buffer_store_dwordx4 v[180:183], v221, s[52:55], s18 offen offset:0 sc1
    v_pk_fma_f32 v[72:73], v[168:169], v[248:249], v[72:73] op_sel_hi:[1,0,1]
    v_pk_fma_f32 v[74:75], v[170:171], v[248:249], v[74:75] op_sel_hi:[1,0,1]
    v_pk_fma_f32 v[76:77], v[172:173], v[248:249], v[76:77] op_sel_hi:[1,0,1]
    v_pk_fma_f32 v[78:79], v[174:175], v[248:249], v[78:79] op_sel_hi:[1,0,1]
    v_pk_mul_f32 v[72:73], v[72:73], v[248:249] op_sel:[0,1] op_sel_hi:[1,1]
    v_pk_mul_f32 v[74:75], v[74:75], v[248:249] op_sel:[0,1] op_sel_hi:[1,1]
    v_pk_mul_f32 v[76:77], v[76:77], v[248:249] op_sel:[0,1] op_sel_hi:[1,1]
    v_pk_mul_f32 v[78:79], v[78:79], v[248:249] op_sel:[0,1] op_sel_hi:[1,1]
    v_exp_f32 v72, v72
    v_exp_f32 v73, v73
    v_exp_f32 v74, v74
    v_exp_f32 v75, v75
    v_exp_f32 v76, v76
    v_exp_f32 v77, v77
    v_exp_f32 v78, v78
    v_exp_f32 v79, v79
    buffer_load_dwordx4 v238, s[56:59], s100 offen offset:3072 sc1 lds
    v_pk_fma_f32 v[88:89], v[204:205], v[248:249], v[88:89] op_sel_hi:[1,0,1]
    v_pk_fma_f32 v[90:91], v[206:207], v[248:249], v[90:91] op_sel_hi:[1,0,1]
    v_pk_fma_f32 v[92:93], v[224:225], v[248:249], v[92:93] op_sel_hi:[1,0,1]
    v_pk_fma_f32 v[94:95], v[226:227], v[248:249], v[94:95] op_sel_hi:[1,0,1]
    v_pk_fma_f32 v[72:73], v[72:73], v[222:223], v[222:223] op_sel:[0,0,0] op_sel_hi:[1,0,0]
    v_pk_fma_f32 v[74:75], v[74:75], v[222:223], v[222:223] op_sel:[0,0,0] op_sel_hi:[1,0,0]
    v_pk_fma_f32 v[76:77], v[76:77], v[222:223], v[222:223] op_sel:[0,0,0] op_sel_hi:[1,0,0]
    v_pk_fma_f32 v[78:79], v[78:79], v[222:223], v[222:223] op_sel:[0,0,0] op_sel_hi:[1,0,0]
    v_rcp_f32 v72, v72
    v_rcp_f32 v73, v73
    v_rcp_f32 v74, v74
    v_rcp_f32 v75, v75
    v_rcp_f32 v76, v76
    v_rcp_f32 v77, v77
    v_rcp_f32 v78, v78
    v_rcp_f32 v79, v79
    s_add_u32 m0, s6, 20480
    s_add_u32 s100, s100, 4096
    buffer_load_dwordx4 v238, s[56:59], s100 offen offset:0 sc1 lds
    v_pk_mul_f32 v[88:89], v[88:89], v[72:73]
    v_pk_mul_f32 v[90:91], v[90:91], v[74:75]
    v_pk_mul_f32 v[92:93], v[92:93], v[76:77]
    v_pk_mul_f32 v[94:95], v[94:95], v[78:79]
    v_cvt_pk_bf16_f32 v184, v88, v89
    v_cvt_pk_bf16_f32 v185, v90, v91
    v_cvt_pk_bf16_f32 v186, v92, v93
    v_cvt_pk_bf16_f32 v187, v94, v95
    buffer_store_dwordx4 v[184:187], v221, s[52:55], s18 offen offset:256 sc1
    v_pk_fma_f32 v[96:97], v[160:161], v[250:251], v[96:97] op_sel_hi:[1,0,1]
    v_pk_fma_f32 v[98:99], v[162:163], v[250:251], v[98:99] op_sel_hi:[1,0,1]
    v_pk_fma_f32 v[100:101], v[164:165], v[250:251], v[100:101] op_sel_hi:[1,0,1]
    v_pk_fma_f32 v[102:103], v[166:167], v[250:251], v[102:103] op_sel_hi:[1,0,1]
    v_pk_mul_f32 v[96:97], v[96:97], v[250:251] op_sel:[0,1] op_sel_hi:[1,1]
    v_pk_mul_f32 v[98:99], v[98:99], v[250:251] op_sel:[0,1] op_sel_hi:[1,1]
    v_pk_mul_f32 v[100:101], v[100:101], v[250:251] op_sel:[0,1] op_sel_hi:[1,1]
    v_pk_mul_f32 v[102:103], v[102:103], v[250:251] op_sel:[0,1] op_sel_hi:[1,1]
    v_exp_f32 v96, v96
    v_exp_f32 v97, v97
    v_exp_f32 v98, v98
    v_exp_f32 v99, v99
    v_exp_f32 v100, v100
    v_exp_f32 v101, v101
    v_exp_f32 v102, v102
    v_exp_f32 v103, v103
    s_add_u32 m0, s71, 20480
    s_add_u32 s100, s70, 102400
    buffer_load_dwordx4 v238, s[56:59], s100 offen offset:0 sc1 lds
    v_pk_fma_f32 v[112:113], v[176:177], v[250:251], v[112:113] op_sel_hi:[1,0,1]
    v_pk_fma_f32 v[114:115], v[178:179], v[250:251], v[114:115] op_sel_hi:[1,0,1]
    v_pk_fma_f32 v[116:117], v[200:201], v[250:251], v[116:117] op_sel_hi:[1,0,1]
    v_pk_fma_f32 v[118:119], v[202:203], v[250:251], v[118:119] op_sel_hi:[1,0,1]
    v_pk_fma_f32 v[96:97], v[96:97], v[222:223], v[222:223] op_sel:[0,1,1] op_sel_hi:[1,1,1]
    v_pk_fma_f32 v[98:99], v[98:99], v[222:223], v[222:223] op_sel:[0,1,1] op_sel_hi:[1,1,1]
    v_pk_fma_f32 v[100:101], v[100:101], v[222:223], v[222:223] op_sel:[0,1,1] op_sel_hi:[1,1,1]
    v_pk_fma_f32 v[102:103], v[102:103], v[222:223], v[222:223] op_sel:[0,1,1] op_sel_hi:[1,1,1]
    v_rcp_f32 v96, v96
    v_rcp_f32 v97, v97
    v_rcp_f32 v98, v98
    v_rcp_f32 v99, v99
    v_rcp_f32 v100, v100
    v_rcp_f32 v101, v101
    v_rcp_f32 v102, v102
    v_rcp_f32 v103, v103
    buffer_load_dwordx4 v238, s[56:59], s100 offen offset:1024 sc1 lds
    v_pk_mul_f32 v[112:113], v[112:113], v[96:97]
    v_pk_mul_f32 v[114:115], v[114:115], v[98:99]
    v_pk_mul_f32 v[116:117], v[116:117], v[100:101]
    v_pk_mul_f32 v[118:119], v[118:119], v[102:103]
    v_cvt_pk_bf16_f32 v188, v112, v113
    v_cvt_pk_bf16_f32 v189, v114, v115
    v_cvt_pk_bf16_f32 v190, v116, v117
    v_cvt_pk_bf16_f32 v191, v118, v119
    buffer_store_dwordx4 v[188:191], v221, s[52:55], s19 offen offset:0 sc1
    v_pk_fma_f32 v[104:105], v[168:169], v[250:251], v[104:105] op_sel_hi:[1,0,1]
    v_pk_fma_f32 v[106:107], v[170:171], v[250:251], v[106:107] op_sel_hi:[1,0,1]
    v_pk_fma_f32 v[108:109], v[172:173], v[250:251], v[108:109] op_sel_hi:[1,0,1]
    v_pk_fma_f32 v[110:111], v[174:175], v[250:251], v[110:111] op_sel_hi:[1,0,1]
    v_pk_mul_f32 v[104:105], v[104:105], v[250:251] op_sel:[0,1] op_sel_hi:[1,1]
    v_pk_mul_f32 v[106:107], v[106:107], v[250:251] op_sel:[0,1] op_sel_hi:[1,1]
    v_pk_mul_f32 v[108:109], v[108:109], v[250:251] op_sel:[0,1] op_sel_hi:[1,1]
    v_pk_mul_f32 v[110:111], v[110:111], v[250:251] op_sel:[0,1] op_sel_hi:[1,1]
    v_exp_f32 v104, v104
    v_exp_f32 v105, v105
    v_exp_f32 v106, v106
    v_exp_f32 v107, v107
    v_exp_f32 v108, v108
    v_exp_f32 v109, v109
    v_exp_f32 v110, v110
    v_exp_f32 v111, v111
    buffer_load_dwordx4 v238, s[56:59], s100 offen offset:2048 sc1 lds
    v_pk_fma_f32 v[120:121], v[204:205], v[250:251], v[120:121] op_sel_hi:[1,0,1]
    v_pk_fma_f32 v[122:123], v[206:207], v[250:251], v[122:123] op_sel_hi:[1,0,1]
    v_pk_fma_f32 v[124:125], v[224:225], v[250:251], v[124:125] op_sel_hi:[1,0,1]
    v_pk_fma_f32 v[126:127], v[226:227], v[250:251], v[126:127] op_sel_hi:[1,0,1]
    v_pk_fma_f32 v[104:105], v[104:105], v[222:223], v[222:223] op_sel:[0,1,1] op_sel_hi:[1,1,1]
    v_pk_fma_f32 v[106:107], v[106:107], v[222:223], v[222:223] op_sel:[0,1,1] op_sel_hi:[1,1,1]
    v_pk_fma_f32 v[108:109], v[108:109], v[222:223], v[222:223] op_sel:[0,1,1] op_sel_hi:[1,1,1]
    v_pk_fma_f32 v[110:111], v[110:111], v[222:223], v[222:223] op_sel:[0,1,1] op_sel_hi:[1,1,1]
    v_rcp_f32 v104, v104
    v_rcp_f32 v105, v105
    v_rcp_f32 v106, v106
    v_rcp_f32 v107, v107
    v_rcp_f32 v108, v108
    v_rcp_f32 v109, v109
    v_rcp_f32 v110, v110
    v_rcp_f32 v111, v111
    buffer_load_dwordx4 v238, s[56:59], s100 offen offset:3072 sc1 lds
    v_pk_mul_f32 v[120:121], v[120:121], v[104:105]
    v_pk_mul_f32 v[122:123], v[122:123], v[106:107]
    v_pk_mul_f32 v[124:125], v[124:125], v[108:109]
    v_pk_mul_f32 v[126:127], v[126:127], v[110:111]
    v_cvt_pk_bf16_f32 v192, v120, v121
    v_cvt_pk_bf16_f32 v193, v122, v123
    v_cvt_pk_bf16_f32 v194, v124, v125
    v_cvt_pk_bf16_f32 v195, v126, v127
    buffer_store_dwordx4 v[192:195], v221, s[52:55], s19 offen offset:256 sc1
    v_pk_fma_f32 v[128:129], v[160:161], v[252:253], v[128:129] op_sel_hi:[1,0,1]
    v_pk_fma_f32 v[130:131], v[162:163], v[252:253], v[130:131] op_sel_hi:[1,0,1]
    v_pk_fma_f32 v[132:133], v[164:165], v[252:253], v[132:133] op_sel_hi:[1,0,1]
    v_pk_fma_f32 v[134:135], v[166:167], v[252:253], v[134:135] op_sel_hi:[1,0,1]
    v_pk_mul_f32 v[128:129], v[128:129], v[252:253] op_sel:[0,1] op_sel_hi:[1,1]
    v_pk_mul_f32 v[130:131], v[130:131], v[252:253] op_sel:[0,1] op_sel_hi:[1,1]
    v_pk_mul_f32 v[132:133], v[132:133], v[252:253] op_sel:[0,1] op_sel_hi:[1,1]
    v_pk_mul_f32 v[134:135], v[134:135], v[252:253] op_sel:[0,1] op_sel_hi:[1,1]
    v_exp_f32 v128, v128
    v_exp_f32 v129, v129
    v_exp_f32 v130, v130
    v_exp_f32 v131, v131
    v_exp_f32 v132, v132
    v_exp_f32 v133, v133
    v_exp_f32 v134, v134
    v_exp_f32 v135, v135
    s_add_u32 m0, s71, 24576
    s_add_u32 s100, s100, 4096
    buffer_load_dwordx4 v238, s[56:59], s100 offen offset:0 sc1 lds
    v_pk_fma_f32 v[144:145], v[176:177], v[252:253], v[144:145] op_sel_hi:[1,0,1]
    v_pk_fma_f32 v[146:147], v[178:179], v[252:253], v[146:147] op_sel_hi:[1,0,1]
    v_pk_fma_f32 v[148:149], v[200:201], v[252:253], v[148:149] op_sel_hi:[1,0,1]
    v_pk_fma_f32 v[150:151], v[202:203], v[252:253], v[150:151] op_sel_hi:[1,0,1]
    v_pk_fma_f32 v[128:129], v[128:129], v[234:235], v[234:235] op_sel:[0,0,0] op_sel_hi:[1,0,0]
    v_pk_fma_f32 v[130:131], v[130:131], v[234:235], v[234:235] op_sel:[0,0,0] op_sel_hi:[1,0,0]
    v_pk_fma_f32 v[132:133], v[132:133], v[234:235], v[234:235] op_sel:[0,0,0] op_sel_hi:[1,0,0]
    v_pk_fma_f32 v[134:135], v[134:135], v[234:235], v[234:235] op_sel:[0,0,0] op_sel_hi:[1,0,0]
    v_rcp_f32 v128, v128
    v_rcp_f32 v129, v129
    v_rcp_f32 v130, v130
    v_rcp_f32 v131, v131
    v_rcp_f32 v132, v132
    v_rcp_f32 v133, v133
    v_rcp_f32 v134, v134
    v_rcp_f32_e64 v135, v135
    s_add_u32 m0, s6, 0
    s_add_u32 s100, s70, 122880
    buffer_load_dwordx4 v238, s[56:59], s100 offen offset:0 sc1 lds
    v_pk_mul_f32 v[144:145], v[144:145], v[128:129]
    v_pk_mul_f32 v[146:147], v[146:147], v[130:131]
    v_pk_mul_f32 v[148:149], v[148:149], v[132:133]
    v_pk_mul_f32 v[150:151], v[150:151], v[134:135]
    v_cvt_pk_bf16_f32 v180, v144, v145
    v_cvt_pk_bf16_f32 v181, v146, v147
    v_cvt_pk_bf16_f32 v182, v148, v149
    v_cvt_pk_bf16_f32 v183, v150, v151
    buffer_store_dwordx4 v[180:183], v221, s[52:55], s20 offen offset:0 sc1
    v_pk_fma_f32 v[136:137], v[168:169], v[252:253], v[136:137] op_sel_hi:[1,0,1]
    v_pk_fma_f32 v[138:139], v[170:171], v[252:253], v[138:139] op_sel_hi:[1,0,1]
    v_pk_fma_f32 v[140:141], v[172:173], v[252:253], v[140:141] op_sel_hi:[1,0,1]
    v_pk_fma_f32 v[142:143], v[174:175], v[252:253], v[142:143] op_sel_hi:[1,0,1]
    v_pk_mul_f32 v[136:137], v[136:137], v[252:253] op_sel:[0,1] op_sel_hi:[1,1]
    v_pk_mul_f32 v[138:139], v[138:139], v[252:253] op_sel:[0,1] op_sel_hi:[1,1]
    v_pk_mul_f32 v[140:141], v[140:141], v[252:253] op_sel:[0,1] op_sel_hi:[1,1]
    v_pk_mul_f32 v[142:143], v[142:143], v[252:253] op_sel:[0,1] op_sel_hi:[1,1]
    v_exp_f32 v136, v136
    v_exp_f32 v137, v137
    v_exp_f32 v138, v138
    v_exp_f32 v139, v139
    v_exp_f32 v140, v140
    v_exp_f32 v141, v141
    v_exp_f32 v142, v142
    v_exp_f32 v143, v143
    buffer_load_dwordx4 v238, s[56:59], s100 offen offset:1024 sc1 lds
    v_pk_fma_f32 v[152:153], v[204:205], v[252:253], v[152:153] op_sel_hi:[1,0,1]
    v_pk_fma_f32 v[154:155], v[206:207], v[252:253], v[154:155] op_sel_hi:[1,0,1]
    v_pk_fma_f32 v[156:157], v[224:225], v[252:253], v[156:157] op_sel_hi:[1,0,1]
    v_pk_fma_f32 v[158:159], v[226:227], v[252:253], v[158:159] op_sel_hi:[1,0,1]
    v_pk_fma_f32 v[136:137], v[136:137], v[234:235], v[234:235] op_sel:[0,0,0] op_sel_hi:[1,0,0]
    v_pk_fma_f32 v[138:139], v[138:139], v[234:235], v[234:235] op_sel:[0,0,0] op_sel_hi:[1,0,0]
    v_pk_fma_f32 v[140:141], v[140:141], v[234:235], v[234:235] op_sel:[0,0,0] op_sel_hi:[1,0,0]
    v_pk_fma_f32 v[142:143], v[142:143], v[234:235], v[234:235] op_sel:[0,0,0] op_sel_hi:[1,0,0]
    v_rcp_f32 v136, v136
    v_rcp_f32 v137, v137
    v_rcp_f32 v138, v138
    v_rcp_f32 v139, v139
    v_rcp_f32 v140, v140
    v_rcp_f32 v141, v141
    v_rcp_f32 v142, v142
    v_rcp_f32 v143, v143
    buffer_load_dwordx4 v238, s[56:59], s100 offen offset:2048 sc1 lds
    v_pk_mul_f32 v[152:153], v[152:153], v[136:137]
    v_pk_mul_f32 v[154:155], v[154:155], v[138:139]
    v_pk_mul_f32 v[156:157], v[156:157], v[140:141]
    v_pk_mul_f32 v[158:159], v[158:159], v[142:143]
    v_cvt_pk_bf16_f32 v184, v152, v153
    v_cvt_pk_bf16_f32 v185, v154, v155
    v_cvt_pk_bf16_f32 v186, v156, v157
    v_cvt_pk_bf16_f32 v187, v158, v159
    buffer_store_dwordx4 v[184:187], v221, s[52:55], s20 offen offset:256 sc1
    buffer_load_dwordx4 v238, s[56:59], s100 offen offset:3072 sc1 lds
    s_add_u32 m0, s6, 4096
    s_add_u32 s100, s100, 4096
    buffer_load_dwordx4 v238, s[56:59], s100 offen offset:0 sc1 lds
    s_add_u32 s100, s70, 40960
    buffer_load_dwordx4 v[160:163], v238, s[56:59], s100 offen offset:0 sc1
    buffer_load_dwordx4 v[164:167], v238, s[56:59], s100 offen offset:1024 sc1
    v_mov_b32 v239, s83
    s_mov_b64 exec, 1
    s_waitcnt vmcnt(4)
    buffer_store_dword v239, off, s[56:59], s67 sc1
    s_mov_b64 exec, -1
    s_mov_b32 s48, s24
    s_mov_b32 s49, s25
    s_mov_b32 s50, 1280
    s_mov_b32 s51, 0x20000
    s_lshl_b32 s73, s4, 6
    s_lshl_b32 s75, s64, 2
    s_mul_i32 s74, s5, 20
    s_add_u32 s73, s73, s75
    s_mul_i32 s75, s64, 1344
    v_lshrrev_b32 v239, 4, v233
    v_and_b32 v240, 15, v233
    v_mul_u32_u24 v241, 336, v239
    v_lshl_add_u32 v241, v240, 4, v241
    v_add_u32 v222, s75, v241
    v_add_u32 v239, s73, v239
    v_add_u32 v240, s74, v240
    v_mul_u32_u24 v241, 160, v239
    v_add_u32 v241, v241, v240
    v_lshlrev_b32 v220, 4, v241
    v_lshlrev_b32 v241, 3, v241
    v_lshlrev_b32 v240, 3, v240
    s_mov_b32 s76, 0
    buffer_load_dwordx2 v[0:1], v241, s[40:43], s76 offen
    s_mov_b32 s76, 20480
    buffer_load_dwordx2 v[2:3], v241, s[40:43], s76 offen
    s_mov_b32 s76, 40960
    buffer_load_dwordx2 v[4:5], v241, s[40:43], s76 offen
    s_mov_b32 s76, 61440
    buffer_load_dwordx2 v[6:7], v241, s[40:43], s76 offen
    buffer_load_dwordx2 v[10:11], v240, s[48:51], 0 offen
    v_and_b32 v239, 48, v233
    v_bfe_u32 v240, v233, 2, 2
    v_add_u32 v239, v239, v240
    v_and_b32 v240, 3, v233
    v_add_u32 v240, 16, v240
    v_mul_u32_u24 v241, 336, v239
    v_lshl_add_u32 v241, v240, 4, v241
    v_add_u32 v224, s75, v241
    v_add_u32 v239, s73, v239
    v_add_u32 v240, s74, v240
    v_mul_u32_u24 v241, 160, v239
    v_add_u32 v241, v241, v240
    v_lshlrev_b32 v221, 4, v241
    v_lshlrev_b32 v241, 3, v241
    v_lshlrev_b32 v240, 3, v240
    buffer_load_dwordx2 v[8:9], v241, s[40:43], 0 offen
    v_lshlrev_b32 v239, 3, v239
    s_mov_b32 s76, 4194304
    buffer_load_dwordx2 v[14:15], v239, s[56:59], s76 offen sc1
    buffer_load_dwordx2 v[12:13], v240, s[48:51], 0 offen
    s_mov_b32 s44, s34
    s_mov_b32 s45, s35
    s_mov_b32 s46, 5242880
    s_mov_b32 s47, 0x20000
    v_add_u32 v223, 43008, v222
    s_mul_i32 s75, s64, 21504
    v_and_b32 v230, 15, v233
    v_mul_u32_u24 v230, 336, v230
    v_and_b32 v239, 48, v233
    v_add3_u32 v230, v230, v239, s75
    buffer_load_dwordx4 v[168:171], v238, s[56:59], s100 offen offset:2048 sc1
    buffer_load_dwordx4 v[172:175], v238, s[56:59], s100 offen offset:3072 sc1
    s_add_u32 s100, s100, 4096
    buffer_load_dwordx4 v[176:179], v238, s[56:59], s100 offen offset:0 sc1
    s_add_u32 s100, s70, 61440
    buffer_load_dwordx4 v[180:183], v238, s[56:59], s100 offen offset:0 sc1
    buffer_load_dwordx4 v[184:187], v238, s[56:59], s100 offen offset:1024 sc1
    buffer_load_dwordx4 v[188:191], v238, s[56:59], s100 offen offset:2048 sc1
    buffer_load_dwordx4 v[192:195], v238, s[56:59], s100 offen offset:3072 sc1
    s_add_u32 s100, s100, 4096
    buffer_load_dwordx4 v[196:199], v238, s[56:59], s100 offen offset:0 sc1
    s_add_u32 m0, s71, 40960
    s_add_u32 s100, s70, 143360
    buffer_load_dwordx4 v238, s[56:59], s100 offen offset:0 sc1 lds
    buffer_load_dwordx4 v238, s[56:59], s100 offen offset:1024 sc1 lds
    buffer_load_dwordx4 v238, s[56:59], s100 offen offset:2048 sc1 lds
    buffer_load_dwordx4 v238, s[56:59], s100 offen offset:3072 sc1 lds
    s_add_u32 m0, s71, 45056
    s_add_u32 s100, s100, 4096
    buffer_load_dwordx4 v238, s[56:59], s100 offen offset:0 sc1 lds
    s_add_u32 m0, s6, 32768
    s_add_u32 s100, s70, 163840
    buffer_load_dwordx4 v238, s[56:59], s100 offen offset:0 sc1 lds
    buffer_load_dwordx4 v238, s[56:59], s100 offen offset:1024 sc1 lds
    buffer_load_dwordx4 v238, s[56:59], s100 offen offset:2048 sc1 lds
    buffer_load_dwordx4 v238, s[56:59], s100 offen offset:3072 sc1 lds
    s_add_u32 m0, s6, 36864
    s_add_u32 s100, s100, 4096
    buffer_load_dwordx4 v238, s[56:59], s100 offen offset:0 sc1 lds
    s_add_u32 m0, s71, 0
    s_nop 0
    s_add_u32 s100, s70, 184320
    buffer_load_dwordx4 v238, s[56:59], s100 offen offset:0 sc1 lds
    buffer_load_dwordx4 v238, s[56:59], s100 offen offset:1024 sc1 lds
    buffer_load_dwordx4 v238, s[56:59], s100 offen offset:2048 sc1 lds
    buffer_load_dwordx4 v238, s[56:59], s100 offen offset:3072 sc1 lds
    s_add_u32 m0, s71, 4096
    s_add_u32 s100, s100, 4096
    buffer_load_dwordx4 v238, s[56:59], s100 offen offset:0 sc1 lds
    s_add_u32 m0, s6, 21504
    s_add_u32 s100, s70, 204800
    buffer_load_dwordx4 v238, s[56:59], s100 offen offset:0 sc1 lds
    buffer_load_dwordx4 v238, s[56:59], s100 offen offset:1024 sc1 lds
    buffer_load_dwordx4 v238, s[56:59], s100 offen offset:2048 sc1 lds
    s_add_u32 m0, s6, 2048
    s_nop 0
    buffer_load_dwordx4 v238, s[56:59], s100 offen offset:3072 sc1 lds
    s_add_u32 m0, s6, 6144
    s_add_u32 s100, s100, 4096
    buffer_load_dwordx4 v238, s[56:59], s100 offen offset:0 sc1 lds
    s_branch L_p2_g
L_ssm2:
    s_mov_b32 s60, s36
    s_mov_b32 s61, s37
    s_mov_b32 s62, 256
    s_mov_b32 s63, 0x20000
    s_add_u32 s52, s38, 0
    s_addc_u32 s53, s39, 0
    s_mov_b32 s54, 12320768
    s_mov_b32 s55, 0x20000
    s_add_u32 s56, s38, 16777216
    s_addc_u32 s57, s39, 0
    s_mov_b32 s58, 5242880
    s_mov_b32 s59, 0x20000
    s_lshl_b32 s73, s2, 4
    s_add_u32 s73, s73, 4259840
    s_and_b32 s74, s2, 7
    s_or_b32 s74, s74, s64
    s_cselect_b32 s73, 134217728, s73
    buffer_load_dword a255, off, s[56:59], s73
    v_bfe_u32 v5, v233, 3, 2
    v_mul_u32_u24 v5, 5120, v5
    v_lshl_add_u32 v5, v3, 7, v5
    v_bfe_u32 v6, v233, 1, 3
    v_xor_b32 v6, v6, v7
    v_xor_b32 v8, 0, v6
    v_lshl_add_u32 v216, v8, 4, v5
    v_xor_b32 v8, 2, v6
    v_lshl_add_u32 v217, v8, 4, v5
    v_xor_b32 v8, 4, v6
    v_lshl_add_u32 v218, v8, 4, v5
    v_xor_b32 v8, 6, v6
    v_lshl_add_u32 v219, v8, 4, v5
    buffer_load_dwordx4 v230, s[48:51], s68 offen offset:1024 lds
    buffer_load_dwordx4 v231, s[48:51], s68 offen offset:2048 lds
    buffer_load_dwordx4 v232, s[48:51], s68 offen offset:3072 lds
    s_waitcnt lgkmcnt(0)
    s_or_b32 s73, s2, s64
    s_cselect_b32 s73, 0x1000, 0
    s_or_b32 s75, s98, 1
    v_mov_b32 v12, s75
    v_mov_b32 v13, s73
    v_mov_b32 v14, 0
    s_mov_b64 exec, 1
    buffer_store_dword v12, v13, s[60:63], 0 offen sc1
    s_mov_b64 exec, -1
    v_and_b32 v12, 31, v233
    v_add_u32 v13, s77, v12
    v_lshlrev_b32 v13, 1, v13
    global_load_ushort v244, v13, s[10:11]
    global_load_ushort v245, v13, s[12:13]
    global_load_ushort v246, v13, s[22:23]
    v_lshl_add_u32 v9, v12, 7, s72
    s_lshl_b32 s73, s64, 10
    v_xor_b32 v10, 0, v6
    v_lshl_add_u32 v220, v10, 4, v9
    v_add_u32 v140, s73, v216
    v_xor_b32 v10, 2, v6
    v_lshl_add_u32 v221, v10, 4, v9
    v_add_u32 v141, s73, v217
    v_xor_b32 v10, 4, v6
    v_lshl_add_u32 v222, v10, 4, v9
    v_add_u32 v142, s73, v218
    v_xor_b32 v10, 6, v6
    v_lshl_add_u32 v223, v10, 4, v9
    v_add_u32 v143, s73, v219
    s_lshl_b32 s67, s65, 5
    s_add_u32 s67, s67, s78
    s_lshl_b32 s67, s67, 5
    s_add_u32 s67, s67, 5079040
    s_mov_b32 s6, s72
    s_and_b32 s73, s2, 6
    s_lshl_b32 s73, s73, 2
    s_lshr_b32 s74, s2, 5
    s_add_u32 s4, s73, s74
    s_and_b32 s73, s2, 1
    s_lshl_b32 s73, s73, 2
    s_bfe_u32 s5, s2, 0x20003
    s_add_u32 s5, s5, s73
    s_mul_i32 s73, s4, 94
    s_add_u32 s69, s73, s64
    s_lshl_b32 s69, s69, 12
    s_and_b32 s74, s64, 2
    s_add_u32 s74, s74, 54
    s_lshl_b32 s74, s74, 12
    s_add_u32 s99, s69, s74
    s_mul_i32 s70, s5, 481280
    s_mul_i32 s73, s64, 5120
    s_add_u32 s70, s70, s73
    s_cmp_ge_u32 s64, 2
    s_cselect_b32 s7, 134217728, 0
    s_lshl_b32 s29, s64, 10
    s_and_b32 s74, s64, 2
    s_add_u32 s74, s74, 54
    s_mul_i32 s74, s74, 5120
    s_add_u32 s9, s70, s74
    s_bitcmp1_b32 s64, 0
    s_cselect_b32 s92, s20, s18
    s_cselect_b32 s93, s21, s19
    s_mov_b32 s94, 819200
    s_mov_b32 s95, 0x20000
    s_mul_i32 s98, s5, 102400
    s_lshr_b32 s73, s64, 1
    s_lshl_b32 s73, s73, 7
    s_add_u32 s98, s98, s73
    s_mov_b32 s12, 0
    s_add_u32 s13, s12, 256
    s_cmp_eq_u32 s13, 1280
    s_cselect_b32 s13, 0, s13
    s_add_u32 s14, s13, 256
    s_cmp_eq_u32 s14, 1280
    s_cselect_b32 s14, 0, s14
    s_add_u32 s15, s14, 256
    s_cmp_eq_u32 s15, 1280
    s_cselect_b32 s15, 0, s15
    s_add_u32 s30, s15, 256
    s_cmp_eq_u32 s30, 1280
    s_cselect_b32 s30, 0, s30
    s_add_u32 s73, s72, 16384
    v_mul_u32_u24 v14, 1280, v2
    v_lshrrev_b32 v15, 1, v2
    v_xor_b32 v15, v15, v3
    v_lshl_add_u32 v234, v15, 4, v14
    v_xor_b32 v235, 64, v234
    v_add_u32 v235, 9216, v235
    v_bfe_u32 v14, v233, 1, 3
    v_lshrrev_b32 v15, 4, v233
    v_xor_b32 v14, v14, v15
    v_and_b32 v15, 15, v233
    v_lshl_add_u32 v15, v15, 7, s73
    v_lshl_add_u32 v236, v14, 4, v15
    v_xor_b32 v237, 64, v236
    s_mul_i32 s27, s65, 20
    s_add_u32 s27, s27, s78
    s_mul_i32 s100, s27, 8193
    s_lshr_b32 s100, s100, 16
    s_mul_i32 s101, s100, 8
    s_sub_u32 s101, s27, s101
    s_add_u32 s101, s101, 2
    s_cmp_ge_u32 s100, 20
    s_cselect_b32 s88, s20, s18
    s_cselect_b32 s89, s21, s19
    s_cselect_b32 s75, 20, 0
    s_cselect_b32 s74, 5120, 0
    s_mov_b32 s90, 819200
    s_mov_b32 s91, 0x20000
    s_sub_u32 s100, s100, s75
    s_mul_i32 s96, s100, 40960
    s_lshl_b32 s76, s101, 7
    s_add_u32 s96, s96, s76
    s_mul_i32 s73, s101, 20480
    s_add_u32 s74, s74, s73
    s_add_u32 s74, s74, 276480
    s_cmp_ge_u32 s100, 20
    s_cselect_b32 s74, 134217728, s74
    s_lshl_b32 s73, s100, 1
    s_add_u32 s73, s73, 0
    s_mul_i32 s75, s73, 13
    s_lshr_b32 s75, s75, 6
    s_mul_i32 s75, s75, 476160
    s_lshl_b32 s73, s73, 10
    s_add_u32 s75, s75, s73
    s_add_u32 s32, s75, s74
    s_add_u32 s33, s32, 10240
    s_lshl_b32 s73, s100, 1
    s_add_u32 s73, s73, 1
    s_mul_i32 s75, s73, 13
    s_lshr_b32 s75, s75, 6
    s_mul_i32 s75, s75, 476160
    s_lshl_b32 s73, s73, 10
    s_add_u32 s75, s75, s73
    s_add_u32 s16, s75, s74
    s_add_u32 s17, s16, 10240
    s_add_u32 m0, s71, 20480
    s_add_u32 s3, s3, 128
    s_cmp_eq_u32 s3, 1280
    s_cselect_b32 s3, 0, s3
    s_add_u32 s68, s3, 0
    buffer_load_dwordx4 v224, s[40:43], s68 offen offset:0 lds
    buffer_load_dwordx4 v225, s[40:43], s68 offen offset:1024 lds
    buffer_load_dwordx4 v226, s[40:43], s68 offen offset:2048 lds
    buffer_load_dwordx4 v227, s[40:43], s68 offen offset:3072 lds
    s_add_u32 m0, s72, 8192
    s_nop 0
    buffer_load_dwordx4 v229, s[44:47], s68 offen offset:0 lds
    buffer_load_dwordx4 v230, s[44:47], s68 offen offset:1024 lds
    buffer_load_dwordx4 v231, s[44:47], s68 offen offset:2048 lds
    buffer_load_dwordx4 v232, s[44:47], s68 offen offset:3072 lds
    s_waitcnt vmcnt(12)
    s_barrier
    ds_read_b128 v[200:203], v220 offset:0
    ds_read_b128 v[204:207], v220 offset:4096
    ds_read_b128 v[160:163], v216 offset:0
    ds_read_b128 v[164:167], v216 offset:1024
    ds_read_b128 v[168:171], v216 offset:2048
    ds_read_b128 v[172:175], v216 offset:3072
    ds_read_b128 v[144:147], v140 offset:0
    v_mov_b32 v152, 0
    v_mov_b32 v153, 0
    v_lshrrev_b32 v128, 2, v233
    v_lshrrev_b32 v129, 4, v233
    v_xor_b32 v128, v128, v129
    v_and_b32 v128, 1, v128
    v_add_u32 v128, -1, v128
    v_and_b32 v128, 0x3f803f80, v128
    v_mov_b32 v129, v128
    v_mov_b32 v130, v128
    v_mov_b32 v131, v128
    s_waitcnt lgkmcnt(0)
    v_mfma_f32_32x32x16_bf16 v[0:15], v[160:163], v[200:203], 0
    ds_read_b128 v[208:211], v221 offset:0
    ds_read_b128 v[212:215], v221 offset:4096
    v_accvgpr_write_b32 a232, 0
    v_lshlrev_b32 v154, 16, v144
    v_and_b32 v155, 0xffff0000, v144
    v_add_f32 v152, v152, v154
    v_mfma_f32_32x32x16_bf16 v[16:31], v[160:163], v[204:207], 0
    ds_read_b128 v[180:183], v217 offset:0
    ds_read_b128 v[184:187], v217 offset:1024
    v_fmac_f32 v153, v154, v154
    v_add_f32 v152, v152, v155
    v_fmac_f32 v153, v155, v155
    v_mfma_f32_32x32x16_bf16 v[32:47], v[164:167], v[200:203], 0
    ds_read_b128 v[188:191], v217 offset:2048
    ds_read_b128 v[192:195], v217 offset:3072
    s_add_u32 m0, s72, 16384
    s_add_u32 s68, s98, s12
    s_add_u32 s68, s68, 0
    buffer_load_dwordx4 v234, s[92:95], s68 offen offset:0 lds
    v_lshlrev_b32 v154, 16, v145
    v_and_b32 v155, 0xffff0000, v145
    v_mfma_f32_32x32x16_bf16 v[48:63], v[164:167], v[204:207], 0
    ds_read_b128 v[148:151], v141 offset:0
    buffer_load_dwordx4 v235, s[92:95], s68 offen offset:1024 lds
    v_add_f32 v152, v152, v154
    v_fmac_f32 v153, v154, v154
    v_add_f32 v152, v152, v155
    v_mfma_f32_32x32x16_bf16 v[64:79], v[168:171], v[200:203], 0
    s_add_u32 m0, s72, 12288
    s_add_u32 s68, s3, 0
    buffer_load_dwordx4 v229, s[48:51], s68 offen offset:0 lds
    v_fmac_f32 v153, v155, v155
    v_lshlrev_b32 v154, 16, v146
    v_and_b32 v155, 0xffff0000, v146
    v_add_f32 v152, v152, v154
    v_mfma_f32_32x32x16_bf16 v[80:95], v[168:171], v[204:207], 0
    buffer_load_dwordx4 v230, s[48:51], s68 offen offset:1024 lds
    v_accvgpr_write_b32 a233, 0
    v_fmac_f32 v153, v154, v154
    v_add_f32 v152, v152, v155
    v_fmac_f32 v153, v155, v155
    v_mfma_f32_32x32x16_bf16 v[96:111], v[172:175], v[200:203], 0
    buffer_load_dwordx4 v231, s[48:51], s68 offen offset:2048 lds
    v_accvgpr_write_b32 a234, 0
    v_lshlrev_b32 v154, 16, v147
    v_and_b32 v155, 0xffff0000, v147
    v_add_f32 v152, v152, v154
    v_mfma_f32_16x16x32_bf16 v[132:135], v[128:131], v[200:203], 0
    v_mfma_f32_32x32x16_bf16 v[112:127], v[172:175], v[204:207], 0
    buffer_load_dwordx4 v232, s[48:51], s68 offen offset:3072 lds
    v_accvgpr_write_b32 a235, 0
    v_fmac_f32 v153, v154, v154
    v_add_f32 v152, v152, v155
    v_fmac_f32 v153, v155, v155
    v_mfma_f32_16x16x32_bf16 v[136:139], v[128:131], v[204:207], 0
    s_waitcnt lgkmcnt(0)
    v_mfma_f32_32x32x16_bf16 v[0:15], v[180:183], v[208:211], v[0:15]
    ds_read_b128 v[200:203], v222 offset:0
    ds_read_b128 v[204:207], v222 offset:4096
    v_lshlrev_b32 v154, 16, v148
    v_and_b32 v155, 0xffff0000, v148
    v_add_f32 v152, v152, v154
    v_fmac_f32 v153, v154, v154
    v_mfma_f32_32x32x16_bf16 v[16:31], v[180:183], v[212:215], v[16:31]
    ds_read_b128 v[160:163], v218 offset:0
    ds_read_b128 v[164:167], v218 offset:1024
    v_add_f32 v152, v152, v155
    v_fmac_f32 v153, v155, v155
    v_mfma_f32_32x32x16_bf16 v[32:47], v[184:187], v[208:211], v[32:47]
    ds_read_b128 v[168:171], v218 offset:2048
    ds_read_b128 v[172:175], v218 offset:3072
    s_add_u32 m0, s72, 18432
    s_add_u32 s68, s98, s12
    s_add_u32 s68, s68, 20480
    buffer_load_dwordx4 v234, s[92:95], s68 offen offset:0 lds
    v_lshlrev_b32 v154, 16, v149
    v_and_b32 v155, 0xffff0000, v149
    v_mfma_f32_32x32x16_bf16 v[48:63], v[184:187], v[212:215], v[48:63]
    ds_read_b128 v[144:147], v142 offset:0
    buffer_load_dwordx4 v235, s[92:95], s68 offen offset:1024 lds
    v_add_f32 v152, v152, v154
    v_fmac_f32 v153, v154, v154
    v_mfma_f32_32x32x16_bf16 v[64:79], v[188:191], v[208:211], v[64:79]
    s_add_u32 m0, s72, 20480
    s_add_u32 s68, s96, 0
    buffer_load_dwordx4 v234, s[88:91], s68 offen offset:0 nt lds
    v_add_f32 v152, v152, v155
    v_fmac_f32 v153, v155, v155
    v_lshlrev_b32 v154, 16, v150
    v_and_b32 v155, 0xffff0000, v150
    v_mfma_f32_32x32x16_bf16 v[80:95], v[188:191], v[212:215], v[80:95]
    buffer_load_dwordx4 v235, s[88:91], s68 offen offset:1024 nt lds
    v_add_f32 v152, v152, v154
    v_fmac_f32 v153, v154, v154
    v_add_f32 v152, v152, v155
    v_mfma_f32_32x32x16_bf16 v[96:111], v[192:195], v[208:211], v[96:111]
    s_add_u32 m0, s72, 22528
    s_add_u32 s68, s96, 20480
    buffer_load_dwordx4 v234, s[88:91], s68 offen offset:0 nt lds
    v_fmac_f32 v153, v155, v155
    v_lshlrev_b32 v154, 16, v151
    v_and_b32 v155, 0xffff0000, v151
    v_add_f32 v152, v152, v154
    v_mfma_f32_16x16x32_bf16 v[132:135], v[128:131], v[208:211], v[132:135]
    v_mfma_f32_32x32x16_bf16 v[112:127], v[192:195], v[212:215], v[112:127]
    buffer_load_dwordx4 v235, s[88:91], s68 offen offset:1024 nt lds
    v_fmac_f32 v153, v154, v154
    v_add_f32 v152, v152, v155
    v_fmac_f32 v153, v155, v155
    v_mfma_f32_16x16x32_bf16 v[136:139], v[128:131], v[212:215], v[136:139]
    s_waitcnt lgkmcnt(0)
    v_mfma_f32_32x32x16_bf16 v[0:15], v[160:163], v[200:203], v[0:15]
    ds_read_b128 v[208:211], v223 offset:0
    ds_read_b128 v[212:215], v223 offset:4096
    v_lshlrev_b32 v154, 16, v144
    v_and_b32 v155, 0xffff0000, v144
    v_add_f32 v152, v152, v154
    v_mfma_f32_32x32x16_bf16 v[16:31], v[160:163], v[204:207], v[16:31]
    ds_read_b128 v[180:183], v219 offset:0
    ds_read_b128 v[184:187], v219 offset:1024
    s_add_u32 m0, s71, 40960
    s_add_u32 s3, s3, 128
    s_cmp_eq_u32 s3, 1280
    s_cselect_b32 s3, 0, s3
    s_add_u32 s68, s3, 0
    buffer_load_dwordx4 v224, s[40:43], s68 offen offset:0 lds
    v_fmac_f32 v153, v154, v154
    v_mfma_f32_32x32x16_bf16 v[32:47], v[164:167], v[200:203], v[32:47]
    ds_read_b128 v[188:191], v219 offset:2048
    ds_read_b128 v[192:195], v219 offset:3072
    v_add_f32 v152, v152, v155
    v_fmac_f32 v153, v155, v155
    v_lshlrev_b32 v154, 16, v145
    v_mfma_f32_32x32x16_bf16 v[48:63], v[164:167], v[204:207], v[48:63]
    ds_read_b128 v[148:151], v143 offset:0
    buffer_load_dwordx4 v225, s[40:43], s68 offen offset:1024 lds
    v_and_b32 v155, 0xffff0000, v145
    v_add_f32 v152, v152, v154
    v_mfma_f32_32x32x16_bf16 v[64:79], v[168:171], v[200:203], v[64:79]
    v_fmac_f32 v153, v154, v154
    v_add_f32 v152, v152, v155
    v_fmac_f32 v153, v155, v155
    v_lshlrev_b32 v154, 16, v146
    v_and_b32 v155, 0xffff0000, v146
    v_mfma_f32_32x32x16_bf16 v[80:95], v[168:171], v[204:207], v[80:95]
    s_waitcnt vmcnt(12)
    ds_read_b128 a[0:3], v236 offset:0
    buffer_load_dwordx4 v226, s[40:43], s68 offen offset:2048 lds
    v_add_f32 v152, v152, v154
    v_mfma_f32_32x32x16_bf16 v[96:111], v[172:175], v[200:203], v[96:111]
    ds_read_b128 a[20:23], v237 offset:0
    v_fmac_f32 v153, v154, v154
    v_add_f32 v152, v152, v155
    v_fmac_f32 v153, v155, v155
    v_lshlrev_b32 v154, 16, v147
    v_mfma_f32_16x16x32_bf16 v[132:135], v[128:131], v[200:203], v[132:135]
    v_mfma_f32_32x32x16_bf16 v[112:127], v[172:175], v[204:207], v[112:127]
    v_and_b32 v155, 0xffff0000, v147
    v_add_f32 v152, v152, v154
    v_fmac_f32 v153, v154, v154
    v_add_f32 v152, v152, v155
    v_fmac_f32 v153, v155, v155
    v_mfma_f32_16x16x32_bf16 v[136:139], v[128:131], v[204:207], v[136:139]
    s_waitcnt lgkmcnt(2)
    v_mfma_f32_32x32x16_bf16 v[0:15], v[180:183], v[208:211], v[0:15]
    s_waitcnt vmcnt(9)
    s_barrier
    ds_read_b128 v[200:203], v220 offset:8192
    ds_read_b128 v[204:207], v220 offset:12288
    v_lshlrev_b32 v154, 16, v148
    v_and_b32 v155, 0xffff0000, v148
    v_add_f32 v152, v152, v154
    v_mfma_f32_32x32x16_bf16 v[16:31], v[180:183], v[212:215], v[16:31]
    ds_read_b128 v[160:163], v216 offset:20480
    ds_read_b128 v[164:167], v216 offset:21504
    buffer_load_dwordx4 v227, s[40:43], s68 offen offset:3072 lds
    v_fmac_f32 v153, v154, v154
    v_add_f32 v152, v152, v155
    v_mfma_f32_32x32x16_bf16 v[32:47], v[184:187], v[208:211], v[32:47]
    ds_read_b128 v[168:171], v216 offset:22528
    ds_read_b128 v[172:175], v216 offset:23552
    s_add_u32 m0, s72, 0
    s_nop 0
    buffer_load_dwordx4 v229, s[44:47], s68 offen offset:0 lds
    v_fmac_f32 v153, v155, v155
    v_lshlrev_b32 v154, 16, v149
    v_mfma_f32_32x32x16_bf16 v[48:63], v[184:187], v[212:215], v[48:63]
    ds_read_b128 v[144:147], v140 offset:20480
    v_and_b32 v155, 0xffff0000, v149
    v_add_f32 v152, v152, v154
    v_fmac_f32 v153, v154, v154
    v_add_f32 v152, v152, v155
    v_fmac_f32 v153, v155, v155
    v_mfma_f32_32x32x16_bf16 v[64:79], v[188:191], v[208:211], v[64:79]
    buffer_load_dwordx4 v230, s[44:47], s68 offen offset:1024 lds
    s_and_b32 s74, s67, 0x7f
    s_cselect_b32 s74, 134217728, s67
    v_lshlrev_b32 v154, 16, v150
    v_and_b32 v155, 0xffff0000, v150
    v_mfma_f32_32x32x16_bf16 v[80:95], v[188:191], v[212:215], v[80:95]
    s_waitcnt vmcnt(10)
    ds_read_b128 a[4:7], v236 offset:2048
    v_add_f32 v152, v152, v154
    v_fmac_f32 v153, v154, v154
    v_add_f32 v152, v152, v155
    v_fmac_f32 v153, v155, v155
    v_mfma_f32_32x32x16_bf16 v[96:111], v[192:195], v[208:211], v[96:111]
    ds_read_b128 a[24:27], v237 offset:2048
    buffer_load_dwordx4 v231, s[44:47], s68 offen offset:2048 lds
    v_lshlrev_b32 v154, 16, v151
    v_and_b32 v155, 0xffff0000, v151
    v_add_f32 v152, v152, v154
    v_mfma_f32_16x16x32_bf16 v[132:135], v[128:131], v[208:211], v[132:135]
    v_mfma_f32_32x32x16_bf16 v[112:127], v[192:195], v[212:215], v[112:127]
    s_mov_b64 exec, 0xff
    buffer_store_dwordx4 a[232:235], v238, s[56:59], s74 offen sc1
    s_mov_b64 exec, -1
    v_fmac_f32 v153, v154, v154
    v_add_f32 v152, v152, v155
    v_fmac_f32 v153, v155, v155
    v_mfma_f32_16x16x32_bf16 v[136:139], v[128:131], v[212:215], v[136:139]
    s_waitcnt lgkmcnt(2)
    v_mfma_f32_32x32x16_bf16 v[0:15], v[160:163], v[200:203], v[0:15]
    ds_read_b128 v[208:211], v221 offset:8192
    ds_read_b128 v[212:215], v221 offset:12288
    v_lshlrev_b32 v154, 16, v144
    v_and_b32 v155, 0xffff0000, v144
    v_add_f32 v152, v152, v154
    v_mfma_f32_32x32x16_bf16 v[16:31], v[160:163], v[204:207], v[16:31]
    ds_read_b128 v[180:183], v217 offset:20480
    ds_read_b128 v[184:187], v217 offset:21504
    buffer_load_dwordx4 v232, s[44:47], s68 offen offset:3072 lds
    v_fmac_f32 v153, v154, v154
    v_add_f32 v152, v152, v155
    v_mfma_f32_32x32x16_bf16 v[32:47], v[164:167], v[200:203], v[32:47]
    ds_read_b128 v[188:191], v217 offset:22528
    ds_read_b128 v[192:195], v217 offset:23552
    v_fmac_f32 v153, v155, v155
    v_lshlrev_b32 v154, 16, v145
    v_and_b32 v155, 0xffff0000, v145
    v_mfma_f32_32x32x16_bf16 v[48:63], v[164:167], v[204:207], v[48:63]
    ds_read_b128 v[148:151], v141 offset:20480
    s_add_u32 m0, s72, 4096
    s_nop 0
    buffer_load_dwordx4 v229, s[48:51], s68 offen offset:0 lds
    v_add_f32 v152, v152, v154
    v_fmac_f32 v153, v154, v154
    v_mfma_f32_32x32x16_bf16 v[64:79], v[168:171], v[200:203], v[64:79]
    v_add_f32 v152, v152, v155
    v_fmac_f32 v153, v155, v155
    v_lshlrev_b32 v154, 16, v146
    v_and_b32 v155, 0xffff0000, v146
    v_add_f32 v152, v152, v154
    v_mfma_f32_32x32x16_bf16 v[80:95], v[168:171], v[204:207], v[80:95]
    s_waitcnt vmcnt(10)
    ds_read_b128 a[200:203], v236 offset:4096
    ds_read_b128 a[204:207], v237 offset:4096
    buffer_load_dwordx4 v230, s[48:51], s68 offen offset:1024 lds
    v_fmac_f32 v153, v154, v154
    v_mfma_f32_32x32x16_bf16 v[96:111], v[172:175], v[200:203], v[96:111]
    ds_read_b128 a[208:211], v236 offset:6144
    ds_read_b128 a[212:215], v237 offset:6144
    v_add_f32 v152, v152, v155
    v_fmac_f32 v153, v155, v155
    v_lshlrev_b32 v154, 16, v147
    v_mfma_f32_16x16x32_bf16 v[132:135], v[128:131], v[200:203], v[132:135]
    v_mfma_f32_32x32x16_bf16 v[112:127], v[172:175], v[204:207], v[112:127]
    v_and_b32 v155, 0xffff0000, v147
    v_add_f32 v152, v152, v154
    v_fmac_f32 v153, v154, v154
    v_add_f32 v152, v152, v155
    v_fmac_f32 v153, v155, v155
    v_mfma_f32_16x16x32_bf16 v[136:139], v[128:131], v[204:207], v[136:139]
    s_waitcnt lgkmcnt(0)
    v_mfma_f32_32x32x16_bf16 v[0:15], v[180:183], v[208:211], v[0:15]
    ds_read_b128 v[200:203], v222 offset:8192
    ds_read_b128 v[204:207], v222 offset:12288
    buffer_load_dword v243, off, s[60:63], 0 sc1
    buffer_store_dwordx4 a[200:203], v238, s[56:59], s32 offen sc1
    v_lshlrev_b32 v154, 16, v148
    v_and_b32 v155, 0xffff0000, v148
    v_add_f32 v152, v152, v154
    v_mfma_f32_32x32x16_bf16 v[16:31], v[180:183], v[212:215], v[16:31]
    ds_read_b128 v[160:163], v218 offset:20480
    ds_read_b128 v[164:167], v218 offset:21504
    v_fmac_f32 v153, v154, v154
    v_add_f32 v152, v152, v155
    v_fmac_f32 v153, v155, v155
    v_mfma_f32_32x32x16_bf16 v[32:47], v[184:187], v[208:211], v[32:47]
    ds_read_b128 v[168:171], v218 offset:22528
    ds_read_b128 v[172:175], v218 offset:23552
    s_add_u32 m0, s72, 20480
    s_add_u32 s68, s98, s12
    s_add_u32 s68, s68, 40960
    buffer_load_dwordx4 v234, s[92:95], s68 offen offset:0 lds
    v_lshlrev_b32 v154, 16, v149
    v_and_b32 v155, 0xffff0000, v149
    v_add_f32 v152, v152, v154
    v_mfma_f32_32x32x16_bf16 v[48:63], v[184:187], v[212:215], v[48:63]
    ds_read_b128 v[144:147], v142 offset:20480
    buffer_load_dwordx4 v235, s[92:95], s68 offen offset:1024 lds
    v_fmac_f32 v153, v154, v154
    v_add_f32 v152, v152, v155
    v_fmac_f32 v153, v155, v155
    v_mfma_f32_32x32x16_bf16 v[64:79], v[188:191], v[208:211], v[64:79]
    s_add_u32 m0, s72, 4096
    s_add_u32 s68, s3, 0
    buffer_load_dwordx4 v231, s[48:51], s68 offen offset:2048 lds
    buffer_store_dwordx4 a[204:207], v238, s[56:59], s33 offen sc1
    s_lshl_b32 s73, s78, 4
    v_lshlrev_b32 v154, 16, v150
    v_and_b32 v155, 0xffff0000, v150
    v_add_f32 v152, v152, v154
    v_mfma_f32_32x32x16_bf16 v[80:95], v[188:191], v[212:215], v[80:95]
    buffer_load_dwordx4 v232, s[48:51], s68 offen offset:3072 lds
    s_add_u32 s73, s73, s65
    v_fmac_f32 v153, v154, v154
    v_add_f32 v152, v152, v155
    v_fmac_f32 v153, v155, v155
    v_mfma_f32_32x32x16_bf16 v[96:111], v[192:195], v[208:211], v[96:111]
    s_add_u32 m0, s71, 0
    s_add_u32 s3, s3, 128
    s_cmp_eq_u32 s3, 1280
    s_cselect_b32 s3, 0, s3
    s_add_u32 s68, s3, 0
    buffer_load_dwordx4 v224, s[40:43], s68 offen offset:0 lds
    s_lshl_b32 s73, s73, 9
    s_add_u32 s73, s73, 4587520
    v_lshlrev_b32 v154, 16, v151
    v_and_b32 v155, 0xffff0000, v151
    v_add_f32 v152, v152, v154
    v_mfma_f32_16x16x32_bf16 v[132:135], v[128:131], v[208:211], v[132:135]
    v_mfma_f32_32x32x16_bf16 v[112:127], v[192:195], v[212:215], v[112:127]
    s_mov_b32 exec_hi, 0
    buffer_store_dwordx4 a[232:235], v238, s[56:59], s73 offen sc1
    s_mov_b64 exec, -1
    v_fmac_f32 v153, v154, v154
    v_add_f32 v152, v152, v155
    v_fmac_f32 v153, v155, v155
    v_mfma_f32_16x16x32_bf16 v[136:139], v[128:131], v[212:215], v[136:139]
    s_waitcnt lgkmcnt(0)
    v_mfma_f32_32x32x16_bf16 v[0:15], v[160:163], v[200:203], v[0:15]
    ds_read_b128 v[208:211], v223 offset:8192
    ds_read_b128 v[212:215], v223 offset:12288
    buffer_store_dwordx4 a[208:211], v238, s[56:59], s16 offen sc1
    buffer_store_dwordx4 a[212:215], v238, s[56:59], s17 offen sc1
    v_lshlrev_b32 v154, 16, v144
    v_and_b32 v155, 0xffff0000, v144
    v_add_f32 v152, v152, v154
    v_mfma_f32_32x32x16_bf16 v[16:31], v[160:163], v[204:207], v[16:31]
    ds_read_b128 v[180:183], v219 offset:20480
    ds_read_b128 v[184:187], v219 offset:21504
    s_mul_i32 s73, s65, 52
    v_fmac_f32 v153, v154, v154
    v_add_f32 v152, v152, v155
    v_fmac_f32 v153, v155, v155
    v_mfma_f32_32x32x16_bf16 v[32:47], v[164:167], v[200:203], v[32:47]
    ds_read_b128 v[188:191], v219 offset:22528
    ds_read_b128 v[192:195], v219 offset:23552
    s_add_u32 m0, s72, 22528
    s_add_u32 s68, s98, s12
    s_add_u32 s68, s68, 61440
    buffer_load_dwordx4 v234, s[92:95], s68 offen offset:0 lds
    v_lshlrev_b32 v154, 16, v145
    v_and_b32 v155, 0xffff0000, v145
    v_add_f32 v152, v152, v154
    v_mfma_f32_32x32x16_bf16 v[48:63], v[164:167], v[204:207], v[48:63]
    ds_read_b128 v[148:151], v143 offset:20480
    buffer_load_dwordx4 v235, s[92:95], s68 offen offset:1024 lds
    s_lshr_b32 s73, s73, 8
    v_fmac_f32 v153, v154, v154
    v_add_f32 v152, v152, v155
    v_fmac_f32 v153, v155, v155
    v_mfma_f32_32x32x16_bf16 v[64:79], v[168:171], v[200:203], v[64:79]
    s_add_u32 m0, s71, 0
    s_add_u32 s68, s3, 0
    buffer_load_dwordx4 v225, s[40:43], s68 offen offset:1024 lds
    s_mul_i32 s73, s73, 5
    v_lshlrev_b32 v154, 16, v146
    v_and_b32 v155, 0xffff0000, v146
    v_add_f32 v152, v152, v154
    v_mfma_f32_32x32x16_bf16 v[80:95], v[168:171], v[204:207], v[80:95]
    buffer_load_dwordx4 v226, s[40:43], s68 offen offset:2048 lds
    s_sub_u32 s73, s65, s73
    s_lshl_b32 s27, s65, 10
    v_fmac_f32 v153, v154, v154
    v_add_f32 v152, v152, v155
    v_fmac_f32 v153, v155, v155
    v_mfma_f32_32x32x16_bf16 v[96:111], v[172:175], v[200:203], v[96:111]
    buffer_load_dwordx4 v227, s[40:43], s68 offen offset:3072 lds
    s_add_u32 s27, s27, 4194304
    s_cmp_eq_u32 s73, s66
    s_cselect_b32 s27, s27, 134217728
    v_lshlrev_b32 v154, 16, v147
    v_and_b32 v155, 0xffff0000, v147
    v_mfma_f32_16x16x32_bf16 v[132:135], v[128:131], v[200:203], v[132:135]
    v_mfma_f32_32x32x16_bf16 v[112:127], v[172:175], v[204:207], v[112:127]
    s_cmp_eq_u32 s64, 0
    s_cselect_b32 s73, s27, 134217728
    buffer_store_dwordx4 a[232:235], v238, s[56:59], s73 offen sc1
    v_add_f32 v152, v152, v154
    v_fmac_f32 v153, v154, v154
    v_add_f32 v152, v152, v155
    v_fmac_f32 v153, v155, v155
    v_mfma_f32_16x16x32_bf16 v[136:139], v[128:131], v[204:207], v[136:139]
    s_waitcnt lgkmcnt(0)
    v_mfma_f32_32x32x16_bf16 v[0:15], v[180:183], v[208:211], v[0:15]
    s_waitcnt vmcnt(10)
    s_barrier
    ds_read_b128 v[200:203], v220 offset:0
    ds_read_b128 v[204:207], v220 offset:4096
    v_lshlrev_b32 v154, 16, v148
    v_and_b32 v155, 0xffff0000, v148
    v_add_f32 v152, v152, v154
    v_mfma_f32_32x32x16_bf16 v[16:31], v[180:183], v[212:215], v[16:31]
    ds_read_b128 v[160:163], v216 offset:40960
    v_fmac_f32 v153, v154, v154
    v_add_f32 v152, v152, v155
    v_fmac_f32 v153, v155, v155
    v_lshlrev_b32 v154, 16, v149
    v_mfma_f32_32x32x16_bf16 v[32:47], v[184:187], v[208:211], v[32:47]
    ds_read_b128 v[164:167], v216 offset:41984
    ds_read_b128 v[168:171], v216 offset:43008
    s_add_u32 m0, s72, 16384
    s_add_u32 s68, s98, s12
    s_add_u32 s68, s68, 81920
    buffer_load_dwordx4 v234, s[92:95], s68 offen offset:0 lds
    v_and_b32 v155, 0xffff0000, v149
    v_add_f32 v152, v152, v154
    v_mfma_f32_32x32x16_bf16 v[48:63], v[184:187], v[212:215], v[48:63]
    ds_read_b128 v[172:175], v216 offset:44032
    buffer_load_dwordx4 v235, s[92:95], s68 offen offset:1024 lds
    v_fmac_f32 v153, v154, v154
    v_add_f32 v152, v152, v155
    v_fmac_f32 v153, v155, v155
    v_mfma_f32_32x32x16_bf16 v[64:79], v[188:191], v[208:211], v[64:79]
    s_add_u32 m0, s72, 8192
    s_add_u32 s68, s3, 0
    buffer_load_dwordx4 v229, s[44:47], s68 offen offset:0 lds
    v_lshlrev_b32 v154, 16, v150
    v_and_b32 v155, 0xffff0000, v150
    v_add_f32 v152, v152, v154
    v_mfma_f32_32x32x16_bf16 v[80:95], v[188:191], v[212:215], v[80:95]
    ds_read_b128 a[8:11], v236 offset:4096
    buffer_load_dwordx4 v230, s[44:47], s68 offen offset:1024 lds
    v_fmac_f32 v153, v154, v154
    v_add_f32 v152, v152, v155
    v_mfma_f32_32x32x16_bf16 v[96:111], v[192:195], v[208:211], v[96:111]
    ds_read_b128 a[28:31], v237 offset:4096
    buffer_load_dwordx4 v231, s[44:47], s68 offen offset:2048 lds
    v_fmac_f32 v153, v155, v155
    v_lshlrev_b32 v154, 16, v151
    v_and_b32 v155, 0xffff0000, v151
    v_mfma_f32_16x16x32_bf16 v[132:135], v[128:131], v[208:211], v[132:135]
    v_mfma_f32_32x32x16_bf16 v[112:127], v[192:195], v[212:215], v[112:127]
    buffer_load_dwordx4 v232, s[44:47], s68 offen offset:3072 lds
    v_add_f32 v152, v152, v154
    v_fmac_f32 v153, v154, v154
    v_add_f32 v152, v152, v155
    v_fmac_f32 v153, v155, v155
    v_mfma_f32_16x16x32_bf16 v[136:139], v[128:131], v[212:215], v[136:139]
    s_waitcnt lgkmcnt(2)
    v_mfma_f32_32x32x16_bf16 v[0:15], v[160:163], v[200:203], v[0:15]
    ds_read_b128 v[208:211], v221 offset:0
    ds_read_b128 v[212:215], v221 offset:4096
    v_cmp_eq_u32 vcc, 0, v243
    s_cbranch_vccnz L_slow_non_ssm
L_go_non_ssm:
    v_readfirstlane_b32 s83, v243
    v_lshrrev_b32 v159, 1, v238
    v_mfma_f32_32x32x16_bf16 v[16:31], v[160:163], v[204:207], v[16:31]
    ds_read_b128 v[180:183], v217 offset:40960
    s_add_u32 m0, s72, 12288
    s_nop 0
    buffer_load_dwordx4 v229, s[48:51], s68 offen offset:0 lds
    v_permlane32_swap_b32 v152, v153
    v_mfma_f32_32x32x16_bf16 v[32:47], v[164:167], v[200:203], v[32:47]
    ds_read_b128 v[184:187], v217 offset:41984
    ds_read_b128 v[188:191], v217 offset:43008
    buffer_load_dwordx4 v230, s[48:51], s68 offen offset:1024 lds
    v_mfma_f32_32x32x16_bf16 v[48:63], v[164:167], v[204:207], v[48:63]
    ds_read_b128 v[192:195], v217 offset:44032
    s_lshl_b32 s101, s65, 2
    s_add_u32 s101, s101, s64
    s_mul_i32 s101, s101, 2560
    v_mfma_f32_32x32x16_bf16 v[64:79], v[168:171], v[200:203], v[64:79]
    buffer_load_dwordx4 v231, s[48:51], s68 offen offset:2048 lds
    s_add_u32 s101, s101, 3866624
    v_add_f32 v152, v152, v153
    v_mfma_f32_32x32x16_bf16 v[80:95], v[168:171], v[204:207], v[80:95]
    s_waitcnt vmcnt(13)
    ds_read_b128 a[12:15], v236 offset:6144
    ds_read_b128 a[32:35], v237 offset:6144
    v_mov_b32 v153, s83
    v_mfma_f32_32x32x16_bf16 v[96:111], v[172:175], v[200:203], v[96:111]
    s_waitcnt vmcnt(7)
    ds_read_b128 a[16:19], v236 offset:0
    ds_read_b128 a[36:39], v237 offset:0
    buffer_load_dwordx4 v232, s[48:51], s68 offen offset:3072 lds
    v_mfma_f32_16x16x32_bf16 v[132:135], v[128:131], v[200:203], v[132:135]
    v_mfma_f32_32x32x16_bf16 v[112:127], v[172:175], v[204:207], v[112:127]
    s_lshl_b32 s73, s66, 9
    s_add_u32 s73, s73, s101
    buffer_store_dwordx2 v[152:153], v159, s[56:59], s73 offen sc1
    v_mfma_f32_16x16x32_bf16 v[136:139], v[128:131], v[204:207], v[136:139]
    s_waitcnt lgkmcnt(4)
    v_mfma_f32_32x32x16_bf16 v[0:15], v[180:183], v[208:211], v[0:15]
    ds_read_b128 v[200:203], v222 offset:0
    ds_read_b128 v[204:207], v222 offset:4096
    v_mfma_f32_32x32x16_bf16 v[16:31], v[180:183], v[212:215], v[16:31]
    ds_read_b128 v[160:163], v218 offset:40960
    s_add_u32 m0, s71, 20480
    s_add_u32 s3, s3, 128
    s_cmp_eq_u32 s3, 1280
    s_cselect_b32 s3, 0, s3
    s_add_u32 s68, s3, 0
    buffer_load_dwordx4 v224, s[40:43], s68 offen offset:0 lds
    v_mfma_f32_32x32x16_bf16 v[32:47], v[184:187], v[208:211], v[32:47]
    ds_read_b128 v[164:167], v218 offset:41984
    ds_read_b128 v[168:171], v218 offset:43008
    v_mfma_f32_32x32x16_bf16 v[48:63], v[184:187], v[212:215], v[48:63]
    ds_read_b128 v[172:175], v218 offset:44032
    buffer_load_dwordx4 v225, s[40:43], s68 offen offset:1024 lds
    v_mfma_f32_32x32x16_bf16 v[64:79], v[188:191], v[208:211], v[64:79]
    s_barrier
    s_lshl_b32 s73, s2, 4
    s_add_u32 s73, s73, 4259840
    v_mfma_f32_32x32x16_bf16 v[80:95], v[188:191], v[212:215], v[80:95]
    buffer_load_dwordx4 v226, s[40:43], s68 offen offset:2048 lds
    v_mfma_f32_32x32x16_bf16 v[96:111], v[192:195], v[208:211], v[96:111]
    s_cmp_eq_u32 s64, 0
    s_cselect_b32 s73, s73, 134217728
    v_mov_b32 v241, s83
    v_mfma_f32_16x16x32_bf16 v[132:135], v[128:131], v[208:211], v[132:135]
    v_mfma_f32_32x32x16_bf16 v[112:127], v[192:195], v[212:215], v[112:127]
    s_mov_b64 exec, 1
    buffer_store_dword v241, off, s[56:59], s73 sc1
    s_mov_b64 exec, -1
    v_mfma_f32_16x16x32_bf16 v[136:139], v[128:131], v[212:215], v[136:139]
    s_waitcnt lgkmcnt(0)
    v_mfma_f32_32x32x16_bf16 v[0:15], v[160:163], v[200:203], v[0:15]
    ds_read_b128 v[208:211], v223 offset:0
    ds_read_b128 v[212:215], v223 offset:4096
    v_bfe_u32 v239, v233, 3, 2
    v_mfma_f32_32x32x16_bf16 v[16:31], v[160:163], v[204:207], v[16:31]
    ds_read_b128 v[180:183], v219 offset:40960
    buffer_load_dwordx4 v227, s[40:43], s68 offen offset:3072 lds
    v_mfma_f32_32x32x16_bf16 v[32:47], v[164:167], v[200:203], v[32:47]
    ds_read_b128 v[184:187], v219 offset:41984
    ds_read_b128 v[188:191], v219 offset:43008
    v_mfma_f32_32x32x16_bf16 v[48:63], v[164:167], v[204:207], v[48:63]
    ds_read_b128 v[192:195], v219 offset:44032
    s_add_u32 m0, s72, 16384
    s_nop 0
    buffer_load_dwordx4 v229, s[44:47], s68 offen offset:0 lds
    v_mfma_f32_32x32x16_bf16 v[64:79], v[168:171], v[200:203], v[64:79]
    v_bfe_u32 v240, v233, 1, 1
    v_lshl_add_u32 v239, v239, 1, v240
    s_lshl_b32 s73, s64, 3
    v_mfma_f32_32x32x16_bf16 v[80:95], v[168:171], v[204:207], v[80:95]
    buffer_load_dwordx4 v230, s[44:47], s68 offen offset:1024 lds
    v_add_u32 v239, s73, v239
    v_mfma_f32_32x32x16_bf16 v[96:111], v[172:175], v[200:203], v[96:111]
    v_bfe_u32 v240, v233, 2, 1
    v_and_b32 v241, 1, v233
    v_mfma_f32_16x16x32_bf16 v[132:135], v[128:131], v[200:203], v[132:135]
    v_mfma_f32_32x32x16_bf16 v[112:127], v[172:175], v[204:207], v[112:127]
    v_lshl_add_u32 v156, v240, 5, v239
    v_lshlrev_b32 v156, 4, v156
    v_lshl_add_u32 v156, v241, 2, v156
    v_mfma_f32_16x16x32_bf16 v[136:139], v[128:131], v[204:207], v[136:139]
    s_waitcnt lgkmcnt(0)
    v_mfma_f32_32x32x16_bf16 v[0:15], v[180:183], v[208:211], v[0:15]
    s_waitcnt vmcnt(8)
    s_barrier
    ds_read_b128 v[200:203], v220 offset:8192
    ds_read_b128 v[204:207], v220 offset:12288
    v_add_u32 v156, 159744, v156
    v_mfma_f32_32x32x16_bf16 v[16:31], v[180:183], v[212:215], v[16:31]
    ds_read_b128 v[160:163], v216 offset:0
    buffer_load_dwordx4 v231, s[44:47], s68 offen offset:2048 lds
    v_lshl_add_u32 v157, v240, 1, v241
    v_mfma_f32_32x32x16_bf16 v[32:47], v[184:187], v[208:211], v[32:47]
    ds_read_b128 v[164:167], v216 offset:1024
    ds_read_b128 v[168:171], v216 offset:2048
    buffer_load_dwordx4 v232, s[44:47], s68 offen offset:3072 lds
    v_mfma_f32_32x32x16_bf16 v[48:63], v[184:187], v[212:215], v[48:63]
    ds_read_b128 v[172:175], v216 offset:3072
    v_lshl_add_u32 v157, v157, 5, v239
    v_lshlrev_b32 v157, 3, v157
    v_mfma_f32_32x32x16_bf16 v[64:79], v[188:191], v[208:211], v[64:79]
    s_add_u32 m0, s72, 20480
    s_nop 0
    buffer_load_dwordx4 v229, s[48:51], s68 offen offset:0 lds
    v_and_b32 v158, 32, v233
    v_lshlrev_b32 v158, 4, v158
    v_mfma_f32_32x32x16_bf16 v[80:95], v[188:191], v[212:215], v[80:95]
    v_add_u32 v158, 159744, v158
    s_mul_i32 s73, s65, 52
    s_lshr_b32 s73, s73, 8
    s_mul_i32 s73, s73, 5
    v_mfma_f32_32x32x16_bf16 v[96:111], v[192:195], v[208:211], v[96:111]
    buffer_load_dwordx4 v230, s[48:51], s68 offen offset:1024 lds
    s_sub_u32 s73, s65, s73
    v_mfma_f32_16x16x32_bf16 v[132:135], v[128:131], v[208:211], v[132:135]
    v_mfma_f32_32x32x16_bf16 v[112:127], v[192:195], v[212:215], v[112:127]
    s_lshl_b32 s27, s65, 10
    s_add_u32 s27, s27, 4194304
    s_cmp_eq_u32 s73, s66
    s_cselect_b32 s27, s27, 134217728
    v_mfma_f32_16x16x32_bf16 v[136:139], v[128:131], v[212:215], v[136:139]
    s_waitcnt lgkmcnt(0)
    v_mfma_f32_32x32x16_bf16 v[0:15], v[160:163], v[200:203], v[0:15]
    ds_read_b128 v[208:211], v221 offset:8192
    ds_read_b128 v[212:215], v221 offset:12288
    v_mfma_f32_32x32x16_bf16 v[16:31], v[160:163], v[204:207], v[16:31]
    ds_read_b128 v[180:183], v217 offset:0
    buffer_load_dwordx4 v231, s[48:51], s68 offen offset:2048 lds
    v_mfma_f32_32x32x16_bf16 v[32:47], v[164:167], v[200:203], v[32:47]
    ds_read_b128 v[184:187], v217 offset:1024
    ds_read_b128 v[188:191], v217 offset:2048
    v_mfma_f32_32x32x16_bf16 v[48:63], v[164:167], v[204:207], v[48:63]
    ds_read_b128 v[192:195], v217 offset:3072
    buffer_load_dwordx4 v232, s[48:51], s68 offen offset:3072 lds
    v_mfma_f32_32x32x16_bf16 v[64:79], v[168:171], v[200:203], v[64:79]
    v_mfma_f32_32x32x16_bf16 v[80:95], v[168:171], v[204:207], v[80:95]
    s_add_u32 m0, s71, 40960
    s_add_u32 s3, s3, 128
    s_cmp_eq_u32 s3, 1280
    s_cselect_b32 s3, 0, s3
    s_add_u32 s68, s3, 0
    buffer_load_dwordx4 v224, s[40:43], s68 offen offset:0 lds
    v_mfma_f32_32x32x16_bf16 v[96:111], v[172:175], v[200:203], v[96:111]
    v_mfma_f32_16x16x32_bf16 v[132:135], v[128:131], v[200:203], v[132:135]
    v_mfma_f32_32x32x16_bf16 v[112:127], v[172:175], v[204:207], v[112:127]
    v_mfma_f32_16x16x32_bf16 v[136:139], v[128:131], v[204:207], v[136:139]
    s_waitcnt lgkmcnt(0)
    v_mfma_f32_32x32x16_bf16 v[0:15], v[180:183], v[208:211], v[0:15]
    ds_read_b128 v[200:203], v222 offset:8192
    ds_read_b128 v[204:207], v222 offset:12288
    s_lshr_b32 s73, s2, 3
    v_mfma_f32_32x32x16_bf16 v[16:31], v[180:183], v[212:215], v[16:31]
    ds_read_b128 v[160:163], v218 offset:0
    buffer_load_dwordx4 v225, s[40:43], s68 offen offset:1024 lds
    v_mfma_f32_32x32x16_bf16 v[32:47], v[184:187], v[208:211], v[32:47]
    ds_read_b128 v[164:167], v218 offset:1024
    ds_read_b128 v[168:171], v218 offset:2048
    buffer_load_dwordx4 v226, s[40:43], s68 offen offset:2048 lds
    v_mfma_f32_32x32x16_bf16 v[48:63], v[184:187], v[212:215], v[48:63]
    ds_read_b128 v[172:175], v218 offset:3072
    s_mul_i32 s73, s73, 3072
    v_mfma_f32_32x32x16_bf16 v[64:79], v[188:191], v[208:211], v[64:79]
    buffer_load_dwordx4 v227, s[40:43], s68 offen offset:3072 lds
    v_mfma_f32_32x32x16_bf16 v[80:95], v[188:191], v[212:215], v[80:95]
    s_cmp_eq_u32 s64, 0
    s_cselect_b32 s73, s73, 134217728
    v_lshl_add_u32 v243, v233, 7, s73
    v_mfma_f32_32x32x16_bf16 v[96:111], v[192:195], v[208:211], v[96:111]
    s_add_u32 m0, s72, 0
    s_nop 0
    buffer_load_dwordx4 v229, s[44:47], s68 offen offset:0 lds
    v_mfma_f32_16x16x32_bf16 v[132:135], v[128:131], v[208:211], v[132:135]
    v_mfma_f32_32x32x16_bf16 v[112:127], v[192:195], v[212:215], v[112:127]
    s_mov_b32 exec_lo, 16777215
    s_mov_b32 exec_hi, 0
    buffer_load_dword a255, v243, s[84:87], 0 offen
    s_mov_b64 exec, -1
    v_mfma_f32_16x16x32_bf16 v[136:139], v[128:131], v[212:215], v[136:139]
    s_waitcnt lgkmcnt(0)
    v_mfma_f32_32x32x16_bf16 v[0:15], v[160:163], v[200:203], v[0:15]
    ds_read_b128 v[208:211], v223 offset:8192
    ds_read_b128 v[212:215], v223 offset:12288
    v_mfma_f32_32x32x16_bf16 v[16:31], v[160:163], v[204:207], v[16:31]
    ds_read_b128 v[180:183], v219 offset:0
    buffer_load_dwordx4 v230, s[44:47], s68 offen offset:1024 lds
    v_mfma_f32_32x32x16_bf16 v[32:47], v[164:167], v[200:203], v[32:47]
    ds_read_b128 v[184:187], v219 offset:1024
    ds_read_b128 v[188:191], v219 offset:2048
    v_mfma_f32_32x32x16_bf16 v[48:63], v[164:167], v[204:207], v[48:63]
    ds_read_b128 v[192:195], v219 offset:3072
    buffer_load_dwordx4 v231, s[44:47], s68 offen offset:2048 lds
    v_mfma_f32_32x32x16_bf16 v[64:79], v[168:171], v[200:203], v[64:79]
    buffer_load_dwordx2 v[140:141], v159, s[56:59], s101 offen offset:0 sc1
    v_mfma_f32_32x32x16_bf16 v[80:95], v[168:171], v[204:207], v[80:95]
    buffer_load_dwordx4 v232, s[44:47], s68 offen offset:3072 lds
    v_mfma_f32_32x32x16_bf16 v[96:111], v[172:175], v[200:203], v[96:111]
    buffer_load_dwordx2 v[142:143], v159, s[56:59], s101 offen offset:512 sc1
    buffer_load_dwordx2 v[144:145], v159, s[56:59], s101 offen offset:1024 sc1
    v_mfma_f32_16x16x32_bf16 v[132:135], v[128:131], v[200:203], v[132:135]
    v_mfma_f32_32x32x16_bf16 v[112:127], v[172:175], v[204:207], v[112:127]
    buffer_load_dwordx2 v[146:147], v159, s[56:59], s101 offen offset:1536 sc1
    buffer_load_dwordx2 v[148:149], v159, s[56:59], s101 offen offset:2048 sc1
    v_mfma_f32_16x16x32_bf16 v[136:139], v[128:131], v[204:207], v[136:139]
    s_waitcnt lgkmcnt(0)
    v_mfma_f32_32x32x16_bf16 v[0:15], v[180:183], v[208:211], v[0:15]
    s_waitcnt vmcnt(14)
    s_barrier
    ds_read_b128 v[200:203], v220 offset:16384
    ds_read_b128 v[204:207], v220 offset:20480
    v_mfma_f32_32x32x16_bf16 v[16:31], v[180:183], v[212:215], v[16:31]
    ds_read_b128 v[160:163], v216 offset:20480
    s_add_u32 m0, s72, 4096
    s_nop 0
    buffer_load_dwordx4 v229, s[48:51], s68 offen offset:0 lds
    v_mfma_f32_32x32x16_bf16 v[32:47], v[184:187], v[208:211], v[32:47]
    ds_read_b128 v[164:167], v216 offset:21504
    ds_read_b128 v[168:171], v216 offset:22528
    v_mfma_f32_32x32x16_bf16 v[48:63], v[184:187], v[212:215], v[48:63]
    ds_read_b128 v[172:175], v216 offset:23552
    buffer_load_dwordx4 v230, s[48:51], s68 offen offset:1024 lds
    v_mfma_f32_32x32x16_bf16 v[64:79], v[188:191], v[208:211], v[64:79]
    v_mfma_f32_32x32x16_bf16 v[80:95], v[188:191], v[212:215], v[80:95]
    buffer_load_dwordx4 v231, s[48:51], s68 offen offset:2048 lds
    v_mfma_f32_32x32x16_bf16 v[96:111], v[192:195], v[208:211], v[96:111]
    v_mfma_f32_16x16x32_bf16 v[132:135], v[128:131], v[208:211], v[132:135]
    v_mfma_f32_32x32x16_bf16 v[112:127], v[192:195], v[212:215], v[112:127]
    v_mfma_f32_16x16x32_bf16 v[136:139], v[128:131], v[212:215], v[136:139]
    s_waitcnt lgkmcnt(0)
    v_mfma_f32_32x32x16_bf16 v[0:15], v[160:163], v[200:203], v[0:15]
    ds_read_b128 v[208:211], v221 offset:16384
    ds_read_b128 v[212:215], v221 offset:20480
    v_mfma_f32_32x32x16_bf16 v[16:31], v[160:163], v[204:207], v[16:31]
    ds_read_b128 v[180:183], v217 offset:20480
    buffer_load_dwordx4 v232, s[48:51], s68 offen offset:3072 lds
    v_mfma_f32_32x32x16_bf16 v[32:47], v[164:167], v[200:203], v[32:47]
    ds_read_b128 v[184:187], v217 offset:21504
    ds_read_b128 v[188:191], v217 offset:22528
    s_add_u32 m0, s71, 0
    s_add_u32 s3, s3, 128
    s_cmp_eq_u32 s3, 1280
    s_cselect_b32 s3, 0, s3
    s_add_u32 s68, s3, 0
    buffer_load_dwordx4 v224, s[40:43], s68 offen offset:0 lds
    v_mfma_f32_32x32x16_bf16 v[48:63], v[164:167], v[204:207], v[48:63]
    ds_read_b128 v[192:195], v217 offset:23552
    v_mfma_f32_32x32x16_bf16 v[64:79], v[168:171], v[200:203], v[64:79]
    buffer_load_dwordx4 v225, s[40:43], s68 offen offset:1024 lds
    v_mfma_f32_32x32x16_bf16 v[80:95], v[168:171], v[204:207], v[80:95]
    v_mfma_f32_32x32x16_bf16 v[96:111], v[172:175], v[200:203], v[96:111]
    buffer_load_dwordx4 v226, s[40:43], s68 offen offset:2048 lds
    v_mfma_f32_16x16x32_bf16 v[132:135], v[128:131], v[200:203], v[132:135]
    v_mfma_f32_32x32x16_bf16 v[112:127], v[172:175], v[204:207], v[112:127]
    v_mfma_f32_16x16x32_bf16 v[136:139], v[128:131], v[204:207], v[136:139]
    s_waitcnt lgkmcnt(0)
    v_mfma_f32_32x32x16_bf16 v[0:15], v[180:183], v[208:211], v[0:15]
    ds_read_b128 v[200:203], v222 offset:16384
    ds_read_b128 v[204:207], v222 offset:20480
    v_mfma_f32_32x32x16_bf16 v[16:31], v[180:183], v[212:215], v[16:31]
    ds_read_b128 v[160:163], v218 offset:20480
    buffer_load_dwordx4 v227, s[40:43], s68 offen offset:3072 lds
    v_mfma_f32_32x32x16_bf16 v[32:47], v[184:187], v[208:211], v[32:47]
    ds_read_b128 v[164:167], v218 offset:21504
    ds_read_b128 v[168:171], v218 offset:22528
    s_waitcnt vmcnt(8)
    v_mfma_f32_32x32x16_bf16 v[48:63], v[184:187], v[212:215], v[48:63]
    ds_read_b128 v[172:175], v218 offset:23552
    s_add_u32 m0, s72, 8192
    s_nop 0
    buffer_load_dwordx4 v229, s[44:47], s68 offen offset:0 lds
    v_xor_b32 v152, s83, v141
    v_mfma_f32_32x32x16_bf16 v[64:79], v[188:191], v[208:211], v[64:79]
    v_xor_b32 v153, s83, v143
    v_or_b32 v152, v152, v153
    v_xor_b32 v153, s83, v145
    v_mfma_f32_32x32x16_bf16 v[80:95], v[188:191], v[212:215], v[80:95]
    buffer_load_dwordx4 v230, s[44:47], s68 offen offset:1024 lds
    v_or_b32 v152, v152, v153
    v_mfma_f32_32x32x16_bf16 v[96:111], v[192:195], v[208:211], v[96:111]
    v_xor_b32 v153, s83, v147
    v_or_b32 v152, v152, v153
    v_xor_b32 v153, s83, v149
    v_mfma_f32_16x16x32_bf16 v[132:135], v[128:131], v[208:211], v[132:135]
    v_mfma_f32_32x32x16_bf16 v[112:127], v[192:195], v[212:215], v[112:127]
    v_or_b32 v152, v152, v153
    v_cmp_ne_u32 vcc, 0, v152
    s_cbranch_vccnz L_slow_q
L_go_q:
    v_mfma_f32_16x16x32_bf16 v[136:139], v[128:131], v[212:215], v[136:139]
    s_waitcnt lgkmcnt(0)
    v_mfma_f32_32x32x16_bf16 v[0:15], v[160:163], v[200:203], v[0:15]
    ds_read_b128 v[208:211], v223 offset:16384
    ds_read_b128 v[212:215], v223 offset:20480
    s_lshl_b32 s73, s64, 10
    s_add_u32 s73, s73, 4259840
    v_lshlrev_b32 v243, 4, v233
    buffer_load_dword v243, v243, s[56:59], s73 offen sc1
    v_mfma_f32_32x32x16_bf16 v[16:31], v[160:163], v[204:207], v[16:31]
    ds_read_b128 v[180:183], v219 offset:20480
    buffer_load_dwordx4 v231, s[44:47], s68 offen offset:2048 lds
    v_add_f32 v152, v140, v142
    v_add_f32 v153, v144, v146
    v_mfma_f32_32x32x16_bf16 v[32:47], v[164:167], v[200:203], v[32:47]
    ds_read_b128 v[184:187], v219 offset:21504
    ds_read_b128 v[188:191], v219 offset:22528
    buffer_load_dwordx4 v232, s[44:47], s68 offen offset:3072 lds
    v_add_f32 v152, v152, v148
    v_add_f32 v152, v152, v153
    v_mfma_f32_32x32x16_bf16 v[48:63], v[164:167], v[204:207], v[48:63]
    ds_read_b128 v[192:195], v219 offset:23552
    v_mul_f32 v152, 0x3acccccd, v152
    v_mov_b32 v153, v152
    v_mov_b32 v155, s83
    s_nop 0
    v_permlane32_swap_b32 v152, v153
    v_fma_f32 v153, -v152, v152, v153
    v_mfma_f32_32x32x16_bf16 v[64:79], v[168:171], v[200:203], v[64:79]
    s_add_u32 m0, s72, 12288
    s_nop 0
    buffer_load_dwordx4 v229, s[48:51], s68 offen offset:0 lds
    v_max_f32 v153, 0, v153
    v_cvt_pk_bf16_f32 v153, v153, v153
    v_lshlrev_b32 v153, 16, v153
    v_mfma_f32_32x32x16_bf16 v[80:95], v[168:171], v[204:207], v[80:95]
    v_add_f32 v153, 0x3727c5ac, v153
    v_cvt_pk_bf16_f32 v153, v153, v153
    v_lshlrev_b32 v153, 16, v153
    v_sqrt_f32 v153, v153
    s_nop 0
    v_cvt_pk_bf16_f32 v154, -v152, v153
    v_mfma_f32_32x32x16_bf16 v[96:111], v[172:175], v[200:203], v[96:111]
    buffer_load_dwordx4 v230, s[48:51], s68 offen offset:1024 lds
    s_mov_b32 exec_hi, 0
    buffer_store_dwordx2 v[154:155], v157, s[56:59], s27 offen sc1
    s_mov_b64 exec, -1
    v_mfma_f32_16x16x32_bf16 v[132:135], v[128:131], v[200:203], v[132:135]
    v_mfma_f32_32x32x16_bf16 v[112:127], v[172:175], v[204:207], v[112:127]
    v_and_b32 v153, 0xffff0000, v154
    v_lshlrev_b32 v152, 16, v154
    v_rcp_f32 v153, v153
    s_nop 0
    v_mul_f32 v152, v152, v153
    ds_write2_b32 v156, v153, v152 offset0:0 offset1:2
    v_mfma_f32_16x16x32_bf16 v[136:139], v[128:131], v[204:207], v[136:139]
    s_waitcnt lgkmcnt(1)
    v_mfma_f32_32x32x16_bf16 v[0:15], v[180:183], v[208:211], v[0:15]
    s_waitcnt vmcnt(12)
    s_barrier
    ds_read_b128 v[200:203], v220 offset:0
    ds_read_b128 v[204:207], v220 offset:4096
    v_mfma_f32_32x32x16_bf16 v[16:31], v[180:183], v[212:215], v[16:31]
    ds_read_b128 v[160:163], v216 offset:40960
    buffer_load_dwordx4 v231, s[48:51], s68 offen offset:2048 lds
    v_mfma_f32_32x32x16_bf16 v[32:47], v[184:187], v[208:211], v[32:47]
    ds_read_b128 v[164:167], v216 offset:41984
    ds_read_b128 v[168:171], v216 offset:43008
    v_mfma_f32_32x32x16_bf16 v[48:63], v[184:187], v[212:215], v[48:63]
    ds_read_b128 v[172:175], v216 offset:44032
    buffer_load_dwordx4 v232, s[48:51], s68 offen offset:3072 lds
    v_mfma_f32_32x32x16_bf16 v[64:79], v[188:191], v[208:211], v[64:79]
    v_mfma_f32_32x32x16_bf16 v[80:95], v[188:191], v[212:215], v[80:95]
    s_add_u32 m0, s71, 20480
    s_add_u32 s3, s3, 128
    s_cmp_eq_u32 s3, 1280
    s_cselect_b32 s3, 0, s3
    s_add_u32 s68, s3, 0
    buffer_load_dwordx4 v224, s[40:43], s68 offen offset:0 lds
    v_mfma_f32_32x32x16_bf16 v[96:111], v[192:195], v[208:211], v[96:111]
    v_mfma_f32_16x16x32_bf16 v[132:135], v[128:131], v[208:211], v[132:135]
    v_mfma_f32_32x32x16_bf16 v[112:127], v[192:195], v[212:215], v[112:127]
    v_mfma_f32_16x16x32_bf16 v[136:139], v[128:131], v[212:215], v[136:139]
    s_waitcnt lgkmcnt(0)
    v_mfma_f32_32x32x16_bf16 v[0:15], v[160:163], v[200:203], v[0:15]
    ds_read_b128 v[208:211], v221 offset:0
    ds_read_b128 v[212:215], v221 offset:4096
    v_mfma_f32_32x32x16_bf16 v[16:31], v[160:163], v[204:207], v[16:31]
    ds_read_b128 v[180:183], v217 offset:40960
    buffer_load_dwordx4 v225, s[40:43], s68 offen offset:1024 lds
    v_mfma_f32_32x32x16_bf16 v[32:47], v[164:167], v[200:203], v[32:47]
    ds_read_b128 v[184:187], v217 offset:41984
    ds_read_b128 v[188:191], v217 offset:43008
    v_mfma_f32_32x32x16_bf16 v[48:63], v[164:167], v[204:207], v[48:63]
    ds_read_b128 v[192:195], v217 offset:44032
    buffer_load_dwordx4 v226, s[40:43], s68 offen offset:2048 lds
    v_mfma_f32_32x32x16_bf16 v[64:79], v[168:171], v[200:203], v[64:79]
    s_waitcnt vmcnt(10)
    v_cmp_ne_u32 vcc, s83, v243
    s_cbranch_vccnz L_slow_f1_ssm
L_go_f1_ssm:
    s_barrier
    v_mfma_f32_32x32x16_bf16 v[80:95], v[168:171], v[204:207], v[80:95]
    buffer_load_dwordx4 v227, s[40:43], s68 offen offset:3072 lds
    v_mfma_f32_32x32x16_bf16 v[96:111], v[172:175], v[200:203], v[96:111]
    v_lshlrev_b32 v254, 16, v244
    v_lshlrev_b32 v255, 16, v245
    v_mfma_f32_16x16x32_bf16 v[132:135], v[128:131], v[200:203], v[132:135]
    v_mfma_f32_32x32x16_bf16 v[112:127], v[172:175], v[204:207], v[112:127]
    v_lshlrev_b32 v239, 16, v246
    v_mul_f32 v239, 0x3fb8aa3b, v239
    v_mfma_f32_16x16x32_bf16 v[136:139], v[128:131], v[204:207], v[136:139]
    s_waitcnt lgkmcnt(0)
    v_mfma_f32_32x32x16_bf16 v[0:15], v[180:183], v[208:211], v[0:15]
    ds_read_b128 v[200:203], v222 offset:0
    ds_read_b128 v[204:207], v222 offset:4096
    v_mfma_f32_32x32x16_bf16 v[16:31], v[180:183], v[212:215], v[16:31]
    ds_read_b128 v[160:163], v218 offset:40960
    s_add_u32 m0, s72, 16384
    s_nop 0
    buffer_load_dwordx4 v229, s[44:47], s68 offen offset:0 lds
    v_mfma_f32_32x32x16_bf16 v[32:47], v[184:187], v[208:211], v[32:47]
    ds_read_b128 v[164:167], v218 offset:41984
    ds_read_b128 v[168:171], v218 offset:43008
    buffer_load_dwordx4 v230, s[44:47], s68 offen offset:1024 lds
    v_mfma_f32_32x32x16_bf16 v[48:63], v[184:187], v[212:215], v[48:63]
    ds_read_b128 v[172:175], v218 offset:44032
    v_mfma_f32_32x32x16_bf16 v[64:79], v[188:191], v[208:211], v[64:79]
    buffer_load_dwordx4 v231, s[44:47], s68 offen offset:2048 lds
    v_mfma_f32_32x32x16_bf16 v[80:95], v[188:191], v[212:215], v[80:95]
    v_exp_f32 v239, v239
    s_nop 0
    v_cvt_pk_bf16_f32 v239, v239, v239
    v_mfma_f32_32x32x16_bf16 v[96:111], v[192:195], v[208:211], v[96:111]
    buffer_load_dwordx4 v232, s[44:47], s68 offen offset:3072 lds
    v_lshlrev_b32 v239, 16, v239
    v_mfma_f32_16x16x32_bf16 v[132:135], v[128:131], v[208:211], v[132:135]
    v_mfma_f32_32x32x16_bf16 v[112:127], v[192:195], v[212:215], v[112:127]
    v_mul_f32 v240, v239, v254
    v_mul_f32 v241, v239, v255
    v_mfma_f32_16x16x32_bf16 v[136:139], v[128:131], v[212:215], v[136:139]
    s_waitcnt lgkmcnt(0)
    v_mfma_f32_32x32x16_bf16 v[0:15], v[160:163], v[200:203], v[0:15]
    ds_read_b128 v[208:211], v223 offset:0
    ds_read_b128 v[212:215], v223 offset:4096
    v_mul_f32 v240, 0x3fb8aa3b, v240
    v_mfma_f32_32x32x16_bf16 v[16:31], v[160:163], v[204:207], v[16:31]
    ds_read_b128 v[180:183], v219 offset:40960
    s_add_u32 m0, s72, 20480
    s_nop 0
    buffer_load_dwordx4 v229, s[48:51], s68 offen offset:0 lds
    v_mfma_f32_32x32x16_bf16 v[32:47], v[164:167], v[200:203], v[32:47]
    ds_read_b128 v[184:187], v219 offset:41984
    ds_read_b128 v[188:191], v219 offset:43008
    buffer_load_dwordx4 v230, s[48:51], s68 offen offset:1024 lds
    v_mfma_f32_32x32x16_bf16 v[48:63], v[164:167], v[204:207], v[48:63]
    ds_read_b128 v[192:195], v219 offset:44032
    v_mfma_f32_32x32x16_bf16 v[64:79], v[168:171], v[200:203], v[64:79]
    buffer_load_dwordx4 v231, s[48:51], s68 offen offset:2048 lds
    v_mfma_f32_32x32x16_bf16 v[80:95], v[168:171], v[204:207], v[80:95]
    v_mul_f32 v241, 0.15915494, v241
    v_mul_f32 v242, 0x3f800000, v240
    v_mfma_f32_32x32x16_bf16 v[96:111], v[172:175], v[200:203], v[96:111]
    s_add_u32 s100, s70, 0
    buffer_load_dwordx4 a[40:43], v238, s[56:59], s100 offen offset:0 sc1
    v_mul_f32 v239, 0x3f800000, v241
    v_mfma_f32_16x16x32_bf16 v[132:135], v[128:131], v[200:203], v[132:135]
    v_mfma_f32_32x32x16_bf16 v[112:127], v[172:175], v[204:207], v[112:127]
    v_exp_f32 v242, v242
    v_mfma_f32_16x16x32_bf16 v[136:139], v[128:131], v[204:207], v[136:139]
    s_waitcnt lgkmcnt(0)
    v_mfma_f32_32x32x16_bf16 v[0:15], v[180:183], v[208:211], v[0:15]
    s_waitcnt vmcnt(12)
    s_barrier
    ds_read_b128 v[200:203], v220 offset:8192
    ds_read_b128 v[204:207], v220 offset:12288
    v_mfma_f32_32x32x16_bf16 v[16:31], v[180:183], v[212:215], v[16:31]
    ds_read_b128 v[160:163], v216 offset:0
    buffer_load_dwordx4 v232, s[48:51], s68 offen offset:3072 lds
    v_mfma_f32_32x32x16_bf16 v[32:47], v[184:187], v[208:211], v[32:47]
    ds_read_b128 v[164:167], v216 offset:1024
    ds_read_b128 v[168:171], v216 offset:2048
    s_add_u32 m0, s71, 40960
    s_add_u32 s3, s3, 128
    s_cmp_eq_u32 s3, 1280
    s_cselect_b32 s3, 0, s3
    s_add_u32 s68, s3, 0
    buffer_load_dwordx4 v224, s[40:43], s68 offen offset:0 lds
    v_mfma_f32_32x32x16_bf16 v[48:63], v[184:187], v[212:215], v[48:63]
    ds_read_b128 v[172:175], v216 offset:3072
    v_mfma_f32_32x32x16_bf16 v[64:79], v[188:191], v[208:211], v[64:79]
    buffer_load_dwordx4 v225, s[40:43], s68 offen offset:1024 lds
    v_fract_f32 v239, v239
    v_mfma_f32_32x32x16_bf16 v[80:95], v[188:191], v[212:215], v[80:95]
    v_cos_f32 v244, v239
    v_mfma_f32_32x32x16_bf16 v[96:111], v[192:195], v[208:211], v[96:111]
    buffer_load_dwordx4 v226, s[40:43], s68 offen offset:2048 lds
    v_sin_f32 v245, v239
    v_mfma_f32_16x16x32_bf16 v[132:135], v[128:131], v[208:211], v[132:135]
    v_mfma_f32_32x32x16_bf16 v[112:127], v[192:195], v[212:215], v[112:127]
    v_mul_f32 v244, v244, v242
    v_mul_f32 v245, v245, v242
    v_mfma_f32_16x16x32_bf16 v[136:139], v[128:131], v[212:215], v[136:139]
    s_waitcnt lgkmcnt(0)
    v_mfma_f32_32x32x16_bf16 v[0:15], v[160:163], v[200:203], v[0:15]
    ds_read_b128 v[208:211], v221 offset:8192
    ds_read_b128 v[212:215], v221 offset:12288
    v_mul_f32 v242, v254, v254
    v_mfma_f32_32x32x16_bf16 v[16:31], v[160:163], v[204:207], v[16:31]
    ds_read_b128 v[180:183], v217 offset:0
    buffer_load_dwordx4 v227, s[40:43], s68 offen offset:3072 lds
    v_mfma_f32_32x32x16_bf16 v[32:47], v[164:167], v[200:203], v[32:47]
    ds_read_b128 v[184:187], v217 offset:1024
    ds_read_b128 v[188:191], v217 offset:2048
    s_add_u32 m0, s72, 0
    s_nop 0
    buffer_load_dwordx4 v229, s[44:47], s68 offen offset:0 lds
    v_mfma_f32_32x32x16_bf16 v[48:63], v[164:167], v[204:207], v[48:63]
    ds_read_b128 v[192:195], v217 offset:3072
    buffer_load_dwordx4 v230, s[44:47], s68 offen offset:1024 lds
    v_mfma_f32_32x32x16_bf16 v[64:79], v[168:171], v[200:203], v[64:79]
    v_mfma_f32_32x32x16_bf16 v[80:95], v[168:171], v[204:207], v[80:95]
    buffer_load_dwordx4 a[44:47], v238, s[56:59], s100 offen offset:1024 sc1
    v_fmac_f32 v242, v255, v255
    v_mfma_f32_32x32x16_bf16 v[96:111], v[172:175], v[200:203], v[96:111]
    buffer_load_dwordx4 a[48:51], v238, s[56:59], s100 offen offset:2048 sc1
    v_rcp_f32 v242, v242
    v_mfma_f32_16x16x32_bf16 v[132:135], v[128:131], v[200:203], v[132:135]
    v_mfma_f32_32x32x16_bf16 v[112:127], v[172:175], v[204:207], v[112:127]
    v_add_f32 v239, -1.0, v244
    v_mul_f32 v246, v239, v254
    v_mfma_f32_16x16x32_bf16 v[136:139], v[128:131], v[204:207], v[136:139]
    s_waitcnt lgkmcnt(0)
    v_mfma_f32_32x32x16_bf16 v[0:15], v[180:183], v[208:211], v[0:15]
    ds_read_b128 v[200:203], v222 offset:8192
    ds_read_b128 v[204:207], v222 offset:12288
    v_mfma_f32_32x32x16_bf16 v[16:31], v[180:183], v[212:215], v[16:31]
    ds_read_b128 v[160:163], v218 offset:0
    buffer_load_dwordx4 v231, s[44:47], s68 offen offset:2048 lds
    v_mfma_f32_32x32x16_bf16 v[32:47], v[184:187], v[208:211], v[32:47]
    ds_read_b128 v[164:167], v218 offset:1024
    ds_read_b128 v[168:171], v218 offset:2048
    buffer_load_dwordx4 v232, s[44:47], s68 offen offset:3072 lds
    v_mfma_f32_32x32x16_bf16 v[48:63], v[184:187], v[212:215], v[48:63]
    ds_read_b128 v[172:175], v218 offset:3072
    v_mfma_f32_32x32x16_bf16 v[64:79], v[188:191], v[208:211], v[64:79]
    s_add_u32 m0, s72, 4096
    s_nop 0
    buffer_load_dwordx4 v229, s[48:51], s68 offen offset:0 lds
    v_mfma_f32_32x32x16_bf16 v[80:95], v[188:191], v[212:215], v[80:95]
    v_fmac_f32 v246, v245, v255
    v_mul_f32 v247, v245, v254
    v_mfma_f32_32x32x16_bf16 v[96:111], v[192:195], v[208:211], v[96:111]
    buffer_load_dwordx4 a[52:55], v238, s[56:59], s100 offen offset:3072 sc1
    v_fma_f32 v247, -v239, v255, v247
    v_mfma_f32_16x16x32_bf16 v[132:135], v[128:131], v[208:211], v[132:135]
    v_mfma_f32_32x32x16_bf16 v[112:127], v[192:195], v[212:215], v[112:127]
    v_add_f32 v242, v242, v242
    v_mul_f32 v246, v246, v242
    v_mfma_f32_16x16x32_bf16 v[136:139], v[128:131], v[212:215], v[136:139]
    s_waitcnt lgkmcnt(0)
    v_mfma_f32_32x32x16_bf16 v[0:15], v[160:163], v[200:203], v[0:15]
    ds_read_b128 v[208:211], v223 offset:8192
    ds_read_b128 v[212:215], v223 offset:12288
    v_mul_f32 v247, v247, v242
    v_mfma_f32_32x32x16_bf16 v[16:31], v[160:163], v[204:207], v[16:31]
    ds_read_b128 v[180:183], v219 offset:0
    buffer_load_dwordx4 v230, s[48:51], s68 offen offset:1024 lds
    v_mfma_f32_32x32x16_bf16 v[32:47], v[164:167], v[200:203], v[32:47]
    ds_read_b128 v[184:187], v219 offset:1024
    ds_read_b128 v[188:191], v219 offset:2048
    buffer_load_dwordx4 v231, s[48:51], s68 offen offset:2048 lds
    v_mfma_f32_32x32x16_bf16 v[48:63], v[164:167], v[204:207], v[48:63]
    ds_read_b128 v[192:195], v219 offset:3072
    v_mfma_f32_32x32x16_bf16 v[64:79], v[168:171], v[200:203], v[64:79]
    buffer_load_dwordx4 v232, s[48:51], s68 offen offset:3072 lds
    v_mfma_f32_32x32x16_bf16 v[80:95], v[168:171], v[204:207], v[80:95]
    v_mul_f32 v242, 0x42000000, v240
    v_mul_f32 v239, 0x42000000, v241
    v_mfma_f32_32x32x16_bf16 v[96:111], v[172:175], v[200:203], v[96:111]
    s_add_u32 s100, s100, 4096
    buffer_load_dwordx4 a[56:59], v238, s[56:59], s100 offen offset:0 sc1
    v_mfma_f32_16x16x32_bf16 v[132:135], v[128:131], v[200:203], v[132:135]
    v_mfma_f32_32x32x16_bf16 v[112:127], v[172:175], v[204:207], v[112:127]
    v_exp_f32 v242, v242
    v_fract_f32 v239, v239
    v_mfma_f32_16x16x32_bf16 v[136:139], v[128:131], v[204:207], v[136:139]
    s_waitcnt lgkmcnt(0)
    v_mfma_f32_32x32x16_bf16 v[0:15], v[180:183], v[208:211], v[0:15]
    s_waitcnt vmcnt(16)
    s_barrier
    ds_read_b128 v[200:203], v220 offset:16384
    ds_read_b128 v[204:207], v220 offset:20480
    v_mfma_f32_32x32x16_bf16 v[16:31], v[180:183], v[212:215], v[16:31]
    ds_read_b128 v[160:163], v216 offset:20480
    s_add_u32 m0, s71, 0
    s_add_u32 s3, s3, 128
    s_cmp_eq_u32 s3, 1280
    s_cselect_b32 s3, 0, s3
    s_add_u32 s68, s3, 0
    buffer_load_dwordx4 v224, s[40:43], s68 offen offset:0 lds
    v_mfma_f32_32x32x16_bf16 v[32:47], v[184:187], v[208:211], v[32:47]
    ds_read_b128 v[164:167], v216 offset:21504
    ds_read_b128 v[168:171], v216 offset:22528
    buffer_load_dwordx4 v225, s[40:43], s68 offen offset:1024 lds
    v_mfma_f32_32x32x16_bf16 v[48:63], v[184:187], v[212:215], v[48:63]
    ds_read_b128 v[172:175], v216 offset:23552
    buffer_load_dwordx4 v226, s[40:43], s68 offen offset:2048 lds
    v_mfma_f32_32x32x16_bf16 v[64:79], v[188:191], v[208:211], v[64:79]
    v_cos_f32 v248, v239
    v_mfma_f32_32x32x16_bf16 v[80:95], v[188:191], v[212:215], v[80:95]
    buffer_load_dwordx4 v227, s[40:43], s68 offen offset:3072 lds
    v_sin_f32 v249, v239
    v_mfma_f32_32x32x16_bf16 v[96:111], v[192:195], v[208:211], v[96:111]
    s_add_u32 s100, s70, 20480
    buffer_load_dwordx4 a[60:63], v238, s[56:59], s100 offen offset:0 sc1
    v_mfma_f32_16x16x32_bf16 v[132:135], v[128:131], v[208:211], v[132:135]
    v_mfma_f32_32x32x16_bf16 v[112:127], v[192:195], v[212:215], v[112:127]
    v_mul_f32 v248, v248, v242
    v_mul_f32 v249, v249, v242
    v_mul_f32 v242, 0x42800000, v240
    v_mfma_f32_16x16x32_bf16 v[136:139], v[128:131], v[212:215], v[136:139]
    s_waitcnt lgkmcnt(0)
    v_mfma_f32_32x32x16_bf16 v[0:15], v[160:163], v[200:203], v[0:15]
    ds_read_b128 v[208:211], v221 offset:16384
    ds_read_b128 v[212:215], v221 offset:20480
    v_mul_f32 v239, 0x42800000, v241
    v_mfma_f32_32x32x16_bf16 v[16:31], v[160:163], v[204:207], v[16:31]
    ds_read_b128 v[180:183], v217 offset:20480
    s_add_u32 m0, s72, 8192
    s_nop 0
    buffer_load_dwordx4 v229, s[44:47], s68 offen offset:0 lds
    v_mfma_f32_32x32x16_bf16 v[32:47], v[164:167], v[200:203], v[32:47]
    ds_read_b128 v[184:187], v217 offset:21504
    ds_read_b128 v[188:191], v217 offset:22528
    buffer_load_dwordx4 v230, s[44:47], s68 offen offset:1024 lds
    v_mfma_f32_32x32x16_bf16 v[48:63], v[164:167], v[204:207], v[48:63]
    ds_read_b128 v[192:195], v217 offset:23552
    v_mfma_f32_32x32x16_bf16 v[64:79], v[168:171], v[200:203], v[64:79]
    buffer_load_dwordx4 v231, s[44:47], s68 offen offset:2048 lds
    v_mfma_f32_32x32x16_bf16 v[80:95], v[168:171], v[204:207], v[80:95]
    v_exp_f32 v242, v242
    v_fract_f32 v239, v239
    v_mfma_f32_32x32x16_bf16 v[96:111], v[172:175], v[200:203], v[96:111]
    buffer_load_dwordx4 v232, s[44:47], s68 offen offset:3072 lds
    v_cos_f32 v250, v239
    v_mfma_f32_16x16x32_bf16 v[132:135], v[128:131], v[200:203], v[132:135]
    v_mfma_f32_32x32x16_bf16 v[112:127], v[172:175], v[204:207], v[112:127]
    v_sin_f32 v251, v239
    v_mfma_f32_16x16x32_bf16 v[136:139], v[128:131], v[204:207], v[136:139]
    s_waitcnt lgkmcnt(0)
    v_mfma_f32_32x32x16_bf16 v[0:15], v[180:183], v[208:211], v[0:15]
    ds_read_b128 v[200:203], v222 offset:16384
    ds_read_b128 v[204:207], v222 offset:20480
    s_lshr_b32 s73, s2, 3
    v_mfma_f32_32x32x16_bf16 v[16:31], v[180:183], v[212:215], v[16:31]
    ds_read_b128 v[160:163], v218 offset:20480
    s_add_u32 m0, s72, 12288
    s_nop 0
    buffer_load_dwordx4 v229, s[48:51], s68 offen offset:0 lds
    s_mul_i32 s73, s73, 3072
    v_mfma_f32_32x32x16_bf16 v[32:47], v[184:187], v[208:211], v[32:47]
    ds_read_b128 v[164:167], v218 offset:21504
    ds_read_b128 v[168:171], v218 offset:22528
    s_cmp_eq_u32 s64, 0
    s_cselect_b32 s73, s73, 134217728
    v_mfma_f32_32x32x16_bf16 v[48:63], v[184:187], v[212:215], v[48:63]
    ds_read_b128 v[172:175], v218 offset:23552
    buffer_load_dwordx4 v230, s[48:51], s68 offen offset:1024 lds
    v_mfma_f32_32x32x16_bf16 v[64:79], v[188:191], v[208:211], v[64:79]
    v_lshl_add_u32 v243, v233, 7, s73
    v_mfma_f32_32x32x16_bf16 v[80:95], v[188:191], v[212:215], v[80:95]
    buffer_load_dwordx4 v231, s[48:51], s68 offen offset:2048 lds
    s_mov_b32 exec_lo, 16777215
    s_mov_b32 exec_hi, 0
    buffer_load_dword a255, v243, s[84:87], 0 offen
    s_mov_b64 exec, -1
    v_mfma_f32_32x32x16_bf16 v[96:111], v[192:195], v[208:211], v[96:111]
    v_mul_f32 v250, v250, v242
    v_mul_f32 v251, v251, v242
    v_mul_f32 v242, 0x43000000, v240
    v_mfma_f32_16x16x32_bf16 v[132:135], v[128:131], v[208:211], v[132:135]
    v_mfma_f32_32x32x16_bf16 v[112:127], v[192:195], v[212:215], v[112:127]
    v_mul_f32 v239, 0x43000000, v241
    v_exp_f32 v242, v242
    v_mfma_f32_16x16x32_bf16 v[136:139], v[128:131], v[212:215], v[136:139]
    s_waitcnt lgkmcnt(0)
    v_mfma_f32_32x32x16_bf16 v[0:15], v[160:163], v[200:203], v[0:15]
    ds_read_b128 v[208:211], v223 offset:16384
    ds_read_b128 v[212:215], v223 offset:20480
    v_mfma_f32_32x32x16_bf16 v[16:31], v[160:163], v[204:207], v[16:31]
    ds_read_b128 v[180:183], v219 offset:20480
    buffer_load_dwordx4 v232, s[48:51], s68 offen offset:3072 lds
    v_mfma_f32_32x32x16_bf16 v[32:47], v[164:167], v[200:203], v[32:47]
    ds_read_b128 v[184:187], v219 offset:21504
    ds_read_b128 v[188:191], v219 offset:22528
    buffer_load_dwordx4 a[64:67], v238, s[56:59], s100 offen offset:1024 sc1
    v_mfma_f32_32x32x16_bf16 v[48:63], v[164:167], v[204:207], v[48:63]
    ds_read_b128 v[192:195], v219 offset:23552
    v_mfma_f32_32x32x16_bf16 v[64:79], v[168:171], v[200:203], v[64:79]
    buffer_load_dwordx4 a[68:71], v238, s[56:59], s100 offen offset:2048 sc1
    v_fract_f32 v239, v239
    v_mfma_f32_32x32x16_bf16 v[80:95], v[168:171], v[204:207], v[80:95]
    v_cos_f32 v252, v239
    v_mfma_f32_32x32x16_bf16 v[96:111], v[172:175], v[200:203], v[96:111]
    buffer_load_dwordx4 a[72:75], v238, s[56:59], s100 offen offset:3072 sc1
    v_sin_f32 v253, v239
    v_mfma_f32_16x16x32_bf16 v[132:135], v[128:131], v[200:203], v[132:135]
    v_mfma_f32_32x32x16_bf16 v[112:127], v[172:175], v[204:207], v[112:127]
    v_mul_f32 v252, v252, v242
    v_mul_f32 v253, v253, v242
    v_mfma_f32_16x16x32_bf16 v[136:139], v[128:131], v[204:207], v[136:139]
    s_waitcnt lgkmcnt(0)
    v_mfma_f32_32x32x16_bf16 v[0:15], v[180:183], v[208:211], v[0:15]
    s_waitcnt vmcnt(18)
    s_barrier
    ds_read_b128 v[200:203], v220 offset:0
    ds_read_b128 v[204:207], v220 offset:4096
    v_mfma_f32_32x32x16_bf16 v[16:31], v[180:183], v[212:215], v[16:31]
    ds_read_b128 v[160:163], v216 offset:40960
    s_add_u32 s100, s100, 4096
    buffer_load_dwordx4 a[76:79], v238, s[56:59], s100 offen offset:0 sc1
    v_mfma_f32_32x32x16_bf16 v[32:47], v[184:187], v[208:211], v[32:47]
    ds_read_b128 v[164:167], v216 offset:41984
    ds_read_b128 v[168:171], v216 offset:43008
    s_add_u32 s100, s70, 40960
    buffer_load_dwordx4 a[80:83], v238, s[56:59], s100 offen offset:0 sc1
    v_mfma_f32_32x32x16_bf16 v[48:63], v[184:187], v[212:215], v[48:63]
    ds_read_b128 v[172:175], v216 offset:44032
    buffer_load_dwordx4 a[84:87], v238, s[56:59], s100 offen offset:1024 sc1
    v_mfma_f32_32x32x16_bf16 v[64:79], v[188:191], v[208:211], v[64:79]
    v_mul_f32 v242, 0x43800000, v240
    v_mfma_f32_32x32x16_bf16 v[80:95], v[188:191], v[212:215], v[80:95]
    buffer_load_dwordx4 a[88:91], v238, s[56:59], s100 offen offset:2048 sc1
    v_mul_f32 v239, 0x43800000, v241
    v_mfma_f32_32x32x16_bf16 v[96:111], v[192:195], v[208:211], v[96:111]
    buffer_load_dwordx4 a[92:95], v238, s[56:59], s100 offen offset:3072 sc1
    v_exp_f32 v242, v242
    v_mfma_f32_16x16x32_bf16 v[132:135], v[128:131], v[208:211], v[132:135]
    v_mfma_f32_32x32x16_bf16 v[112:127], v[192:195], v[212:215], v[112:127]
    v_fract_f32 v239, v239
    v_cos_f32 v254, v239
    v_mfma_f32_16x16x32_bf16 v[136:139], v[128:131], v[212:215], v[136:139]
    s_waitcnt lgkmcnt(0)
    v_mfma_f32_32x32x16_bf16 v[0:15], v[160:163], v[200:203], v[0:15]
    ds_read_b128 v[208:211], v221 offset:0
    ds_read_b128 v[212:215], v221 offset:4096
    v_mfma_f32_32x32x16_bf16 v[16:31], v[160:163], v[204:207], v[16:31]
    ds_read_b128 v[180:183], v217 offset:40960
    s_add_u32 s100, s100, 4096
    buffer_load_dwordx4 a[96:99], v238, s[56:59], s100 offen offset:0 sc1
    v_mfma_f32_32x32x16_bf16 v[32:47], v[164:167], v[200:203], v[32:47]
    ds_read_b128 v[184:187], v217 offset:41984
    ds_read_b128 v[188:191], v217 offset:43008
    s_add_u32 s100, s70, 61440
    buffer_load_dwordx4 a[100:103], v238, s[56:59], s100 offen offset:0 sc1
    v_mfma_f32_32x32x16_bf16 v[48:63], v[164:167], v[204:207], v[48:63]
    ds_read_b128 v[192:195], v217 offset:44032
    v_mfma_f32_32x32x16_bf16 v[64:79], v[168:171], v[200:203], v[64:79]
    buffer_load_dwordx4 a[104:107], v238, s[56:59], s100 offen offset:1024 sc1
    v_mfma_f32_32x32x16_bf16 v[80:95], v[168:171], v[204:207], v[80:95]
    v_sin_f32 v255, v239
    v_mfma_f32_32x32x16_bf16 v[96:111], v[172:175], v[200:203], v[96:111]
    buffer_load_dwordx4 a[108:111], v238, s[56:59], s100 offen offset:2048 sc1
    v_mfma_f32_16x16x32_bf16 v[132:135], v[128:131], v[200:203], v[132:135]
    v_mfma_f32_32x32x16_bf16 v[112:127], v[172:175], v[204:207], v[112:127]
    v_mul_f32 v254, v254, v242
    v_mul_f32 v255, v255, v242
    v_mfma_f32_16x16x32_bf16 v[136:139], v[128:131], v[204:207], v[136:139]
    s_waitcnt lgkmcnt(0)
    v_mfma_f32_32x32x16_bf16 v[0:15], v[180:183], v[208:211], v[0:15]
    ds_read_b128 v[200:203], v222 offset:0
    ds_read_b128 v[204:207], v222 offset:4096
    v_mfma_f32_32x32x16_bf16 v[16:31], v[180:183], v[212:215], v[16:31]
    ds_read_b128 v[160:163], v218 offset:40960
    buffer_load_dwordx4 a[112:115], v238, s[56:59], s100 offen offset:3072 sc1
    v_mfma_f32_32x32x16_bf16 v[32:47], v[184:187], v[208:211], v[32:47]
    ds_read_b128 v[164:167], v218 offset:41984
    ds_read_b128 v[168:171], v218 offset:43008
    s_add_u32 s100, s100, 4096
    buffer_load_dwordx4 a[116:119], v238, s[56:59], s100 offen offset:0 sc1
    v_mfma_f32_32x32x16_bf16 v[48:63], v[184:187], v[212:215], v[48:63]
    ds_read_b128 v[172:175], v218 offset:44032
    v_mfma_f32_32x32x16_bf16 v[64:79], v[188:191], v[208:211], v[64:79]
    s_add_u32 s100, s70, 81920
    buffer_load_dwordx4 a[120:123], v238, s[56:59], s100 offen offset:0 sc1
    v_mfma_f32_32x32x16_bf16 v[80:95], v[188:191], v[212:215], v[80:95]
    v_mfma_f32_32x32x16_bf16 v[96:111], v[192:195], v[208:211], v[96:111]
    buffer_load_dwordx4 a[124:127], v238, s[56:59], s100 offen offset:1024 sc1
    v_mfma_f32_16x16x32_bf16 v[132:135], v[128:131], v[208:211], v[132:135]
    v_mfma_f32_32x32x16_bf16 v[112:127], v[192:195], v[212:215], v[112:127]
    v_mfma_f32_16x16x32_bf16 v[136:139], v[128:131], v[212:215], v[136:139]
    s_waitcnt lgkmcnt(0)
    v_mfma_f32_32x32x16_bf16 v[0:15], v[160:163], v[200:203], v[0:15]
    ds_read_b128 v[208:211], v223 offset:0
    ds_read_b128 v[212:215], v223 offset:4096
    v_mfma_f32_32x32x16_bf16 v[16:31], v[160:163], v[204:207], v[16:31]
    ds_read_b128 v[180:183], v219 offset:40960
    buffer_load_dwordx4 a[128:131], v238, s[56:59], s100 offen offset:2048 sc1
    v_mfma_f32_32x32x16_bf16 v[32:47], v[164:167], v[200:203], v[32:47]
    ds_read_b128 v[184:187], v219 offset:41984
    ds_read_b128 v[188:191], v219 offset:43008
    buffer_load_dwordx4 a[132:135], v238, s[56:59], s100 offen offset:3072 sc1
    v_mfma_f32_32x32x16_bf16 v[48:63], v[164:167], v[204:207], v[48:63]
    ds_read_b128 v[192:195], v219 offset:44032
    s_add_u32 s100, s100, 4096
    buffer_load_dwordx4 a[136:139], v238, s[56:59], s100 offen offset:0 sc1
    v_mfma_f32_32x32x16_bf16 v[64:79], v[168:171], v[200:203], v[64:79]
    v_mfma_f32_32x32x16_bf16 v[80:95], v[168:171], v[204:207], v[80:95]
    s_add_u32 s100, s70, 102400
    buffer_load_dwordx4 a[140:143], v238, s[56:59], s100 offen offset:0 sc1
    v_mfma_f32_32x32x16_bf16 v[96:111], v[172:175], v[200:203], v[96:111]
    buffer_load_dwordx4 a[144:147], v238, s[56:59], s100 offen offset:1024 sc1
    v_mfma_f32_16x16x32_bf16 v[132:135], v[128:131], v[200:203], v[132:135]
    v_mfma_f32_32x32x16_bf16 v[112:127], v[172:175], v[204:207], v[112:127]
    v_mfma_f32_16x16x32_bf16 v[136:139], v[128:131], v[204:207], v[136:139]
    s_waitcnt lgkmcnt(0)
    v_mfma_f32_32x32x16_bf16 v[0:15], v[180:183], v[208:211], v[0:15]
    s_waitcnt vmcnt(21)
    s_barrier
    ds_read_b128 v[200:203], v220 offset:8192
    ds_read_b128 v[204:207], v220 offset:12288
    v_mfma_f32_32x32x16_bf16 v[16:31], v[180:183], v[212:215], v[16:31]
    ds_read_b128 v[160:163], v216 offset:0
    buffer_load_dwordx4 a[148:151], v238, s[56:59], s100 offen offset:2048 sc1
    v_mfma_f32_32x32x16_bf16 v[32:47], v[184:187], v[208:211], v[32:47]
    ds_read_b128 v[164:167], v216 offset:1024
    ds_read_b128 v[168:171], v216 offset:2048
    buffer_load_dwordx4 a[152:155], v238, s[56:59], s100 offen offset:3072 sc1
    v_mfma_f32_32x32x16_bf16 v[48:63], v[184:187], v[212:215], v[48:63]
    ds_read_b128 v[172:175], v216 offset:3072
    v_mfma_f32_32x32x16_bf16 v[64:79], v[188:191], v[208:211], v[64:79]
    s_add_u32 s100, s100, 4096
    buffer_load_dwordx4 a[156:159], v238, s[56:59], s100 offen offset:0 sc1
    v_mfma_f32_32x32x16_bf16 v[80:95], v[188:191], v[212:215], v[80:95]
    v_mfma_f32_32x32x16_bf16 v[96:111], v[192:195], v[208:211], v[96:111]
    s_add_u32 s100, s70, 122880
    buffer_load_dwordx4 a[160:163], v238, s[56:59], s100 offen offset:0 sc1
    v_mfma_f32_16x16x32_bf16 v[132:135], v[128:131], v[208:211], v[132:135]
    v_mfma_f32_32x32x16_bf16 v[112:127], v[192:195], v[212:215], v[112:127]
    v_mfma_f32_16x16x32_bf16 v[136:139], v[128:131], v[212:215], v[136:139]
    s_waitcnt lgkmcnt(0)
    v_mfma_f32_32x32x16_bf16 v[0:15], v[160:163], v[200:203], v[0:15]
    ds_read_b128 v[208:211], v221 offset:8192
    ds_read_b128 v[212:215], v221 offset:12288
    v_mfma_f32_32x32x16_bf16 v[16:31], v[160:163], v[204:207], v[16:31]
    ds_read_b128 v[180:183], v217 offset:0
    buffer_load_dwordx4 a[164:167], v238, s[56:59], s100 offen offset:1024 sc1
    v_mfma_f32_32x32x16_bf16 v[32:47], v[164:167], v[200:203], v[32:47]
    ds_read_b128 v[184:187], v217 offset:1024
    ds_read_b128 v[188:191], v217 offset:2048
    buffer_load_dwordx4 a[168:171], v238, s[56:59], s100 offen offset:2048 sc1
    v_mfma_f32_32x32x16_bf16 v[48:63], v[164:167], v[204:207], v[48:63]
    ds_read_b128 v[192:195], v217 offset:3072
    v_mfma_f32_32x32x16_bf16 v[64:79], v[168:171], v[200:203], v[64:79]
    buffer_load_dwordx4 a[172:175], v238, s[56:59], s100 offen offset:3072 sc1
    v_mfma_f32_32x32x16_bf16 v[80:95], v[168:171], v[204:207], v[80:95]
    v_mfma_f32_32x32x16_bf16 v[96:111], v[172:175], v[200:203], v[96:111]
    s_add_u32 s100, s100, 4096
    buffer_load_dwordx4 a[176:179], v238, s[56:59], s100 offen offset:0 sc1
    v_mfma_f32_16x16x32_bf16 v[132:135], v[128:131], v[200:203], v[132:135]
    v_mfma_f32_32x32x16_bf16 v[112:127], v[172:175], v[204:207], v[112:127]
    v_mfma_f32_16x16x32_bf16 v[136:139], v[128:131], v[204:207], v[136:139]
    s_waitcnt lgkmcnt(0)
    v_mfma_f32_32x32x16_bf16 v[0:15], v[180:183], v[208:211], v[0:15]
    ds_read_b128 v[200:203], v222 offset:8192
    ds_read_b128 v[204:207], v222 offset:12288
    v_mfma_f32_32x32x16_bf16 v[16:31], v[180:183], v[212:215], v[16:31]
    ds_read_b128 v[160:163], v218 offset:0
    s_add_u32 s100, s70, 143360
    buffer_load_dwordx4 a[180:183], v238, s[56:59], s100 offen offset:0 sc1
    v_mfma_f32_32x32x16_bf16 v[32:47], v[184:187], v[208:211], v[32:47]
    ds_read_b128 v[164:167], v218 offset:1024
    ds_read_b128 v[168:171], v218 offset:2048
    buffer_load_dwordx4 a[184:187], v238, s[56:59], s100 offen offset:1024 sc1
    v_mfma_f32_32x32x16_bf16 v[48:63], v[184:187], v[212:215], v[48:63]
    ds_read_b128 v[172:175], v218 offset:3072
    buffer_load_dwordx4 a[188:191], v238, s[56:59], s100 offen offset:2048 sc1
    v_mfma_f32_32x32x16_bf16 v[64:79], v[188:191], v[208:211], v[64:79]
    v_mfma_f32_32x32x16_bf16 v[80:95], v[188:191], v[212:215], v[80:95]
    buffer_load_dwordx4 a[192:195], v238, s[56:59], s100 offen offset:3072 sc1
    v_mfma_f32_32x32x16_bf16 v[96:111], v[192:195], v[208:211], v[96:111]
    s_add_u32 s100, s100, 4096
    buffer_load_dwordx4 a[196:199], v238, s[56:59], s100 offen offset:0 sc1
    v_mfma_f32_16x16x32_bf16 v[132:135], v[128:131], v[208:211], v[132:135]
    v_mfma_f32_32x32x16_bf16 v[112:127], v[192:195], v[212:215], v[112:127]
    v_mfma_f32_16x16x32_bf16 v[136:139], v[128:131], v[212:215], v[136:139]
    s_waitcnt lgkmcnt(0)
    v_mfma_f32_32x32x16_bf16 v[0:15], v[160:163], v[200:203], v[0:15]
    ds_read_b128 v[208:211], v223 offset:8192
    ds_read_b128 v[212:215], v223 offset:12288
    v_mfma_f32_32x32x16_bf16 v[16:31], v[160:163], v[204:207], v[16:31]
    ds_read_b128 v[180:183], v219 offset:0
    s_add_u32 s100, s70, 163840
    buffer_load_dwordx4 a[200:203], v238, s[56:59], s100 offen offset:0 sc1
    v_mfma_f32_32x32x16_bf16 v[32:47], v[164:167], v[200:203], v[32:47]
    ds_read_b128 v[184:187], v219 offset:1024
    ds_read_b128 v[188:191], v219 offset:2048
    buffer_load_dwordx4 a[204:207], v238, s[56:59], s100 offen offset:1024 sc1
    v_mfma_f32_32x32x16_bf16 v[48:63], v[164:167], v[204:207], v[48:63]
    ds_read_b128 v[192:195], v219 offset:3072
    v_mfma_f32_32x32x16_bf16 v[64:79], v[168:171], v[200:203], v[64:79]
    buffer_load_dwordx4 a[208:211], v238, s[56:59], s100 offen offset:2048 sc1
    v_mfma_f32_32x32x16_bf16 v[80:95], v[168:171], v[204:207], v[80:95]
    v_mfma_f32_32x32x16_bf16 v[96:111], v[172:175], v[200:203], v[96:111]
    buffer_load_dwordx4 a[212:215], v238, s[56:59], s100 offen offset:3072 sc1
    v_mfma_f32_16x16x32_bf16 v[132:135], v[128:131], v[200:203], v[132:135]
    v_mfma_f32_32x32x16_bf16 v[112:127], v[172:175], v[204:207], v[112:127]
    v_mfma_f32_16x16x32_bf16 v[136:139], v[128:131], v[204:207], v[136:139]
    s_waitcnt lgkmcnt(0)
    v_mfma_f32_32x32x16_bf16 v[0:15], v[180:183], v[208:211], v[0:15]
    s_mov_b32 s48, s24
    s_mov_b32 s49, s25
    s_mov_b32 s50, 1280
    s_mov_b32 s51, 0x20000
    s_lshl_b32 s73, s4, 6
    s_lshl_b32 s75, s64, 2
    s_mul_i32 s74, s5, 20
    s_add_u32 s73, s73, s75
    v_mfma_f32_32x32x16_bf16 v[16:31], v[180:183], v[212:215], v[16:31]
    s_mul_i32 s75, s64, 1344
    v_lshrrev_b32 v239, 4, v233
    v_and_b32 v240, 15, v233
    v_mul_u32_u24 v241, 336, v239
    v_lshl_add_u32 v241, v240, 4, v241
    v_add_u32 v222, s75, v241
    v_add_u32 v239, s73, v239
    v_mfma_f32_32x32x16_bf16 v[32:47], v[184:187], v[208:211], v[32:47]
    v_add_u32 v240, s74, v240
    v_mul_u32_u24 v241, 160, v239
    v_add_u32 v241, v241, v240
    v_lshlrev_b32 v220, 4, v241
    v_lshlrev_b32 v241, 3, v241
    v_lshlrev_b32 v240, 3, v240
    s_mov_b32 s76, 0
    buffer_load_dwordx2 v[140:141], v241, s[40:43], s76 offen
    v_mfma_f32_32x32x16_bf16 v[48:63], v[184:187], v[212:215], v[48:63]
    s_mov_b32 s76, 20480
    buffer_load_dwordx2 v[142:143], v241, s[40:43], s76 offen
    s_mov_b32 s76, 40960
    buffer_load_dwordx2 v[144:145], v241, s[40:43], s76 offen
    s_mov_b32 s76, 61440
    buffer_load_dwordx2 v[146:147], v241, s[40:43], s76 offen
    buffer_load_dwordx2 v[150:151], v240, s[48:51], 0 offen
    v_mfma_f32_32x32x16_bf16 v[64:79], v[188:191], v[208:211], v[64:79]
    v_and_b32 v239, 48, v233
    v_bfe_u32 v240, v233, 2, 2
    v_add_u32 v239, v239, v240
    v_and_b32 v240, 3, v233
    v_add_u32 v240, 16, v240
    v_mul_u32_u24 v241, 336, v239
    v_lshl_add_u32 v241, v240, 4, v241
    v_add_u32 v224, s75, v241
    v_mfma_f32_32x32x16_bf16 v[80:95], v[188:191], v[212:215], v[80:95]
    v_add_u32 v239, s73, v239
    v_add_u32 v240, s74, v240
    v_mul_u32_u24 v241, 160, v239
    v_add_u32 v241, v241, v240
    v_lshlrev_b32 v221, 4, v241
    v_lshlrev_b32 v241, 3, v241
    v_lshlrev_b32 v240, 3, v240
    v_mfma_f32_32x32x16_bf16 v[96:111], v[192:195], v[208:211], v[96:111]
    buffer_load_dwordx2 v[148:149], v241, s[40:43], 0 offen
    v_lshlrev_b32 v239, 3, v239
    s_mov_b32 s76, 4194304
    buffer_load_dwordx2 v[154:155], v239, s[56:59], s76 offen sc1
    buffer_load_dwordx2 v[152:153], v240, s[48:51], 0 offen
    s_mov_b32 s44, s34
    s_mov_b32 s45, s35
    s_mov_b32 s46, 5242880
    v_mfma_f32_16x16x32_bf16 v[132:135], v[128:131], v[208:211], v[132:135]
    v_mfma_f32_32x32x16_bf16 v[112:127], v[192:195], v[212:215], v[112:127]
    s_mov_b32 s47, 0x20000
    v_add_u32 v223, 43008, v222
    s_mul_i32 s75, s64, 21504
    v_and_b32 v230, 15, v233
    v_mul_u32_u24 v230, 336, v230
    v_and_b32 v239, 48, v233
    v_add3_u32 v230, v230, v239, s75
    v_mfma_f32_16x16x32_bf16 v[136:139], v[128:131], v[212:215], v[136:139]
    s_waitcnt lgkmcnt(0)
    s_barrier
    ds_read_b128 v[160:163], v158 offset:0
    ds_read_b128 v[164:167], v158 offset:16
    ds_read_b128 v[168:171], v158 offset:32
    ds_read_b128 v[172:175], v158 offset:48
    ds_read_b128 v[176:179], v158 offset:64
    ds_read_b128 v[180:183], v158 offset:80
    v_mov_b32 v234, v132
    v_mov_b32 v235, v136
    s_lshl_b32 s27, s78, 13
    s_add_u32 s27, s27, 4587520
    s_lshl_b32 s74, s65, 9
    s_add_u32 s101, s74, s27
    s_waitcnt lgkmcnt(4)
    v_pk_mul_f32 v[0:1], v[0:1], v[160:161]
    v_pk_mul_f32 v[16:17], v[16:17], v[160:161]
    v_pk_fma_f32 v[0:1], v[162:163], v[234:235], v[0:1] op_sel_hi:[1,0,1]
    v_pk_fma_f32 v[16:17], v[162:163], v[234:235], v[16:17] op_sel:[0,1,0] op_sel_hi:[1,1,1]
    ds_read_b128 v[184:187], v158 offset:96
    v_pk_mul_f32 v[2:3], v[2:3], v[164:165]
    v_pk_mul_f32 v[18:19], v[18:19], v[164:165]
    v_pk_fma_f32 v[2:3], v[166:167], v[234:235], v[2:3] op_sel_hi:[1,0,1]
    v_pk_fma_f32 v[18:19], v[166:167], v[234:235], v[18:19] op_sel:[0,1,0] op_sel_hi:[1,1,1]
    ds_read_b128 v[188:191], v158 offset:112
    v_pk_fma_f32 v[192:193], v[0:1], v[244:245], v[2:3] op_sel_hi:[1,0,1]
    v_pk_fma_f32 v[194:195], v[16:17], v[244:245], v[18:19] op_sel_hi:[1,0,1]
    v_pk_fma_f32 v[192:193], v[16:17], v[244:245], v[192:193] op_sel:[0,1,0] op_sel_hi:[1,1,1] neg_lo:[0,1,0] neg_hi:[0,1,0]
    v_pk_fma_f32 v[194:195], v[0:1], v[244:245], v[194:195] op_sel:[0,1,0] op_sel_hi:[1,1,1]
    s_waitcnt lgkmcnt(4)
    s_nop 0
    v_pk_mul_f32 v[4:5], v[4:5], v[168:169]
    v_pk_mul_f32 v[20:21], v[20:21], v[168:169]
    v_pk_fma_f32 v[4:5], v[170:171], v[234:235], v[4:5] op_sel_hi:[1,0,1]
    v_pk_fma_f32 v[20:21], v[170:171], v[234:235], v[20:21] op_sel:[0,1,0] op_sel_hi:[1,1,1]
    ds_read_b128 v[160:163], v158 offset:128
    v_pk_fma_f32 v[196:197], v[192:193], v[244:245], v[4:5] op_sel_hi:[1,0,1]
    v_pk_fma_f32 v[198:199], v[194:195], v[244:245], v[20:21] op_sel_hi:[1,0,1]
    v_pk_fma_f32 v[196:197], v[194:195], v[244:245], v[196:197] op_sel:[0,1,0] op_sel_hi:[1,1,1] neg_lo:[0,1,0] neg_hi:[0,1,0]
    v_pk_fma_f32 v[198:199], v[192:193], v[244:245], v[198:199] op_sel:[0,1,0] op_sel_hi:[1,1,1]
    s_add_u32 s100, s100, 4096
    buffer_load_dwordx4 a[216:219], v238, s[56:59], s100 offen offset:0 sc1
    v_pk_mul_f32 v[6:7], v[6:7], v[172:173]
    v_pk_mul_f32 v[22:23], v[22:23], v[172:173]
    v_pk_fma_f32 v[6:7], v[174:175], v[234:235], v[6:7] op_sel_hi:[1,0,1]
    v_pk_fma_f32 v[22:23], v[174:175], v[234:235], v[22:23] op_sel:[0,1,0] op_sel_hi:[1,1,1]
    ds_read_b128 v[164:167], v158 offset:144
    v_pk_fma_f32 v[192:193], v[196:197], v[244:245], v[6:7] op_sel_hi:[1,0,1]
    v_pk_fma_f32 v[194:195], v[198:199], v[244:245], v[22:23] op_sel_hi:[1,0,1]
    v_pk_fma_f32 v[192:193], v[198:199], v[244:245], v[192:193] op_sel:[0,1,0] op_sel_hi:[1,1,1] neg_lo:[0,1,0] neg_hi:[0,1,0]
    v_pk_fma_f32 v[194:195], v[196:197], v[244:245], v[194:195] op_sel:[0,1,0] op_sel_hi:[1,1,1]
    s_add_u32 s100, s70, 184320
    buffer_load_dwordx4 a[220:223], v238, s[56:59], s100 offen offset:0 sc1
    s_waitcnt lgkmcnt(4)
    s_nop 0
    v_pk_mul_f32 v[8:9], v[8:9], v[176:177]
    v_pk_mul_f32 v[24:25], v[24:25], v[176:177]
    v_pk_fma_f32 v[8:9], v[178:179], v[234:235], v[8:9] op_sel_hi:[1,0,1]
    v_pk_fma_f32 v[24:25], v[178:179], v[234:235], v[24:25] op_sel:[0,1,0] op_sel_hi:[1,1,1]
    ds_read_b128 v[168:171], v158 offset:160
    v_pk_fma_f32 v[196:197], v[192:193], v[244:245], v[8:9] op_sel_hi:[1,0,1]
    v_pk_fma_f32 v[198:199], v[194:195], v[244:245], v[24:25] op_sel_hi:[1,0,1]
    v_pk_fma_f32 v[196:197], v[194:195], v[244:245], v[196:197] op_sel:[0,1,0] op_sel_hi:[1,1,1] neg_lo:[0,1,0] neg_hi:[0,1,0]
    v_pk_fma_f32 v[198:199], v[192:193], v[244:245], v[198:199] op_sel:[0,1,0] op_sel_hi:[1,1,1]
    buffer_load_dwordx4 a[224:227], v238, s[56:59], s100 offen offset:1024 sc1
    v_pk_mul_f32 v[10:11], v[10:11], v[180:181]
    v_pk_mul_f32 v[26:27], v[26:27], v[180:181]
    v_pk_fma_f32 v[10:11], v[182:183], v[234:235], v[10:11] op_sel_hi:[1,0,1]
    v_pk_fma_f32 v[26:27], v[182:183], v[234:235], v[26:27] op_sel:[0,1,0] op_sel_hi:[1,1,1]
    ds_read_b128 v[172:175], v158 offset:176
    v_pk_fma_f32 v[192:193], v[196:197], v[244:245], v[10:11] op_sel_hi:[1,0,1]
    v_pk_fma_f32 v[194:195], v[198:199], v[244:245], v[26:27] op_sel_hi:[1,0,1]
    v_pk_fma_f32 v[192:193], v[198:199], v[244:245], v[192:193] op_sel:[0,1,0] op_sel_hi:[1,1,1] neg_lo:[0,1,0] neg_hi:[0,1,0]
    v_pk_fma_f32 v[194:195], v[196:197], v[244:245], v[194:195] op_sel:[0,1,0] op_sel_hi:[1,1,1]
    buffer_load_dwordx4 a[228:231], v238, s[56:59], s100 offen offset:2048 sc1
    s_waitcnt lgkmcnt(4)
    s_nop 0
    v_pk_mul_f32 v[12:13], v[12:13], v[184:185]
    v_pk_mul_f32 v[28:29], v[28:29], v[184:185]
    v_pk_fma_f32 v[12:13], v[186:187], v[234:235], v[12:13] op_sel_hi:[1,0,1]
    v_pk_fma_f32 v[28:29], v[186:187], v[234:235], v[28:29] op_sel:[0,1,0] op_sel_hi:[1,1,1]
    ds_read_b128 v[176:179], v158 offset:192
    v_pk_fma_f32 v[196:197], v[192:193], v[244:245], v[12:13] op_sel_hi:[1,0,1]
    v_pk_fma_f32 v[198:199], v[194:195], v[244:245], v[28:29] op_sel_hi:[1,0,1]
    v_pk_fma_f32 v[196:197], v[194:195], v[244:245], v[196:197] op_sel:[0,1,0] op_sel_hi:[1,1,1] neg_lo:[0,1,0] neg_hi:[0,1,0]
    v_pk_fma_f32 v[198:199], v[192:193], v[244:245], v[198:199] op_sel:[0,1,0] op_sel_hi:[1,1,1]
    buffer_load_dwordx4 a[232:235], v238, s[56:59], s100 offen offset:3072 sc1
    v_pk_mul_f32 v[14:15], v[14:15], v[188:189]
    v_pk_mul_f32 v[30:31], v[30:31], v[188:189]
    v_pk_fma_f32 v[14:15], v[190:191], v[234:235], v[14:15] op_sel_hi:[1,0,1]
    v_pk_fma_f32 v[30:31], v[190:191], v[234:235], v[30:31] op_sel:[0,1,0] op_sel_hi:[1,1,1]
    ds_read_b128 v[180:183], v158 offset:208
    v_pk_fma_f32 v[192:193], v[196:197], v[244:245], v[14:15] op_sel_hi:[1,0,1]
    v_pk_fma_f32 v[194:195], v[198:199], v[244:245], v[30:31] op_sel_hi:[1,0,1]
    v_pk_fma_f32 v[192:193], v[198:199], v[244:245], v[192:193] op_sel:[0,1,0] op_sel_hi:[1,1,1] neg_lo:[0,1,0] neg_hi:[0,1,0]
    v_pk_fma_f32 v[194:195], v[196:197], v[244:245], v[194:195] op_sel:[0,1,0] op_sel_hi:[1,1,1]
    s_waitcnt lgkmcnt(4)
    s_nop 0
    v_pk_mul_f32 v[32:33], v[32:33], v[160:161]
    v_pk_mul_f32 v[48:49], v[48:49], v[160:161]
    v_pk_fma_f32 v[32:33], v[162:163], v[234:235], v[32:33] op_sel_hi:[1,0,1]
    v_pk_fma_f32 v[48:49], v[162:163], v[234:235], v[48:49] op_sel:[0,1,0] op_sel_hi:[1,1,1]
    ds_read_b128 v[184:187], v158 offset:224
    v_pk_fma_f32 v[196:197], v[192:193], v[244:245], v[32:33] op_sel_hi:[1,0,1]
    v_pk_fma_f32 v[198:199], v[194:195], v[244:245], v[48:49] op_sel_hi:[1,0,1]
    v_pk_fma_f32 v[196:197], v[194:195], v[244:245], v[196:197] op_sel:[0,1,0] op_sel_hi:[1,1,1] neg_lo:[0,1,0] neg_hi:[0,1,0]
    v_pk_fma_f32 v[198:199], v[192:193], v[244:245], v[198:199] op_sel:[0,1,0] op_sel_hi:[1,1,1]
    s_add_u32 s100, s100, 4096
    buffer_load_dwordx4 a[236:239], v238, s[56:59], s100 offen offset:0 sc1
    v_pk_mul_f32 v[34:35], v[34:35], v[164:165]
    v_pk_mul_f32 v[50:51], v[50:51], v[164:165]
    v_pk_fma_f32 v[34:35], v[166:167], v[234:235], v[34:35] op_sel_hi:[1,0,1]
    v_pk_fma_f32 v[50:51], v[166:167], v[234:235], v[50:51] op_sel:[0,1,0] op_sel_hi:[1,1,1]
    ds_read_b128 v[188:191], v158 offset:240
    v_pk_fma_f32 v[192:193], v[196:197], v[244:245], v[34:35] op_sel_hi:[1,0,1]
    v_pk_fma_f32 v[194:195], v[198:199], v[244:245], v[50:51] op_sel_hi:[1,0,1]
    v_pk_fma_f32 v[192:193], v[198:199], v[244:245], v[192:193] op_sel:[0,1,0] op_sel_hi:[1,1,1] neg_lo:[0,1,0] neg_hi:[0,1,0]
    v_pk_fma_f32 v[194:195], v[196:197], v[244:245], v[194:195] op_sel:[0,1,0] op_sel_hi:[1,1,1]
    s_add_u32 m0, s6, 16384
    s_add_u32 s100, s70, 204800
    buffer_load_dwordx4 v238, s[56:59], s100 offen offset:0 sc1 lds
    s_waitcnt lgkmcnt(4)
    s_nop 0
    v_pk_mul_f32 v[36:37], v[36:37], v[168:169]
    v_pk_mul_f32 v[52:53], v[52:53], v[168:169]
    v_pk_fma_f32 v[36:37], v[170:171], v[234:235], v[36:37] op_sel_hi:[1,0,1]
    v_pk_fma_f32 v[52:53], v[170:171], v[234:235], v[52:53] op_sel:[0,1,0] op_sel_hi:[1,1,1]
    ds_read_b128 v[160:163], v158 offset:256
    v_pk_fma_f32 v[196:197], v[192:193], v[244:245], v[36:37] op_sel_hi:[1,0,1]
    v_pk_fma_f32 v[198:199], v[194:195], v[244:245], v[52:53] op_sel_hi:[1,0,1]
    v_pk_fma_f32 v[196:197], v[194:195], v[244:245], v[196:197] op_sel:[0,1,0] op_sel_hi:[1,1,1] neg_lo:[0,1,0] neg_hi:[0,1,0]
    v_pk_fma_f32 v[198:199], v[192:193], v[244:245], v[198:199] op_sel:[0,1,0] op_sel_hi:[1,1,1]
    buffer_load_dwordx4 v238, s[56:59], s100 offen offset:1024 sc1 lds
    v_pk_mul_f32 v[38:39], v[38:39], v[172:173]
    v_pk_mul_f32 v[54:55], v[54:55], v[172:173]
    v_pk_fma_f32 v[38:39], v[174:175], v[234:235], v[38:39] op_sel_hi:[1,0,1]
    v_pk_fma_f32 v[54:55], v[174:175], v[234:235], v[54:55] op_sel:[0,1,0] op_sel_hi:[1,1,1]
    ds_read_b128 v[164:167], v158 offset:272
    v_pk_fma_f32 v[192:193], v[196:197], v[244:245], v[38:39] op_sel_hi:[1,0,1]
    v_pk_fma_f32 v[194:195], v[198:199], v[244:245], v[54:55] op_sel_hi:[1,0,1]
    v_pk_fma_f32 v[192:193], v[198:199], v[244:245], v[192:193] op_sel:[0,1,0] op_sel_hi:[1,1,1] neg_lo:[0,1,0] neg_hi:[0,1,0]
    v_pk_fma_f32 v[194:195], v[196:197], v[244:245], v[194:195] op_sel:[0,1,0] op_sel_hi:[1,1,1]
    buffer_load_dwordx4 v238, s[56:59], s100 offen offset:2048 sc1 lds
    s_waitcnt lgkmcnt(4)
    s_nop 0
    v_pk_mul_f32 v[40:41], v[40:41], v[176:177]
    v_pk_mul_f32 v[56:57], v[56:57], v[176:177]
    v_pk_fma_f32 v[40:41], v[178:179], v[234:235], v[40:41] op_sel_hi:[1,0,1]
    v_pk_fma_f32 v[56:57], v[178:179], v[234:235], v[56:57] op_sel:[0,1,0] op_sel_hi:[1,1,1]
    ds_read_b128 v[168:171], v158 offset:288
    v_pk_fma_f32 v[196:197], v[192:193], v[244:245], v[40:41] op_sel_hi:[1,0,1]
    v_pk_fma_f32 v[198:199], v[194:195], v[244:245], v[56:57] op_sel_hi:[1,0,1]
    v_pk_fma_f32 v[196:197], v[194:195], v[244:245], v[196:197] op_sel:[0,1,0] op_sel_hi:[1,1,1] neg_lo:[0,1,0] neg_hi:[0,1,0]
    v_pk_fma_f32 v[198:199], v[192:193], v[244:245], v[198:199] op_sel:[0,1,0] op_sel_hi:[1,1,1]
    buffer_load_dwordx4 v238, s[56:59], s100 offen offset:3072 sc1 lds
    v_pk_mul_f32 v[42:43], v[42:43], v[180:181]
    v_pk_mul_f32 v[58:59], v[58:59], v[180:181]
    v_pk_fma_f32 v[42:43], v[182:183], v[234:235], v[42:43] op_sel_hi:[1,0,1]
    v_pk_fma_f32 v[58:59], v[182:183], v[234:235], v[58:59] op_sel:[0,1,0] op_sel_hi:[1,1,1]
    ds_read_b128 v[172:175], v158 offset:304
    v_pk_fma_f32 v[192:193], v[196:197], v[244:245], v[42:43] op_sel_hi:[1,0,1]
    v_pk_fma_f32 v[194:195], v[198:199], v[244:245], v[58:59] op_sel_hi:[1,0,1]
    v_pk_fma_f32 v[192:193], v[198:199], v[244:245], v[192:193] op_sel:[0,1,0] op_sel_hi:[1,1,1] neg_lo:[0,1,0] neg_hi:[0,1,0]
    v_pk_fma_f32 v[194:195], v[196:197], v[244:245], v[194:195] op_sel:[0,1,0] op_sel_hi:[1,1,1]
    s_add_u32 m0, s6, 20480
    s_add_u32 s100, s100, 4096
    buffer_load_dwordx4 v238, s[56:59], s100 offen offset:0 sc1 lds
    s_waitcnt lgkmcnt(4)
    s_nop 0
    v_pk_mul_f32 v[44:45], v[44:45], v[184:185]
    v_pk_mul_f32 v[60:61], v[60:61], v[184:185]
    v_pk_fma_f32 v[44:45], v[186:187], v[234:235], v[44:45] op_sel_hi:[1,0,1]
    v_pk_fma_f32 v[60:61], v[186:187], v[234:235], v[60:61] op_sel:[0,1,0] op_sel_hi:[1,1,1]
    ds_read_b128 v[176:179], v158 offset:320
    v_pk_fma_f32 v[196:197], v[192:193], v[244:245], v[44:45] op_sel_hi:[1,0,1]
    v_pk_fma_f32 v[198:199], v[194:195], v[244:245], v[60:61] op_sel_hi:[1,0,1]
    v_pk_fma_f32 v[196:197], v[194:195], v[244:245], v[196:197] op_sel:[0,1,0] op_sel_hi:[1,1,1] neg_lo:[0,1,0] neg_hi:[0,1,0]
    v_pk_fma_f32 v[198:199], v[192:193], v[244:245], v[198:199] op_sel:[0,1,0] op_sel_hi:[1,1,1]
    v_pk_mul_f32 v[46:47], v[46:47], v[188:189]
    v_pk_mul_f32 v[62:63], v[62:63], v[188:189]
    v_pk_fma_f32 v[46:47], v[190:191], v[234:235], v[46:47] op_sel_hi:[1,0,1]
    v_pk_fma_f32 v[62:63], v[190:191], v[234:235], v[62:63] op_sel:[0,1,0] op_sel_hi:[1,1,1]
    ds_read_b128 v[180:183], v158 offset:336
    v_pk_fma_f32 v[192:193], v[196:197], v[244:245], v[46:47] op_sel_hi:[1,0,1]
    v_pk_fma_f32 v[194:195], v[198:199], v[244:245], v[62:63] op_sel_hi:[1,0,1]
    v_pk_fma_f32 v[192:193], v[198:199], v[244:245], v[192:193] op_sel:[0,1,0] op_sel_hi:[1,1,1] neg_lo:[0,1,0] neg_hi:[0,1,0]
    v_pk_fma_f32 v[194:195], v[196:197], v[244:245], v[194:195] op_sel:[0,1,0] op_sel_hi:[1,1,1]
    s_add_u32 m0, s71, 20480
    s_add_u32 s100, s70, 225280
    buffer_load_dwordx4 v238, s[56:59], s100 offen offset:0 sc1 lds
    s_waitcnt lgkmcnt(4)
    s_nop 0
    v_pk_mul_f32 v[64:65], v[64:65], v[160:161]
    v_pk_mul_f32 v[80:81], v[80:81], v[160:161]
    v_pk_fma_f32 v[64:65], v[162:163], v[234:235], v[64:65] op_sel_hi:[1,0,1]
    v_pk_fma_f32 v[80:81], v[162:163], v[234:235], v[80:81] op_sel:[0,1,0] op_sel_hi:[1,1,1]
    ds_read_b128 v[184:187], v158 offset:352
    v_pk_fma_f32 v[196:197], v[192:193], v[244:245], v[64:65] op_sel_hi:[1,0,1]
    v_pk_fma_f32 v[198:199], v[194:195], v[244:245], v[80:81] op_sel_hi:[1,0,1]
    v_pk_fma_f32 v[196:197], v[194:195], v[244:245], v[196:197] op_sel:[0,1,0] op_sel_hi:[1,1,1] neg_lo:[0,1,0] neg_hi:[0,1,0]
    v_pk_fma_f32 v[198:199], v[192:193], v[244:245], v[198:199] op_sel:[0,1,0] op_sel_hi:[1,1,1]
    buffer_load_dwordx4 v238, s[56:59], s100 offen offset:1024 sc1 lds
    v_pk_mul_f32 v[66:67], v[66:67], v[164:165]
    v_pk_mul_f32 v[82:83], v[82:83], v[164:165]
    v_pk_fma_f32 v[66:67], v[166:167], v[234:235], v[66:67] op_sel_hi:[1,0,1]
    v_pk_fma_f32 v[82:83], v[166:167], v[234:235], v[82:83] op_sel:[0,1,0] op_sel_hi:[1,1,1]
    ds_read_b128 v[188:191], v158 offset:368
    v_pk_fma_f32 v[192:193], v[196:197], v[244:245], v[66:67] op_sel_hi:[1,0,1]
    v_pk_fma_f32 v[194:195], v[198:199], v[244:245], v[82:83] op_sel_hi:[1,0,1]
    v_pk_fma_f32 v[192:193], v[198:199], v[244:245], v[192:193] op_sel:[0,1,0] op_sel_hi:[1,1,1] neg_lo:[0,1,0] neg_hi:[0,1,0]
    v_pk_fma_f32 v[194:195], v[196:197], v[244:245], v[194:195] op_sel:[0,1,0] op_sel_hi:[1,1,1]
    buffer_load_dwordx4 v238, s[56:59], s100 offen offset:2048 sc1 lds
    s_waitcnt lgkmcnt(4)
    s_nop 0
    v_pk_mul_f32 v[68:69], v[68:69], v[168:169]
    v_pk_mul_f32 v[84:85], v[84:85], v[168:169]
    v_pk_fma_f32 v[68:69], v[170:171], v[234:235], v[68:69] op_sel_hi:[1,0,1]
    v_pk_fma_f32 v[84:85], v[170:171], v[234:235], v[84:85] op_sel:[0,1,0] op_sel_hi:[1,1,1]
    ds_read_b128 v[160:163], v158 offset:384
    v_pk_fma_f32 v[196:197], v[192:193], v[244:245], v[68:69] op_sel_hi:[1,0,1]
    v_pk_fma_f32 v[198:199], v[194:195], v[244:245], v[84:85] op_sel_hi:[1,0,1]
    v_pk_fma_f32 v[196:197], v[194:195], v[244:245], v[196:197] op_sel:[0,1,0] op_sel_hi:[1,1,1] neg_lo:[0,1,0] neg_hi:[0,1,0]
    v_pk_fma_f32 v[198:199], v[192:193], v[244:245], v[198:199] op_sel:[0,1,0] op_sel_hi:[1,1,1]
    buffer_load_dwordx4 v238, s[56:59], s100 offen offset:3072 sc1 lds
    v_pk_mul_f32 v[70:71], v[70:71], v[172:173]
    v_pk_mul_f32 v[86:87], v[86:87], v[172:173]
    v_pk_fma_f32 v[70:71], v[174:175], v[234:235], v[70:71] op_sel_hi:[1,0,1]
    v_pk_fma_f32 v[86:87], v[174:175], v[234:235], v[86:87] op_sel:[0,1,0] op_sel_hi:[1,1,1]
    ds_read_b128 v[164:167], v158 offset:400
    v_pk_fma_f32 v[192:193], v[196:197], v[244:245], v[70:71] op_sel_hi:[1,0,1]
    v_pk_fma_f32 v[194:195], v[198:199], v[244:245], v[86:87] op_sel_hi:[1,0,1]
    v_pk_fma_f32 v[192:193], v[198:199], v[244:245], v[192:193] op_sel:[0,1,0] op_sel_hi:[1,1,1] neg_lo:[0,1,0] neg_hi:[0,1,0]
    v_pk_fma_f32 v[194:195], v[196:197], v[244:245], v[194:195] op_sel:[0,1,0] op_sel_hi:[1,1,1]
    s_add_u32 m0, s71, 24576
    s_add_u32 s100, s100, 4096
    buffer_load_dwordx4 v238, s[56:59], s100 offen offset:0 sc1 lds
    s_waitcnt lgkmcnt(4)
    s_nop 0
    v_pk_mul_f32 v[72:73], v[72:73], v[176:177]
    v_pk_mul_f32 v[88:89], v[88:89], v[176:177]
    v_pk_fma_f32 v[72:73], v[178:179], v[234:235], v[72:73] op_sel_hi:[1,0,1]
    v_pk_fma_f32 v[88:89], v[178:179], v[234:235], v[88:89] op_sel:[0,1,0] op_sel_hi:[1,1,1]
    ds_read_b128 v[168:171], v158 offset:416
    v_pk_fma_f32 v[196:197], v[192:193], v[244:245], v[72:73] op_sel_hi:[1,0,1]
    v_pk_fma_f32 v[198:199], v[194:195], v[244:245], v[88:89] op_sel_hi:[1,0,1]
    v_pk_fma_f32 v[196:197], v[194:195], v[244:245], v[196:197] op_sel:[0,1,0] op_sel_hi:[1,1,1] neg_lo:[0,1,0] neg_hi:[0,1,0]
    v_pk_fma_f32 v[198:199], v[192:193], v[244:245], v[198:199] op_sel:[0,1,0] op_sel_hi:[1,1,1]
    v_pk_mul_f32 v[74:75], v[74:75], v[180:181]
    v_pk_mul_f32 v[90:91], v[90:91], v[180:181]
    v_pk_fma_f32 v[74:75], v[182:183], v[234:235], v[74:75] op_sel_hi:[1,0,1]
    v_pk_fma_f32 v[90:91], v[182:183], v[234:235], v[90:91] op_sel:[0,1,0] op_sel_hi:[1,1,1]
    ds_read_b128 v[172:175], v158 offset:432
    v_pk_fma_f32 v[192:193], v[196:197], v[244:245], v[74:75] op_sel_hi:[1,0,1]
    v_pk_fma_f32 v[194:195], v[198:199], v[244:245], v[90:91] op_sel_hi:[1,0,1]
    v_pk_fma_f32 v[192:193], v[198:199], v[244:245], v[192:193] op_sel:[0,1,0] op_sel_hi:[1,1,1] neg_lo:[0,1,0] neg_hi:[0,1,0]
    v_pk_fma_f32 v[194:195], v[196:197], v[244:245], v[194:195] op_sel:[0,1,0] op_sel_hi:[1,1,1]
    s_add_u32 m0, s6, 0
    s_add_u32 s100, s70, 245760
    buffer_load_dwordx4 v238, s[56:59], s100 offen offset:0 sc1 lds
    s_waitcnt lgkmcnt(4)
    v_pk_mul_f32 v[76:77], v[76:77], v[184:185]
    v_pk_mul_f32 v[92:93], v[92:93], v[184:185]
    v_pk_fma_f32 v[76:77], v[186:187], v[234:235], v[76:77] op_sel_hi:[1,0,1]
    v_pk_fma_f32 v[92:93], v[186:187], v[234:235], v[92:93] op_sel:[0,1,0] op_sel_hi:[1,1,1]
    ds_read_b128 v[176:179], v158 offset:448
    v_pk_fma_f32 v[196:197], v[192:193], v[244:245], v[76:77] op_sel_hi:[1,0,1]
    v_pk_fma_f32 v[198:199], v[194:195], v[244:245], v[92:93] op_sel_hi:[1,0,1]
    v_pk_fma_f32 v[196:197], v[194:195], v[244:245], v[196:197] op_sel:[0,1,0] op_sel_hi:[1,1,1] neg_lo:[0,1,0] neg_hi:[0,1,0]
    v_pk_fma_f32 v[198:199], v[192:193], v[244:245], v[198:199] op_sel:[0,1,0] op_sel_hi:[1,1,1]
    buffer_load_dwordx4 v238, s[56:59], s100 offen offset:1024 sc1 lds
    v_pk_mul_f32 v[78:79], v[78:79], v[188:189]
    v_pk_mul_f32 v[94:95], v[94:95], v[188:189]
    v_pk_fma_f32 v[78:79], v[190:191], v[234:235], v[78:79] op_sel_hi:[1,0,1]
    v_pk_fma_f32 v[94:95], v[190:191], v[234:235], v[94:95] op_sel:[0,1,0] op_sel_hi:[1,1,1]
    ds_read_b128 v[180:183], v158 offset:464
    v_pk_fma_f32 v[192:193], v[196:197], v[244:245], v[78:79] op_sel_hi:[1,0,1]
    v_pk_fma_f32 v[194:195], v[198:199], v[244:245], v[94:95] op_sel_hi:[1,0,1]
    v_pk_fma_f32 v[192:193], v[198:199], v[244:245], v[192:193] op_sel:[0,1,0] op_sel_hi:[1,1,1] neg_lo:[0,1,0] neg_hi:[0,1,0]
    v_pk_fma_f32 v[194:195], v[196:197], v[244:245], v[194:195] op_sel:[0,1,0] op_sel_hi:[1,1,1]
    buffer_load_dwordx4 v238, s[56:59], s100 offen offset:2048 sc1 lds
    s_waitcnt lgkmcnt(4)
    s_nop 0
    v_pk_mul_f32 v[96:97], v[96:97], v[160:161]
    v_pk_mul_f32 v[112:113], v[112:113], v[160:161]
    v_pk_fma_f32 v[96:97], v[162:163], v[234:235], v[96:97] op_sel_hi:[1,0,1]
    v_pk_fma_f32 v[112:113], v[162:163], v[234:235], v[112:113] op_sel:[0,1,0] op_sel_hi:[1,1,1]
    ds_read_b128 v[184:187], v158 offset:480
    v_pk_fma_f32 v[196:197], v[192:193], v[244:245], v[96:97] op_sel_hi:[1,0,1]
    v_pk_fma_f32 v[198:199], v[194:195], v[244:245], v[112:113] op_sel_hi:[1,0,1]
    v_pk_fma_f32 v[196:197], v[194:195], v[244:245], v[196:197] op_sel:[0,1,0] op_sel_hi:[1,1,1] neg_lo:[0,1,0] neg_hi:[0,1,0]
    v_pk_fma_f32 v[198:199], v[192:193], v[244:245], v[198:199] op_sel:[0,1,0] op_sel_hi:[1,1,1]
    buffer_load_dwordx4 v238, s[56:59], s100 offen offset:3072 sc1 lds
    v_pk_mul_f32 v[98:99], v[98:99], v[164:165]
    v_pk_mul_f32 v[114:115], v[114:115], v[164:165]
    v_pk_fma_f32 v[98:99], v[166:167], v[234:235], v[98:99] op_sel_hi:[1,0,1]
    v_pk_fma_f32 v[114:115], v[166:167], v[234:235], v[114:115] op_sel:[0,1,0] op_sel_hi:[1,1,1]
    ds_read_b128 v[188:191], v158 offset:496
    v_pk_fma_f32 v[192:193], v[196:197], v[244:245], v[98:99] op_sel_hi:[1,0,1]
    v_pk_fma_f32 v[194:195], v[198:199], v[244:245], v[114:115] op_sel_hi:[1,0,1]
    v_pk_fma_f32 v[192:193], v[198:199], v[244:245], v[192:193] op_sel:[0,1,0] op_sel_hi:[1,1,1] neg_lo:[0,1,0] neg_hi:[0,1,0]
    v_pk_fma_f32 v[194:195], v[196:197], v[244:245], v[194:195] op_sel:[0,1,0] op_sel_hi:[1,1,1]
    s_add_u32 m0, s6, 4096
    s_add_u32 s100, s100, 4096
    buffer_load_dwordx4 v238, s[56:59], s100 offen offset:0 sc1 lds
    s_waitcnt lgkmcnt(4)
    s_nop 0
    v_pk_mul_f32 v[100:101], v[100:101], v[168:169]
    v_pk_mul_f32 v[116:117], v[116:117], v[168:169]
    v_pk_fma_f32 v[100:101], v[170:171], v[234:235], v[100:101] op_sel_hi:[1,0,1]
    v_pk_fma_f32 v[116:117], v[170:171], v[234:235], v[116:117] op_sel:[0,1,0] op_sel_hi:[1,1,1]
    v_pk_fma_f32 v[196:197], v[192:193], v[244:245], v[100:101] op_sel_hi:[1,0,1]
    v_pk_fma_f32 v[198:199], v[194:195], v[244:245], v[116:117] op_sel_hi:[1,0,1]
    v_pk_fma_f32 v[196:197], v[194:195], v[244:245], v[196:197] op_sel:[0,1,0] op_sel_hi:[1,1,1] neg_lo:[0,1,0] neg_hi:[0,1,0]
    v_pk_fma_f32 v[198:199], v[192:193], v[244:245], v[198:199] op_sel:[0,1,0] op_sel_hi:[1,1,1]
    s_add_u32 m0, s71, 40960
    s_add_u32 s100, s70, 266240
    s_add_u32 s100, s100, s7
    s_nop 0
    buffer_load_dwordx4 v238, s[56:59], s100 offen offset:0 sc1 lds
    v_pk_mul_f32 v[102:103], v[102:103], v[172:173]
    v_pk_mul_f32 v[118:119], v[118:119], v[172:173]
    v_pk_fma_f32 v[102:103], v[174:175], v[234:235], v[102:103] op_sel_hi:[1,0,1]
    v_pk_fma_f32 v[118:119], v[174:175], v[234:235], v[118:119] op_sel:[0,1,0] op_sel_hi:[1,1,1]
    v_pk_fma_f32 v[192:193], v[196:197], v[244:245], v[102:103] op_sel_hi:[1,0,1]
    v_pk_fma_f32 v[194:195], v[198:199], v[244:245], v[118:119] op_sel_hi:[1,0,1]
    v_pk_fma_f32 v[192:193], v[198:199], v[244:245], v[192:193] op_sel:[0,1,0] op_sel_hi:[1,1,1] neg_lo:[0,1,0] neg_hi:[0,1,0]
    v_pk_fma_f32 v[194:195], v[196:197], v[244:245], v[194:195] op_sel:[0,1,0] op_sel_hi:[1,1,1]
    s_waitcnt lgkmcnt(2)
    s_nop 0
    v_pk_mul_f32 v[104:105], v[104:105], v[176:177]
    v_pk_mul_f32 v[120:121], v[120:121], v[176:177]
    v_pk_fma_f32 v[104:105], v[178:179], v[234:235], v[104:105] op_sel_hi:[1,0,1]
    v_pk_fma_f32 v[120:121], v[178:179], v[234:235], v[120:121] op_sel:[0,1,0] op_sel_hi:[1,1,1]
    v_pk_fma_f32 v[196:197], v[192:193], v[244:245], v[104:105] op_sel_hi:[1,0,1]
    v_pk_fma_f32 v[198:199], v[194:195], v[244:245], v[120:121] op_sel_hi:[1,0,1]
    v_pk_fma_f32 v[196:197], v[194:195], v[244:245], v[196:197] op_sel:[0,1,0] op_sel_hi:[1,1,1] neg_lo:[0,1,0] neg_hi:[0,1,0]
    v_pk_fma_f32 v[198:199], v[192:193], v[244:245], v[198:199] op_sel:[0,1,0] op_sel_hi:[1,1,1]
    v_pk_mul_f32 v[106:107], v[106:107], v[180:181]
    v_pk_mul_f32 v[122:123], v[122:123], v[180:181]
    v_pk_fma_f32 v[106:107], v[182:183], v[234:235], v[106:107] op_sel_hi:[1,0,1]
    v_pk_fma_f32 v[122:123], v[182:183], v[234:235], v[122:123] op_sel:[0,1,0] op_sel_hi:[1,1,1]
    v_pk_fma_f32 v[192:193], v[196:197], v[244:245], v[106:107] op_sel_hi:[1,0,1]
    v_pk_fma_f32 v[194:195], v[198:199], v[244:245], v[122:123] op_sel_hi:[1,0,1]
    v_pk_fma_f32 v[192:193], v[198:199], v[244:245], v[192:193] op_sel:[0,1,0] op_sel_hi:[1,1,1] neg_lo:[0,1,0] neg_hi:[0,1,0]
    v_pk_fma_f32 v[194:195], v[196:197], v[244:245], v[194:195] op_sel:[0,1,0] op_sel_hi:[1,1,1]
    s_waitcnt lgkmcnt(0)
    s_nop 0
    v_pk_mul_f32 v[108:109], v[108:109], v[184:185]
    v_pk_mul_f32 v[124:125], v[124:125], v[184:185]
    v_pk_fma_f32 v[108:109], v[186:187], v[234:235], v[108:109] op_sel_hi:[1,0,1]
    v_pk_fma_f32 v[124:125], v[186:187], v[234:235], v[124:125] op_sel:[0,1,0] op_sel_hi:[1,1,1]
    v_pk_fma_f32 v[196:197], v[192:193], v[244:245], v[108:109] op_sel_hi:[1,0,1]
    v_pk_fma_f32 v[198:199], v[194:195], v[244:245], v[124:125] op_sel_hi:[1,0,1]
    v_pk_fma_f32 v[196:197], v[194:195], v[244:245], v[196:197] op_sel:[0,1,0] op_sel_hi:[1,1,1] neg_lo:[0,1,0] neg_hi:[0,1,0]
    v_pk_fma_f32 v[198:199], v[192:193], v[244:245], v[198:199] op_sel:[0,1,0] op_sel_hi:[1,1,1]
    v_pk_mul_f32 v[110:111], v[110:111], v[188:189]
    v_pk_mul_f32 v[126:127], v[126:127], v[188:189]
    v_pk_fma_f32 v[110:111], v[190:191], v[234:235], v[110:111] op_sel_hi:[1,0,1]
    v_pk_fma_f32 v[126:127], v[190:191], v[234:235], v[126:127] op_sel:[0,1,0] op_sel_hi:[1,1,1]
    v_pk_fma_f32 v[192:193], v[196:197], v[244:245], v[110:111] op_sel_hi:[1,0,1]
    v_pk_fma_f32 v[194:195], v[198:199], v[244:245], v[126:127] op_sel_hi:[1,0,1]
    v_pk_fma_f32 v[192:193], v[198:199], v[244:245], v[192:193] op_sel:[0,1,0] op_sel_hi:[1,1,1] neg_lo:[0,1,0] neg_hi:[0,1,0]
    v_pk_fma_f32 v[194:195], v[196:197], v[244:245], v[194:195] op_sel:[0,1,0] op_sel_hi:[1,1,1]
    v_mov_b32 v176, v192
    v_mov_b32 v177, v194
    v_mov_b32 v178, v193
    v_mov_b32 v179, v195
    v_pk_fma_f32 v[180:181], v[176:177], v[248:249], v[178:179] op_sel:[0,0,0] op_sel_hi:[1,0,1]
    v_pk_fma_f32 v[180:181], v[176:177], v[248:249], v[180:181] op_sel:[1,1,0] op_sel_hi:[0,1,1] neg_lo:[1,0,0]
    v_mov_b32 v182, v180
    v_mov_b32 v183, v181
    v_mov_b32 v186, s83
    v_mov_b32 v187, 0
    v_permlane32_swap_b32 v180, v182
    v_permlane32_swap_b32 v181, v183
    v_pk_fma_f32 v[184:185], v[180:181], v[250:251], v[182:183] op_sel:[0,0,0] op_sel_hi:[1,0,1]
    v_pk_fma_f32 v[184:185], v[180:181], v[250:251], v[184:185] op_sel:[1,1,0] op_sel_hi:[0,1,1] neg_lo:[1,0,0]
    s_mov_b32 exec_hi, 0
    buffer_store_dwordx4 v[184:187], v238, s[56:59], s101 offen sc1
    s_mov_b64 exec, -1
    s_waitcnt vmcnt(23)
    v_cmp_ne_u32 vcc, s83, v155
    s_cbranch_vccnz L_slow_sts
L_go_sts:
    v_and_b32 v239, 48, v233
    ds_bpermute_b32 v156, v239, v154 offset:0
    ds_bpermute_b32 v158, v239, v154 offset:64
    ds_bpermute_b32 v160, v239, v154 offset:128
    ds_bpermute_b32 v162, v239, v154 offset:192
    v_lshlrev_b32 v164, 16, v150
    v_and_b32 v165, 0xffff0000, v150
    v_lshlrev_b32 v166, 16, v151
    v_and_b32 v167, 0xffff0000, v151
    v_lshlrev_b32 v168, 16, v152
    v_and_b32 v169, 0xffff0000, v152
    v_lshlrev_b32 v170, 16, v153
    v_and_b32 v171, 0xffff0000, v153
    v_and_b32 v155, 0xffff0000, v154
    v_lshlrev_b32 v154, 16, v154
    v_rcp_f32 v155, v155
    v_lshlrev_b32 v216, 16, v148
    v_and_b32 v217, 0xffff0000, v148
    v_lshlrev_b32 v218, 16, v149
    v_and_b32 v219, 0xffff0000, v149
    v_pk_add_f32 v[150:151], v[216:217], v[154:155] op_sel_hi:[1,0]
    v_pk_mul_f32 v[150:151], v[150:151], v[154:155] op_sel:[0,1] op_sel_hi:[1,1]
    v_pk_fma_f32 v[216:217], v[150:151], v[168:169], v[216:217]
    v_pk_add_f32 v[152:153], v[218:219], v[154:155] op_sel_hi:[1,0]
    v_pk_mul_f32 v[152:153], v[152:153], v[154:155] op_sel:[0,1] op_sel_hi:[1,1]
    v_pk_fma_f32 v[218:219], v[152:153], v[170:171], v[218:219]
    s_waitcnt lgkmcnt(0)
    v_and_b32 v157, 0xffff0000, v156
    v_lshlrev_b32 v156, 16, v156
    v_rcp_f32 v157, v157
    v_lshlrev_b32 v200, 16, v140
    v_and_b32 v201, 0xffff0000, v140
    v_lshlrev_b32_e64 v202, 16, v141
    v_and_b32 v203, 0xffff0000, v141
    v_pk_add_f32 v[150:151], v[200:201], v[156:157] op_sel_hi:[1,0]
    v_pk_mul_f32 v[150:151], v[150:151], v[156:157] op_sel:[0,1] op_sel_hi:[1,1]
    v_pk_fma_f32 v[200:201], v[150:151], v[164:165], v[200:201]
    v_pk_add_f32 v[152:153], v[202:203], v[156:157] op_sel_hi:[1,0]
    v_pk_mul_f32 v[152:153], v[152:153], v[156:157] op_sel:[0,1] op_sel_hi:[1,1]
    v_pk_fma_f32 v[202:203], v[152:153], v[166:167], v[202:203]
    v_and_b32 v159, 0xffff0000, v158
    v_lshlrev_b32 v158, 16, v158
    v_rcp_f32 v159, v159
    v_lshlrev_b32 v204, 16, v142
    v_and_b32 v205, 0xffff0000, v142
    v_lshlrev_b32 v206, 16, v143
    v_and_b32 v207, 0xffff0000, v143
    v_pk_add_f32 v[150:151], v[204:205], v[158:159] op_sel_hi:[1,0]
    v_pk_mul_f32 v[150:151], v[150:151], v[158:159] op_sel:[0,1] op_sel_hi:[1,1]
    v_pk_fma_f32 v[204:205], v[150:151], v[164:165], v[204:205]
    v_pk_add_f32 v[152:153], v[206:207], v[158:159] op_sel_hi:[1,0]
    v_pk_mul_f32 v[152:153], v[152:153], v[158:159] op_sel:[0,1] op_sel_hi:[1,1]
    v_pk_fma_f32 v[206:207], v[152:153], v[166:167], v[206:207]
    v_and_b32 v161, 0xffff0000, v160
    v_lshlrev_b32 v160, 16, v160
    v_rcp_f32 v161, v161
    v_lshlrev_b32 v208, 16, v144
    v_and_b32 v209, 0xffff0000, v144
    v_lshlrev_b32 v210, 16, v145
    v_and_b32 v211, 0xffff0000, v145
    v_pk_add_f32 v[150:151], v[208:209], v[160:161] op_sel_hi:[1,0]
    v_pk_mul_f32 v[150:151], v[150:151], v[160:161] op_sel:[0,1] op_sel_hi:[1,1]
    v_pk_fma_f32 v[208:209], v[150:151], v[164:165], v[208:209]
    v_pk_add_f32 v[152:153], v[210:211], v[160:161] op_sel_hi:[1,0]
    v_pk_mul_f32 v[152:153], v[152:153], v[160:161] op_sel:[0,1] op_sel_hi:[1,1]
    v_pk_fma_f32 v[210:211], v[152:153], v[166:167], v[210:211]
    v_and_b32 v163, 0xffff0000, v162
    v_lshlrev_b32 v162, 16, v162
    v_rcp_f32 v163, v163
    v_lshlrev_b32 v212, 16, v146
    v_and_b32 v213, 0xffff0000, v146
    v_lshlrev_b32 v214, 16, v147
    v_and_b32 v215, 0xffff0000, v147
    v_pk_add_f32 v[150:151], v[212:213], v[162:163] op_sel_hi:[1,0]
    v_pk_mul_f32 v[150:151], v[150:151], v[162:163] op_sel:[0,1] op_sel_hi:[1,1]
    v_pk_fma_f32 v[212:213], v[150:151], v[164:165], v[212:213]
    v_pk_add_f32 v[152:153], v[214:215], v[162:163] op_sel_hi:[1,0]
    v_pk_mul_f32 v[152:153], v[152:153], v[162:163] op_sel:[0,1] op_sel_hi:[1,1]
    v_pk_fma_f32 v[214:215], v[152:153], v[166:167], v[214:215]
    v_lshrrev_b32 v188, 5, v233
    v_sub_u32 v188, s65, v188
    v_mov_b32 v189, 134217728
    v_and_b32 v239, 0x1f0, v238
    v_mov_b32 v241, s83
    v_add_u32 v240, -1, v188
    v_cmp_le_i32 vcc, 0, v240
    v_lshl_add_u32 v240, v240, 9, v239
    s_nop 0
    v_cndmask_b32 v160, v189, v240, vcc
    v_cndmask_b32 v168, 0, v241, vcc
    v_add_u32 v240, -3, v188
    v_cmp_le_i32 vcc, 0, v240
    v_lshl_add_u32 v240, v240, 9, v239
    s_nop 0
    v_cndmask_b32 v161, v189, v240, vcc
    v_cndmask_b32 v169, 0, v241, vcc
    v_add_u32 v240, -5, v188
    v_cmp_le_i32 vcc, 0, v240
    v_lshl_add_u32 v240, v240, 9, v239
    s_nop 0
    v_cndmask_b32 v162, v189, v240, vcc
    v_cndmask_b32 v170, 0, v241, vcc
    v_add_u32 v240, -7, v188
    v_cmp_le_i32 vcc, 0, v240
    v_lshl_add_u32 v240, v240, 9, v239
    s_nop 0
    v_cndmask_b32 v163, v189, v240, vcc
    v_cndmask_b32 v171, 0, v241, vcc
    v_add_u32 v240, -9, v188
    v_cmp_le_i32 vcc, 0, v240
    v_lshl_add_u32 v240, v240, 9, v239
    s_nop 0
    v_cndmask_b32 v164, v189, v240, vcc
    v_cndmask_b32 v172, 0, v241, vcc
    v_add_u32 v240, -11, v188
    v_cmp_le_i32 vcc, 0, v240
    v_lshl_add_u32 v240, v240, 9, v239
    s_nop 0
    v_cndmask_b32 v165, v189, v240, vcc
    v_cndmask_b32 v173, 0, v241, vcc
    v_add_u32 v240, -13, v188
    v_cmp_le_i32 vcc, 0, v240
    v_lshl_add_u32 v240, v240, 9, v239
    s_nop 0
    v_cndmask_b32 v166, v189, v240, vcc
    v_cndmask_b32 v174, 0, v241, vcc
    v_add_u32 v240, -15, v188
    v_cmp_le_i32 vcc, 0, v240
    v_lshl_add_u32 v240, v240, 9, v239
    s_nop 0
    v_cndmask_b32 v167, v189, v240, vcc
    v_cndmask_b32 v175, 0, v241, vcc
    s_nop 0
    buffer_load_dwordx4 v238, s[56:59], s100 offen offset:1024 sc1 lds
    v_pk_mul_f32 v[194:195], v[16:17], v[246:247] op_sel:[0,1] op_sel_hi:[1,1]
    v_pk_mul_f32 v[16:17], v[16:17], v[246:247] op_sel_hi:[1,0]
    v_pk_fma_f32 v[16:17], v[0:1], v[246:247], v[16:17] op_sel:[0,1,0] op_sel_hi:[1,1,1]
    v_pk_fma_f32 v[0:1], v[0:1], v[246:247], v[194:195] op_sel_hi:[1,0,1] neg_lo:[0,0,1] neg_hi:[0,0,1]
    buffer_load_dwordx4 v238, s[56:59], s100 offen offset:2048 sc1 lds
    v_pk_mul_f32 v[192:193], v[18:19], v[246:247] op_sel:[0,1] op_sel_hi:[1,1]
    v_pk_mul_f32 v[18:19], v[18:19], v[246:247] op_sel_hi:[1,0]
    v_pk_fma_f32 v[18:19], v[2:3], v[246:247], v[18:19] op_sel:[0,1,0] op_sel_hi:[1,1,1]
    v_pk_fma_f32 v[2:3], v[2:3], v[246:247], v[192:193] op_sel_hi:[1,0,1] neg_lo:[0,0,1] neg_hi:[0,0,1]
    buffer_load_dwordx4 v238, s[56:59], s100 offen offset:3072 sc1 lds
    v_pk_mul_f32 v[194:195], v[20:21], v[246:247] op_sel:[0,1] op_sel_hi:[1,1]
    v_pk_mul_f32 v[20:21], v[20:21], v[246:247] op_sel_hi:[1,0]
    v_pk_fma_f32 v[20:21], v[4:5], v[246:247], v[20:21] op_sel:[0,1,0] op_sel_hi:[1,1,1]
    v_pk_fma_f32 v[4:5], v[4:5], v[246:247], v[194:195] op_sel_hi:[1,0,1] neg_lo:[0,0,1] neg_hi:[0,0,1]
    s_add_u32 m0, s71, 45056
    s_add_u32 s100, s100, 4096
    buffer_load_dwordx4 v238, s[56:59], s100 offen offset:0 sc1 lds
    v_pk_mul_f32 v[192:193], v[22:23], v[246:247] op_sel:[0,1] op_sel_hi:[1,1]
    v_pk_mul_f32 v[22:23], v[22:23], v[246:247] op_sel_hi:[1,0]
    v_pk_fma_f32 v[22:23], v[6:7], v[246:247], v[22:23] op_sel:[0,1,0] op_sel_hi:[1,1,1]
    v_pk_fma_f32 v[6:7], v[6:7], v[246:247], v[192:193] op_sel_hi:[1,0,1] neg_lo:[0,0,1] neg_hi:[0,0,1]
    s_add_u32 m0, s71, 0
    s_mul_i32 s100, s13, 160
    s_add_u32 s100, s100, s9
    buffer_load_dwordx4 v238, s[56:59], s100 offen offset:0 sc1 lds
    v_pk_mul_f32 v[194:195], v[24:25], v[246:247] op_sel:[0,1] op_sel_hi:[1,1]
    v_pk_mul_f32 v[24:25], v[24:25], v[246:247] op_sel_hi:[1,0]
    v_pk_fma_f32 v[24:25], v[8:9], v[246:247], v[24:25] op_sel:[0,1,0] op_sel_hi:[1,1,1]
    v_pk_fma_f32 v[8:9], v[8:9], v[246:247], v[194:195] op_sel_hi:[1,0,1] neg_lo:[0,0,1] neg_hi:[0,0,1]
    buffer_load_dwordx4 v238, s[56:59], s100 offen offset:1024 sc1 lds
    v_pk_mul_f32 v[192:193], v[26:27], v[246:247] op_sel:[0,1] op_sel_hi:[1,1]
    v_pk_mul_f32 v[26:27], v[26:27], v[246:247] op_sel_hi:[1,0]
    v_pk_fma_f32 v[26:27], v[10:11], v[246:247], v[26:27] op_sel:[0,1,0] op_sel_hi:[1,1,1]
    v_pk_fma_f32 v[10:11], v[10:11], v[246:247], v[192:193] op_sel_hi:[1,0,1] neg_lo:[0,0,1] neg_hi:[0,0,1]
    buffer_load_dwordx4 v238, s[56:59], s100 offen offset:2048 sc1 lds
    v_pk_mul_f32 v[194:195], v[28:29], v[246:247] op_sel:[0,1] op_sel_hi:[1,1]
    v_pk_mul_f32 v[28:29], v[28:29], v[246:247] op_sel_hi:[1,0]
    v_pk_fma_f32 v[28:29], v[12:13], v[246:247], v[28:29] op_sel:[0,1,0] op_sel_hi:[1,1,1]
    v_pk_fma_f32 v[12:13], v[12:13], v[246:247], v[194:195] op_sel_hi:[1,0,1] neg_lo:[0,0,1] neg_hi:[0,0,1]
    buffer_load_dwordx4 v238, s[56:59], s100 offen offset:3072 sc1 lds
    v_pk_mul_f32 v[192:193], v[30:31], v[246:247] op_sel:[0,1] op_sel_hi:[1,1]
    v_pk_mul_f32 v[30:31], v[30:31], v[246:247] op_sel_hi:[1,0]
    v_pk_fma_f32 v[30:31], v[14:15], v[246:247], v[30:31] op_sel:[0,1,0] op_sel_hi:[1,1,1]
    v_pk_fma_f32 v[14:15], v[14:15], v[246:247], v[192:193] op_sel_hi:[1,0,1] neg_lo:[0,0,1] neg_hi:[0,0,1]
    s_add_u32 m0, s71, 4096
    s_add_u32 s100, s100, 4096
    buffer_load_dwordx4 v238, s[56:59], s100 offen offset:0 sc1 lds
    v_pk_mul_f32 v[194:195], v[48:49], v[246:247] op_sel:[0,1] op_sel_hi:[1,1]
    v_pk_mul_f32 v[48:49], v[48:49], v[246:247] op_sel_hi:[1,0]
    v_pk_fma_f32 v[48:49], v[32:33], v[246:247], v[48:49] op_sel:[0,1,0] op_sel_hi:[1,1,1]
    v_pk_fma_f32 v[32:33], v[32:33], v[246:247], v[194:195] op_sel_hi:[1,0,1] neg_lo:[0,0,1] neg_hi:[0,0,1]
    s_add_u32 m0, s6, 21504
    s_mul_i32 s100, s13, 160
    s_add_u32 s100, s100, s9
    s_nop 0
    s_add_u32 s100, s100, 10240
    buffer_load_dwordx4 v238, s[56:59], s100 offen offset:0 sc1 lds
    v_pk_mul_f32 v[192:193], v[50:51], v[246:247] op_sel:[0,1] op_sel_hi:[1,1]
    v_pk_mul_f32 v[50:51], v[50:51], v[246:247] op_sel_hi:[1,0]
    v_pk_fma_f32 v[50:51], v[34:35], v[246:247], v[50:51] op_sel:[0,1,0] op_sel_hi:[1,1,1]
    v_pk_fma_f32 v[34:35], v[34:35], v[246:247], v[192:193] op_sel_hi:[1,0,1] neg_lo:[0,0,1] neg_hi:[0,0,1]
    buffer_load_dwordx4 v238, s[56:59], s100 offen offset:1024 sc1 lds
    v_pk_mul_f32 v[194:195], v[52:53], v[246:247] op_sel:[0,1] op_sel_hi:[1,1]
    v_pk_mul_f32 v[52:53], v[52:53], v[246:247] op_sel_hi:[1,0]
    v_pk_fma_f32 v[52:53], v[36:37], v[246:247], v[52:53] op_sel:[0,1,0] op_sel_hi:[1,1,1]
    v_pk_fma_f32 v[36:37], v[36:37], v[246:247], v[194:195] op_sel_hi:[1,0,1] neg_lo:[0,0,1] neg_hi:[0,0,1]
    buffer_load_dwordx4 v238, s[56:59], s100 offen offset:2048 sc1 lds
    v_pk_mul_f32 v[192:193], v[54:55], v[246:247] op_sel:[0,1] op_sel_hi:[1,1]
    v_pk_mul_f32 v[54:55], v[54:55], v[246:247] op_sel_hi:[1,0]
    v_pk_fma_f32 v[54:55], v[38:39], v[246:247], v[54:55] op_sel:[0,1,0] op_sel_hi:[1,1,1]
    v_pk_fma_f32 v[38:39], v[38:39], v[246:247], v[192:193] op_sel_hi:[1,0,1] neg_lo:[0,0,1] neg_hi:[0,0,1]
    s_add_u32 m0, s6, 2048
    s_nop 0
    s_nop 0
    buffer_load_dwordx4 v238, s[56:59], s100 offen offset:3072 sc1 lds
    v_pk_mul_f32 v[194:195], v[56:57], v[246:247] op_sel:[0,1] op_sel_hi:[1,1]
    v_pk_mul_f32 v[56:57], v[56:57], v[246:247] op_sel_hi:[1,0]
    v_pk_fma_f32 v[56:57], v[40:41], v[246:247], v[56:57] op_sel:[0,1,0] op_sel_hi:[1,1,1]
    v_pk_fma_f32 v[40:41], v[40:41], v[246:247], v[194:195] op_sel_hi:[1,0,1] neg_lo:[0,0,1] neg_hi:[0,0,1]
    s_add_u32 m0, s6, 6144
    s_add_u32 s100, s100, 4096
    buffer_load_dwordx4 v238, s[56:59], s100 offen offset:0 sc1 lds
    v_pk_mul_f32 v[192:193], v[58:59], v[246:247] op_sel:[0,1] op_sel_hi:[1,1]
    v_pk_mul_f32 v[58:59], v[58:59], v[246:247] op_sel_hi:[1,0]
    v_pk_fma_f32 v[58:59], v[42:43], v[246:247], v[58:59] op_sel:[0,1,0] op_sel_hi:[1,1,1]
    v_pk_fma_f32 v[42:43], v[42:43], v[246:247], v[192:193] op_sel_hi:[1,0,1] neg_lo:[0,0,1] neg_hi:[0,0,1]
    v_pk_mul_f32 v[194:195], v[60:61], v[246:247] op_sel:[0,1] op_sel_hi:[1,1]
    v_pk_mul_f32 v[60:61], v[60:61], v[246:247] op_sel_hi:[1,0]
    v_pk_fma_f32 v[60:61], v[44:45], v[246:247], v[60:61] op_sel:[0,1,0] op_sel_hi:[1,1,1]
    v_pk_fma_f32 v[44:45], v[44:45], v[246:247], v[194:195] op_sel_hi:[1,0,1] neg_lo:[0,0,1] neg_hi:[0,0,1]
    v_pk_mul_f32 v[192:193], v[62:63], v[246:247] op_sel:[0,1] op_sel_hi:[1,1]
    v_pk_mul_f32 v[62:63], v[62:63], v[246:247] op_sel_hi:[1,0]
    v_pk_fma_f32 v[62:63], v[46:47], v[246:247], v[62:63] op_sel:[0,1,0] op_sel_hi:[1,1,1]
    v_pk_fma_f32 v[46:47], v[46:47], v[246:247], v[192:193] op_sel_hi:[1,0,1] neg_lo:[0,0,1] neg_hi:[0,0,1]
    v_pk_mul_f32 v[194:195], v[80:81], v[246:247] op_sel:[0,1] op_sel_hi:[1,1]
    v_pk_mul_f32 v[80:81], v[80:81], v[246:247] op_sel_hi:[1,0]
    v_pk_fma_f32 v[80:81], v[64:65], v[246:247], v[80:81] op_sel:[0,1,0] op_sel_hi:[1,1,1]
    v_pk_fma_f32 v[64:65], v[64:65], v[246:247], v[194:195] op_sel_hi:[1,0,1] neg_lo:[0,0,1] neg_hi:[0,0,1]
    v_pk_mul_f32 v[192:193], v[82:83], v[246:247] op_sel:[0,1] op_sel_hi:[1,1]
    v_pk_mul_f32 v[82:83], v[82:83], v[246:247] op_sel_hi:[1,0]
    v_pk_fma_f32 v[82:83], v[66:67], v[246:247], v[82:83] op_sel:[0,1,0] op_sel_hi:[1,1,1]
    v_pk_fma_f32 v[66:67], v[66:67], v[246:247], v[192:193] op_sel_hi:[1,0,1] neg_lo:[0,0,1] neg_hi:[0,0,1]
    v_pk_mul_f32 v[194:195], v[84:85], v[246:247] op_sel:[0,1] op_sel_hi:[1,1]
    v_pk_mul_f32 v[84:85], v[84:85], v[246:247] op_sel_hi:[1,0]
    v_pk_fma_f32 v[84:85], v[68:69], v[246:247], v[84:85] op_sel:[0,1,0] op_sel_hi:[1,1,1]
    v_pk_fma_f32 v[68:69], v[68:69], v[246:247], v[194:195] op_sel_hi:[1,0,1] neg_lo:[0,0,1] neg_hi:[0,0,1]
    v_pk_mul_f32 v[192:193], v[86:87], v[246:247] op_sel:[0,1] op_sel_hi:[1,1]
    v_pk_mul_f32 v[86:87], v[86:87], v[246:247] op_sel_hi:[1,0]
    v_pk_fma_f32 v[86:87], v[70:71], v[246:247], v[86:87] op_sel:[0,1,0] op_sel_hi:[1,1,1]
    v_pk_fma_f32 v[70:71], v[70:71], v[246:247], v[192:193] op_sel_hi:[1,0,1] neg_lo:[0,0,1] neg_hi:[0,0,1]
    v_pk_mul_f32 v[194:195], v[88:89], v[246:247] op_sel:[0,1] op_sel_hi:[1,1]
    v_pk_mul_f32 v[88:89], v[88:89], v[246:247] op_sel_hi:[1,0]
    v_pk_fma_f32 v[88:89], v[72:73], v[246:247], v[88:89] op_sel:[0,1,0] op_sel_hi:[1,1,1]
    v_pk_fma_f32 v[72:73], v[72:73], v[246:247], v[194:195] op_sel_hi:[1,0,1] neg_lo:[0,0,1] neg_hi:[0,0,1]
    v_pk_mul_f32 v[192:193], v[90:91], v[246:247] op_sel:[0,1] op_sel_hi:[1,1]
    v_pk_mul_f32 v[90:91], v[90:91], v[246:247] op_sel_hi:[1,0]
    v_pk_fma_f32 v[90:91], v[74:75], v[246:247], v[90:91] op_sel:[0,1,0] op_sel_hi:[1,1,1]
    v_pk_fma_f32 v[74:75], v[74:75], v[246:247], v[192:193] op_sel_hi:[1,0,1] neg_lo:[0,0,1] neg_hi:[0,0,1]
    v_pk_mul_f32 v[194:195], v[92:93], v[246:247] op_sel:[0,1] op_sel_hi:[1,1]
    v_pk_mul_f32 v[92:93], v[92:93], v[246:247] op_sel_hi:[1,0]
    v_pk_fma_f32 v[92:93], v[76:77], v[246:247], v[92:93] op_sel:[0,1,0] op_sel_hi:[1,1,1]
    v_pk_fma_f32 v[76:77], v[76:77], v[246:247], v[194:195] op_sel_hi:[1,0,1] neg_lo:[0,0,1] neg_hi:[0,0,1]
    v_pk_mul_f32 v[192:193], v[94:95], v[246:247] op_sel:[0,1] op_sel_hi:[1,1]
    v_pk_mul_f32 v[94:95], v[94:95], v[246:247] op_sel_hi:[1,0]
    v_pk_fma_f32 v[94:95], v[78:79], v[246:247], v[94:95] op_sel:[0,1,0] op_sel_hi:[1,1,1]
    v_pk_fma_f32 v[78:79], v[78:79], v[246:247], v[192:193] op_sel_hi:[1,0,1] neg_lo:[0,0,1] neg_hi:[0,0,1]
    v_pk_mul_f32 v[194:195], v[112:113], v[246:247] op_sel:[0,1] op_sel_hi:[1,1]
    v_pk_mul_f32 v[112:113], v[112:113], v[246:247] op_sel_hi:[1,0]
    v_pk_fma_f32 v[112:113], v[96:97], v[246:247], v[112:113] op_sel:[0,1,0] op_sel_hi:[1,1,1]
    v_pk_fma_f32 v[96:97], v[96:97], v[246:247], v[194:195] op_sel_hi:[1,0,1] neg_lo:[0,0,1] neg_hi:[0,0,1]
    v_pk_mul_f32 v[192:193], v[114:115], v[246:247] op_sel:[0,1] op_sel_hi:[1,1]
    v_pk_mul_f32 v[114:115], v[114:115], v[246:247] op_sel_hi:[1,0]
    v_pk_fma_f32 v[114:115], v[98:99], v[246:247], v[114:115] op_sel:[0,1,0] op_sel_hi:[1,1,1]
    v_pk_fma_f32 v[98:99], v[98:99], v[246:247], v[192:193] op_sel_hi:[1,0,1] neg_lo:[0,0,1] neg_hi:[0,0,1]
    v_pk_mul_f32 v[194:195], v[116:117], v[246:247] op_sel:[0,1] op_sel_hi:[1,1]
    v_pk_mul_f32 v[116:117], v[116:117], v[246:247] op_sel_hi:[1,0]
    v_pk_fma_f32 v[116:117], v[100:101], v[246:247], v[116:117] op_sel:[0,1,0] op_sel_hi:[1,1,1]
    v_pk_fma_f32 v[100:101], v[100:101], v[246:247], v[194:195] op_sel_hi:[1,0,1] neg_lo:[0,0,1] neg_hi:[0,0,1]
    v_pk_mul_f32 v[192:193], v[118:119], v[246:247] op_sel:[0,1] op_sel_hi:[1,1]
    v_pk_mul_f32 v[118:119], v[118:119], v[246:247] op_sel_hi:[1,0]
    v_pk_fma_f32 v[118:119], v[102:103], v[246:247], v[118:119] op_sel:[0,1,0] op_sel_hi:[1,1,1]
    v_pk_fma_f32 v[102:103], v[102:103], v[246:247], v[192:193] op_sel_hi:[1,0,1] neg_lo:[0,0,1] neg_hi:[0,0,1]
    v_pk_mul_f32 v[194:195], v[120:121], v[246:247] op_sel:[0,1] op_sel_hi:[1,1]
    v_pk_mul_f32 v[120:121], v[120:121], v[246:247] op_sel_hi:[1,0]
    v_pk_fma_f32 v[120:121], v[104:105], v[246:247], v[120:121] op_sel:[0,1,0] op_sel_hi:[1,1,1]
    v_pk_fma_f32 v[104:105], v[104:105], v[246:247], v[194:195] op_sel_hi:[1,0,1] neg_lo:[0,0,1] neg_hi:[0,0,1]
    v_pk_mul_f32 v[192:193], v[122:123], v[246:247] op_sel:[0,1] op_sel_hi:[1,1]
    v_pk_mul_f32 v[122:123], v[122:123], v[246:247] op_sel_hi:[1,0]
    v_pk_fma_f32 v[122:123], v[106:107], v[246:247], v[122:123] op_sel:[0,1,0] op_sel_hi:[1,1,1]
    v_pk_fma_f32 v[106:107], v[106:107], v[246:247], v[192:193] op_sel_hi:[1,0,1] neg_lo:[0,0,1] neg_hi:[0,0,1]
    v_pk_mul_f32 v[194:195], v[124:125], v[246:247] op_sel:[0,1] op_sel_hi:[1,1]
    v_pk_mul_f32 v[124:125], v[124:125], v[246:247] op_sel_hi:[1,0]
    v_pk_fma_f32 v[124:125], v[108:109], v[246:247], v[124:125] op_sel:[0,1,0] op_sel_hi:[1,1,1]
    v_pk_fma_f32 v[108:109], v[108:109], v[246:247], v[194:195] op_sel_hi:[1,0,1] neg_lo:[0,0,1] neg_hi:[0,0,1]
    buffer_load_dwordx4 v[128:131], v160, s[56:59], s27 offen sc1
    buffer_load_dwordx4 v[132:135], v161, s[56:59], s27 offen sc1
    buffer_load_dwordx4 v[136:139], v162, s[56:59], s27 offen sc1
    buffer_load_dwordx4 v[140:143], v163, s[56:59], s27 offen sc1
    buffer_load_dwordx4 v[144:147], v164, s[56:59], s27 offen sc1
    buffer_load_dwordx4 v[148:151], v165, s[56:59], s27 offen sc1
    buffer_load_dwordx4 v[152:155], v166, s[56:59], s27 offen sc1
    buffer_load_dwordx4 v[156:159], v167, s[56:59], s27 offen sc1
    v_pk_mul_f32 v[192:193], v[126:127], v[246:247] op_sel:[0,1] op_sel_hi:[1,1]
    v_pk_mul_f32 v[126:127], v[126:127], v[246:247] op_sel_hi:[1,0]
    v_pk_fma_f32 v[126:127], v[110:111], v[246:247], v[126:127] op_sel:[0,1,0] op_sel_hi:[1,1,1]
    v_pk_fma_f32 v[110:111], v[110:111], v[246:247], v[192:193] op_sel_hi:[1,0,1] neg_lo:[0,0,1] neg_hi:[0,0,1]
    s_barrier
    s_add_u32 s73, s6, 8192
    v_and_b32 v190, 31, v233
    v_mul_u32_u24 v190, 80, v190
    v_and_b32 v191, 32, v233
    v_add3_u32 v190, v190, v191, s73
    v_lshrrev_b32 v191, 4, v233
    v_lshlrev_b32 v191, 3, v191
    v_bfe_u32 v239, v233, 2, 2
    v_add_u32 v191, v191, v239
    v_mul_u32_u24 v191, 80, v191
    v_and_b32 v239, 3, v233
    v_lshlrev_b32 v239, 3, v239
    v_add3_u32 v191, v191, v239, s73
    v_bfe_u32 v239, v233, 3, 1
    v_and_b32 v189, 0x370, v238
    v_lshl_add_u32 v189, v239, 11, v189
    s_mul_i32 s16, s65, 188
    s_lshl_b32 s73, s78, 1
    s_add_u32 s16, s16, s73
    s_add_u32 s16, s16, 54
    s_lshl_b32 s16, s16, 12
    s_add_u32 s17, s16, 4096
    s_add_u32 s18, s16, 385024
    s_add_u32 s19, s16, 389120
    s_lshl_b32 s73, s4, 1
    v_lshrrev_b32 v242, 5, v233
    v_add_u32 v242, s73, v242
    v_mul_u32_u24 v242, 205, v242
    v_lshrrev_b32 v242, 10, v242
    v_and_b32 v241, 15, v233
    v_lshl_add_u32 v242, v242, 6, v241
    s_lshl_b32 s75, s64, 4
    v_add_u32 v242, s75, v242
    v_and_b32 v243, 14, v241
    s_and_b32 s74, s64, 2
    s_lshr_b32 s73, s4, 1
    s_lshl_b32 s73, s73, 5
    s_add_u32 s74, s74, s73
    s_add_u32 s74, s74, 1024
    v_add3_u32 v243, v243, v241, s74
    v_and_b32 v241, 16, v233
    v_cmp_eq_u32 vcc, 0, v241
    s_mov_b32 s28, 5046272
    s_nop 0
    v_cndmask_b32 v231, v243, v242, vcc
    v_lshlrev_b32 v231, 5, v231
    s_cmp_ge_u32 s64, 2
    s_cselect_b32 s23, 0, 0x2000
    s_or_b32 s22, s23, 0x3ff0000
    s_mov_b32 s10, 0x1fff
    s_mov_b32 s11, 0x1fff
    s_add_u32 m0, s6, 7168
    s_mul_i32 s100, s14, 160
    s_add_u32 s100, s100, s9
    buffer_load_dwordx4 v238, s[56:59], s100 offen offset:0 sc1 lds
    s_add_u32 m0, s6, 12288
    s_nop 0
    buffer_load_dwordx4 v238, s[56:59], s100 offen offset:1024 sc1 lds
    buffer_load_dwordx4 v238, s[56:59], s100 offen offset:2048 sc1 lds
    buffer_load_dwordx4 v238, s[56:59], s100 offen offset:3072 sc1 lds
    s_add_u32 m0, s29, 159744
    s_add_u32 s100, s100, 4096
    buffer_load_dwordx4 v238, s[56:59], s100 offen offset:0 sc1 lds
    s_waitcnt vmcnt(5)
    v_xor_b32 v239, v130, v168
    v_xor_b32 v240, v134, v169
    v_or_b32 v239, v239, v240
    v_xor_b32 v240, v138, v170
    v_or_b32 v239, v239, v240
    v_xor_b32 v240, v142, v171
    v_or_b32 v239, v239, v240
    v_xor_b32 v240, v146, v172
    v_or_b32 v239, v239, v240
    v_xor_b32 v240, v150, v173
    v_or_b32 v239, v239, v240
    v_xor_b32 v240, v154, v174
    v_or_b32 v239, v239, v240
    v_xor_b32 v240, v158, v175
    v_or_b32 v239, v239, v240
    v_cmp_ne_u32 vcc, 0, v239
    s_cbranch_vccnz L_slow_e
L_go_e:
    v_pk_fma_f32 v[152:153], v[156:157], v[254:255], v[152:153] op_sel:[0,0,0] op_sel_hi:[1,0,1]
    v_pk_fma_f32 v[152:153], v[156:157], v[254:255], v[152:153] op_sel:[1,1,0] op_sel_hi:[0,1,1] neg_lo:[1,0,0]
    v_pk_fma_f32 v[148:149], v[152:153], v[254:255], v[148:149] op_sel:[0,0,0] op_sel_hi:[1,0,1]
    v_pk_fma_f32 v[148:149], v[152:153], v[254:255], v[148:149] op_sel:[1,1,0] op_sel_hi:[0,1,1] neg_lo:[1,0,0]
    v_pk_fma_f32 v[144:145], v[148:149], v[254:255], v[144:145] op_sel:[0,0,0] op_sel_hi:[1,0,1]
    v_pk_fma_f32 v[144:145], v[148:149], v[254:255], v[144:145] op_sel:[1,1,0] op_sel_hi:[0,1,1] neg_lo:[1,0,0]
    v_pk_fma_f32 v[140:141], v[144:145], v[254:255], v[140:141] op_sel:[0,0,0] op_sel_hi:[1,0,1]
    v_pk_fma_f32 v[140:141], v[144:145], v[254:255], v[140:141] op_sel:[1,1,0] op_sel_hi:[0,1,1] neg_lo:[1,0,0]
    v_pk_fma_f32 v[136:137], v[140:141], v[254:255], v[136:137] op_sel:[0,0,0] op_sel_hi:[1,0,1]
    v_pk_fma_f32 v[136:137], v[140:141], v[254:255], v[136:137] op_sel:[1,1,0] op_sel_hi:[0,1,1] neg_lo:[1,0,0]
    v_pk_fma_f32 v[132:133], v[136:137], v[254:255], v[132:133] op_sel:[0,0,0] op_sel_hi:[1,0,1]
    v_pk_fma_f32 v[132:133], v[136:137], v[254:255], v[132:133] op_sel:[1,1,0] op_sel_hi:[0,1,1] neg_lo:[1,0,0]
    v_pk_fma_f32 v[128:129], v[132:133], v[254:255], v[128:129] op_sel:[0,0,0] op_sel_hi:[1,0,1]
    v_pk_fma_f32 v[128:129], v[132:133], v[254:255], v[128:129] op_sel:[1,1,0] op_sel_hi:[0,1,1] neg_lo:[1,0,0]
    v_mov_b32 v198, v128
    v_mov_b32 v199, v129
    v_mov_b32 v182, 0
    v_mov_b32 v183, 0
    v_cmp_gt_u32 vcc, 32, v233
    v_permlane32_swap_b32 v128, v198
    v_permlane32_swap_b32 v129, v199
    v_pk_fma_f32 v[196:197], v[198:199], v[252:253], v[128:129] op_sel:[0,0,0] op_sel_hi:[1,0,1]
    v_pk_fma_f32 v[196:197], v[198:199], v[252:253], v[196:197] op_sel:[1,1,0] op_sel_hi:[0,1,1] neg_lo:[1,0,0]
    v_pk_fma_f32 v[180:181], v[196:197], v[250:251], v[180:181] op_sel:[0,0,0] op_sel_hi:[1,0,1]
    v_pk_fma_f32 v[180:181], v[196:197], v[250:251], v[180:181] op_sel:[1,1,0] op_sel_hi:[0,1,1] neg_lo:[1,0,0]
    v_cndmask_b32 v196, v180, v196, vcc
    v_cndmask_b32 v197, v181, v197, vcc
    v_pk_fma_f32 v[176:177], v[196:197], v[248:249], v[176:177] op_sel:[0,0,0] op_sel_hi:[1,0,1]
    v_pk_fma_f32 v[176:177], v[196:197], v[248:249], v[176:177] op_sel:[1,1,0] op_sel_hi:[0,1,1] neg_lo:[1,0,0]
    v_pk_fma_f32 v[178:179], v[196:197], v[246:247], v[182:183] op_sel:[0,0,0] op_sel_hi:[1,0,1]
    v_pk_fma_f32 v[178:179], v[196:197], v[246:247], v[178:179] op_sel:[1,1,0] op_sel_hi:[0,1,1] neg_lo:[1,0,0]
    v_pk_fma_f32 v[180:181], v[176:177], v[246:247], v[182:183] op_sel:[0,0,0] op_sel_hi:[1,0,1]
    v_pk_fma_f32 v[180:181], v[176:177], v[246:247], v[180:181] op_sel:[1,1,0] op_sel_hi:[0,1,1] neg_lo:[1,0,0]
    v_mov_b32 v192, v178
    v_mov_b32 v193, v180
    v_mov_b32 v194, v179
    v_mov_b32_e64 v195, v181
    v_pk_fma_f32 v[0:1], v[192:193], v[244:245], v[0:1] op_sel_hi:[1,0,1]
    v_pk_fma_f32 v[16:17], v[194:195], v[244:245], v[16:17] op_sel_hi:[1,0,1]
    v_pk_fma_f32 v[0:1], v[194:195], v[244:245], v[0:1] op_sel:[0,1,0] op_sel_hi:[1,1,1] neg_lo:[0,1,0] neg_hi:[0,1,0]
    v_pk_fma_f32 v[16:17], v[192:193], v[244:245], v[16:17] op_sel:[0,1,0] op_sel_hi:[1,1,1]
    v_pk_fma_f32 v[2:3], v[0:1], v[244:245], v[2:3] op_sel_hi:[1,0,1]
    v_pk_fma_f32 v[18:19], v[16:17], v[244:245], v[18:19] op_sel_hi:[1,0,1]
    v_pk_fma_f32 v[2:3], v[16:17], v[244:245], v[2:3] op_sel:[0,1,0] op_sel_hi:[1,1,1] neg_lo:[0,1,0] neg_hi:[0,1,0]
    v_pk_fma_f32 v[18:19], v[0:1], v[244:245], v[18:19] op_sel:[0,1,0] op_sel_hi:[1,1,1]
    v_cvt_pk_bf16_f32 v128, v0, v2
    v_cvt_pk_bf16_f32 v136, -v16, -v18
    v_cvt_pk_bf16_f32 v132, v1, v3
    v_cvt_pk_bf16_f32 v140, -v17, -v19
    v_pk_fma_f32 v[4:5], v[2:3], v[244:245], v[4:5] op_sel_hi:[1,0,1]
    v_pk_fma_f32 v[20:21], v[18:19], v[244:245], v[20:21] op_sel_hi:[1,0,1]
    v_pk_fma_f32 v[4:5], v[18:19], v[244:245], v[4:5] op_sel:[0,1,0] op_sel_hi:[1,1,1] neg_lo:[0,1,0] neg_hi:[0,1,0]
    v_pk_fma_f32 v[20:21], v[2:3], v[244:245], v[20:21] op_sel:[0,1,0] op_sel_hi:[1,1,1]
    v_pk_fma_f32 v[6:7], v[4:5], v[244:245], v[6:7] op_sel_hi:[1,0,1]
    v_pk_fma_f32 v[22:23], v[20:21], v[244:245], v[22:23] op_sel_hi:[1,0,1]
    v_pk_fma_f32 v[6:7], v[20:21], v[244:245], v[6:7] op_sel:[0,1,0] op_sel_hi:[1,1,1] neg_lo:[0,1,0] neg_hi:[0,1,0]
    v_pk_fma_f32 v[22:23], v[4:5], v[244:245], v[22:23] op_sel:[0,1,0] op_sel_hi:[1,1,1]
    v_cvt_pk_bf16_f32 v129, v4, v6
    v_cvt_pk_bf16_f32 v137, -v20, -v22
    v_cvt_pk_bf16_f32 v133, v5, v7
    v_cvt_pk_bf16_f32 v141, -v21, -v23
    v_pk_fma_f32 v[8:9], v[6:7], v[244:245], v[8:9] op_sel_hi:[1,0,1]
    v_pk_fma_f32 v[24:25], v[22:23], v[244:245], v[24:25] op_sel_hi:[1,0,1]
    v_pk_fma_f32 v[8:9], v[22:23], v[244:245], v[8:9] op_sel:[0,1,0] op_sel_hi:[1,1,1] neg_lo:[0,1,0] neg_hi:[0,1,0]
    v_pk_fma_f32 v[24:25], v[6:7], v[244:245], v[24:25] op_sel:[0,1,0] op_sel_hi:[1,1,1]
    v_pk_fma_f32 v[10:11], v[8:9], v[244:245], v[10:11] op_sel_hi:[1,0,1]
    v_pk_fma_f32 v[26:27], v[24:25], v[244:245], v[26:27] op_sel_hi:[1,0,1]
    v_pk_fma_f32 v[10:11], v[24:25], v[244:245], v[10:11] op_sel:[0,1,0] op_sel_hi:[1,1,1] neg_lo:[0,1,0] neg_hi:[0,1,0]
    v_pk_fma_f32 v[26:27], v[8:9], v[244:245], v[26:27] op_sel:[0,1,0] op_sel_hi:[1,1,1]
    v_cvt_pk_bf16_f32 v130, v8, v10
    v_cvt_pk_bf16_f32 v138, -v24, -v26
    v_cvt_pk_bf16_f32 v134, v9, v11
    v_cvt_pk_bf16_f32 v142, -v25, -v27
    v_pk_fma_f32 v[12:13], v[10:11], v[244:245], v[12:13] op_sel_hi:[1,0,1]
    v_pk_fma_f32 v[28:29], v[26:27], v[244:245], v[28:29] op_sel_hi:[1,0,1]
    v_pk_fma_f32 v[12:13], v[26:27], v[244:245], v[12:13] op_sel:[0,1,0] op_sel_hi:[1,1,1] neg_lo:[0,1,0] neg_hi:[0,1,0]
    v_pk_fma_f32 v[28:29], v[10:11], v[244:245], v[28:29] op_sel:[0,1,0] op_sel_hi:[1,1,1]
    v_pk_fma_f32 v[14:15], v[12:13], v[244:245], v[14:15] op_sel_hi:[1,0,1]
    v_pk_fma_f32 v[30:31], v[28:29], v[244:245], v[30:31] op_sel_hi:[1,0,1]
    v_pk_fma_f32 v[14:15], v[28:29], v[244:245], v[14:15] op_sel:[0,1,0] op_sel_hi:[1,1,1] neg_lo:[0,1,0] neg_hi:[0,1,0]
    v_pk_fma_f32 v[30:31], v[12:13], v[244:245], v[30:31] op_sel:[0,1,0] op_sel_hi:[1,1,1]
    v_cvt_pk_bf16_f32 v131, v12, v14
    v_cvt_pk_bf16_f32 v139, -v28, -v30
    v_cvt_pk_bf16_f32 v135, v13, v15
    v_cvt_pk_bf16_f32 v143, -v29, -v31
    ds_write_b128 v190, v[128:131] offset:0
    ds_write_b128 v190, v[132:135] offset:16
    ds_write_b128 v190, v[136:139] offset:2560
    ds_write_b128 v190, v[140:143] offset:2576
    ds_read_b64_tr_b16 v[0:1], v191 offset:0
    ds_read_b64_tr_b16 v[2:3], v191 offset:320
    ds_read_b64_tr_b16 v[4:5], v191 offset:32
    ds_read_b64_tr_b16 v[6:7], v191 offset:352
    ds_read_b64_tr_b16 v[16:17], v191 offset:2560
    ds_read_b64_tr_b16 v[18:19], v191 offset:2880
    ds_read_b64_tr_b16 v[20:21], v191 offset:2592
    ds_read_b64_tr_b16 v[22:23], v191 offset:2912
    v_pk_fma_f32 v[32:33], v[14:15], v[244:245], v[32:33] op_sel_hi:[1,0,1]
    v_pk_fma_f32 v[48:49], v[30:31], v[244:245], v[48:49] op_sel_hi:[1,0,1]
    v_pk_fma_f32 v[32:33], v[30:31], v[244:245], v[32:33] op_sel:[0,1,0] op_sel_hi:[1,1,1] neg_lo:[0,1,0] neg_hi:[0,1,0]
    v_pk_fma_f32 v[48:49], v[14:15], v[244:245], v[48:49] op_sel:[0,1,0] op_sel_hi:[1,1,1]
    v_pk_fma_f32 v[34:35], v[32:33], v[244:245], v[34:35] op_sel_hi:[1,0,1]
    v_pk_fma_f32 v[50:51], v[48:49], v[244:245], v[50:51] op_sel_hi:[1,0,1]
    v_pk_fma_f32 v[34:35], v[48:49], v[244:245], v[34:35] op_sel:[0,1,0] op_sel_hi:[1,1,1] neg_lo:[0,1,0] neg_hi:[0,1,0]
    v_pk_fma_f32 v[50:51], v[32:33], v[244:245], v[50:51] op_sel:[0,1,0] op_sel_hi:[1,1,1]
    v_cvt_pk_bf16_f32 v128, v32, v34
    v_cvt_pk_bf16_f32 v136, -v48, -v50
    v_cvt_pk_bf16_f32 v132, v33, v35
    v_cvt_pk_bf16_f32 v140, -v49, -v51
    v_pk_fma_f32 v[36:37], v[34:35], v[244:245], v[36:37] op_sel_hi:[1,0,1]
    v_pk_fma_f32 v[52:53], v[50:51], v[244:245], v[52:53] op_sel_hi:[1,0,1]
    v_pk_fma_f32 v[36:37], v[50:51], v[244:245], v[36:37] op_sel:[0,1,0] op_sel_hi:[1,1,1] neg_lo:[0,1,0] neg_hi:[0,1,0]
    v_pk_fma_f32 v[52:53], v[34:35], v[244:245], v[52:53] op_sel:[0,1,0] op_sel_hi:[1,1,1]
    s_waitcnt lgkmcnt(6)
    buffer_store_dwordx4 v[0:3], v189, s[52:55], s16 offen offset:0 sc1
    v_pk_fma_f32 v[38:39], v[36:37], v[244:245], v[38:39] op_sel_hi:[1,0,1]
    v_pk_fma_f32 v[54:55], v[52:53], v[244:245], v[54:55] op_sel_hi:[1,0,1]
    v_pk_fma_f32 v[38:39], v[52:53], v[244:245], v[38:39] op_sel:[0,1,0] op_sel_hi:[1,1,1] neg_lo:[0,1,0] neg_hi:[0,1,0]
    v_pk_fma_f32 v[54:55], v[36:37], v[244:245], v[54:55] op_sel:[0,1,0] op_sel_hi:[1,1,1]
    s_waitcnt lgkmcnt(4)
    buffer_store_dwordx4 v[4:7], v189, s[52:55], s18 offen offset:0 sc1
    v_cvt_pk_bf16_f32 v129, v36, v38
    v_cvt_pk_bf16_f32 v137, -v52, -v54
    v_cvt_pk_bf16_f32 v133, v37, v39
    v_cvt_pk_bf16_f32 v141, -v53, -v55
    v_pk_fma_f32 v[40:41], v[38:39], v[244:245], v[40:41] op_sel_hi:[1,0,1]
    v_pk_fma_f32 v[56:57], v[54:55], v[244:245], v[56:57] op_sel_hi:[1,0,1]
    v_pk_fma_f32 v[40:41], v[54:55], v[244:245], v[40:41] op_sel:[0,1,0] op_sel_hi:[1,1,1] neg_lo:[0,1,0] neg_hi:[0,1,0]
    v_pk_fma_f32 v[56:57], v[38:39], v[244:245], v[56:57] op_sel:[0,1,0] op_sel_hi:[1,1,1]
    s_waitcnt lgkmcnt(2)
    buffer_store_dwordx4 v[16:19], v189, s[52:55], s17 offen offset:0 sc1
    v_pk_fma_f32 v[42:43], v[40:41], v[244:245], v[42:43] op_sel_hi:[1,0,1]
    v_pk_fma_f32 v[58:59], v[56:57], v[244:245], v[58:59] op_sel_hi:[1,0,1]
    v_pk_fma_f32 v[42:43], v[56:57], v[244:245], v[42:43] op_sel:[0,1,0] op_sel_hi:[1,1,1] neg_lo:[0,1,0] neg_hi:[0,1,0]
    v_pk_fma_f32 v[58:59], v[40:41], v[244:245], v[58:59] op_sel:[0,1,0] op_sel_hi:[1,1,1]
    s_waitcnt lgkmcnt(0)
    buffer_store_dwordx4 v[20:23], v189, s[52:55], s19 offen offset:0 sc1
    v_cvt_pk_bf16_f32 v130, v40, v42
    v_cvt_pk_bf16_f32 v138, -v56, -v58
    v_cvt_pk_bf16_f32 v134, v41, v43
    v_cvt_pk_bf16_f32 v142, -v57, -v59
    v_pk_fma_f32 v[44:45], v[42:43], v[244:245], v[44:45] op_sel_hi:[1,0,1]
    v_pk_fma_f32 v[60:61], v[58:59], v[244:245], v[60:61] op_sel_hi:[1,0,1]
    v_pk_fma_f32 v[44:45], v[58:59], v[244:245], v[44:45] op_sel:[0,1,0] op_sel_hi:[1,1,1] neg_lo:[0,1,0] neg_hi:[0,1,0]
    v_pk_fma_f32 v[60:61], v[42:43], v[244:245], v[60:61] op_sel:[0,1,0] op_sel_hi:[1,1,1]
    v_pk_fma_f32 v[46:47], v[44:45], v[244:245], v[46:47] op_sel_hi:[1,0,1]
    v_pk_fma_f32 v[62:63], v[60:61], v[244:245], v[62:63] op_sel_hi:[1,0,1]
    v_pk_fma_f32 v[46:47], v[60:61], v[244:245], v[46:47] op_sel:[0,1,0] op_sel_hi:[1,1,1] neg_lo:[0,1,0] neg_hi:[0,1,0]
    v_pk_fma_f32 v[62:63], v[44:45], v[244:245], v[62:63] op_sel:[0,1,0] op_sel_hi:[1,1,1]
    v_cvt_pk_bf16_f32 v131, v44, v46
    v_cvt_pk_bf16_f32 v139, -v60, -v62
    v_cvt_pk_bf16_f32 v135, v45, v47
    v_cvt_pk_bf16_f32 v143, -v61, -v63
    ds_write_b128 v190, v[128:131] offset:0
    ds_write_b128 v190, v[132:135] offset:16
    ds_write_b128 v190, v[136:139] offset:2560
    ds_write_b128 v190, v[140:143] offset:2576
    ds_read_b64_tr_b16 v[32:33], v191 offset:0
    ds_read_b64_tr_b16 v[34:35], v191 offset:320
    ds_read_b64_tr_b16 v[36:37], v191 offset:32
    ds_read_b64_tr_b16 v[38:39], v191 offset:352
    ds_read_b64_tr_b16 v[48:49], v191 offset:2560
    ds_read_b64_tr_b16 v[50:51], v191 offset:2880
    ds_read_b64_tr_b16 v[52:53], v191 offset:2592
    ds_read_b64_tr_b16 v[54:55], v191 offset:2912
    v_pk_fma_f32 v[64:65], v[46:47], v[244:245], v[64:65] op_sel_hi:[1,0,1]
    v_pk_fma_f32 v[80:81], v[62:63], v[244:245], v[80:81] op_sel_hi:[1,0,1]
    v_pk_fma_f32 v[64:65], v[62:63], v[244:245], v[64:65] op_sel:[0,1,0] op_sel_hi:[1,1,1] neg_lo:[0,1,0] neg_hi:[0,1,0]
    v_pk_fma_f32 v[80:81], v[46:47], v[244:245], v[80:81] op_sel:[0,1,0] op_sel_hi:[1,1,1]
    v_pk_fma_f32 v[66:67], v[64:65], v[244:245], v[66:67] op_sel_hi:[1,0,1]
    v_pk_fma_f32 v[82:83], v[80:81], v[244:245], v[82:83] op_sel_hi:[1,0,1]
    v_pk_fma_f32 v[66:67], v[80:81], v[244:245], v[66:67] op_sel:[0,1,0] op_sel_hi:[1,1,1] neg_lo:[0,1,0] neg_hi:[0,1,0]
    v_pk_fma_f32 v[82:83], v[64:65], v[244:245], v[82:83] op_sel:[0,1,0] op_sel_hi:[1,1,1]
    v_cvt_pk_bf16_f32 v128, v64, v66
    v_cvt_pk_bf16_f32 v136, -v80, -v82
    v_cvt_pk_bf16_f32 v132, v65, v67
    v_cvt_pk_bf16_f32 v140, -v81, -v83
    v_pk_fma_f32 v[68:69], v[66:67], v[244:245], v[68:69] op_sel_hi:[1,0,1]
    v_pk_fma_f32 v[84:85], v[82:83], v[244:245], v[84:85] op_sel_hi:[1,0,1]
    v_pk_fma_f32 v[68:69], v[82:83], v[244:245], v[68:69] op_sel:[0,1,0] op_sel_hi:[1,1,1] neg_lo:[0,1,0] neg_hi:[0,1,0]
    v_pk_fma_f32 v[84:85], v[66:67], v[244:245], v[84:85] op_sel:[0,1,0] op_sel_hi:[1,1,1]
    s_waitcnt lgkmcnt(6)
    buffer_store_dwordx4 v[32:35], v189, s[52:55], s16 offen offset:128 sc1
    v_pk_fma_f32 v[70:71], v[68:69], v[244:245], v[70:71] op_sel_hi:[1,0,1]
    v_pk_fma_f32 v[86:87], v[84:85], v[244:245], v[86:87] op_sel_hi:[1,0,1]
    v_pk_fma_f32 v[70:71], v[84:85], v[244:245], v[70:71] op_sel:[0,1,0] op_sel_hi:[1,1,1] neg_lo:[0,1,0] neg_hi:[0,1,0]
    v_pk_fma_f32 v[86:87], v[68:69], v[244:245], v[86:87] op_sel:[0,1,0] op_sel_hi:[1,1,1]
    s_waitcnt lgkmcnt(4)
    buffer_store_dwordx4 v[36:39], v189, s[52:55], s18 offen offset:128 sc1
    v_cvt_pk_bf16_f32 v129, v68, v70
    v_cvt_pk_bf16_f32 v137, -v84, -v86
    v_cvt_pk_bf16_f32 v133, v69, v71
    v_cvt_pk_bf16_f32 v141, -v85, -v87
    v_pk_fma_f32 v[72:73], v[70:71], v[244:245], v[72:73] op_sel_hi:[1,0,1]
    v_pk_fma_f32 v[88:89], v[86:87], v[244:245], v[88:89] op_sel_hi:[1,0,1]
    v_pk_fma_f32 v[72:73], v[86:87], v[244:245], v[72:73] op_sel:[0,1,0] op_sel_hi:[1,1,1] neg_lo:[0,1,0] neg_hi:[0,1,0]
    v_pk_fma_f32 v[88:89], v[70:71], v[244:245], v[88:89] op_sel:[0,1,0] op_sel_hi:[1,1,1]
    s_waitcnt lgkmcnt(2)
    buffer_store_dwordx4 v[48:51], v189, s[52:55], s17 offen offset:128 sc1
    s_mov_b64 exec, s[10:11]
    buffer_load_dword v232, v231, s[56:59], s28 offen sc1
    s_mov_b64 exec, -1
    v_pk_fma_f32 v[74:75], v[72:73], v[244:245], v[74:75] op_sel_hi:[1,0,1]
    v_pk_fma_f32 v[90:91], v[88:89], v[244:245], v[90:91] op_sel_hi:[1,0,1]
    v_pk_fma_f32 v[74:75], v[88:89], v[244:245], v[74:75] op_sel:[0,1,0] op_sel_hi:[1,1,1] neg_lo:[0,1,0] neg_hi:[0,1,0]
    v_pk_fma_f32 v[90:91], v[72:73], v[244:245], v[90:91] op_sel:[0,1,0] op_sel_hi:[1,1,1]
    s_waitcnt lgkmcnt(0)
    buffer_store_dwordx4 v[52:55], v189, s[52:55], s19 offen offset:128 sc1
    v_cvt_pk_bf16_f32 v130, v72, v74
    v_cvt_pk_bf16_f32 v138, -v88, -v90
    v_cvt_pk_bf16_f32 v134, v73, v75
    v_cvt_pk_bf16_f32 v142, -v89, -v91
    v_pk_fma_f32 v[76:77], v[74:75], v[244:245], v[76:77] op_sel_hi:[1,0,1]
    v_pk_fma_f32 v[92:93], v[90:91], v[244:245], v[92:93] op_sel_hi:[1,0,1]
    v_pk_fma_f32 v[76:77], v[90:91], v[244:245], v[76:77] op_sel:[0,1,0] op_sel_hi:[1,1,1] neg_lo:[0,1,0] neg_hi:[0,1,0]
    v_pk_fma_f32 v[92:93], v[74:75], v[244:245], v[92:93] op_sel:[0,1,0] op_sel_hi:[1,1,1]
    v_pk_fma_f32 v[78:79], v[76:77], v[244:245], v[78:79] op_sel_hi:[1,0,1]
    v_pk_fma_f32 v[94:95], v[92:93], v[244:245], v[94:95] op_sel_hi:[1,0,1]
    v_pk_fma_f32 v[78:79], v[92:93], v[244:245], v[78:79] op_sel:[0,1,0] op_sel_hi:[1,1,1] neg_lo:[0,1,0] neg_hi:[0,1,0]
    v_pk_fma_f32 v[94:95], v[76:77], v[244:245], v[94:95] op_sel:[0,1,0] op_sel_hi:[1,1,1]
    v_cvt_pk_bf16_f32 v131, v76, v78
    v_cvt_pk_bf16_f32 v139, -v92, -v94
    v_cvt_pk_bf16_f32 v135, v77, v79
    v_cvt_pk_bf16_f32 v143, -v93, -v95
    ds_write_b128 v190, v[128:131] offset:0
    ds_write_b128 v190, v[132:135] offset:16
    ds_write_b128 v190, v[136:139] offset:2560
    ds_write_b128 v190, v[140:143] offset:2576
    ds_read_b64_tr_b16 v[64:65], v191 offset:0
    ds_read_b64_tr_b16 v[66:67], v191 offset:320
    ds_read_b64_tr_b16 v[68:69], v191 offset:32
    ds_read_b64_tr_b16 v[70:71], v191 offset:352
    ds_read_b64_tr_b16 v[80:81], v191 offset:2560
    ds_read_b64_tr_b16 v[82:83], v191 offset:2880
    ds_read_b64_tr_b16 v[84:85], v191 offset:2592
    ds_read_b64_tr_b16 v[86:87], v191 offset:2912
    v_pk_fma_f32 v[96:97], v[78:79], v[244:245], v[96:97] op_sel_hi:[1,0,1]
    v_pk_fma_f32 v[112:113], v[94:95], v[244:245], v[112:113] op_sel_hi:[1,0,1]
    v_pk_fma_f32 v[96:97], v[94:95], v[244:245], v[96:97] op_sel:[0,1,0] op_sel_hi:[1,1,1] neg_lo:[0,1,0] neg_hi:[0,1,0]
    v_pk_fma_f32 v[112:113], v[78:79], v[244:245], v[112:113] op_sel:[0,1,0] op_sel_hi:[1,1,1]
    v_pk_fma_f32 v[98:99], v[96:97], v[244:245], v[98:99] op_sel_hi:[1,0,1]
    v_pk_fma_f32 v[114:115], v[112:113], v[244:245], v[114:115] op_sel_hi:[1,0,1]
    v_pk_fma_f32 v[98:99], v[112:113], v[244:245], v[98:99] op_sel:[0,1,0] op_sel_hi:[1,1,1] neg_lo:[0,1,0] neg_hi:[0,1,0]
    v_pk_fma_f32 v[114:115], v[96:97], v[244:245], v[114:115] op_sel:[0,1,0] op_sel_hi:[1,1,1]
    v_cvt_pk_bf16_f32 v128, v96, v98
    v_cvt_pk_bf16_f32 v136, -v112, -v114
    v_cvt_pk_bf16_f32 v132, v97, v99
    v_cvt_pk_bf16_f32 v140, -v113, -v115
    v_pk_fma_f32 v[100:101], v[98:99], v[244:245], v[100:101] op_sel_hi:[1,0,1]
    v_pk_fma_f32 v[116:117], v[114:115], v[244:245], v[116:117] op_sel_hi:[1,0,1]
    v_pk_fma_f32 v[100:101], v[114:115], v[244:245], v[100:101] op_sel:[0,1,0] op_sel_hi:[1,1,1] neg_lo:[0,1,0] neg_hi:[0,1,0]
    v_pk_fma_f32 v[116:117], v[98:99], v[244:245], v[116:117] op_sel:[0,1,0] op_sel_hi:[1,1,1]
    s_waitcnt lgkmcnt(6)
    buffer_store_dwordx4 v[64:67], v189, s[52:55], s16 offen offset:1024 sc1
    v_pk_fma_f32 v[102:103], v[100:101], v[244:245], v[102:103] op_sel_hi:[1,0,1]
    v_pk_fma_f32 v[118:119], v[116:117], v[244:245], v[118:119] op_sel_hi:[1,0,1]
    v_pk_fma_f32 v[102:103], v[116:117], v[244:245], v[102:103] op_sel:[0,1,0] op_sel_hi:[1,1,1] neg_lo:[0,1,0] neg_hi:[0,1,0]
    v_pk_fma_f32 v[118:119], v[100:101], v[244:245], v[118:119] op_sel:[0,1,0] op_sel_hi:[1,1,1]
    s_waitcnt lgkmcnt(4)
    buffer_store_dwordx4 v[68:71], v189, s[52:55], s18 offen offset:1024 sc1
    v_cvt_pk_bf16_f32 v129, v100, v102
    v_cvt_pk_bf16_f32 v137, -v116, -v118
    v_cvt_pk_bf16_f32 v133, v101, v103
    v_cvt_pk_bf16_f32 v141, -v117, -v119
    v_pk_fma_f32 v[104:105], v[102:103], v[244:245], v[104:105] op_sel_hi:[1,0,1]
    v_pk_fma_f32 v[120:121], v[118:119], v[244:245], v[120:121] op_sel_hi:[1,0,1]
    v_pk_fma_f32 v[104:105], v[118:119], v[244:245], v[104:105] op_sel:[0,1,0] op_sel_hi:[1,1,1] neg_lo:[0,1,0] neg_hi:[0,1,0]
    v_pk_fma_f32 v[120:121], v[102:103], v[244:245], v[120:121] op_sel:[0,1,0] op_sel_hi:[1,1,1]
    s_waitcnt lgkmcnt(2)
    buffer_store_dwordx4 v[80:83], v189, s[52:55], s17 offen offset:1024 sc1
    v_pk_fma_f32 v[106:107], v[104:105], v[244:245], v[106:107] op_sel_hi:[1,0,1]
    v_pk_fma_f32 v[122:123], v[120:121], v[244:245], v[122:123] op_sel_hi:[1,0,1]
    v_pk_fma_f32 v[106:107], v[120:121], v[244:245], v[106:107] op_sel:[0,1,0] op_sel_hi:[1,1,1] neg_lo:[0,1,0] neg_hi:[0,1,0]
    v_pk_fma_f32 v[122:123], v[104:105], v[244:245], v[122:123] op_sel:[0,1,0] op_sel_hi:[1,1,1]
    s_waitcnt lgkmcnt(0)
    buffer_store_dwordx4 v[84:87], v189, s[52:55], s19 offen offset:1024 sc1
    v_cvt_pk_bf16_f32 v130, v104, v106
    v_cvt_pk_bf16_f32 v138, -v120, -v122
    v_cvt_pk_bf16_f32 v134, v105, v107
    v_cvt_pk_bf16_f32 v142, -v121, -v123
    v_pk_fma_f32 v[108:109], v[106:107], v[244:245], v[108:109] op_sel_hi:[1,0,1]
    v_pk_fma_f32 v[124:125], v[122:123], v[244:245], v[124:125] op_sel_hi:[1,0,1]
    v_pk_fma_f32 v[108:109], v[122:123], v[244:245], v[108:109] op_sel:[0,1,0] op_sel_hi:[1,1,1] neg_lo:[0,1,0] neg_hi:[0,1,0]
    v_pk_fma_f32 v[124:125], v[106:107], v[244:245], v[124:125] op_sel:[0,1,0] op_sel_hi:[1,1,1]
    v_pk_fma_f32 v[110:111], v[108:109], v[244:245], v[110:111] op_sel_hi:[1,0,1]
    v_pk_fma_f32 v[126:127], v[124:125], v[244:245], v[126:127] op_sel_hi:[1,0,1]
    v_pk_fma_f32 v[110:111], v[124:125], v[244:245], v[110:111] op_sel:[0,1,0] op_sel_hi:[1,1,1] neg_lo:[0,1,0] neg_hi:[0,1,0]
    v_pk_fma_f32 v[126:127], v[108:109], v[244:245], v[126:127] op_sel:[0,1,0] op_sel_hi:[1,1,1]
    v_cvt_pk_bf16_f32 v131, v108, v110
    v_cvt_pk_bf16_f32 v139, -v124, -v126
    v_cvt_pk_bf16_f32 v135, v109, v111
    v_cvt_pk_bf16_f32 v143, -v125, -v127
    ds_write_b128 v190, v[128:131] offset:0
    ds_write_b128 v190, v[132:135] offset:16
    ds_write_b128 v190, v[136:139] offset:2560
    ds_write_b128 v190, v[140:143] offset:2576
    ds_read_b64_tr_b16 v[96:97], v191 offset:0
    ds_read_b64_tr_b16 v[98:99], v191 offset:320
    ds_read_b64_tr_b16 v[100:101], v191 offset:32
    ds_read_b64_tr_b16 v[102:103], v191 offset:352
    ds_read_b64_tr_b16 v[112:113], v191 offset:2560
    ds_read_b64_tr_b16 v[114:115], v191 offset:2880
    ds_read_b64_tr_b16 v[116:117], v191 offset:2592
    ds_read_b64_tr_b16 v[118:119], v191 offset:2912
    s_waitcnt lgkmcnt(6)
    buffer_store_dwordx4 v[96:99], v189, s[52:55], s16 offen offset:1152 sc1
    s_waitcnt lgkmcnt(4)
    buffer_store_dwordx4 v[100:103], v189, s[52:55], s18 offen offset:1152 sc1
    s_waitcnt lgkmcnt(2)
    buffer_store_dwordx4 v[112:115], v189, s[52:55], s17 offen offset:1152 sc1
    s_waitcnt lgkmcnt(0)
    buffer_store_dwordx4 v[116:119], v189, s[52:55], s19 offen offset:1152 sc1
    s_waitcnt vmcnt(9)
L_p2_s:
    v_cmp_ne_u32 vcc, s83, v232
    s_nop 0
    s_and_b64 vcc, vcc, s[10:11]
    s_cbranch_vccnz L_slow_gs
L_go_gs:
    s_add_u32 s101, s69, 0
    buffer_load_dwordx4 v[80:83], v238, s[52:55], s101 offen offset:0 sc1
    buffer_load_dwordx4 v[84:87], v238, s[52:55], s101 offen offset:1024 sc1
    buffer_load_dwordx4 v[88:91], v238, s[52:55], s101 offen offset:2048 sc1
    buffer_load_dwordx4 v[92:95], v238, s[52:55], s101 offen offset:3072 sc1
    s_add_u32 s101, s69, 16384
    buffer_load_dwordx4 v[96:99], v238, s[52:55], s101 offen offset:0 sc1
    buffer_load_dwordx4 v[100:103], v238, s[52:55], s101 offen offset:1024 sc1
    buffer_load_dwordx4 v[104:107], v238, s[52:55], s101 offen offset:2048 sc1
    buffer_load_dwordx4 v[108:111], v238, s[52:55], s101 offen offset:3072 sc1
    s_add_u32 s101, s69, 32768
    buffer_load_dwordx4 v[112:115], v238, s[52:55], s101 offen offset:0 sc1
    buffer_load_dwordx4 v[116:119], v238, s[52:55], s101 offen offset:1024 sc1
    buffer_load_dwordx4 v[120:123], v238, s[52:55], s101 offen offset:2048 sc1
    buffer_load_dwordx4 v[124:127], v238, s[52:55], s101 offen offset:3072 sc1
    s_add_u32 s101, s69, 49152
    buffer_load_dwordx4 v[128:131], v238, s[52:55], s101 offen offset:0 sc1
    buffer_load_dwordx4 v[132:135], v238, s[52:55], s101 offen offset:1024 sc1
    buffer_load_dwordx4 v[136:139], v238, s[52:55], s101 offen offset:2048 sc1
    buffer_load_dwordx4 v[140:143], v238, s[52:55], s101 offen offset:3072 sc1
    v_add_u32 v234, s71, v238
    v_add_u32 v236, s6, v238
    v_add_u32 v237, s29, v238
    v_add_u32 v237, 159744, v237
    s_waitcnt vmcnt(16)
    v_mov_b32 v232, s83
    s_mov_b64 exec, 1
    buffer_store_dword v232, off, s[56:59], s67 sc1
    s_mov_b64 exec, -1
    s_waitcnt vmcnt(13)
    v_mfma_f32_16x16x32_bf16 v[0:3], a[40:43], v[80:83], 0
    s_add_u32 s101, s69, 65536
    buffer_load_dwordx4 v[144:147], v238, s[52:55], s101 offen offset:0 sc1
    v_mfma_f32_16x16x32_bf16 v[4:7], a[44:47], v[80:83], 0
    v_mfma_f32_16x16x32_bf16 v[8:11], a[48:51], v[80:83], 0
    v_mfma_f32_16x16x32_bf16 v[12:15], a[52:55], v[80:83], 0
    buffer_load_dwordx4 v[148:151], v238, s[52:55], s101 offen offset:1024 sc1
    v_mfma_f32_16x16x32_bf16 v[16:19], a[56:59], v[80:83], 0
    v_mfma_f32_16x16x32_bf16 v[20:23], a[40:43], v[84:87], 0
    v_mfma_f32_16x16x32_bf16 v[24:27], a[44:47], v[84:87], 0
    buffer_load_dwordx4 v[152:155], v238, s[52:55], s101 offen offset:2048 sc1
    v_mfma_f32_16x16x32_bf16 v[28:31], a[48:51], v[84:87], 0
    v_mfma_f32_16x16x32_bf16 v[32:35], a[52:55], v[84:87], 0
    v_mfma_f32_16x16x32_bf16 v[36:39], a[56:59], v[84:87], 0
    v_mfma_f32_16x16x32_bf16 v[40:43], a[40:43], v[88:91], 0
    buffer_load_dwordx4 v[156:159], v238, s[52:55], s101 offen offset:3072 sc1
    v_mfma_f32_16x16x32_bf16 v[44:47], a[44:47], v[88:91], 0
    v_mfma_f32_16x16x32_bf16 v[48:51], a[48:51], v[88:91], 0
    v_mfma_f32_16x16x32_bf16 v[52:55], a[52:55], v[88:91], 0
    s_add_u32 m0, s6, 8192
    s_mul_i32 s100, s14, 160
    s_add_u32 s100, s100, s9
    s_add_u32 s100, s100, 10240
    buffer_load_dwordx4 v238, s[56:59], s100 offen offset:0 sc1 lds
    v_mfma_f32_16x16x32_bf16 v[56:59], a[56:59], v[88:91], 0
    v_mfma_f32_16x16x32_bf16 v[60:63], a[40:43], v[92:95], 0
    v_mfma_f32_16x16x32_bf16 v[64:67], a[44:47], v[92:95], 0
    buffer_load_dwordx4 v238, s[56:59], s100 offen offset:1024 sc1 lds
    v_mfma_f32_16x16x32_bf16 v[68:71], a[48:51], v[92:95], 0
    v_mfma_f32_16x16x32_bf16 v[72:75], a[52:55], v[92:95], 0
    v_mfma_f32_16x16x32_bf16 v[76:79], a[56:59], v[92:95], 0
    s_waitcnt vmcnt(15)
    v_mfma_f32_16x16x32_bf16 v[0:3], a[60:63], v[96:99], v[0:3]
    s_add_u32 s101, s69, 81920
    buffer_load_dwordx4 v[80:83], v238, s[52:55], s101 offen offset:0 sc1
    v_mfma_f32_16x16x32_bf16 v[4:7], a[64:67], v[96:99], v[4:7]
    v_mfma_f32_16x16x32_bf16 v[8:11], a[68:71], v[96:99], v[8:11]
    v_mfma_f32_16x16x32_bf16 v[12:15], a[72:75], v[96:99], v[12:15]
    buffer_load_dwordx4 v[84:87], v238, s[52:55], s101 offen offset:1024 sc1
    v_mfma_f32_16x16x32_bf16 v[16:19], a[76:79], v[96:99], v[16:19]
    v_mfma_f32_16x16x32_bf16 v[20:23], a[60:63], v[100:103], v[20:23]
    v_mfma_f32_16x16x32_bf16 v[24:27], a[64:67], v[100:103], v[24:27]
    buffer_load_dwordx4 v[88:91], v238, s[52:55], s101 offen offset:2048 sc1
    v_mfma_f32_16x16x32_bf16 v[28:31], a[68:71], v[100:103], v[28:31]
    v_mfma_f32_16x16x32_bf16 v[32:35], a[72:75], v[100:103], v[32:35]
    v_mfma_f32_16x16x32_bf16 v[36:39], a[76:79], v[100:103], v[36:39]
    v_mfma_f32_16x16x32_bf16 v[40:43], a[60:63], v[104:107], v[40:43]
    buffer_load_dwordx4 v[92:95], v238, s[52:55], s101 offen offset:3072 sc1
    v_mfma_f32_16x16x32_bf16 v[44:47], a[64:67], v[104:107], v[44:47]
    v_mfma_f32_16x16x32_bf16 v[48:51], a[68:71], v[104:107], v[48:51]
    v_mfma_f32_16x16x32_bf16 v[52:55], a[72:75], v[104:107], v[52:55]
    buffer_load_dwordx4 v238, s[56:59], s100 offen offset:2048 sc1 lds
    v_mfma_f32_16x16x32_bf16 v[56:59], a[76:79], v[104:107], v[56:59]
    v_mfma_f32_16x16x32_bf16 v[60:63], a[60:63], v[108:111], v[60:63]
    v_mfma_f32_16x16x32_bf16 v[64:67], a[64:67], v[108:111], v[64:67]
    buffer_load_dwordx4 v238, s[56:59], s100 offen offset:3072 sc1 lds
    v_mfma_f32_16x16x32_bf16 v[68:71], a[68:71], v[108:111], v[68:71]
    v_mfma_f32_16x16x32_bf16 v[72:75], a[72:75], v[108:111], v[72:75]
    v_mfma_f32_16x16x32_bf16 v[76:79], a[76:79], v[108:111], v[76:79]
    s_waitcnt vmcnt(17)
    v_mfma_f32_16x16x32_bf16 v[0:3], a[80:83], v[112:115], v[0:3]
    s_add_u32 s101, s69, 98304
    buffer_load_dwordx4 v[96:99], v238, s[52:55], s101 offen offset:0 sc1
    v_mfma_f32_16x16x32_bf16 v[4:7], a[84:87], v[112:115], v[4:7]
    v_mfma_f32_16x16x32_bf16 v[8:11], a[88:91], v[112:115], v[8:11]
    v_mfma_f32_16x16x32_bf16 v[12:15], a[92:95], v[112:115], v[12:15]
    buffer_load_dwordx4 v[100:103], v238, s[52:55], s101 offen offset:1024 sc1
    v_mfma_f32_16x16x32_bf16 v[16:19], a[96:99], v[112:115], v[16:19]
    v_mfma_f32_16x16x32_bf16 v[20:23], a[80:83], v[116:119], v[20:23]
    v_mfma_f32_16x16x32_bf16 v[24:27], a[84:87], v[116:119], v[24:27]
    buffer_load_dwordx4 v[104:107], v238, s[52:55], s101 offen offset:2048 sc1
    v_mfma_f32_16x16x32_bf16 v[28:31], a[88:91], v[116:119], v[28:31]
    v_mfma_f32_16x16x32_bf16 v[32:35], a[92:95], v[116:119], v[32:35]
    v_mfma_f32_16x16x32_bf16 v[36:39], a[96:99], v[116:119], v[36:39]
    v_mfma_f32_16x16x32_bf16 v[40:43], a[80:83], v[120:123], v[40:43]
    buffer_load_dwordx4 v[108:111], v238, s[52:55], s101 offen offset:3072 sc1
    v_mfma_f32_16x16x32_bf16 v[44:47], a[84:87], v[120:123], v[44:47]
    v_mfma_f32_16x16x32_bf16 v[48:51], a[88:91], v[120:123], v[48:51]
    v_mfma_f32_16x16x32_bf16 v[52:55], a[92:95], v[120:123], v[52:55]
    s_add_u32 m0, s6, 12288
    s_add_u32 s100, s100, 4096
    buffer_load_dwordx4 v238, s[56:59], s100 offen offset:0 sc1 lds
    v_mfma_f32_16x16x32_bf16 v[56:59], a[96:99], v[120:123], v[56:59]
    v_mfma_f32_16x16x32_bf16 v[60:63], a[80:83], v[124:127], v[60:63]
    v_mfma_f32_16x16x32_bf16 v[64:67], a[84:87], v[124:127], v[64:67]
    s_mul_i32 s100, s15, 160
    s_add_u32 s100, s100, s9
    buffer_load_dwordx4 v[160:163], v238, s[56:59], s100 offen offset:0 sc1
    v_mfma_f32_16x16x32_bf16 v[68:71], a[88:91], v[124:127], v[68:71]
    v_mfma_f32_16x16x32_bf16 v[72:75], a[92:95], v[124:127], v[72:75]
    v_mfma_f32_16x16x32_bf16 v[76:79], a[96:99], v[124:127], v[76:79]
    s_waitcnt vmcnt(19)
    v_mfma_f32_16x16x32_bf16 v[0:3], a[100:103], v[128:131], v[0:3]
    s_add_u32 s101, s69, 114688
    buffer_load_dwordx4 v[112:115], v238, s[52:55], s101 offen offset:0 sc1
    v_mfma_f32_16x16x32_bf16 v[4:7], a[104:107], v[128:131], v[4:7]
    v_mfma_f32_16x16x32_bf16 v[8:11], a[108:111], v[128:131], v[8:11]
    v_mfma_f32_16x16x32_bf16 v[12:15], a[112:115], v[128:131], v[12:15]
    buffer_load_dwordx4 v[116:119], v238, s[52:55], s101 offen offset:1024 sc1
    v_mfma_f32_16x16x32_bf16 v[16:19], a[116:119], v[128:131], v[16:19]
    v_mfma_f32_16x16x32_bf16 v[20:23], a[100:103], v[132:135], v[20:23]
    v_mfma_f32_16x16x32_bf16 v[24:27], a[104:107], v[132:135], v[24:27]
    buffer_load_dwordx4 v[120:123], v238, s[52:55], s101 offen offset:2048 sc1
    v_mfma_f32_16x16x32_bf16 v[28:31], a[108:111], v[132:135], v[28:31]
    v_mfma_f32_16x16x32_bf16 v[32:35], a[112:115], v[132:135], v[32:35]
    v_mfma_f32_16x16x32_bf16 v[36:39], a[116:119], v[132:135], v[36:39]
    v_mfma_f32_16x16x32_bf16 v[40:43], a[100:103], v[136:139], v[40:43]
    buffer_load_dwordx4 v[124:127], v238, s[52:55], s101 offen offset:3072 sc1
    v_mfma_f32_16x16x32_bf16 v[44:47], a[104:107], v[136:139], v[44:47]
    v_mfma_f32_16x16x32_bf16 v[48:51], a[108:111], v[136:139], v[48:51]
    v_mfma_f32_16x16x32_bf16 v[52:55], a[112:115], v[136:139], v[52:55]
    buffer_load_dwordx4 v[164:167], v238, s[56:59], s100 offen offset:1024 sc1
    v_mfma_f32_16x16x32_bf16 v[56:59], a[116:119], v[136:139], v[56:59]
    v_mfma_f32_16x16x32_bf16 v[60:63], a[100:103], v[140:143], v[60:63]
    v_mfma_f32_16x16x32_bf16 v[64:67], a[104:107], v[140:143], v[64:67]
    buffer_load_dwordx4 v[168:171], v238, s[56:59], s100 offen offset:2048 sc1
    v_mfma_f32_16x16x32_bf16 v[68:71], a[108:111], v[140:143], v[68:71]
    v_mfma_f32_16x16x32_bf16 v[72:75], a[112:115], v[140:143], v[72:75]
    v_mfma_f32_16x16x32_bf16 v[76:79], a[116:119], v[140:143], v[76:79]
    s_waitcnt vmcnt(20)
    v_mfma_f32_16x16x32_bf16 v[0:3], a[120:123], v[144:147], v[0:3]
    s_add_u32 s101, s69, 131072
    buffer_load_dwordx4 v[128:131], v238, s[52:55], s101 offen offset:0 sc1
    v_mfma_f32_16x16x32_bf16 v[4:7], a[124:127], v[144:147], v[4:7]
    v_mfma_f32_16x16x32_bf16 v[8:11], a[128:131], v[144:147], v[8:11]
    v_mfma_f32_16x16x32_bf16 v[12:15], a[132:135], v[144:147], v[12:15]
    buffer_load_dwordx4 v[132:135], v238, s[52:55], s101 offen offset:1024 sc1
    v_mfma_f32_16x16x32_bf16 v[16:19], a[136:139], v[144:147], v[16:19]
    v_mfma_f32_16x16x32_bf16 v[20:23], a[120:123], v[148:151], v[20:23]
    v_mfma_f32_16x16x32_bf16 v[24:27], a[124:127], v[148:151], v[24:27]
    buffer_load_dwordx4 v[136:139], v238, s[52:55], s101 offen offset:2048 sc1
    v_mfma_f32_16x16x32_bf16 v[28:31], a[128:131], v[148:151], v[28:31]
    v_mfma_f32_16x16x32_bf16 v[32:35], a[132:135], v[148:151], v[32:35]
    v_mfma_f32_16x16x32_bf16 v[36:39], a[136:139], v[148:151], v[36:39]
    v_mfma_f32_16x16x32_bf16 v[40:43], a[120:123], v[152:155], v[40:43]
    buffer_load_dwordx4 v[140:143], v238, s[52:55], s101 offen offset:3072 sc1
    v_mfma_f32_16x16x32_bf16 v[44:47], a[124:127], v[152:155], v[44:47]
    v_mfma_f32_16x16x32_bf16 v[48:51], a[128:131], v[152:155], v[48:51]
    v_mfma_f32_16x16x32_bf16 v[52:55], a[132:135], v[152:155], v[52:55]
    buffer_load_dwordx4 v[172:175], v238, s[56:59], s100 offen offset:3072 sc1
    v_mfma_f32_16x16x32_bf16 v[56:59], a[136:139], v[152:155], v[56:59]
    v_mfma_f32_16x16x32_bf16 v[60:63], a[120:123], v[156:159], v[60:63]
    v_mfma_f32_16x16x32_bf16 v[64:67], a[124:127], v[156:159], v[64:67]
    s_add_u32 s100, s100, 4096
    buffer_load_dwordx4 v[176:179], v238, s[56:59], s100 offen offset:0 sc1
    v_mfma_f32_16x16x32_bf16 v[68:71], a[128:131], v[156:159], v[68:71]
    v_mfma_f32_16x16x32_bf16 v[72:75], a[132:135], v[156:159], v[72:75]
    v_mfma_f32_16x16x32_bf16 v[76:79], a[136:139], v[156:159], v[76:79]
    s_waitcnt vmcnt(20)
    v_mfma_f32_16x16x32_bf16 v[0:3], a[140:143], v[80:83], v[0:3]
    s_add_u32 s101, s69, 147456
    buffer_load_dwordx4 v[144:147], v238, s[52:55], s101 offen offset:0 sc1
    v_mfma_f32_16x16x32_bf16 v[4:7], a[144:147], v[80:83], v[4:7]
    v_mfma_f32_16x16x32_bf16 v[8:11], a[148:151], v[80:83], v[8:11]
    v_mfma_f32_16x16x32_bf16 v[12:15], a[152:155], v[80:83], v[12:15]
    buffer_load_dwordx4 v[148:151], v238, s[52:55], s101 offen offset:1024 sc1
    v_mfma_f32_16x16x32_bf16 v[16:19], a[156:159], v[80:83], v[16:19]
    v_mfma_f32_16x16x32_bf16 v[20:23], a[140:143], v[84:87], v[20:23]
    v_mfma_f32_16x16x32_bf16 v[24:27], a[144:147], v[84:87], v[24:27]
    buffer_load_dwordx4 v[152:155], v238, s[52:55], s101 offen offset:2048 sc1
    v_mfma_f32_16x16x32_bf16 v[28:31], a[148:151], v[84:87], v[28:31]
    v_mfma_f32_16x16x32_bf16 v[32:35], a[152:155], v[84:87], v[32:35]
    v_mfma_f32_16x16x32_bf16 v[36:39], a[156:159], v[84:87], v[36:39]
    v_mfma_f32_16x16x32_bf16 v[40:43], a[140:143], v[88:91], v[40:43]
    buffer_load_dwordx4 v[156:159], v238, s[52:55], s101 offen offset:3072 sc1
    v_mfma_f32_16x16x32_bf16 v[44:47], a[144:147], v[88:91], v[44:47]
    v_mfma_f32_16x16x32_bf16 v[48:51], a[148:151], v[88:91], v[48:51]
    v_mfma_f32_16x16x32_bf16 v[52:55], a[152:155], v[88:91], v[52:55]
    s_mul_i32 s100, s15, 160
    s_add_u32 s100, s100, s9
    s_add_u32 s100, s100, 10240
    buffer_load_dwordx4 v[180:183], v238, s[56:59], s100 offen offset:0 sc1
    v_mfma_f32_16x16x32_bf16 v[56:59], a[156:159], v[88:91], v[56:59]
    v_mfma_f32_16x16x32_bf16 v[60:63], a[140:143], v[92:95], v[60:63]
    v_mfma_f32_16x16x32_bf16 v[64:67], a[144:147], v[92:95], v[64:67]
    buffer_load_dwordx4 v[184:187], v238, s[56:59], s100 offen offset:1024 sc1
    v_mfma_f32_16x16x32_bf16 v[68:71], a[148:151], v[92:95], v[68:71]
    v_mfma_f32_16x16x32_bf16 v[72:75], a[152:155], v[92:95], v[72:75]
    v_mfma_f32_16x16x32_bf16 v[76:79], a[156:159], v[92:95], v[76:79]
    s_waitcnt vmcnt(20)
    v_mfma_f32_16x16x32_bf16 v[0:3], a[160:163], v[96:99], v[0:3]
    s_add_u32 s101, s69, 163840
    buffer_load_dwordx4 v[80:83], v238, s[52:55], s101 offen offset:0 sc1
    v_mfma_f32_16x16x32_bf16 v[4:7], a[164:167], v[96:99], v[4:7]
    v_mfma_f32_16x16x32_bf16 v[8:11], a[168:171], v[96:99], v[8:11]
    v_mfma_f32_16x16x32_bf16 v[12:15], a[172:175], v[96:99], v[12:15]
    buffer_load_dwordx4 v[84:87], v238, s[52:55], s101 offen offset:1024 sc1
    v_mfma_f32_16x16x32_bf16 v[16:19], a[176:179], v[96:99], v[16:19]
    v_mfma_f32_16x16x32_bf16 v[20:23], a[160:163], v[100:103], v[20:23]
    v_mfma_f32_16x16x32_bf16 v[24:27], a[164:167], v[100:103], v[24:27]
    buffer_load_dwordx4 v[88:91], v238, s[52:55], s101 offen offset:2048 sc1
    v_mfma_f32_16x16x32_bf16 v[28:31], a[168:171], v[100:103], v[28:31]
    v_mfma_f32_16x16x32_bf16 v[32:35], a[172:175], v[100:103], v[32:35]
    v_mfma_f32_16x16x32_bf16 v[36:39], a[176:179], v[100:103], v[36:39]
    v_mfma_f32_16x16x32_bf16 v[40:43], a[160:163], v[104:107], v[40:43]
    buffer_load_dwordx4 v[92:95], v238, s[52:55], s101 offen offset:3072 sc1
    v_mfma_f32_16x16x32_bf16 v[44:47], a[164:167], v[104:107], v[44:47]
    v_mfma_f32_16x16x32_bf16 v[48:51], a[168:171], v[104:107], v[48:51]
    v_mfma_f32_16x16x32_bf16 v[52:55], a[172:175], v[104:107], v[52:55]
    buffer_load_dwordx4 v[188:191], v238, s[56:59], s100 offen offset:2048 sc1
    v_mfma_f32_16x16x32_bf16 v[56:59], a[176:179], v[104:107], v[56:59]
    v_mfma_f32_16x16x32_bf16 v[60:63], a[160:163], v[108:111], v[60:63]
    v_mfma_f32_16x16x32_bf16 v[64:67], a[164:167], v[108:111], v[64:67]
    buffer_load_dwordx4 v[192:195], v238, s[56:59], s100 offen offset:3072 sc1
    v_mfma_f32_16x16x32_bf16 v[68:71], a[168:171], v[108:111], v[68:71]
    v_mfma_f32_16x16x32_bf16 v[72:75], a[172:175], v[108:111], v[72:75]
    v_mfma_f32_16x16x32_bf16 v[76:79], a[176:179], v[108:111], v[76:79]
    s_waitcnt vmcnt(20)
    v_mfma_f32_16x16x32_bf16 v[0:3], a[180:183], v[112:115], v[0:3]
    s_add_u32 s101, s69, 180224
    buffer_load_dwordx4 v[96:99], v238, s[52:55], s101 offen offset:0 sc1
    v_mfma_f32_16x16x32_bf16 v[4:7], a[184:187], v[112:115], v[4:7]
    v_mfma_f32_16x16x32_bf16 v[8:11], a[188:191], v[112:115], v[8:11]
    v_mfma_f32_16x16x32_bf16 v[12:15], a[192:195], v[112:115], v[12:15]
    v_mfma_f32_16x16x32_bf16 v[16:19], a[196:199], v[112:115], v[16:19]
    buffer_load_dwordx4 v[100:103], v238, s[52:55], s101 offen offset:1024 sc1
    v_mfma_f32_16x16x32_bf16 v[20:23], a[180:183], v[116:119], v[20:23]
    v_mfma_f32_16x16x32_bf16 v[24:27], a[184:187], v[116:119], v[24:27]
    v_mfma_f32_16x16x32_bf16 v[28:31], a[188:191], v[116:119], v[28:31]
    v_mfma_f32_16x16x32_bf16 v[32:35], a[192:195], v[116:119], v[32:35]
    buffer_load_dwordx4 v[104:107], v238, s[52:55], s101 offen offset:2048 sc1
    v_mfma_f32_16x16x32_bf16 v[36:39], a[196:199], v[116:119], v[36:39]
    v_mfma_f32_16x16x32_bf16 v[40:43], a[180:183], v[120:123], v[40:43]
    v_mfma_f32_16x16x32_bf16 v[44:47], a[184:187], v[120:123], v[44:47]
    v_mfma_f32_16x16x32_bf16 v[48:51], a[188:191], v[120:123], v[48:51]
    buffer_load_dwordx4 v[108:111], v238, s[52:55], s101 offen offset:3072 sc1
    v_mfma_f32_16x16x32_bf16 v[52:55], a[192:195], v[120:123], v[52:55]
    v_mfma_f32_16x16x32_bf16 v[56:59], a[196:199], v[120:123], v[56:59]
    v_mfma_f32_16x16x32_bf16 v[60:63], a[180:183], v[124:127], v[60:63]
    v_mfma_f32_16x16x32_bf16 v[64:67], a[184:187], v[124:127], v[64:67]
    s_add_u32 s100, s100, 4096
    buffer_load_dwordx4 v[196:199], v238, s[56:59], s100 offen offset:0 sc1
    v_mfma_f32_16x16x32_bf16 v[68:71], a[188:191], v[124:127], v[68:71]
    v_mfma_f32_16x16x32_bf16 v[72:75], a[192:195], v[124:127], v[72:75]
    v_mfma_f32_16x16x32_bf16 v[76:79], a[196:199], v[124:127], v[76:79]
    s_waitcnt vmcnt(19)
    v_mfma_f32_16x16x32_bf16 v[0:3], a[200:203], v[128:131], v[0:3]
    s_mov_b64 exec, s[22:23]
    buffer_load_dword v232, v231, s[56:59], s28 offen sc1
    s_mov_b64 exec, -1
    v_mfma_f32_16x16x32_bf16 v[4:7], a[204:207], v[128:131], v[4:7]
    v_mfma_f32_16x16x32_bf16 v[8:11], a[208:211], v[128:131], v[8:11]
    s_add_u32 s101, s69, 196608
    buffer_load_dwordx4 v[112:115], v238, s[52:55], s101 offen offset:0 sc1
    v_mfma_f32_16x16x32_bf16 v[12:15], a[212:215], v[128:131], v[12:15]
    v_mfma_f32_16x16x32_bf16 v[16:19], a[216:219], v[128:131], v[16:19]
    v_mfma_f32_16x16x32_bf16 v[20:23], a[200:203], v[132:135], v[20:23]
    buffer_load_dwordx4 v[116:119], v238, s[52:55], s101 offen offset:1024 sc1
    v_mfma_f32_16x16x32_bf16 v[24:27], a[204:207], v[132:135], v[24:27]
    v_mfma_f32_16x16x32_bf16 v[28:31], a[208:211], v[132:135], v[28:31]
    v_mfma_f32_16x16x32_bf16 v[32:35], a[212:215], v[132:135], v[32:35]
    buffer_load_dwordx4 v[120:123], v238, s[52:55], s101 offen offset:2048 sc1
    v_mfma_f32_16x16x32_bf16 v[36:39], a[216:219], v[132:135], v[36:39]
    v_mfma_f32_16x16x32_bf16 v[40:43], a[200:203], v[136:139], v[40:43]
    v_mfma_f32_16x16x32_bf16 v[44:47], a[204:207], v[136:139], v[44:47]
    buffer_load_dwordx4 v[124:127], v238, s[52:55], s101 offen offset:3072 sc1
    v_mfma_f32_16x16x32_bf16 v[48:51], a[208:211], v[136:139], v[48:51]
    v_mfma_f32_16x16x32_bf16 v[52:55], a[212:215], v[136:139], v[52:55]
    v_mfma_f32_16x16x32_bf16 v[56:59], a[216:219], v[136:139], v[56:59]
    s_mul_i32 s100, s30, 160
    s_add_u32 s100, s100, s9
    buffer_load_dwordx4 a[40:43], v238, s[56:59], s100 offen offset:0 sc1
    v_mfma_f32_16x16x32_bf16 v[60:63], a[200:203], v[140:143], v[60:63]
    v_mfma_f32_16x16x32_bf16 v[64:67], a[204:207], v[140:143], v[64:67]
    v_mfma_f32_16x16x32_bf16 v[68:71], a[208:211], v[140:143], v[68:71]
    buffer_load_dwordx4 a[44:47], v238, s[56:59], s100 offen offset:1024 sc1
    v_mfma_f32_16x16x32_bf16 v[72:75], a[212:215], v[140:143], v[72:75]
    v_mfma_f32_16x16x32_bf16 v[76:79], a[216:219], v[140:143], v[76:79]
    s_waitcnt vmcnt(20)
    v_mfma_f32_16x16x32_bf16 v[0:3], a[220:223], v[144:147], v[0:3]
    v_mfma_f32_16x16x32_bf16 v[4:7], a[224:227], v[144:147], v[4:7]
    v_mfma_f32_16x16x32_bf16 v[8:11], a[228:231], v[144:147], v[8:11]
    ds_read_b128 a[60:63], v236 offset:16384
    v_mfma_f32_16x16x32_bf16 v[12:15], a[232:235], v[144:147], v[12:15]
    v_mfma_f32_16x16x32_bf16 v[16:19], a[236:239], v[144:147], v[16:19]
    v_mfma_f32_16x16x32_bf16 v[20:23], a[220:223], v[148:151], v[20:23]
    ds_read_b128 a[64:67], v236 offset:17408
    v_mfma_f32_16x16x32_bf16 v[24:27], a[224:227], v[148:151], v[24:27]
    v_mfma_f32_16x16x32_bf16 v[28:31], a[228:231], v[148:151], v[28:31]
    ds_read_b128 a[68:71], v236 offset:18432
    v_mfma_f32_16x16x32_bf16 v[32:35], a[232:235], v[148:151], v[32:35]
    v_mfma_f32_16x16x32_bf16 v[36:39], a[236:239], v[148:151], v[36:39]
    v_mfma_f32_16x16x32_bf16 v[40:43], a[220:223], v[152:155], v[40:43]
    ds_read_b128 a[72:75], v236 offset:19456
    v_mfma_f32_16x16x32_bf16 v[44:47], a[224:227], v[152:155], v[44:47]
    v_mfma_f32_16x16x32_bf16 v[48:51], a[228:231], v[152:155], v[48:51]
    ds_read_b128 a[76:79], v236 offset:20480
    v_mfma_f32_16x16x32_bf16 v[52:55], a[232:235], v[152:155], v[52:55]
    v_mfma_f32_16x16x32_bf16 v[56:59], a[236:239], v[152:155], v[56:59]
    v_mfma_f32_16x16x32_bf16 v[60:63], a[220:223], v[156:159], v[60:63]
    buffer_load_dwordx4 a[48:51], v238, s[56:59], s100 offen offset:2048 sc1
    v_mfma_f32_16x16x32_bf16 v[64:67], a[224:227], v[156:159], v[64:67]
    v_mfma_f32_16x16x32_bf16 v[68:71], a[228:231], v[156:159], v[68:71]
    buffer_load_dwordx4 a[52:55], v238, s[56:59], s100 offen offset:3072 sc1
    v_mfma_f32_16x16x32_bf16 v[72:75], a[232:235], v[156:159], v[72:75]
    v_mfma_f32_16x16x32_bf16 v[76:79], a[236:239], v[156:159], v[76:79]
    s_waitcnt vmcnt(16) lgkmcnt(0)
    v_mfma_f32_16x16x32_bf16 v[0:3], a[60:63], v[80:83], v[0:3]
    v_mfma_f32_16x16x32_bf16 v[4:7], a[64:67], v[80:83], v[4:7]
    ds_read_b128 a[80:83], v234 offset:20480
    v_mfma_f32_16x16x32_bf16 v[8:11], a[68:71], v[80:83], v[8:11]
    ds_read_b128 a[84:87], v234 offset:21504
    v_mfma_f32_16x16x32_bf16 v[12:15], a[72:75], v[80:83], v[12:15]
    ds_read_b128 a[88:91], v234 offset:22528
    v_mfma_f32_16x16x32_bf16 v[16:19], a[76:79], v[80:83], v[16:19]
    ds_read_b128 a[92:95], v234 offset:23552
    v_mfma_f32_16x16x32_bf16 v[20:23], a[60:63], v[84:87], v[20:23]
    ds_read_b128 a[96:99], v234 offset:24576
    v_mfma_f32_16x16x32_bf16 v[24:27], a[64:67], v[84:87], v[24:27]
    v_mfma_f32_16x16x32_bf16 v[28:31], a[68:71], v[84:87], v[28:31]
    s_waitcnt vmcnt(8)
    v_cmp_ne_u32 vcc, s83, v232
    s_nop 0
    s_and_b64 vcc, vcc, s[22:23]
    s_cbranch_vccnz L_slow_ss
L_go_ss:
    v_mfma_f32_16x16x32_bf16 v[32:35], a[72:75], v[84:87], v[32:35]
    s_add_u32 s101, s69, 212992
    s_add_u32 s101, s101, s7
    buffer_load_dwordx4 v[128:131], v238, s[52:55], s101 offen offset:0 sc1
    v_mfma_f32_16x16x32_bf16 v[36:39], a[76:79], v[84:87], v[36:39]
    buffer_load_dwordx4 v[132:135], v238, s[52:55], s101 offen offset:1024 sc1
    v_mfma_f32_16x16x32_bf16 v[40:43], a[60:63], v[88:91], v[40:43]
    buffer_load_dwordx4 v[136:139], v238, s[52:55], s101 offen offset:2048 sc1
    v_mfma_f32_16x16x32_bf16 v[44:47], a[64:67], v[88:91], v[44:47]
    buffer_load_dwordx4 v[140:143], v238, s[52:55], s101 offen offset:3072 sc1
    v_mfma_f32_16x16x32_bf16 v[48:51], a[68:71], v[88:91], v[48:51]
    s_lshl_b32 s101, s12, 7
    s_add_u32 s101, s101, s99
    buffer_load_dwordx4 v[144:147], v238, s[52:55], s101 offen offset:0 sc1
    v_mfma_f32_16x16x32_bf16 v[52:55], a[72:75], v[88:91], v[52:55]
    v_mfma_f32_16x16x32_bf16 v[56:59], a[76:79], v[88:91], v[56:59]
    buffer_load_dwordx4 v[148:151], v238, s[52:55], s101 offen offset:1024 sc1
    v_mfma_f32_16x16x32_bf16 v[60:63], a[60:63], v[92:95], v[60:63]
    buffer_load_dwordx4 v[152:155], v238, s[52:55], s101 offen offset:2048 sc1
    v_mfma_f32_16x16x32_bf16 v[64:67], a[64:67], v[92:95], v[64:67]
    buffer_load_dwordx4 v[156:159], v238, s[52:55], s101 offen offset:3072 sc1
    v_mfma_f32_16x16x32_bf16 v[68:71], a[68:71], v[92:95], v[68:71]
    s_add_u32 s100, s100, 4096
    buffer_load_dwordx4 a[56:59], v238, s[56:59], s100 offen offset:0 sc1
    v_mfma_f32_16x16x32_bf16 v[72:75], a[72:75], v[92:95], v[72:75]
    s_mul_i32 s100, s30, 160
    s_add_u32 s100, s100, s9
    s_add_u32 s100, s100, 10240
    buffer_load_dwordx4 a[100:103], v238, s[56:59], s100 offen offset:0 sc1
    v_mfma_f32_16x16x32_bf16 v[76:79], a[76:79], v[92:95], v[76:79]
    s_waitcnt lgkmcnt(0)
    v_mfma_f32_16x16x32_bf16 v[0:3], a[80:83], v[96:99], v[0:3]
    v_mfma_f32_16x16x32_bf16 v[4:7], a[84:87], v[96:99], v[4:7]
    ds_read_b128 a[120:123], v236 offset:0
    v_mfma_f32_16x16x32_bf16 v[8:11], a[88:91], v[96:99], v[8:11]
    v_mfma_f32_16x16x32_bf16 v[12:15], a[92:95], v[96:99], v[12:15]
    ds_read_b128 a[124:127], v236 offset:1024
    v_mfma_f32_16x16x32_bf16 v[16:19], a[96:99], v[96:99], v[16:19]
    v_mfma_f32_16x16x32_bf16 v[20:23], a[80:83], v[100:103], v[20:23]
    ds_read_b128 a[128:131], v236 offset:2048
    v_mfma_f32_16x16x32_bf16 v[24:27], a[84:87], v[100:103], v[24:27]
    ds_read_b128 a[132:135], v236 offset:3072
    v_mfma_f32_16x16x32_bf16 v[28:31], a[88:91], v[100:103], v[28:31]
    v_mfma_f32_16x16x32_bf16 v[32:35], a[92:95], v[100:103], v[32:35]
    ds_read_b128 a[136:139], v236 offset:4096
    v_mfma_f32_16x16x32_bf16 v[36:39], a[96:99], v[100:103], v[36:39]
    v_mfma_f32_16x16x32_bf16 v[40:43], a[80:83], v[104:107], v[40:43]
    s_lshl_b32 s101, s12, 7
    s_add_u32 s101, s101, s99
    s_add_u32 s101, s101, 8192
    buffer_load_dwordx4 v[80:83], v238, s[52:55], s101 offen offset:0 sc1
    v_mfma_f32_16x16x32_bf16 v[44:47], a[84:87], v[104:107], v[44:47]
    buffer_load_dwordx4 v[84:87], v238, s[52:55], s101 offen offset:1024 sc1
    v_mfma_f32_16x16x32_bf16 v[48:51], a[88:91], v[104:107], v[48:51]
    v_mfma_f32_16x16x32_bf16 v[52:55], a[92:95], v[104:107], v[52:55]
    buffer_load_dwordx4 v[88:91], v238, s[52:55], s101 offen offset:2048 sc1
    v_mfma_f32_16x16x32_bf16 v[56:59], a[96:99], v[104:107], v[56:59]
    v_mfma_f32_16x16x32_bf16 v[60:63], a[80:83], v[108:111], v[60:63]
    buffer_load_dwordx4 v[92:95], v238, s[52:55], s101 offen offset:3072 sc1
    v_mfma_f32_16x16x32_bf16 v[64:67], a[84:87], v[108:111], v[64:67]
    buffer_load_dwordx4 a[104:107], v238, s[56:59], s100 offen offset:1024 sc1
    v_mfma_f32_16x16x32_bf16 v[68:71], a[88:91], v[108:111], v[68:71]
    v_mfma_f32_16x16x32_bf16 v[72:75], a[92:95], v[108:111], v[72:75]
    buffer_load_dwordx4 a[108:111], v238, s[56:59], s100 offen offset:2048 sc1
    v_mfma_f32_16x16x32_bf16 v[76:79], a[96:99], v[108:111], v[76:79]
    s_waitcnt vmcnt(20) lgkmcnt(0)
    v_mfma_f32_16x16x32_bf16 v[0:3], a[120:123], v[112:115], v[0:3]
    v_mfma_f32_16x16x32_bf16 v[4:7], a[124:127], v[112:115], v[4:7]
    ds_read_b128 a[140:143], v234 offset:40960
    v_mfma_f32_16x16x32_bf16 v[8:11], a[128:131], v[112:115], v[8:11]
    v_mfma_f32_16x16x32_bf16 v[12:15], a[132:135], v[112:115], v[12:15]
    ds_read_b128 a[144:147], v234 offset:41984
    v_mfma_f32_16x16x32_bf16 v[16:19], a[136:139], v[112:115], v[16:19]
    v_mfma_f32_16x16x32_bf16 v[20:23], a[120:123], v[116:119], v[20:23]
    ds_read_b128 a[148:151], v234 offset:43008
    v_mfma_f32_16x16x32_bf16 v[24:27], a[124:127], v[116:119], v[24:27]
    ds_read_b128 a[152:155], v234 offset:44032
    v_mfma_f32_16x16x32_bf16 v[28:31], a[128:131], v[116:119], v[28:31]
    v_mfma_f32_16x16x32_bf16 v[32:35], a[132:135], v[116:119], v[32:35]
    ds_read_b128 a[156:159], v234 offset:45056
    v_mfma_f32_16x16x32_bf16 v[36:39], a[136:139], v[116:119], v[36:39]
    v_mfma_f32_16x16x32_bf16 v[40:43], a[120:123], v[120:123], v[40:43]
    s_lshl_b32 s101, s13, 7
    s_add_u32 s101, s101, s99
    buffer_load_dwordx4 v[96:99], v238, s[52:55], s101 offen offset:0 sc1
    v_mfma_f32_16x16x32_bf16 v[44:47], a[124:127], v[120:123], v[44:47]
    buffer_load_dwordx4 v[100:103], v238, s[52:55], s101 offen offset:1024 sc1
    v_mfma_f32_16x16x32_bf16 v[48:51], a[128:131], v[120:123], v[48:51]
    v_mfma_f32_16x16x32_bf16 v[52:55], a[132:135], v[120:123], v[52:55]
    buffer_load_dwordx4 v[104:107], v238, s[52:55], s101 offen offset:2048 sc1
    v_mfma_f32_16x16x32_bf16 v[56:59], a[136:139], v[120:123], v[56:59]
    v_mfma_f32_16x16x32_bf16 v[60:63], a[120:123], v[124:127], v[60:63]
    buffer_load_dwordx4 v[108:111], v238, s[52:55], s101 offen offset:3072 sc1
    v_mfma_f32_16x16x32_bf16 v[64:67], a[124:127], v[124:127], v[64:67]
    buffer_load_dwordx4 a[112:115], v238, s[56:59], s100 offen offset:3072 sc1
    v_mfma_f32_16x16x32_bf16 v[68:71], a[128:131], v[124:127], v[68:71]
    v_mfma_f32_16x16x32_bf16 v[72:75], a[132:135], v[124:127], v[72:75]
    s_add_u32 s100, s100, 4096
    buffer_load_dwordx4 a[116:119], v238, s[56:59], s100 offen offset:0 sc1
    v_mfma_f32_16x16x32_bf16 v[76:79], a[136:139], v[124:127], v[76:79]
    s_waitcnt vmcnt(18) lgkmcnt(0)
    v_mfma_f32_16x16x32_bf16 v[0:3], a[140:143], v[128:131], v[0:3]
    s_lshl_b32 s101, s13, 7
    s_add_u32 s101, s101, s99
    s_add_u32 s101, s101, 8192
    buffer_load_dwordx4 v[112:115], v238, s[52:55], s101 offen offset:0 sc1
    v_mfma_f32_16x16x32_bf16 v[4:7], a[144:147], v[128:131], v[4:7]
    v_mfma_f32_16x16x32_bf16 v[8:11], a[148:151], v[128:131], v[8:11]
    v_mfma_f32_16x16x32_bf16 v[12:15], a[152:155], v[128:131], v[12:15]
    v_mfma_f32_16x16x32_bf16 v[16:19], a[156:159], v[128:131], v[16:19]
    v_mfma_f32_16x16x32_bf16 v[20:23], a[140:143], v[132:135], v[20:23]
    buffer_load_dwordx4 v[116:119], v238, s[52:55], s101 offen offset:1024 sc1
    v_mfma_f32_16x16x32_bf16 v[24:27], a[144:147], v[132:135], v[24:27]
    v_mfma_f32_16x16x32_bf16 v[28:31], a[148:151], v[132:135], v[28:31]
    v_mfma_f32_16x16x32_bf16 v[32:35], a[152:155], v[132:135], v[32:35]
    v_mfma_f32_16x16x32_bf16 v[36:39], a[156:159], v[132:135], v[36:39]
    v_mfma_f32_16x16x32_bf16 v[40:43], a[140:143], v[136:139], v[40:43]
    buffer_load_dwordx4 v[120:123], v238, s[52:55], s101 offen offset:2048 sc1
    v_mfma_f32_16x16x32_bf16 v[44:47], a[144:147], v[136:139], v[44:47]
    v_mfma_f32_16x16x32_bf16 v[48:51], a[148:151], v[136:139], v[48:51]
    v_mfma_f32_16x16x32_bf16 v[52:55], a[152:155], v[136:139], v[52:55]
    v_mfma_f32_16x16x32_bf16 v[56:59], a[156:159], v[136:139], v[56:59]
    v_mfma_f32_16x16x32_bf16 v[60:63], a[140:143], v[140:143], v[60:63]
    buffer_load_dwordx4 v[124:127], v238, s[52:55], s101 offen offset:3072 sc1
    v_mfma_f32_16x16x32_bf16 v[64:67], a[144:147], v[140:143], v[64:67]
    v_mfma_f32_16x16x32_bf16 v[68:71], a[148:151], v[140:143], v[68:71]
    v_mfma_f32_16x16x32_bf16 v[72:75], a[152:155], v[140:143], v[72:75]
    v_mfma_f32_16x16x32_bf16 v[76:79], a[156:159], v[140:143], v[76:79]
    s_waitcnt vmcnt(18)
    v_mfma_f32_16x16x32_bf16 v[0:3], a[0:3], v[144:147], v[0:3]
    s_lshl_b32 s101, s14, 7
    s_add_u32 s101, s101, s99
    buffer_load_dwordx4 v[128:131], v238, s[52:55], s101 offen offset:0 sc1
    v_mfma_f32_16x16x32_bf16 v[4:7], a[4:7], v[144:147], v[4:7]
    v_mfma_f32_16x16x32_bf16 v[8:11], a[8:11], v[144:147], v[8:11]
    v_mfma_f32_16x16x32_bf16 v[12:15], a[12:15], v[144:147], v[12:15]
    v_mfma_f32_16x16x32_bf16 v[16:19], a[16:19], v[144:147], v[16:19]
    v_mfma_f32_16x16x32_bf16 v[20:23], a[0:3], v[148:151], v[20:23]
    buffer_load_dwordx4 v[132:135], v238, s[52:55], s101 offen offset:1024 sc1
    v_mfma_f32_16x16x32_bf16 v[24:27], a[4:7], v[148:151], v[24:27]
    v_mfma_f32_16x16x32_bf16 v[28:31], a[8:11], v[148:151], v[28:31]
    v_mfma_f32_16x16x32_bf16 v[32:35], a[12:15], v[148:151], v[32:35]
    v_mfma_f32_16x16x32_bf16 v[36:39], a[16:19], v[148:151], v[36:39]
    v_mfma_f32_16x16x32_bf16 v[40:43], a[0:3], v[152:155], v[40:43]
    buffer_load_dwordx4 v[136:139], v238, s[52:55], s101 offen offset:2048 sc1
    v_mfma_f32_16x16x32_bf16 v[44:47], a[4:7], v[152:155], v[44:47]
    v_mfma_f32_16x16x32_bf16 v[48:51], a[8:11], v[152:155], v[48:51]
    v_mfma_f32_16x16x32_bf16 v[52:55], a[12:15], v[152:155], v[52:55]
    v_mfma_f32_16x16x32_bf16 v[56:59], a[16:19], v[152:155], v[56:59]
    v_mfma_f32_16x16x32_bf16 v[60:63], a[0:3], v[156:159], v[60:63]
    buffer_load_dwordx4 v[140:143], v238, s[52:55], s101 offen offset:3072 sc1
    v_mfma_f32_16x16x32_bf16 v[64:67], a[4:7], v[156:159], v[64:67]
    v_mfma_f32_16x16x32_bf16 v[68:71], a[8:11], v[156:159], v[68:71]
    v_mfma_f32_16x16x32_bf16 v[72:75], a[12:15], v[156:159], v[72:75]
    v_mfma_f32_16x16x32_bf16 v[76:79], a[16:19], v[156:159], v[76:79]
    s_waitcnt vmcnt(16)
    v_mfma_f32_16x16x32_bf16 v[0:3], a[20:23], v[80:83], v[0:3]
    v_mfma_f32_16x16x32_bf16 v[4:7], a[24:27], v[80:83], v[4:7]
    v_mfma_f32_16x16x32_bf16 v[8:11], a[28:31], v[80:83], v[8:11]
    ds_read_b128 a[160:163], v234 offset:0
    v_mfma_f32_16x16x32_bf16 v[12:15], a[32:35], v[80:83], v[12:15]
    v_mfma_f32_16x16x32_bf16 v[16:19], a[36:39], v[80:83], v[16:19]
    ds_read_b128 a[164:167], v234 offset:1024
    v_mfma_f32_16x16x32_bf16 v[20:23], a[20:23], v[84:87], v[20:23]
    v_mfma_f32_16x16x32_bf16 v[24:27], a[24:27], v[84:87], v[24:27]
    ds_read_b128 a[168:171], v234 offset:2048
    v_mfma_f32_16x16x32_bf16 v[28:31], a[28:31], v[84:87], v[28:31]
    v_mfma_f32_16x16x32_bf16 v[32:35], a[32:35], v[84:87], v[32:35]
    ds_read_b128 a[172:175], v234 offset:3072
    v_mfma_f32_16x16x32_bf16 v[36:39], a[36:39], v[84:87], v[36:39]
    v_mfma_f32_16x16x32_bf16 v[40:43], a[20:23], v[88:91], v[40:43]
    ds_read_b128 a[176:179], v234 offset:4096
    v_mfma_f32_16x16x32_bf16 v[44:47], a[24:27], v[88:91], v[44:47]
    v_mfma_f32_16x16x32_bf16 v[48:51], a[28:31], v[88:91], v[48:51]
    s_lshl_b32 s101, s14, 7
    s_add_u32 s101, s101, s99
    s_add_u32 s101, s101, 8192
    buffer_load_dwordx4 v[144:147], v238, s[52:55], s101 offen offset:0 sc1
    v_mfma_f32_16x16x32_bf16 v[52:55], a[32:35], v[88:91], v[52:55]
    v_mfma_f32_16x16x32_bf16 v[56:59], a[36:39], v[88:91], v[56:59]
    buffer_load_dwordx4 v[148:151], v238, s[52:55], s101 offen offset:1024 sc1
    v_mfma_f32_16x16x32_bf16 v[60:63], a[20:23], v[92:95], v[60:63]
    v_mfma_f32_16x16x32_bf16 v[64:67], a[24:27], v[92:95], v[64:67]
    buffer_load_dwordx4 v[152:155], v238, s[52:55], s101 offen offset:2048 sc1
    v_mfma_f32_16x16x32_bf16 v[68:71], a[28:31], v[92:95], v[68:71]
    v_mfma_f32_16x16x32_bf16 v[72:75], a[32:35], v[92:95], v[72:75]
    buffer_load_dwordx4 v[156:159], v238, s[52:55], s101 offen offset:3072 sc1
    v_mfma_f32_16x16x32_bf16 v[76:79], a[36:39], v[92:95], v[76:79]
    s_waitcnt vmcnt(14) lgkmcnt(0)
    v_mfma_f32_16x16x32_bf16 v[0:3], a[160:163], v[96:99], v[0:3]
    v_mfma_f32_16x16x32_bf16 v[4:7], a[164:167], v[96:99], v[4:7]
    v_mfma_f32_16x16x32_bf16 v[8:11], a[168:171], v[96:99], v[8:11]
    ds_read_b128 a[180:183], v236 offset:21504
    v_mfma_f32_16x16x32_bf16 v[12:15], a[172:175], v[96:99], v[12:15]
    v_mfma_f32_16x16x32_bf16 v[16:19], a[176:179], v[96:99], v[16:19]
    ds_read_b128 a[184:187], v236 offset:22528
    v_mfma_f32_16x16x32_bf16 v[20:23], a[160:163], v[100:103], v[20:23]
    v_mfma_f32_16x16x32_bf16 v[24:27], a[164:167], v[100:103], v[24:27]
    ds_read_b128 a[188:191], v236 offset:23552
    v_mfma_f32_16x16x32_bf16 v[28:31], a[168:171], v[100:103], v[28:31]
    v_mfma_f32_16x16x32_bf16 v[32:35], a[172:175], v[100:103], v[32:35]
    ds_read_b128 a[192:195], v236 offset:5120
    v_mfma_f32_16x16x32_bf16 v[36:39], a[176:179], v[100:103], v[36:39]
    v_mfma_f32_16x16x32_bf16 v[40:43], a[160:163], v[104:107], v[40:43]
    ds_read_b128 a[196:199], v236 offset:6144
    v_mfma_f32_16x16x32_bf16 v[44:47], a[164:167], v[104:107], v[44:47]
    v_mfma_f32_16x16x32_bf16 v[48:51], a[168:171], v[104:107], v[48:51]
    s_lshl_b32 s101, s15, 7
    s_add_u32 s101, s101, s99
    buffer_load_dwordx4 v[80:83], v238, s[52:55], s101 offen offset:0 sc1
    v_mfma_f32_16x16x32_bf16 v[52:55], a[172:175], v[104:107], v[52:55]
    v_mfma_f32_16x16x32_bf16 v[56:59], a[176:179], v[104:107], v[56:59]
    buffer_load_dwordx4 v[84:87], v238, s[52:55], s101 offen offset:1024 sc1
    v_mfma_f32_16x16x32_bf16 v[60:63], a[160:163], v[108:111], v[60:63]
    v_mfma_f32_16x16x32_bf16 v[64:67], a[164:167], v[108:111], v[64:67]
    buffer_load_dwordx4 v[88:91], v238, s[52:55], s101 offen offset:2048 sc1
    v_mfma_f32_16x16x32_bf16 v[68:71], a[168:171], v[108:111], v[68:71]
    v_mfma_f32_16x16x32_bf16 v[72:75], a[172:175], v[108:111], v[72:75]
    buffer_load_dwordx4 v[92:95], v238, s[52:55], s101 offen offset:3072 sc1
    v_mfma_f32_16x16x32_bf16 v[76:79], a[176:179], v[108:111], v[76:79]
    s_waitcnt vmcnt(12) lgkmcnt(0)
    v_mfma_f32_16x16x32_bf16 v[0:3], a[180:183], v[112:115], v[0:3]
    v_mfma_f32_16x16x32_bf16 v[4:7], a[184:187], v[112:115], v[4:7]
    v_mfma_f32_16x16x32_bf16 v[8:11], a[188:191], v[112:115], v[8:11]
    ds_read_b128 a[200:203], v236 offset:7168
    v_mfma_f32_16x16x32_bf16 v[12:15], a[192:195], v[112:115], v[12:15]
    v_mfma_f32_16x16x32_bf16 v[16:19], a[196:199], v[112:115], v[16:19]
    ds_read_b128 a[204:207], v236 offset:13312
    v_mfma_f32_16x16x32_bf16 v[20:23], a[180:183], v[116:119], v[20:23]
    v_mfma_f32_16x16x32_bf16 v[24:27], a[184:187], v[116:119], v[24:27]
    ds_read_b128 a[208:211], v236 offset:14336
    v_mfma_f32_16x16x32_bf16 v[28:31], a[188:191], v[116:119], v[28:31]
    v_mfma_f32_16x16x32_bf16 v[32:35], a[192:195], v[116:119], v[32:35]
    ds_read_b128 a[212:215], v236 offset:15360
    v_mfma_f32_16x16x32_bf16 v[36:39], a[196:199], v[116:119], v[36:39]
    v_mfma_f32_16x16x32_bf16 v[40:43], a[180:183], v[120:123], v[40:43]
    ds_read_b128 a[216:219], v237 offset:0
    v_mfma_f32_16x16x32_bf16 v[44:47], a[184:187], v[120:123], v[44:47]
    v_mfma_f32_16x16x32_bf16 v[48:51], a[188:191], v[120:123], v[48:51]
    s_lshl_b32 s101, s15, 7
    s_add_u32 s101, s101, s99
    s_add_u32 s101, s101, 8192
    buffer_load_dwordx4 v[96:99], v238, s[52:55], s101 offen offset:0 sc1
    v_mfma_f32_16x16x32_bf16 v[52:55], a[192:195], v[120:123], v[52:55]
    v_mfma_f32_16x16x32_bf16 v[56:59], a[196:199], v[120:123], v[56:59]
    buffer_load_dwordx4 v[100:103], v238, s[52:55], s101 offen offset:1024 sc1
    v_mfma_f32_16x16x32_bf16 v[60:63], a[180:183], v[124:127], v[60:63]
    v_mfma_f32_16x16x32_bf16 v[64:67], a[184:187], v[124:127], v[64:67]
    buffer_load_dwordx4 v[104:107], v238, s[52:55], s101 offen offset:2048 sc1
    v_mfma_f32_16x16x32_bf16 v[68:71], a[188:191], v[124:127], v[68:71]
    v_mfma_f32_16x16x32_bf16 v[72:75], a[192:195], v[124:127], v[72:75]
    buffer_load_dwordx4 v[108:111], v238, s[52:55], s101 offen offset:3072 sc1
    v_mfma_f32_16x16x32_bf16 v[76:79], a[196:199], v[124:127], v[76:79]
    s_waitcnt vmcnt(12) lgkmcnt(0)
    v_mfma_f32_16x16x32_bf16 v[0:3], a[200:203], v[128:131], v[0:3]
    v_mfma_f32_16x16x32_bf16 v[4:7], a[204:207], v[128:131], v[4:7]
    v_mfma_f32_16x16x32_bf16 v[8:11], a[208:211], v[128:131], v[8:11]
    ds_read_b128 a[220:223], v236 offset:8192
    v_mfma_f32_16x16x32_bf16 v[12:15], a[212:215], v[128:131], v[12:15]
    v_mfma_f32_16x16x32_bf16 v[16:19], a[216:219], v[128:131], v[16:19]
    ds_read_b128 a[224:227], v236 offset:9216
    v_mfma_f32_16x16x32_bf16 v[20:23], a[200:203], v[132:135], v[20:23]
    v_mfma_f32_16x16x32_bf16 v[24:27], a[204:207], v[132:135], v[24:27]
    ds_read_b128 a[228:231], v236 offset:10240
    v_mfma_f32_16x16x32_bf16 v[28:31], a[208:211], v[132:135], v[28:31]
    v_mfma_f32_16x16x32_bf16 v[32:35], a[212:215], v[132:135], v[32:35]
    ds_read_b128 a[232:235], v236 offset:11264
    v_mfma_f32_16x16x32_bf16 v[36:39], a[216:219], v[132:135], v[36:39]
    v_mfma_f32_16x16x32_bf16 v[40:43], a[200:203], v[136:139], v[40:43]
    ds_read_b128 a[236:239], v236 offset:12288
    v_mfma_f32_16x16x32_bf16 v[44:47], a[204:207], v[136:139], v[44:47]
    v_mfma_f32_16x16x32_bf16 v[48:51], a[208:211], v[136:139], v[48:51]
    s_lshl_b32 s101, s30, 7
    s_add_u32 s101, s101, s99
    buffer_load_dwordx4 v[112:115], v238, s[52:55], s101 offen offset:0 sc1
    v_mfma_f32_16x16x32_bf16 v[52:55], a[212:215], v[136:139], v[52:55]
    v_mfma_f32_16x16x32_bf16 v[56:59], a[216:219], v[136:139], v[56:59]
    buffer_load_dwordx4 v[116:119], v238, s[52:55], s101 offen offset:1024 sc1
    v_mfma_f32_16x16x32_bf16 v[60:63], a[200:203], v[140:143], v[60:63]
    v_mfma_f32_16x16x32_bf16 v[64:67], a[204:207], v[140:143], v[64:67]
    buffer_load_dwordx4 v[120:123], v238, s[52:55], s101 offen offset:2048 sc1
    v_mfma_f32_16x16x32_bf16 v[68:71], a[208:211], v[140:143], v[68:71]
    v_mfma_f32_16x16x32_bf16 v[72:75], a[212:215], v[140:143], v[72:75]
    buffer_load_dwordx4 v[124:127], v238, s[52:55], s101 offen offset:3072 sc1
    v_mfma_f32_16x16x32_bf16 v[76:79], a[216:219], v[140:143], v[76:79]
    s_waitcnt vmcnt(12) lgkmcnt(0)
    v_mfma_f32_16x16x32_bf16 v[0:3], a[220:223], v[144:147], v[0:3]
    s_lshl_b32 s101, s30, 7
    s_add_u32 s101, s101, s99
    s_add_u32 s101, s101, 8192
    buffer_load_dwordx4 v[128:131], v238, s[52:55], s101 offen offset:0 sc1
    v_mfma_f32_16x16x32_bf16 v[4:7], a[224:227], v[144:147], v[4:7]
    v_mfma_f32_16x16x32_bf16 v[8:11], a[228:231], v[144:147], v[8:11]
    v_mfma_f32_16x16x32_bf16 v[12:15], a[232:235], v[144:147], v[12:15]
    v_mfma_f32_16x16x32_bf16 v[16:19], a[236:239], v[144:147], v[16:19]
    buffer_load_dwordx4 v[132:135], v238, s[52:55], s101 offen offset:1024 sc1
    v_mfma_f32_16x16x32_bf16 v[20:23], a[220:223], v[148:151], v[20:23]
    v_mfma_f32_16x16x32_bf16 v[24:27], a[224:227], v[148:151], v[24:27]
    v_mfma_f32_16x16x32_bf16 v[28:31], a[228:231], v[148:151], v[28:31]
    v_mfma_f32_16x16x32_bf16 v[32:35], a[232:235], v[148:151], v[32:35]
    buffer_load_dwordx4 v[136:139], v238, s[52:55], s101 offen offset:2048 sc1
    v_mfma_f32_16x16x32_bf16 v[36:39], a[236:239], v[148:151], v[36:39]
    v_mfma_f32_16x16x32_bf16 v[40:43], a[220:223], v[152:155], v[40:43]
    v_mfma_f32_16x16x32_bf16 v[44:47], a[224:227], v[152:155], v[44:47]
    v_mfma_f32_16x16x32_bf16 v[48:51], a[228:231], v[152:155], v[48:51]
    buffer_load_dwordx4 v[140:143], v238, s[52:55], s101 offen offset:3072 sc1
    v_mfma_f32_16x16x32_bf16 v[52:55], a[232:235], v[152:155], v[52:55]
    v_mfma_f32_16x16x32_bf16 v[56:59], a[236:239], v[152:155], v[56:59]
    v_mfma_f32_16x16x32_bf16 v[60:63], a[220:223], v[156:159], v[60:63]
    v_mfma_f32_16x16x32_bf16 v[64:67], a[224:227], v[156:159], v[64:67]
    s_barrier
    v_mfma_f32_16x16x32_bf16 v[68:71], a[228:231], v[156:159], v[68:71]
    v_mfma_f32_16x16x32_bf16 v[72:75], a[232:235], v[156:159], v[72:75]
    v_mfma_f32_16x16x32_bf16 v[76:79], a[236:239], v[156:159], v[76:79]
    s_waitcnt vmcnt(12)
    v_mfma_f32_16x16x32_bf16 v[0:3], v[160:163], v[80:83], v[0:3]
    v_mfma_f32_16x16x32_bf16 v[4:7], v[164:167], v[80:83], v[4:7]
    v_mfma_f32_16x16x32_bf16 v[8:11], v[168:171], v[80:83], v[8:11]
    v_mfma_f32_16x16x32_bf16 v[12:15], v[172:175], v[80:83], v[12:15]
    v_mfma_f32_16x16x32_bf16 v[16:19], v[176:179], v[80:83], v[16:19]
    v_mfma_f32_16x16x32_bf16 v[20:23], v[160:163], v[84:87], v[20:23]
    v_mfma_f32_16x16x32_bf16 v[24:27], v[164:167], v[84:87], v[24:27]
    v_mfma_f32_16x16x32_bf16 v[28:31], v[168:171], v[84:87], v[28:31]
    v_mfma_f32_16x16x32_bf16 v[32:35], v[172:175], v[84:87], v[32:35]
    v_mfma_f32_16x16x32_bf16 v[36:39], v[176:179], v[84:87], v[36:39]
    v_mfma_f32_16x16x32_bf16 v[40:43], v[160:163], v[88:91], v[40:43]
    v_mfma_f32_16x16x32_bf16 v[44:47], v[164:167], v[88:91], v[44:47]
    v_mfma_f32_16x16x32_bf16 v[48:51], v[168:171], v[88:91], v[48:51]
    v_mfma_f32_16x16x32_bf16 v[52:55], v[172:175], v[88:91], v[52:55]
    v_mfma_f32_16x16x32_bf16 v[56:59], v[176:179], v[88:91], v[56:59]
    v_mfma_f32_16x16x32_bf16 v[60:63], v[160:163], v[92:95], v[60:63]
    v_mfma_f32_16x16x32_bf16 v[64:67], v[164:167], v[92:95], v[64:67]
    v_mfma_f32_16x16x32_bf16 v[68:71], v[168:171], v[92:95], v[68:71]
    v_mfma_f32_16x16x32_bf16 v[72:75], v[172:175], v[92:95], v[72:75]
    v_mfma_f32_16x16x32_bf16 v[76:79], v[176:179], v[92:95], v[76:79]
    s_waitcnt vmcnt(8)
    v_mfma_f32_16x16x32_bf16 v[0:3], v[180:183], v[96:99], v[0:3]
    v_mfma_f32_16x16x32_bf16 v[4:7], v[184:187], v[96:99], v[4:7]
    v_mfma_f32_16x16x32_bf16 v[8:11], v[188:191], v[96:99], v[8:11]
    v_mfma_f32_16x16x32_bf16 v[12:15], v[192:195], v[96:99], v[12:15]
    v_mfma_f32_16x16x32_bf16 v[16:19], v[196:199], v[96:99], v[16:19]
    s_waitcnt vmcnt(4)
    v_mfma_f32_16x16x32_bf16 v[0:3], a[40:43], v[112:115], v[0:3]
    v_mfma_f32_16x16x32_bf16 v[4:7], a[44:47], v[112:115], v[4:7]
    v_mfma_f32_16x16x32_bf16 v[8:11], a[48:51], v[112:115], v[8:11]
    v_mfma_f32_16x16x32_bf16 v[12:15], a[52:55], v[112:115], v[12:15]
    v_mfma_f32_16x16x32_bf16 v[16:19], a[56:59], v[112:115], v[16:19]
    s_waitcnt vmcnt(0)
    v_mfma_f32_16x16x32_bf16 v[0:3], a[100:103], v[128:131], v[0:3]
    v_mfma_f32_16x16x32_bf16 v[4:7], a[104:107], v[128:131], v[4:7]
    v_mfma_f32_16x16x32_bf16 v[8:11], a[108:111], v[128:131], v[8:11]
    v_mfma_f32_16x16x32_bf16 v[12:15], a[112:115], v[128:131], v[12:15]
    v_mfma_f32_16x16x32_bf16 v[16:19], a[116:119], v[128:131], v[16:19]
    v_mfma_f32_16x16x32_bf16 v[20:23], v[180:183], v[100:103], v[20:23]
    v_mfma_f32_16x16x32_bf16 v[24:27], v[184:187], v[100:103], v[24:27]
    v_mfma_f32_16x16x32_bf16 v[28:31], v[188:191], v[100:103], v[28:31]
    s_nop 0
    ds_write_b128 v230, v[0:3] offset:0
    v_mfma_f32_16x16x32_bf16 v[32:35], v[192:195], v[100:103], v[32:35]
    v_mfma_f32_16x16x32_bf16 v[36:39], v[196:199], v[100:103], v[36:39]
    ds_write_b128 v230, v[4:7] offset:64
    v_mfma_f32_16x16x32_bf16 v[20:23], a[40:43], v[116:119], v[20:23]
    v_mfma_f32_16x16x32_bf16 v[24:27], a[44:47], v[116:119], v[24:27]
    ds_write_b128 v230, v[8:11] offset:128
    v_mfma_f32_16x16x32_bf16 v[28:31], a[48:51], v[116:119], v[28:31]
    v_mfma_f32_16x16x32_bf16 v[32:35], a[52:55], v[116:119], v[32:35]
    ds_write_b128 v230, v[12:15] offset:192
    v_mfma_f32_16x16x32_bf16 v[36:39], a[56:59], v[116:119], v[36:39]
    v_mfma_f32_16x16x32_bf16 v[20:23], a[100:103], v[132:135], v[20:23]
    ds_write_b128 v230, v[16:19] offset:256
    v_mfma_f32_16x16x32_bf16 v[24:27], a[104:107], v[132:135], v[24:27]
    v_mfma_f32_16x16x32_bf16 v[28:31], a[108:111], v[132:135], v[28:31]
    v_mfma_f32_16x16x32_bf16 v[32:35], a[112:115], v[132:135], v[32:35]
    v_mfma_f32_16x16x32_bf16 v[36:39], a[116:119], v[132:135], v[36:39]
    s_waitcnt lgkmcnt(0)
    s_barrier
    v_mfma_f32_16x16x32_bf16 v[40:43], v[180:183], v[104:107], v[40:43]
    ds_read_b128 v[80:83], v222 offset:0
    ds_read_b128 v[84:87], v222 offset:21504
    v_mfma_f32_16x16x32_bf16 v[44:47], v[184:187], v[104:107], v[44:47]
    ds_read_b128 v[88:91], v223 offset:0
    ds_read_b128 v[92:95], v223 offset:21504
    v_mfma_f32_16x16x32_bf16 v[48:51], v[188:191], v[104:107], v[48:51]
    ds_write_b128 v230, v[20:23] offset:5376
    v_mfma_f32_16x16x32_bf16 v[52:55], v[192:195], v[104:107], v[52:55]
    v_mfma_f32_16x16x32_bf16 v[56:59], v[196:199], v[104:107], v[56:59]
    ds_write_b128 v230, v[24:27] offset:5440
    v_mfma_f32_16x16x32_bf16 v[40:43], a[40:43], v[120:123], v[40:43]
    v_mfma_f32_16x16x32_bf16 v[44:47], a[44:47], v[120:123], v[44:47]
    ds_write_b128 v230, v[28:31] offset:5504
    v_mfma_f32_16x16x32_bf16 v[48:51], a[48:51], v[120:123], v[48:51]
    v_mfma_f32_16x16x32_bf16 v[52:55], a[52:55], v[120:123], v[52:55]
    ds_write_b128 v230, v[32:35] offset:5568
    v_mfma_f32_16x16x32_bf16 v[56:59], a[56:59], v[120:123], v[56:59]
    v_mfma_f32_16x16x32_bf16 v[40:43], a[100:103], v[136:139], v[40:43]
    ds_write_b128 v230, v[36:39] offset:5632
    v_mfma_f32_16x16x32_bf16 v[44:47], a[104:107], v[136:139], v[44:47]
    v_mfma_f32_16x16x32_bf16 v[48:51], a[108:111], v[136:139], v[48:51]
    v_mfma_f32_16x16x32_bf16 v[52:55], a[112:115], v[136:139], v[52:55]
    v_mfma_f32_16x16x32_bf16 v[56:59], a[116:119], v[136:139], v[56:59]
    s_waitcnt lgkmcnt(0)
    s_barrier
    v_mfma_f32_16x16x32_bf16 v[60:63], v[180:183], v[108:111], v[60:63]
    ds_read_b128 v[144:147], v222 offset:5376
    ds_read_b128 v[148:151], v222 offset:26880
    v_mfma_f32_16x16x32_bf16 v[64:67], v[184:187], v[108:111], v[64:67]
    ds_read_b128 v[152:155], v223 offset:5376
    ds_read_b128 v[156:159], v223 offset:26880
    v_mfma_f32_16x16x32_bf16 v[68:71], v[188:191], v[108:111], v[68:71]
    ds_write_b128 v230, v[40:43] offset:10752
    s_mov_b32 s73, 0
    v_mfma_f32_16x16x32_bf16 v[72:75], v[192:195], v[108:111], v[72:75]
    v_add_f32 v200, v200, v80
    v_mfma_f32_16x16x32_bf16 v[76:79], v[196:199], v[108:111], v[76:79]
    ds_write_b128 v230, v[44:47] offset:10816
    v_add_f32 v201, v201, v81
    v_add_f32 v202, v202, v82
    v_mfma_f32_16x16x32_bf16 v[60:63], a[40:43], v[124:127], v[60:63]
    v_add_f32 v203, v203, v83
    v_mfma_f32_16x16x32_bf16 v[64:67], a[44:47], v[124:127], v[64:67]
    ds_write_b128 v230, v[48:51] offset:10880
    v_add_f32 v200, v200, v84
    v_add_f32 v201, v201, v85
    v_mfma_f32_16x16x32_bf16 v[68:71], a[48:51], v[124:127], v[68:71]
    v_add_f32 v202, v202, v86
    v_mfma_f32_16x16x32_bf16 v[72:75], a[52:55], v[124:127], v[72:75]
    ds_write_b128 v230, v[52:55] offset:10944
    v_add_f32 v203, v203, v87
    v_add_f32 v200, v200, v88
    v_mfma_f32_16x16x32_bf16 v[76:79], a[56:59], v[124:127], v[76:79]
    v_add_f32 v201, v201, v89
    v_mfma_f32_16x16x32_bf16 v[60:63], a[100:103], v[140:143], v[60:63]
    ds_write_b128 v230, v[56:59] offset:11008
    v_add_f32 v202, v202, v90
    v_add_f32 v203, v203, v91
    v_mfma_f32_16x16x32_bf16 v[64:67], a[104:107], v[140:143], v[64:67]
    v_add_f32 v200, v200, v92
    v_mfma_f32_16x16x32_bf16 v[68:71], a[108:111], v[140:143], v[68:71]
    v_add_f32 v201, v201, v93
    v_add_f32 v202, v202, v94
    v_mfma_f32_16x16x32_bf16 v[72:75], a[112:115], v[140:143], v[72:75]
    v_add_f32 v203, v203, v95
    v_mfma_f32_16x16x32_bf16 v[76:79], a[116:119], v[140:143], v[76:79]
    buffer_store_dwordx4 v[200:203], v220, s[44:47], s73 offen nt
    s_waitcnt lgkmcnt(0)
    s_barrier
    s_nop 0
    ds_read_b128 v[0:3], v222 offset:10752
    ds_read_b128 v[4:7], v222 offset:32256
    ds_read_b128 v[8:11], v223 offset:10752
    ds_read_b128 v[12:15], v223 offset:32256
    ds_write_b128 v230, v[60:63] offset:16128
    ds_write_b128 v230, v[64:67] offset:16192
    ds_write_b128 v230, v[68:71] offset:16256
    ds_write_b128 v230, v[72:75] offset:16320
    ds_write_b128 v230, v[76:79] offset:16384
    s_mov_b32 s73, 40960
    v_pk_add_f32 v[204:205], v[204:205], v[144:145]
    v_pk_add_f32 v[206:207], v[206:207], v[146:147]
    v_pk_add_f32 v[204:205], v[204:205], v[148:149]
    v_pk_add_f32 v[206:207], v[206:207], v[150:151]
    v_pk_add_f32 v[204:205], v[204:205], v[152:153]
    v_pk_add_f32 v[206:207], v[206:207], v[154:155]
    v_pk_add_f32 v[204:205], v[204:205], v[156:157]
    v_pk_add_f32 v[206:207], v[206:207], v[158:159]
    buffer_store_dwordx4 v[204:207], v220, s[44:47], s73 offen nt
    s_mov_b32 s73, 81920
    s_waitcnt lgkmcnt(5)
    s_nop 0
    v_pk_add_f32 v[208:209], v[208:209], v[0:1]
    v_pk_add_f32 v[210:211], v[210:211], v[2:3]
    v_pk_add_f32 v[208:209], v[208:209], v[4:5]
    v_pk_add_f32 v[210:211], v[210:211], v[6:7]
    v_pk_add_f32 v[208:209], v[208:209], v[8:9]
    v_pk_add_f32 v[210:211], v[210:211], v[10:11]
    v_pk_add_f32 v[208:209], v[208:209], v[12:13]
    v_pk_add_f32 v[210:211], v[210:211], v[14:15]
    buffer_store_dwordx4 v[208:211], v220, s[44:47], s73 offen nt
    s_waitcnt lgkmcnt(0)
    s_barrier
    ds_read_b128 v[96:99], v222 offset:16128
    ds_read_b128 v[100:103], v222 offset:37632
    ds_read_b128 v[104:107], v223 offset:16128
    ds_read_b128 v[108:111], v223 offset:37632
    ds_read_b128 v[112:115], v224 offset:0
    ds_read_b128 v[116:119], v224 offset:21504
    ds_read_b128 v[120:123], v224 offset:43008
    ds_read_b128 v[124:127], v224 offset:64512
    s_mov_b32 s73, 122880
    s_waitcnt lgkmcnt(4)
    s_nop 0
    v_pk_add_f32 v[212:213], v[212:213], v[96:97]
    v_pk_add_f32 v[214:215], v[214:215], v[98:99]
    v_pk_add_f32 v[212:213], v[212:213], v[100:101]
    v_pk_add_f32 v[214:215], v[214:215], v[102:103]
    v_pk_add_f32 v[212:213], v[212:213], v[104:105]
    v_pk_add_f32 v[214:215], v[214:215], v[106:107]
    v_pk_add_f32 v[212:213], v[212:213], v[108:109]
    v_pk_add_f32 v[214:215], v[214:215], v[110:111]
    buffer_store_dwordx4 v[212:215], v220, s[44:47], s73 offen nt
    s_mov_b32 s73, 0
    s_waitcnt lgkmcnt(0)
    v_pk_add_f32 v[216:217], v[216:217], v[112:113]
    v_pk_add_f32 v[218:219], v[218:219], v[114:115]
    v_pk_add_f32 v[216:217], v[216:217], v[116:117]
    v_pk_add_f32 v[218:219], v[218:219], v[118:119]
    v_pk_add_f32 v[216:217], v[216:217], v[120:121]
    v_pk_add_f32 v[218:219], v[218:219], v[122:123]
    v_pk_add_f32 v[216:217], v[216:217], v[124:125]
    v_pk_add_f32 v[218:219], v[218:219], v[126:127]
    buffer_store_dwordx4 v[216:219], v221, s[44:47], s73 offen nt
    s_endpgm
L_g12:
    s_nop 0
    ds_read_b64_tr_b16 v[200:201], v220 offset:0
    ds_read_b64_tr_b16 v[202:203], v220 offset:256
    ds_read_b64_tr_b16 v[204:205], v220 offset:8192
    ds_read_b64_tr_b16 v[206:207], v220 offset:8448
    ds_read_b128 v[160:163], v216 offset:0
    ds_read_b128 v[164:167], v216 offset:1024
    ds_read_b128 v[168:171], v216 offset:2048
    ds_read_b128 v[172:175], v216 offset:3072
    s_waitcnt lgkmcnt(0)
    v_mfma_f32_32x32x16_bf16 v[0:15], v[200:203], v[160:163], 0
    ds_read_b64_tr_b16 v[208:209], v220 offset:2048
    ds_read_b64_tr_b16 v[210:211], v220 offset:2304
    v_accvgpr_write_b32 a232, 0
    v_mfma_f32_32x32x16_bf16 v[16:31], v[204:207], v[160:163], 0
    ds_read_b64_tr_b16 v[212:213], v220 offset:10240
    ds_read_b64_tr_b16 v[214:215], v220 offset:10496
    v_mfma_f32_32x32x16_bf16 v[32:47], v[200:203], v[164:167], 0
    ds_read_b128 v[180:183], v217 offset:0
    ds_read_b128 v[184:187], v217 offset:1024
    s_add_u32 m0, s72, 32768
    s_add_u32 s68, s98, s12
    s_add_u32 s68, s68, 0
    buffer_load_dwordx4 v250, s[92:95], s68 offen offset:0 lds
    v_mfma_f32_32x32x16_bf16 v[48:63], v[204:207], v[164:167], 0
    ds_read_b128 v[188:191], v217 offset:2048
    ds_read_b128 v[192:195], v217 offset:3072
    buffer_load_dwordx4 v251, s[92:95], s68 offen offset:1024 lds
    v_mfma_f32_32x32x16_bf16 v[64:79], v[200:203], v[168:171], 0
    s_add_u32 m0, s72, 16384
    s_add_u32 s68, s26, 0
    buffer_load_dwordx4 v232, s[44:47], s68 offen offset:3072 lds
    v_mfma_f32_32x32x16_bf16 v[80:95], v[204:207], v[168:171], 0
    s_add_u32 m0, s72, 20480
    s_add_u32 s68, s26, 110592
    buffer_load_dwordx4 v229, s[44:47], s68 offen offset:0 lds
    v_accvgpr_write_b32 a233, 0
    v_mfma_f32_32x32x16_bf16 v[96:111], v[200:203], v[172:175], 0
    buffer_load_dwordx4 v230, s[44:47], s68 offen offset:1024 lds
    v_accvgpr_write_b32 a234, 0
    v_mfma_f32_32x32x16_bf16 v[112:127], v[204:207], v[172:175], 0
    buffer_load_dwordx4 v231, s[44:47], s68 offen offset:2048 lds
    v_accvgpr_write_b32 a235, 0
    s_waitcnt lgkmcnt(0)
    v_mfma_f32_32x32x16_bf16 v[0:15], v[208:211], v[180:183], v[0:15]
    ds_read_b64_tr_b16 v[200:201], v220 offset:4096
    ds_read_b64_tr_b16 v[202:203], v220 offset:4352
    v_mfma_f32_32x32x16_bf16 v[16:31], v[212:215], v[180:183], v[16:31]
    ds_read_b64_tr_b16 v[204:205], v220 offset:12288
    ds_read_b64_tr_b16 v[206:207], v220 offset:12544
    v_mfma_f32_32x32x16_bf16 v[32:47], v[208:211], v[184:187], v[32:47]
    ds_read_b128 v[160:163], v218 offset:0
    ds_read_b128 v[164:167], v218 offset:1024
    s_add_u32 m0, s72, 34816
    s_add_u32 s68, s98, s12
    s_add_u32 s68, s68, 20480
    buffer_load_dwordx4 v250, s[92:95], s68 offen offset:0 lds
    v_mfma_f32_32x32x16_bf16 v[48:63], v[212:215], v[184:187], v[48:63]
    ds_read_b128 v[168:171], v218 offset:2048
    ds_read_b128 v[172:175], v218 offset:3072
    buffer_load_dwordx4 v251, s[92:95], s68 offen offset:1024 lds
    v_mfma_f32_32x32x16_bf16 v[64:79], v[208:211], v[188:191], v[64:79]
    s_add_u32 m0, s72, 20480
    s_add_u32 s68, s26, 110592
    buffer_load_dwordx4 v232, s[44:47], s68 offen offset:3072 lds
    v_mfma_f32_32x32x16_bf16 v[80:95], v[212:215], v[188:191], v[80:95]
    s_add_u32 m0, s71, 40960
    s_add_u32 s68, s97, 0
    buffer_load_dwordx4 v249, s[88:91], s68 offen offset:0 nt lds
    v_mfma_f32_32x32x16_bf16 v[96:111], v[208:211], v[192:195], v[96:111]
    s_add_u32 s68, s97, 9216
    buffer_load_dwordx4 v249, s[88:91], s68 offen offset:1024 nt lds
    v_mfma_f32_32x32x16_bf16 v[112:127], v[212:215], v[192:195], v[112:127]
    s_add_u32 s68, s97, 18432
    buffer_load_dwordx4 v249, s[88:91], s68 offen offset:2048 nt lds
    s_waitcnt lgkmcnt(0)
    v_mfma_f32_32x32x16_bf16 v[0:15], v[200:203], v[160:163], v[0:15]
    ds_read_b64_tr_b16 v[208:209], v220 offset:6144
    ds_read_b64_tr_b16 v[210:211], v220 offset:6400
    v_mfma_f32_32x32x16_bf16 v[16:31], v[204:207], v[160:163], v[16:31]
    ds_read_b64_tr_b16 v[212:213], v220 offset:14336
    ds_read_b64_tr_b16 v[214:215], v220 offset:14592
    v_mfma_f32_32x32x16_bf16 v[32:47], v[200:203], v[164:167], v[32:47]
    ds_read_b128 v[180:183], v219 offset:0
    ds_read_b128 v[184:187], v219 offset:1024
    s_add_u32 m0, s72, 36864
    s_add_u32 s68, s98, s12
    s_add_u32 s68, s68, 40960
    buffer_load_dwordx4 v250, s[92:95], s68 offen offset:0 lds
    v_mfma_f32_32x32x16_bf16 v[48:63], v[204:207], v[164:167], v[48:63]
    ds_read_b128 v[188:191], v219 offset:2048
    ds_read_b128 v[192:195], v219 offset:3072
    v_mfma_f32_32x32x16_bf16 v[64:79], v[200:203], v[168:171], v[64:79]
    buffer_load_dwordx4 v251, s[92:95], s68 offen offset:1024 lds
    v_mfma_f32_32x32x16_bf16 v[80:95], v[204:207], v[168:171], v[80:95]
    s_waitcnt vmcnt(12)
    ds_read_b128 a[0:3], v252 offset:0
    v_mfma_f32_32x32x16_bf16 v[96:111], v[200:203], v[172:175], v[96:111]
    ds_read_b128 a[20:23], v253 offset:0
    s_add_u32 m0, s71, 40960
    s_add_u32 s68, s97, 27648
    buffer_load_dwordx4 v249, s[88:91], s68 offen offset:3072 nt lds
    v_mfma_f32_32x32x16_bf16 v[112:127], v[204:207], v[172:175], v[112:127]
    s_waitcnt lgkmcnt(2)
    v_mfma_f32_32x32x16_bf16 v[0:15], v[208:211], v[180:183], v[0:15]
    s_waitcnt vmcnt(6)
    s_barrier
    ds_read_b64_tr_b16 v[200:201], v220 offset:16384
    ds_read_b64_tr_b16 v[202:203], v220 offset:16640
    v_mfma_f32_32x32x16_bf16 v[16:31], v[212:215], v[180:183], v[16:31]
    ds_read_b64_tr_b16 v[204:205], v220 offset:24576
    ds_read_b64_tr_b16 v[206:207], v220 offset:24832
    s_and_b32 s74, s67, 0x7f
    s_cselect_b32 s74, 134217728, s67
    v_mfma_f32_32x32x16_bf16 v[32:47], v[208:211], v[184:187], v[32:47]
    ds_read_b128 v[160:163], v216 offset:20480
    ds_read_b128 v[164:167], v216 offset:21504
    s_add_u32 m0, s72, 38912
    s_add_u32 s68, s98, s12
    s_add_u32 s68, s68, 61440
    buffer_load_dwordx4 v250, s[92:95], s68 offen offset:0 lds
    v_mfma_f32_32x32x16_bf16 v[48:63], v[212:215], v[184:187], v[48:63]
    ds_read_b128 v[168:171], v216 offset:22528
    ds_read_b128 v[172:175], v216 offset:23552
    buffer_load_dwordx4 v251, s[92:95], s68 offen offset:1024 lds
    v_mfma_f32_32x32x16_bf16 v[64:79], v[208:211], v[188:191], v[64:79]
    s_add_u32 m0, s72, 0
    s_add_u32 s3, s3, 128
    s_cmp_eq_u32 s3, 1280
    s_cselect_b32 s3, 0, s3
    s_mul_i32 s26, s3, 1728
    s_add_u32 s68, s26, 0
    buffer_load_dwordx4 v229, s[44:47], s68 offen offset:0 lds
    v_mfma_f32_32x32x16_bf16 v[80:95], v[212:215], v[188:191], v[80:95]
    ds_read_b128 a[4:7], v252 offset:2048
    buffer_load_dwordx4 v230, s[44:47], s68 offen offset:1024 lds
    v_mfma_f32_32x32x16_bf16 v[96:111], v[208:211], v[192:195], v[96:111]
    ds_read_b128 a[24:27], v253 offset:2048
    buffer_load_dwordx4 v231, s[44:47], s68 offen offset:2048 lds
    v_mfma_f32_32x32x16_bf16 v[112:127], v[212:215], v[192:195], v[112:127]
    buffer_load_dwordx4 v232, s[44:47], s68 offen offset:3072 lds
    s_mov_b64 exec, 0xff
    buffer_store_dwordx4 a[232:235], v238, s[56:59], s74 offen sc1
    s_mov_b64 exec, -1
    s_waitcnt lgkmcnt(2)
    v_mfma_f32_32x32x16_bf16 v[0:15], v[200:203], v[160:163], v[0:15]
    ds_read_b64_tr_b16 v[208:209], v220 offset:18432
    ds_read_b64_tr_b16 v[210:211], v220 offset:18688
    v_mfma_f32_32x32x16_bf16 v[16:31], v[204:207], v[160:163], v[16:31]
    ds_read_b64_tr_b16 v[212:213], v220 offset:26624
    ds_read_b64_tr_b16 v[214:215], v220 offset:26880
    v_mfma_f32_32x32x16_bf16 v[32:47], v[200:203], v[164:167], v[32:47]
    ds_read_b128 v[180:183], v217 offset:20480
    ds_read_b128 v[184:187], v217 offset:21504
    s_add_u32 m0, s72, 32768
    s_add_u32 s68, s98, s12
    s_add_u32 s68, s68, 81920
    buffer_load_dwordx4 v250, s[92:95], s68 offen offset:0 lds
    v_mfma_f32_32x32x16_bf16 v[48:63], v[204:207], v[164:167], v[48:63]
    ds_read_b128 v[188:191], v217 offset:22528
    ds_read_b128 v[192:195], v217 offset:23552
    buffer_load_dwordx4 v251, s[92:95], s68 offen offset:1024 lds
    v_mfma_f32_32x32x16_bf16 v[64:79], v[200:203], v[168:171], v[64:79]
    s_add_u32 m0, s72, 4096
    s_add_u32 s68, s26, 110592
    buffer_load_dwordx4 v229, s[44:47], s68 offen offset:0 lds
    v_mfma_f32_32x32x16_bf16 v[80:95], v[204:207], v[168:171], v[80:95]
    s_waitcnt vmcnt(11)
    ds_read_b128 a[8:11], v252 offset:4096
    ds_read_b128 a[28:31], v253 offset:4096
    s_waitcnt vmcnt(10)
    ds_read_b64_tr_b16 a[200:201], v247 offset:40960
    ds_read_b64_tr_b16 a[202:203], v247 offset:41472
    buffer_load_dwordx4 v230, s[44:47], s68 offen offset:1024 lds
    v_mfma_f32_32x32x16_bf16 v[96:111], v[200:203], v[172:175], v[96:111]
    ds_read_b64_tr_b16 a[204:205], v247 offset:41984
    ds_read_b64_tr_b16 a[206:207], v247 offset:42496
    ds_read_b64_tr_b16 a[208:209], v247 offset:43008
    ds_read_b64_tr_b16 a[210:211], v247 offset:43520
    ds_read_b64_tr_b16 a[212:213], v247 offset:44032
    ds_read_b64_tr_b16 a[214:215], v247 offset:44544
    buffer_load_dwordx4 v231, s[44:47], s68 offen offset:2048 lds
    v_mfma_f32_32x32x16_bf16 v[112:127], v[204:207], v[172:175], v[112:127]
    buffer_load_dwordx4 v232, s[44:47], s68 offen offset:3072 lds
    s_waitcnt lgkmcnt(0)
    v_mfma_f32_32x32x16_bf16 v[0:15], v[208:211], v[180:183], v[0:15]
    ds_read_b64_tr_b16 v[200:201], v220 offset:20480
    ds_read_b64_tr_b16 v[202:203], v220 offset:20736
    buffer_load_dword v243, off, s[60:63], 0 sc1
    v_mfma_f32_32x32x16_bf16 v[16:31], v[212:215], v[180:183], v[16:31]
    ds_read_b64_tr_b16 v[204:205], v220 offset:28672
    ds_read_b64_tr_b16 v[206:207], v220 offset:28928
    s_add_u32 m0, s71, 40960
    s_add_u32 s68, s3, 0
    buffer_load_dwordx4 v224, s[40:43], s68 offen offset:0 lds
    v_mfma_f32_32x32x16_bf16 v[32:47], v[208:211], v[184:187], v[32:47]
    ds_read_b128 v[160:163], v218 offset:20480
    ds_read_b128 v[164:167], v218 offset:21504
    v_mfma_f32_32x32x16_bf16 v[48:63], v[212:215], v[184:187], v[48:63]
    ds_read_b128 v[168:171], v218 offset:22528
    ds_read_b128 v[172:175], v218 offset:23552
    buffer_load_dwordx4 v225, s[40:43], s68 offen offset:1024 lds
    v_mfma_f32_32x32x16_bf16 v[64:79], v[208:211], v[188:191], v[64:79]
    buffer_store_dwordx4 a[200:203], v248, s[56:59], s96 offen offset:0 sc1
    v_mfma_f32_32x32x16_bf16 v[80:95], v[212:215], v[188:191], v[80:95]
    s_waitcnt vmcnt(15)
    ds_read_b128 a[12:15], v252 offset:6144
    ds_read_b128 a[32:35], v253 offset:6144
    buffer_load_dwordx4 v226, s[40:43], s68 offen offset:2048 lds
    v_mfma_f32_32x32x16_bf16 v[96:111], v[208:211], v[192:195], v[96:111]
    s_waitcnt vmcnt(9)
    ds_read_b128 a[16:19], v252 offset:0
    ds_read_b128 a[36:39], v253 offset:0
    v_mfma_f32_32x32x16_bf16 v[112:127], v[212:215], v[192:195], v[112:127]
    buffer_store_dwordx4 a[204:207], v248, s[56:59], s96 offen offset:256 sc1
    s_waitcnt lgkmcnt(4)
    v_mfma_f32_32x32x16_bf16 v[0:15], v[200:203], v[160:163], v[0:15]
    ds_read_b64_tr_b16 v[208:209], v220 offset:22528
    ds_read_b64_tr_b16 v[210:211], v220 offset:22784
    v_mfma_f32_32x32x16_bf16 v[16:31], v[204:207], v[160:163], v[16:31]
    ds_read_b64_tr_b16 v[212:213], v220 offset:30720
    ds_read_b64_tr_b16 v[214:215], v220 offset:30976
    buffer_load_dwordx4 v227, s[40:43], s68 offen offset:3072 lds
    v_mfma_f32_32x32x16_bf16 v[32:47], v[200:203], v[164:167], v[32:47]
    ds_read_b128 v[180:183], v219 offset:20480
    ds_read_b128 v[184:187], v219 offset:21504
    s_add_u32 m0, s71, 0
    s_add_u32 s3, s3, 128
    s_cmp_eq_u32 s3, 1280
    s_cselect_b32 s3, 0, s3
    s_mul_i32 s26, s3, 1728
    s_add_u32 s68, s3, 0
    buffer_load_dwordx4 v224, s[40:43], s68 offen offset:0 lds
    v_mfma_f32_32x32x16_bf16 v[48:63], v[204:207], v[164:167], v[48:63]
    ds_read_b128 v[188:191], v219 offset:22528
    ds_read_b128 v[192:195], v219 offset:23552
    v_mfma_f32_32x32x16_bf16 v[64:79], v[200:203], v[168:171], v[64:79]
    buffer_load_dwordx4 v225, s[40:43], s68 offen offset:1024 lds
    v_mfma_f32_32x32x16_bf16 v[80:95], v[204:207], v[168:171], v[80:95]
    v_mfma_f32_32x32x16_bf16 v[96:111], v[200:203], v[172:175], v[96:111]
    buffer_load_dwordx4 v226, s[40:43], s68 offen offset:2048 lds
    v_mfma_f32_32x32x16_bf16 v[112:127], v[204:207], v[172:175], v[112:127]
    buffer_store_dwordx4 a[208:211], v248, s[56:59], s96 offen offset:512 sc1
    buffer_store_dwordx4 a[212:215], v248, s[56:59], s96 offen offset:768 sc1
    s_waitcnt lgkmcnt(0)
    v_mfma_f32_32x32x16_bf16 v[0:15], v[208:211], v[180:183], v[0:15]
    s_waitcnt vmcnt(5)
    s_barrier
    ds_read_b64_tr_b16 v[200:201], v220 offset:0
    ds_read_b64_tr_b16 v[202:203], v220 offset:256
    v_mfma_f32_32x32x16_bf16 v[16:31], v[212:215], v[180:183], v[16:31]
    ds_read_b64_tr_b16 v[204:205], v220 offset:8192
    ds_read_b64_tr_b16 v[206:207], v220 offset:8448
    buffer_load_dwordx4 v227, s[40:43], s68 offen offset:3072 lds
    v_mfma_f32_32x32x16_bf16 v[32:47], v[208:211], v[184:187], v[32:47]
    ds_read_b128 v[160:163], v216 offset:40960
    ds_read_b128 v[164:167], v216 offset:41984
    v_mfma_f32_32x32x16_bf16 v[48:63], v[212:215], v[184:187], v[48:63]
    ds_read_b128 v[168:171], v216 offset:43008
    ds_read_b128 v[172:175], v216 offset:44032
    s_add_u32 m0, s72, 32768
    s_add_u32 s68, s26, 0
    buffer_load_dwordx4 v229, s[44:47], s68 offen offset:0 lds
    v_mfma_f32_32x32x16_bf16 v[64:79], v[208:211], v[188:191], v[64:79]
    v_mfma_f32_32x32x16_bf16 v[80:95], v[212:215], v[188:191], v[80:95]
    buffer_load_dwordx4 v230, s[44:47], s68 offen offset:1024 lds
    v_mfma_f32_32x32x16_bf16 v[96:111], v[208:211], v[192:195], v[96:111]
    v_mfma_f32_32x32x16_bf16 v[112:127], v[212:215], v[192:195], v[112:127]
    s_waitcnt lgkmcnt(0)
    v_mfma_f32_32x32x16_bf16 v[0:15], v[200:203], v[160:163], v[0:15]
    ds_read_b64_tr_b16 v[208:209], v220 offset:2048
    ds_read_b64_tr_b16 v[210:211], v220 offset:2304
    v_mfma_f32_32x32x16_bf16 v[16:31], v[204:207], v[160:163], v[16:31]
    ds_read_b64_tr_b16 v[212:213], v220 offset:10240
    ds_read_b64_tr_b16 v[214:215], v220 offset:10496
    buffer_load_dwordx4 v231, s[44:47], s68 offen offset:2048 lds
    v_mfma_f32_32x32x16_bf16 v[32:47], v[200:203], v[164:167], v[32:47]
    ds_read_b128 v[180:183], v217 offset:40960
    ds_read_b128 v[184:187], v217 offset:41984
    v_mfma_f32_32x32x16_bf16 v[48:63], v[204:207], v[164:167], v[48:63]
    ds_read_b128 v[188:191], v217 offset:43008
    ds_read_b128 v[192:195], v217 offset:44032
    buffer_load_dwordx4 v232, s[44:47], s68 offen offset:3072 lds
    v_mfma_f32_32x32x16_bf16 v[64:79], v[200:203], v[168:171], v[64:79]
    v_mfma_f32_32x32x16_bf16 v[80:95], v[204:207], v[168:171], v[80:95]
    s_add_u32 m0, s72, 36864
    s_add_u32 s68, s26, 110592
    buffer_load_dwordx4 v229, s[44:47], s68 offen offset:0 lds
    v_mfma_f32_32x32x16_bf16 v[96:111], v[200:203], v[172:175], v[96:111]
    v_mfma_f32_32x32x16_bf16 v[112:127], v[204:207], v[172:175], v[112:127]
    v_cmp_eq_u32 vcc, 0, v243
    s_cbranch_vccnz L_slow_non_g12
L_go_non_g12:
    v_readfirstlane_b32 s83, v243
    s_waitcnt lgkmcnt(0)
    v_mfma_f32_32x32x16_bf16 v[0:15], v[208:211], v[180:183], v[0:15]
    ds_read_b64_tr_b16 v[200:201], v220 offset:4096
    ds_read_b64_tr_b16 v[202:203], v220 offset:4352
    s_waitcnt vmcnt(6)
    v_mfma_f32_32x32x16_bf16 v[16:31], v[212:215], v[180:183], v[16:31]
    ds_read_b64_tr_b16 v[204:205], v220 offset:12288
    ds_read_b64_tr_b16 v[206:207], v220 offset:12544
    buffer_load_dwordx4 v230, s[44:47], s68 offen offset:1024 lds
    v_mfma_f32_32x32x16_bf16 v[32:47], v[208:211], v[184:187], v[32:47]
    ds_read_b128 v[160:163], v218 offset:40960
    ds_read_b128 v[164:167], v218 offset:41984
    buffer_load_dwordx4 v231, s[44:47], s68 offen offset:2048 lds
    v_mfma_f32_32x32x16_bf16 v[48:63], v[212:215], v[184:187], v[48:63]
    ds_read_b128 v[168:171], v218 offset:43008
    ds_read_b128 v[172:175], v218 offset:44032
    v_mfma_f32_32x32x16_bf16 v[64:79], v[208:211], v[188:191], v[64:79]
    buffer_load_dwordx4 v232, s[44:47], s68 offen offset:3072 lds
    s_barrier
    v_mfma_f32_32x32x16_bf16 v[80:95], v[212:215], v[188:191], v[80:95]
    s_lshl_b32 s73, s2, 4
    s_add_u32 s73, s73, 4259840
    s_cmp_eq_u32 s64, 0
    s_cselect_b32 s73, s73, 134217728
    v_mfma_f32_32x32x16_bf16 v[96:111], v[208:211], v[192:195], v[96:111]
    s_add_u32 m0, s71, 20480
    s_add_u32 s3, s3, 128
    s_cmp_eq_u32 s3, 1280
    s_cselect_b32 s3, 0, s3
    s_mul_i32 s26, s3, 1728
    s_add_u32 s68, s3, 0
    buffer_load_dwordx4 v224, s[40:43], s68 offen offset:0 lds
    v_mov_b32 v241, s83
    v_mfma_f32_32x32x16_bf16 v[112:127], v[212:215], v[192:195], v[112:127]
    s_mov_b64 exec, 1
    buffer_store_dword v241, off, s[56:59], s73 sc1
    s_mov_b64 exec, -1
    s_waitcnt lgkmcnt(0)
    v_mfma_f32_32x32x16_bf16 v[0:15], v[200:203], v[160:163], v[0:15]
    ds_read_b64_tr_b16 v[208:209], v220 offset:6144
    ds_read_b64_tr_b16 v[210:211], v220 offset:6400
    v_mfma_f32_32x32x16_bf16 v[16:31], v[204:207], v[160:163], v[16:31]
    ds_read_b64_tr_b16 v[212:213], v220 offset:14336
    ds_read_b64_tr_b16 v[214:215], v220 offset:14592
    buffer_load_dwordx4 v225, s[40:43], s68 offen offset:1024 lds
    v_mfma_f32_32x32x16_bf16 v[32:47], v[200:203], v[164:167], v[32:47]
    ds_read_b128 v[180:183], v219 offset:40960
    ds_read_b128 v[184:187], v219 offset:41984
    v_mfma_f32_32x32x16_bf16 v[48:63], v[204:207], v[164:167], v[48:63]
    ds_read_b128 v[188:191], v219 offset:43008
    ds_read_b128 v[192:195], v219 offset:44032
    buffer_load_dwordx4 v226, s[40:43], s68 offen offset:2048 lds
    v_mfma_f32_32x32x16_bf16 v[64:79], v[200:203], v[168:171], v[64:79]
    v_mfma_f32_32x32x16_bf16 v[80:95], v[204:207], v[168:171], v[80:95]
    buffer_load_dwordx4 v227, s[40:43], s68 offen offset:3072 lds
    v_mfma_f32_32x32x16_bf16 v[96:111], v[200:203], v[172:175], v[96:111]
    v_mfma_f32_32x32x16_bf16 v[112:127], v[204:207], v[172:175], v[112:127]
    s_waitcnt lgkmcnt(0)
    v_mfma_f32_32x32x16_bf16 v[0:15], v[208:211], v[180:183], v[0:15]
    s_waitcnt vmcnt(5)
    s_barrier
    ds_read_b64_tr_b16 v[200:201], v220 offset:32768
    ds_read_b64_tr_b16 v[202:203], v220 offset:33024
    v_mfma_f32_32x32x16_bf16 v[16:31], v[212:215], v[180:183], v[16:31]
    ds_read_b64_tr_b16 v[204:205], v220 offset:40960
    ds_read_b64_tr_b16 v[206:207], v220 offset:41216
    s_add_u32 m0, s72, 16384
    s_add_u32 s68, s26, 0
    buffer_load_dwordx4 v229, s[44:47], s68 offen offset:0 lds
    v_mfma_f32_32x32x16_bf16 v[32:47], v[208:211], v[184:187], v[32:47]
    ds_read_b128 v[160:163], v216 offset:0
    ds_read_b128 v[164:167], v216 offset:1024
    buffer_load_dwordx4 v230, s[44:47], s68 offen offset:1024 lds
    v_mfma_f32_32x32x16_bf16 v[48:63], v[212:215], v[184:187], v[48:63]
    ds_read_b128 v[168:171], v216 offset:2048
    ds_read_b128 v[172:175], v216 offset:3072
    v_mfma_f32_32x32x16_bf16 v[64:79], v[208:211], v[188:191], v[64:79]
    buffer_load_dwordx4 v231, s[44:47], s68 offen offset:2048 lds
    v_mfma_f32_32x32x16_bf16 v[80:95], v[212:215], v[188:191], v[80:95]
    v_mfma_f32_32x32x16_bf16 v[96:111], v[208:211], v[192:195], v[96:111]
    buffer_load_dwordx4 v232, s[44:47], s68 offen offset:3072 lds
    v_mfma_f32_32x32x16_bf16 v[112:127], v[212:215], v[192:195], v[112:127]
    s_waitcnt lgkmcnt(0)
    v_mfma_f32_32x32x16_bf16 v[0:15], v[200:203], v[160:163], v[0:15]
    ds_read_b64_tr_b16 v[208:209], v220 offset:34816
    ds_read_b64_tr_b16 v[210:211], v220 offset:35072
    v_mfma_f32_32x32x16_bf16 v[16:31], v[204:207], v[160:163], v[16:31]
    ds_read_b64_tr_b16 v[212:213], v220 offset:43008
    ds_read_b64_tr_b16 v[214:215], v220 offset:43264
    s_add_u32 m0, s72, 20480
    s_add_u32 s68, s26, 110592
    buffer_load_dwordx4 v229, s[44:47], s68 offen offset:0 lds
    v_mfma_f32_32x32x16_bf16 v[32:47], v[200:203], v[164:167], v[32:47]
    ds_read_b128 v[180:183], v217 offset:0
    ds_read_b128 v[184:187], v217 offset:1024
    v_mfma_f32_32x32x16_bf16 v[48:63], v[204:207], v[164:167], v[48:63]
    ds_read_b128 v[188:191], v217 offset:2048
    ds_read_b128 v[192:195], v217 offset:3072
    buffer_load_dwordx4 v230, s[44:47], s68 offen offset:1024 lds
    v_mfma_f32_32x32x16_bf16 v[64:79], v[200:203], v[168:171], v[64:79]
    v_mfma_f32_32x32x16_bf16 v[80:95], v[204:207], v[168:171], v[80:95]
    buffer_load_dwordx4 v231, s[44:47], s68 offen offset:2048 lds
    v_mfma_f32_32x32x16_bf16 v[96:111], v[200:203], v[172:175], v[96:111]
    v_mfma_f32_32x32x16_bf16 v[112:127], v[204:207], v[172:175], v[112:127]
    s_waitcnt lgkmcnt(0)
    v_mfma_f32_32x32x16_bf16 v[0:15], v[208:211], v[180:183], v[0:15]
    ds_read_b64_tr_b16 v[200:201], v220 offset:36864
    ds_read_b64_tr_b16 v[202:203], v220 offset:37120
    s_lshr_b32 s73, s2, 3
    v_mfma_f32_32x32x16_bf16 v[16:31], v[212:215], v[180:183], v[16:31]
    ds_read_b64_tr_b16 v[204:205], v220 offset:45056
    ds_read_b64_tr_b16 v[206:207], v220 offset:45312
    buffer_load_dwordx4 v232, s[44:47], s68 offen offset:3072 lds
    v_mfma_f32_32x32x16_bf16 v[32:47], v[208:211], v[184:187], v[32:47]
    ds_read_b128 v[160:163], v218 offset:0
    ds_read_b128 v[164:167], v218 offset:1024
    v_mfma_f32_32x32x16_bf16 v[48:63], v[212:215], v[184:187], v[48:63]
    ds_read_b128 v[168:171], v218 offset:2048
    ds_read_b128 v[172:175], v218 offset:3072
    s_add_u32 m0, s71, 40960
    s_add_u32 s3, s3, 128
    s_cmp_eq_u32 s3, 1280
    s_cselect_b32 s3, 0, s3
    s_mul_i32 s26, s3, 1728
    s_add_u32 s68, s3, 0
    buffer_load_dwordx4 v224, s[40:43], s68 offen offset:0 lds
    v_mfma_f32_32x32x16_bf16 v[64:79], v[208:211], v[188:191], v[64:79]
    s_mul_i32 s73, s73, 3072
    v_mfma_f32_32x32x16_bf16 v[80:95], v[212:215], v[188:191], v[80:95]
    buffer_load_dwordx4 v225, s[40:43], s68 offen offset:1024 lds
    s_cmp_eq_u32 s64, 0
    s_cselect_b32 s73, s73, 134217728
    v_mfma_f32_32x32x16_bf16 v[96:111], v[208:211], v[192:195], v[96:111]
    v_lshl_add_u32 v243, v233, 7, s73
    v_mfma_f32_32x32x16_bf16 v[112:127], v[212:215], v[192:195], v[112:127]
    s_mov_b32 exec_lo, 16777215
    s_mov_b32 exec_hi, 0
    buffer_load_dword a255, v243, s[84:87], 0 offen
    s_mov_b64 exec, -1
    s_waitcnt lgkmcnt(0)
    v_mfma_f32_32x32x16_bf16 v[0:15], v[200:203], v[160:163], v[0:15]
    ds_read_b64_tr_b16 v[208:209], v220 offset:38912
    ds_read_b64_tr_b16 v[210:211], v220 offset:39168
    v_mfma_f32_32x32x16_bf16 v[16:31], v[204:207], v[160:163], v[16:31]
    ds_read_b64_tr_b16 v[212:213], v220 offset:47104
    ds_read_b64_tr_b16 v[214:215], v220 offset:47360
    buffer_load_dwordx4 v226, s[40:43], s68 offen offset:2048 lds
    v_mfma_f32_32x32x16_bf16 v[32:47], v[200:203], v[164:167], v[32:47]
    ds_read_b128 v[180:183], v219 offset:0
    ds_read_b128 v[184:187], v219 offset:1024
    buffer_load_dwordx4 v227, s[40:43], s68 offen offset:3072 lds
    v_mfma_f32_32x32x16_bf16 v[48:63], v[204:207], v[164:167], v[48:63]
    ds_read_b128 v[188:191], v219 offset:2048
    ds_read_b128 v[192:195], v219 offset:3072
    v_mfma_f32_32x32x16_bf16 v[64:79], v[200:203], v[168:171], v[64:79]
    s_add_u32 m0, s72, 0
    s_add_u32 s68, s26, 0
    buffer_load_dwordx4 v229, s[44:47], s68 offen offset:0 lds
    v_mfma_f32_32x32x16_bf16 v[80:95], v[204:207], v[168:171], v[80:95]
    v_mfma_f32_32x32x16_bf16 v[96:111], v[200:203], v[172:175], v[96:111]
    buffer_load_dwordx4 v230, s[44:47], s68 offen offset:1024 lds
    v_mfma_f32_32x32x16_bf16 v[112:127], v[204:207], v[172:175], v[112:127]
    s_waitcnt lgkmcnt(0)
    v_mfma_f32_32x32x16_bf16 v[0:15], v[208:211], v[180:183], v[0:15]
    s_waitcnt vmcnt(7)
    s_barrier
    ds_read_b64_tr_b16 v[200:201], v220 offset:16384
    ds_read_b64_tr_b16 v[202:203], v220 offset:16640
    v_mfma_f32_32x32x16_bf16 v[16:31], v[212:215], v[180:183], v[16:31]
    ds_read_b64_tr_b16 v[204:205], v220 offset:24576
    ds_read_b64_tr_b16 v[206:207], v220 offset:24832
    buffer_load_dwordx4 v231, s[44:47], s68 offen offset:2048 lds
    v_mfma_f32_32x32x16_bf16 v[32:47], v[208:211], v[184:187], v[32:47]
    ds_read_b128 v[160:163], v216 offset:20480
    ds_read_b128 v[164:167], v216 offset:21504
    v_mfma_f32_32x32x16_bf16 v[48:63], v[212:215], v[184:187], v[48:63]
    ds_read_b128 v[168:171], v216 offset:22528
    ds_read_b128 v[172:175], v216 offset:23552
    buffer_load_dwordx4 v232, s[44:47], s68 offen offset:3072 lds
    v_mfma_f32_32x32x16_bf16 v[64:79], v[208:211], v[188:191], v[64:79]
    v_mfma_f32_32x32x16_bf16 v[80:95], v[212:215], v[188:191], v[80:95]
    s_add_u32 m0, s72, 4096
    s_add_u32 s68, s26, 110592
    buffer_load_dwordx4 v229, s[44:47], s68 offen offset:0 lds
    v_mfma_f32_32x32x16_bf16 v[96:111], v[208:211], v[192:195], v[96:111]
    v_mfma_f32_32x32x16_bf16 v[112:127], v[212:215], v[192:195], v[112:127]
    s_waitcnt lgkmcnt(0)
    v_mfma_f32_32x32x16_bf16 v[0:15], v[200:203], v[160:163], v[0:15]
    ds_read_b64_tr_b16 v[208:209], v220 offset:18432
    ds_read_b64_tr_b16 v[210:211], v220 offset:18688
    v_permlane32_swap_b32 v234, v235
    v_mfma_f32_32x32x16_bf16 v[16:31], v[204:207], v[160:163], v[16:31]
    ds_read_b64_tr_b16 v[212:213], v220 offset:26624
    ds_read_b64_tr_b16 v[214:215], v220 offset:26880
    buffer_load_dwordx4 v230, s[44:47], s68 offen offset:1024 lds
    v_mfma_f32_32x32x16_bf16 v[32:47], v[200:203], v[164:167], v[32:47]
    ds_read_b128 v[180:183], v217 offset:20480
    ds_read_b128 v[184:187], v217 offset:21504
    buffer_load_dwordx4 v231, s[44:47], s68 offen offset:2048 lds
    v_mfma_f32_32x32x16_bf16 v[48:63], v[204:207], v[164:167], v[48:63]
    ds_read_b128 v[188:191], v217 offset:22528
    ds_read_b128 v[192:195], v217 offset:23552
    v_mfma_f32_32x32x16_bf16 v[64:79], v[200:203], v[168:171], v[64:79]
    buffer_load_dwordx4 v232, s[44:47], s68 offen offset:3072 lds
    v_mfma_f32_32x32x16_bf16 v[80:95], v[204:207], v[168:171], v[80:95]
    v_lshrrev_b32 v236, 1, v238
    s_mul_i32 s101, s78, 2560
    s_add_u32 s101, s101, 4390912
    v_mfma_f32_32x32x16_bf16 v[96:111], v[200:203], v[172:175], v[96:111]
    s_add_u32 m0, s71, 0
    s_add_u32 s3, s3, 128
    s_cmp_eq_u32 s3, 1280
    s_cselect_b32 s3, 0, s3
    s_mul_i32 s26, s3, 1728
    s_add_u32 s68, s3, 0
    buffer_load_dwordx4 v224, s[40:43], s68 offen offset:0 lds
    v_add_f32 v234, v234, v235
    v_mfma_f32_32x32x16_bf16 v[112:127], v[204:207], v[172:175], v[112:127]
    v_mov_b32 v235, s83
    s_add_u32 s73, s101, s31
    buffer_store_dwordx2 v[234:235], v236, s[56:59], s73 offen sc1
    s_waitcnt lgkmcnt(0)
    v_mfma_f32_32x32x16_bf16 v[0:15], v[208:211], v[180:183], v[0:15]
    ds_read_b64_tr_b16 v[200:201], v220 offset:20480
    ds_read_b64_tr_b16 v[202:203], v220 offset:20736
    v_mfma_f32_32x32x16_bf16 v[16:31], v[212:215], v[180:183], v[16:31]
    ds_read_b64_tr_b16 v[204:205], v220 offset:28672
    ds_read_b64_tr_b16 v[206:207], v220 offset:28928
    buffer_load_dwordx4 v225, s[40:43], s68 offen offset:1024 lds
    v_mfma_f32_32x32x16_bf16 v[32:47], v[208:211], v[184:187], v[32:47]
    ds_read_b128 v[160:163], v218 offset:20480
    ds_read_b128 v[164:167], v218 offset:21504
    v_mfma_f32_32x32x16_bf16 v[48:63], v[212:215], v[184:187], v[48:63]
    ds_read_b128 v[168:171], v218 offset:22528
    ds_read_b128 v[172:175], v218 offset:23552
    buffer_load_dwordx4 v226, s[40:43], s68 offen offset:2048 lds
    v_mfma_f32_32x32x16_bf16 v[64:79], v[208:211], v[188:191], v[64:79]
    v_mfma_f32_32x32x16_bf16 v[80:95], v[212:215], v[188:191], v[80:95]
    buffer_load_dwordx4 v227, s[40:43], s68 offen offset:3072 lds
    v_mfma_f32_32x32x16_bf16 v[96:111], v[208:211], v[192:195], v[96:111]
    v_mfma_f32_32x32x16_bf16 v[112:127], v[212:215], v[192:195], v[112:127]
    s_waitcnt lgkmcnt(0)
    v_mfma_f32_32x32x16_bf16 v[0:15], v[200:203], v[160:163], v[0:15]
    ds_read_b64_tr_b16 v[208:209], v220 offset:22528
    ds_read_b64_tr_b16 v[210:211], v220 offset:22784
    v_mfma_f32_32x32x16_bf16 v[16:31], v[204:207], v[160:163], v[16:31]
    ds_read_b64_tr_b16 v[212:213], v220 offset:30720
    ds_read_b64_tr_b16 v[214:215], v220 offset:30976
    s_add_u32 m0, s72, 32768
    s_add_u32 s68, s26, 0
    buffer_load_dwordx4 v229, s[44:47], s68 offen offset:0 lds
    v_mfma_f32_32x32x16_bf16 v[32:47], v[200:203], v[164:167], v[32:47]
    ds_read_b128 v[180:183], v219 offset:20480
    ds_read_b128 v[184:187], v219 offset:21504
    v_mfma_f32_32x32x16_bf16 v[48:63], v[204:207], v[164:167], v[48:63]
    ds_read_b128 v[188:191], v219 offset:22528
    ds_read_b128 v[192:195], v219 offset:23552
    buffer_load_dwordx4 v230, s[44:47], s68 offen offset:1024 lds
    v_mfma_f32_32x32x16_bf16 v[64:79], v[200:203], v[168:171], v[64:79]
    v_mfma_f32_32x32x16_bf16 v[80:95], v[204:207], v[168:171], v[80:95]
    buffer_load_dwordx4 v231, s[44:47], s68 offen offset:2048 lds
    v_mfma_f32_32x32x16_bf16 v[96:111], v[200:203], v[172:175], v[96:111]
    v_mfma_f32_32x32x16_bf16 v[112:127], v[204:207], v[172:175], v[112:127]
    s_waitcnt lgkmcnt(0)
    v_mfma_f32_32x32x16_bf16 v[0:15], v[208:211], v[180:183], v[0:15]
    s_waitcnt vmcnt(8)
    s_barrier
    ds_read_b64_tr_b16 v[200:201], v220 offset:0
    ds_read_b64_tr_b16 v[202:203], v220 offset:256
    v_mfma_f32_32x32x16_bf16 v[16:31], v[212:215], v[180:183], v[16:31]
    ds_read_b64_tr_b16 v[204:205], v220 offset:8192
    ds_read_b64_tr_b16 v[206:207], v220 offset:8448
    buffer_load_dwordx4 v232, s[44:47], s68 offen offset:3072 lds
    v_mfma_f32_32x32x16_bf16 v[32:47], v[208:211], v[184:187], v[32:47]
    ds_read_b128 v[160:163], v216 offset:40960
    ds_read_b128 v[164:167], v216 offset:41984
    s_add_u32 m0, s72, 36864
    s_add_u32 s68, s26, 110592
    buffer_load_dwordx4 v229, s[44:47], s68 offen offset:0 lds
    v_mfma_f32_32x32x16_bf16 v[48:63], v[212:215], v[184:187], v[48:63]
    ds_read_b128 v[168:171], v216 offset:43008
    ds_read_b128 v[172:175], v216 offset:44032
    v_mfma_f32_32x32x16_bf16 v[64:79], v[208:211], v[188:191], v[64:79]
    buffer_load_dwordx4 v230, s[44:47], s68 offen offset:1024 lds
    v_mfma_f32_32x32x16_bf16 v[80:95], v[212:215], v[188:191], v[80:95]
    v_mfma_f32_32x32x16_bf16 v[96:111], v[208:211], v[192:195], v[96:111]
    buffer_load_dwordx4 v231, s[44:47], s68 offen offset:2048 lds
    v_mfma_f32_32x32x16_bf16 v[112:127], v[212:215], v[192:195], v[112:127]
    s_waitcnt lgkmcnt(0)
    v_mfma_f32_32x32x16_bf16 v[0:15], v[200:203], v[160:163], v[0:15]
    ds_read_b64_tr_b16 v[208:209], v220 offset:2048
    ds_read_b64_tr_b16 v[210:211], v220 offset:2304
    v_mfma_f32_32x32x16_bf16 v[16:31], v[204:207], v[160:163], v[16:31]
    ds_read_b64_tr_b16 v[212:213], v220 offset:10240
    ds_read_b64_tr_b16 v[214:215], v220 offset:10496
    buffer_load_dwordx4 v232, s[44:47], s68 offen offset:3072 lds
    v_mfma_f32_32x32x16_bf16 v[32:47], v[200:203], v[164:167], v[32:47]
    ds_read_b128 v[180:183], v217 offset:40960
    ds_read_b128 v[184:187], v217 offset:41984
    v_mfma_f32_32x32x16_bf16 v[48:63], v[204:207], v[164:167], v[48:63]
    ds_read_b128 v[188:191], v217 offset:43008
    ds_read_b128 v[192:195], v217 offset:44032
    s_add_u32 m0, s71, 20480
    s_add_u32 s3, s3, 128
    s_cmp_eq_u32 s3, 1280
    s_cselect_b32 s3, 0, s3
    s_mul_i32 s26, s3, 1728
    s_add_u32 s68, s3, 0
    buffer_load_dwordx4 v224, s[40:43], s68 offen offset:0 lds
    v_mfma_f32_32x32x16_bf16 v[64:79], v[200:203], v[168:171], v[64:79]
    v_mfma_f32_32x32x16_bf16 v[80:95], v[204:207], v[168:171], v[80:95]
    buffer_load_dwordx4 v225, s[40:43], s68 offen offset:1024 lds
    v_mfma_f32_32x32x16_bf16 v[96:111], v[200:203], v[172:175], v[96:111]
    v_mfma_f32_32x32x16_bf16 v[112:127], v[204:207], v[172:175], v[112:127]
    s_waitcnt lgkmcnt(0)
    v_mfma_f32_32x32x16_bf16 v[0:15], v[208:211], v[180:183], v[0:15]
    ds_read_b64_tr_b16 v[200:201], v220 offset:4096
    ds_read_b64_tr_b16 v[202:203], v220 offset:4352
    s_lshl_b32 s73, s64, 10
    v_mfma_f32_32x32x16_bf16 v[16:31], v[212:215], v[180:183], v[16:31]
    ds_read_b64_tr_b16 v[204:205], v220 offset:12288
    ds_read_b64_tr_b16 v[206:207], v220 offset:12544
    buffer_load_dwordx4 v226, s[40:43], s68 offen offset:2048 lds
    v_mfma_f32_32x32x16_bf16 v[32:47], v[208:211], v[184:187], v[32:47]
    ds_read_b128 v[160:163], v218 offset:40960
    ds_read_b128 v[164:167], v218 offset:41984
    buffer_load_dwordx4 v227, s[40:43], s68 offen offset:3072 lds
    v_mfma_f32_32x32x16_bf16 v[48:63], v[212:215], v[184:187], v[48:63]
    ds_read_b128 v[168:171], v218 offset:43008
    ds_read_b128 v[172:175], v218 offset:44032
    v_mfma_f32_32x32x16_bf16 v[64:79], v[208:211], v[188:191], v[64:79]
    s_add_u32 m0, s72, 16384
    s_add_u32 s68, s26, 0
    buffer_load_dwordx4 v229, s[44:47], s68 offen offset:0 lds
    v_mfma_f32_32x32x16_bf16 v[80:95], v[212:215], v[188:191], v[80:95]
    v_mfma_f32_32x32x16_bf16 v[96:111], v[208:211], v[192:195], v[96:111]
    buffer_load_dwordx4 v230, s[44:47], s68 offen offset:1024 lds
    s_add_u32 s73, s73, 4259840
    v_mfma_f32_32x32x16_bf16 v[112:127], v[212:215], v[192:195], v[112:127]
    v_lshlrev_b32 v243, 4, v233
    buffer_load_dword v243, v243, s[56:59], s73 offen sc1
    s_waitcnt lgkmcnt(0)
    v_mfma_f32_32x32x16_bf16 v[0:15], v[200:203], v[160:163], v[0:15]
    ds_read_b64_tr_b16 v[208:209], v220 offset:6144
    ds_read_b64_tr_b16 v[210:211], v220 offset:6400
    v_mfma_f32_32x32x16_bf16 v[16:31], v[204:207], v[160:163], v[16:31]
    ds_read_b64_tr_b16 v[212:213], v220 offset:14336
    ds_read_b64_tr_b16 v[214:215], v220 offset:14592
    buffer_load_dwordx4 v231, s[44:47], s68 offen offset:2048 lds
    v_mfma_f32_32x32x16_bf16 v[32:47], v[200:203], v[164:167], v[32:47]
    ds_read_b128 v[180:183], v219 offset:40960
    ds_read_b128 v[184:187], v219 offset:41984
    v_mfma_f32_32x32x16_bf16 v[48:63], v[204:207], v[164:167], v[48:63]
    ds_read_b128 v[188:191], v219 offset:43008
    ds_read_b128 v[192:195], v219 offset:44032
    buffer_load_dwordx4 v232, s[44:47], s68 offen offset:3072 lds
    v_mfma_f32_32x32x16_bf16 v[64:79], v[200:203], v[168:171], v[64:79]
    v_mfma_f32_32x32x16_bf16 v[80:95], v[204:207], v[168:171], v[80:95]
    s_add_u32 m0, s72, 20480
    s_add_u32 s68, s26, 110592
    buffer_load_dwordx4 v229, s[44:47], s68 offen offset:0 lds
    v_mfma_f32_32x32x16_bf16 v[96:111], v[200:203], v[172:175], v[96:111]
    v_mfma_f32_32x32x16_bf16 v[112:127], v[204:207], v[172:175], v[112:127]
    s_waitcnt lgkmcnt(0)
    v_mfma_f32_32x32x16_bf16 v[0:15], v[208:211], v[180:183], v[0:15]
    s_waitcnt vmcnt(10)
    s_barrier
    ds_read_b64_tr_b16 v[200:201], v220 offset:32768
    ds_read_b64_tr_b16 v[202:203], v220 offset:33024
    v_mfma_f32_32x32x16_bf16 v[16:31], v[212:215], v[180:183], v[16:31]
    ds_read_b64_tr_b16 v[204:205], v220 offset:40960
    ds_read_b64_tr_b16 v[206:207], v220 offset:41216
    buffer_load_dwordx4 v230, s[44:47], s68 offen offset:1024 lds
    v_mfma_f32_32x32x16_bf16 v[32:47], v[208:211], v[184:187], v[32:47]
    ds_read_b128 v[160:163], v216 offset:0
    ds_read_b128 v[164:167], v216 offset:1024
    v_mfma_f32_32x32x16_bf16 v[48:63], v[212:215], v[184:187], v[48:63]
    ds_read_b128 v[168:171], v216 offset:2048
    ds_read_b128 v[172:175], v216 offset:3072
    buffer_load_dwordx4 v231, s[44:47], s68 offen offset:2048 lds
    v_mfma_f32_32x32x16_bf16 v[64:79], v[208:211], v[188:191], v[64:79]
    v_mfma_f32_32x32x16_bf16 v[80:95], v[212:215], v[188:191], v[80:95]
    buffer_load_dwordx4 v232, s[44:47], s68 offen offset:3072 lds
    v_mfma_f32_32x32x16_bf16 v[96:111], v[208:211], v[192:195], v[96:111]
    v_mfma_f32_32x32x16_bf16 v[112:127], v[212:215], v[192:195], v[112:127]
    s_waitcnt vmcnt(6)
    v_cmp_ne_u32 vcc, s83, v243
    s_cbranch_vccnz L_slow_f1_g12
L_go_f1_g12:
    s_barrier
    s_waitcnt lgkmcnt(0)
    v_mfma_f32_32x32x16_bf16 v[0:15], v[200:203], v[160:163], v[0:15]
    ds_read_b64_tr_b16 v[208:209], v220 offset:34816
    ds_read_b64_tr_b16 v[210:211], v220 offset:35072
    v_mfma_f32_32x32x16_bf16 v[16:31], v[204:207], v[160:163], v[16:31]
    ds_read_b64_tr_b16 v[212:213], v220 offset:43008
    ds_read_b64_tr_b16 v[214:215], v220 offset:43264
    s_add_u32 m0, s71, 40960
    s_add_u32 s3, s3, 128
    s_cmp_eq_u32 s3, 1280
    s_cselect_b32 s3, 0, s3
    s_mul_i32 s26, s3, 1728
    s_add_u32 s68, s3, 0
    buffer_load_dwordx4 v224, s[40:43], s68 offen offset:0 lds
    v_mfma_f32_32x32x16_bf16 v[32:47], v[200:203], v[164:167], v[32:47]
    ds_read_b128 v[180:183], v217 offset:0
    ds_read_b128 v[184:187], v217 offset:1024
    buffer_load_dwordx4 v225, s[40:43], s68 offen offset:1024 lds
    v_mfma_f32_32x32x16_bf16 v[48:63], v[204:207], v[164:167], v[48:63]
    ds_read_b128 v[188:191], v217 offset:2048
    ds_read_b128 v[192:195], v217 offset:3072
    v_mfma_f32_32x32x16_bf16 v[64:79], v[200:203], v[168:171], v[64:79]
    buffer_load_dwordx4 v226, s[40:43], s68 offen offset:2048 lds
    v_mfma_f32_32x32x16_bf16 v[80:95], v[204:207], v[168:171], v[80:95]
    v_mfma_f32_32x32x16_bf16 v[96:111], v[200:203], v[172:175], v[96:111]
    buffer_load_dwordx4 v227, s[40:43], s68 offen offset:3072 lds
    v_mfma_f32_32x32x16_bf16 v[112:127], v[204:207], v[172:175], v[112:127]
    s_waitcnt lgkmcnt(0)
    v_mfma_f32_32x32x16_bf16 v[0:15], v[208:211], v[180:183], v[0:15]
    ds_read_b64_tr_b16 v[200:201], v220 offset:36864
    ds_read_b64_tr_b16 v[202:203], v220 offset:37120
    v_mfma_f32_32x32x16_bf16 v[16:31], v[212:215], v[180:183], v[16:31]
    ds_read_b64_tr_b16 v[204:205], v220 offset:45056
    ds_read_b64_tr_b16 v[206:207], v220 offset:45312
    s_add_u32 m0, s72, 0
    s_add_u32 s68, s26, 0
    buffer_load_dwordx4 v229, s[44:47], s68 offen offset:0 lds
    v_mfma_f32_32x32x16_bf16 v[32:47], v[208:211], v[184:187], v[32:47]
    ds_read_b128 v[160:163], v218 offset:0
    ds_read_b128 v[164:167], v218 offset:1024
    buffer_load_dwordx4 v230, s[44:47], s68 offen offset:1024 lds
    v_mfma_f32_32x32x16_bf16 v[48:63], v[212:215], v[184:187], v[48:63]
    ds_read_b128 v[168:171], v218 offset:2048
    ds_read_b128 v[172:175], v218 offset:3072
    v_mfma_f32_32x32x16_bf16 v[64:79], v[208:211], v[188:191], v[64:79]
    buffer_load_dwordx4 v231, s[44:47], s68 offen offset:2048 lds
    v_mfma_f32_32x32x16_bf16 v[80:95], v[212:215], v[188:191], v[80:95]
    v_mfma_f32_32x32x16_bf16 v[96:111], v[208:211], v[192:195], v[96:111]
    s_mul_i32 s100, s13, 160
    s_add_u32 s100, s100, s9
    buffer_load_dwordx4 a[40:43], v238, s[56:59], s100 offen offset:0 sc1
    v_mfma_f32_32x32x16_bf16 v[112:127], v[212:215], v[192:195], v[112:127]
    s_waitcnt lgkmcnt(0)
    v_mfma_f32_32x32x16_bf16 v[0:15], v[200:203], v[160:163], v[0:15]
    ds_read_b64_tr_b16 v[208:209], v220 offset:38912
    ds_read_b64_tr_b16 v[210:211], v220 offset:39168
    v_mfma_f32_32x32x16_bf16 v[16:31], v[204:207], v[160:163], v[16:31]
    ds_read_b64_tr_b16 v[212:213], v220 offset:47104
    ds_read_b64_tr_b16 v[214:215], v220 offset:47360
    buffer_load_dwordx4 v232, s[44:47], s68 offen offset:3072 lds
    v_mfma_f32_32x32x16_bf16 v[32:47], v[200:203], v[164:167], v[32:47]
    ds_read_b128 v[180:183], v219 offset:0
    ds_read_b128 v[184:187], v219 offset:1024
    s_add_u32 m0, s72, 4096
    s_add_u32 s68, s26, 110592
    buffer_load_dwordx4 v229, s[44:47], s68 offen offset:0 lds
    v_mfma_f32_32x32x16_bf16 v[48:63], v[204:207], v[164:167], v[48:63]
    ds_read_b128 v[188:191], v219 offset:2048
    ds_read_b128 v[192:195], v219 offset:3072
    v_mfma_f32_32x32x16_bf16 v[64:79], v[200:203], v[168:171], v[64:79]
    buffer_load_dwordx4 v230, s[44:47], s68 offen offset:1024 lds
    v_mfma_f32_32x32x16_bf16 v[80:95], v[204:207], v[168:171], v[80:95]
    v_mfma_f32_32x32x16_bf16 v[96:111], v[200:203], v[172:175], v[96:111]
    buffer_load_dwordx4 v231, s[44:47], s68 offen offset:2048 lds
    v_mfma_f32_32x32x16_bf16 v[112:127], v[204:207], v[172:175], v[112:127]
    s_waitcnt lgkmcnt(0)
    v_mfma_f32_32x32x16_bf16 v[0:15], v[208:211], v[180:183], v[0:15]
    s_waitcnt vmcnt(12)
    s_barrier
    ds_read_b64_tr_b16 v[200:201], v220 offset:16384
    ds_read_b64_tr_b16 v[202:203], v220 offset:16640
    v_mfma_f32_32x32x16_bf16 v[16:31], v[212:215], v[180:183], v[16:31]
    ds_read_b64_tr_b16 v[204:205], v220 offset:24576
    ds_read_b64_tr_b16 v[206:207], v220 offset:24832
    buffer_load_dwordx4 v232, s[44:47], s68 offen offset:3072 lds
    v_mfma_f32_32x32x16_bf16 v[32:47], v[208:211], v[184:187], v[32:47]
    ds_read_b128 v[160:163], v216 offset:20480
    ds_read_b128 v[164:167], v216 offset:21504
    s_add_u32 m0, s71, 0
    s_add_u32 s3, s3, 128
    s_cmp_eq_u32 s3, 1280
    s_cselect_b32 s3, 0, s3
    s_mul_i32 s26, s3, 1728
    s_add_u32 s68, s3, 0
    buffer_load_dwordx4 v224, s[40:43], s68 offen offset:0 lds
    v_mfma_f32_32x32x16_bf16 v[48:63], v[212:215], v[184:187], v[48:63]
    ds_read_b128 v[168:171], v216 offset:22528
    ds_read_b128 v[172:175], v216 offset:23552
    buffer_load_dwordx4 v225, s[40:43], s68 offen offset:1024 lds
    v_mfma_f32_32x32x16_bf16 v[64:79], v[208:211], v[188:191], v[64:79]
    v_mfma_f32_32x32x16_bf16 v[80:95], v[212:215], v[188:191], v[80:95]
    buffer_load_dwordx4 a[44:47], v238, s[56:59], s100 offen offset:1024 sc1
    v_mfma_f32_32x32x16_bf16 v[96:111], v[208:211], v[192:195], v[96:111]
    buffer_load_dwordx4 a[48:51], v238, s[56:59], s100 offen offset:2048 sc1
    v_mfma_f32_32x32x16_bf16 v[112:127], v[212:215], v[192:195], v[112:127]
    s_waitcnt lgkmcnt(0)
    v_mfma_f32_32x32x16_bf16 v[0:15], v[200:203], v[160:163], v[0:15]
    ds_read_b64_tr_b16 v[208:209], v220 offset:18432
    ds_read_b64_tr_b16 v[210:211], v220 offset:18688
    v_mfma_f32_32x32x16_bf16 v[16:31], v[204:207], v[160:163], v[16:31]
    ds_read_b64_tr_b16 v[212:213], v220 offset:26624
    ds_read_b64_tr_b16 v[214:215], v220 offset:26880
    buffer_load_dwordx4 v226, s[40:43], s68 offen offset:2048 lds
    v_mfma_f32_32x32x16_bf16 v[32:47], v[200:203], v[164:167], v[32:47]
    ds_read_b128 v[180:183], v217 offset:20480
    ds_read_b128 v[184:187], v217 offset:21504
    buffer_load_dwordx4 v227, s[40:43], s68 offen offset:3072 lds
    v_mfma_f32_32x32x16_bf16 v[48:63], v[204:207], v[164:167], v[48:63]
    ds_read_b128 v[188:191], v217 offset:22528
    ds_read_b128 v[192:195], v217 offset:23552
    v_mfma_f32_32x32x16_bf16 v[64:79], v[200:203], v[168:171], v[64:79]
    s_add_u32 m0, s72, 32768
    s_add_u32 s68, s26, 0
    buffer_load_dwordx4 v229, s[44:47], s68 offen offset:0 lds
    v_mfma_f32_32x32x16_bf16 v[80:95], v[204:207], v[168:171], v[80:95]
    v_mfma_f32_32x32x16_bf16 v[96:111], v[200:203], v[172:175], v[96:111]
    buffer_load_dwordx4 a[52:55], v238, s[56:59], s100 offen offset:3072 sc1
    v_mfma_f32_32x32x16_bf16 v[112:127], v[204:207], v[172:175], v[112:127]
    s_waitcnt lgkmcnt(0)
    v_mfma_f32_32x32x16_bf16 v[0:15], v[208:211], v[180:183], v[0:15]
    ds_read_b64_tr_b16 v[200:201], v220 offset:20480
    ds_read_b64_tr_b16 v[202:203], v220 offset:20736
    s_lshr_b32 s73, s2, 3
    s_mul_i32 s73, s73, 3072
    v_mfma_f32_32x32x16_bf16 v[16:31], v[212:215], v[180:183], v[16:31]
    ds_read_b64_tr_b16 v[204:205], v220 offset:28672
    ds_read_b64_tr_b16 v[206:207], v220 offset:28928
    buffer_load_dwordx4 v230, s[44:47], s68 offen offset:1024 lds
    v_mfma_f32_32x32x16_bf16 v[32:47], v[208:211], v[184:187], v[32:47]
    ds_read_b128 v[160:163], v218 offset:20480
    ds_read_b128 v[164:167], v218 offset:21504
    buffer_load_dwordx4 v231, s[44:47], s68 offen offset:2048 lds
    v_mfma_f32_32x32x16_bf16 v[48:63], v[212:215], v[184:187], v[48:63]
    ds_read_b128 v[168:171], v218 offset:22528
    ds_read_b128 v[172:175], v218 offset:23552
    v_mfma_f32_32x32x16_bf16 v[64:79], v[208:211], v[188:191], v[64:79]
    buffer_load_dwordx4 v232, s[44:47], s68 offen offset:3072 lds
    s_cmp_eq_u32 s64, 0
    s_cselect_b32 s73, s73, 134217728
    v_mfma_f32_32x32x16_bf16 v[80:95], v[212:215], v[188:191], v[80:95]
    v_lshl_add_u32 v243, v233, 7, s73
    s_mov_b32 exec_lo, 16777215
    s_mov_b32 exec_hi, 0
    buffer_load_dword a255, v243, s[84:87], 0 offen
    s_mov_b64 exec, -1
    v_mfma_f32_32x32x16_bf16 v[96:111], v[208:211], v[192:195], v[96:111]
    s_add_u32 m0, s72, 36864
    s_add_u32 s68, s26, 110592
    buffer_load_dwordx4 v229, s[44:47], s68 offen offset:0 lds
    v_mfma_f32_32x32x16_bf16 v[112:127], v[212:215], v[192:195], v[112:127]
    buffer_load_dwordx2 a[240:241], v236, s[56:59], s101 offen offset:0 sc1
    buffer_load_dwordx2 a[242:243], v236, s[56:59], s101 offen offset:512 sc1
    buffer_load_dwordx2 a[244:245], v236, s[56:59], s101 offen offset:1024 sc1
    s_waitcnt lgkmcnt(0)
    v_mfma_f32_32x32x16_bf16 v[0:15], v[200:203], v[160:163], v[0:15]
    ds_read_b64_tr_b16 v[208:209], v220 offset:22528
    ds_read_b64_tr_b16 v[210:211], v220 offset:22784
    buffer_load_dwordx2 a[246:247], v236, s[56:59], s101 offen offset:1536 sc1
    buffer_load_dwordx2 a[248:249], v236, s[56:59], s101 offen offset:2048 sc1
    v_mfma_f32_32x32x16_bf16 v[16:31], v[204:207], v[160:163], v[16:31]
    ds_read_b64_tr_b16 v[212:213], v220 offset:30720
    ds_read_b64_tr_b16 v[214:215], v220 offset:30976
    buffer_load_dwordx4 v230, s[44:47], s68 offen offset:1024 lds
    v_mfma_f32_32x32x16_bf16 v[32:47], v[200:203], v[164:167], v[32:47]
    ds_read_b128 v[180:183], v219 offset:20480
    ds_read_b128 v[184:187], v219 offset:21504
    s_lshl_b32 s75, s78, 12
    s_cmp_ge_u32 s78, 54
    s_cselect_b32 s21, 134217728, s75
    v_mfma_f32_32x32x16_bf16 v[48:63], v[204:207], v[164:167], v[48:63]
    ds_read_b128 v[188:191], v219 offset:22528
    ds_read_b128 v[192:195], v219 offset:23552
    buffer_load_dwordx4 v231, s[44:47], s68 offen offset:2048 lds
    v_mfma_f32_32x32x16_bf16 v[64:79], v[200:203], v[168:171], v[64:79]
    s_mul_i32 s73, s65, 5
    s_add_u32 s73, s73, 0
    s_lshr_b32 s74, s73, 1
    s_mul_i32 s74, s74, 380928
    v_mfma_f32_32x32x16_bf16 v[80:95], v[204:207], v[168:171], v[80:95]
    buffer_load_dwordx4 v232, s[44:47], s68 offen offset:3072 lds
    s_lshl_b32 s73, s73, 11
    s_add_u32 s74, s74, s73
    v_mfma_f32_32x32x16_bf16 v[96:111], v[200:203], v[172:175], v[96:111]
    s_add_u32 s16, s74, s21
    s_mul_i32 s73, s65, 5
    s_add_u32 s73, s73, 1
    s_lshr_b32 s74, s73, 1
    v_mfma_f32_32x32x16_bf16 v[112:127], v[204:207], v[172:175], v[112:127]
    s_mul_i32 s74, s74, 380928
    s_lshl_b32 s73, s73, 11
    s_add_u32 s74, s74, s73
    s_add_u32 s17, s74, s21
    s_waitcnt lgkmcnt(0)
    v_mfma_f32_32x32x16_bf16 v[0:15], v[208:211], v[180:183], v[0:15]
    s_waitcnt vmcnt(21)
    s_barrier
    ds_read_b64_tr_b16 v[200:201], v220 offset:0
    ds_read_b64_tr_b16 v[202:203], v220 offset:256
    s_mul_i32 s73, s65, 5
    v_mfma_f32_32x32x16_bf16 v[16:31], v[212:215], v[180:183], v[16:31]
    ds_read_b64_tr_b16 v[204:205], v220 offset:8192
    ds_read_b64_tr_b16 v[206:207], v220 offset:8448
    s_add_u32 s73, s73, 2
    s_lshr_b32 s74, s73, 1
    v_mfma_f32_32x32x16_bf16 v[32:47], v[208:211], v[184:187], v[32:47]
    ds_read_b128 v[160:163], v216 offset:40960
    ds_read_b128 v[164:167], v216 offset:41984
    s_mul_i32 s74, s74, 380928
    v_mfma_f32_32x32x16_bf16 v[48:63], v[212:215], v[184:187], v[48:63]
    ds_read_b128 v[168:171], v216 offset:43008
    ds_read_b128 v[172:175], v216 offset:44032
    s_lshl_b32 s73, s73, 11
    s_add_u32 s74, s74, s73
    v_mfma_f32_32x32x16_bf16 v[64:79], v[208:211], v[188:191], v[64:79]
    s_add_u32 s18, s74, s21
    s_mul_i32 s73, s65, 5
    s_add_u32 s73, s73, 3
    s_lshr_b32 s74, s73, 1
    v_mfma_f32_32x32x16_bf16 v[80:95], v[212:215], v[188:191], v[80:95]
    s_mul_i32 s74, s74, 380928
    s_lshl_b32 s73, s73, 11
    s_add_u32 s74, s74, s73
    s_add_u32 s19, s74, s21
    v_mfma_f32_32x32x16_bf16 v[96:111], v[208:211], v[192:195], v[96:111]
    s_mul_i32 s73, s65, 5
    s_add_u32 s73, s73, 4
    s_lshr_b32 s74, s73, 1
    v_mfma_f32_32x32x16_bf16 v[112:127], v[212:215], v[192:195], v[112:127]
    s_mul_i32 s74, s74, 380928
    s_lshl_b32 s73, s73, 11
    s_add_u32 s74, s74, s73
    s_add_u32 s20, s74, s21
    s_waitcnt lgkmcnt(0)
    v_mfma_f32_32x32x16_bf16 v[0:15], v[200:203], v[160:163], v[0:15]
    ds_read_b64_tr_b16 v[208:209], v220 offset:2048
    ds_read_b64_tr_b16 v[210:211], v220 offset:2304
    v_mfma_f32_32x32x16_bf16 v[16:31], v[204:207], v[160:163], v[16:31]
    ds_read_b64_tr_b16 v[212:213], v220 offset:10240
    ds_read_b64_tr_b16 v[214:215], v220 offset:10496
    s_add_u32 s100, s100, 4096
    buffer_load_dwordx4 a[56:59], v238, s[56:59], s100 offen offset:0 sc1
    v_mfma_f32_32x32x16_bf16 v[32:47], v[200:203], v[164:167], v[32:47]
    ds_read_b128 v[180:183], v217 offset:40960
    ds_read_b128 v[184:187], v217 offset:41984
    s_mul_i32 s100, s13, 160
    s_add_u32 s100, s100, s9
    s_add_u32 s100, s100, 10240
    buffer_load_dwordx4 a[60:63], v238, s[56:59], s100 offen offset:0 sc1
    v_mfma_f32_32x32x16_bf16 v[48:63], v[204:207], v[164:167], v[48:63]
    ds_read_b128 v[188:191], v217 offset:43008
    ds_read_b128 v[192:195], v217 offset:44032
    v_mfma_f32_32x32x16_bf16 v[64:79], v[200:203], v[168:171], v[64:79]
    buffer_load_dwordx4 a[64:67], v238, s[56:59], s100 offen offset:1024 sc1
    v_mfma_f32_32x32x16_bf16 v[80:95], v[204:207], v[168:171], v[80:95]
    v_mfma_f32_32x32x16_bf16 v[96:111], v[200:203], v[172:175], v[96:111]
    buffer_load_dwordx4 a[68:71], v238, s[56:59], s100 offen offset:2048 sc1
    v_mfma_f32_32x32x16_bf16 v[112:127], v[204:207], v[172:175], v[112:127]
    s_waitcnt lgkmcnt(0)
    v_mfma_f32_32x32x16_bf16 v[0:15], v[208:211], v[180:183], v[0:15]
    ds_read_b64_tr_b16 v[200:201], v220 offset:4096
    ds_read_b64_tr_b16 v[202:203], v220 offset:4352
    s_mul_i32 s27, s65, 1280
    s_add_u32 s27, s27, 4194304
    v_lshrrev_b32 v240, 1, v238
    v_mfma_f32_32x32x16_bf16 v[16:31], v[212:215], v[180:183], v[16:31]
    ds_read_b64_tr_b16 v[204:205], v220 offset:12288
    ds_read_b64_tr_b16 v[206:207], v220 offset:12544
    buffer_load_dwordx4 a[72:75], v238, s[56:59], s100 offen offset:3072 sc1
    v_and_b32 v239, 0xf8, v240
    v_mfma_f32_32x32x16_bf16 v[32:47], v[208:211], v[184:187], v[32:47]
    ds_read_b128 v[160:163], v218 offset:40960
    ds_read_b128 v[164:167], v218 offset:41984
    buffer_load_dwordx2 v[244:245], v239, s[56:59], s27 offen offset:0 sc1
    buffer_load_dwordx2 v[246:247], v239, s[56:59], s27 offen offset:256 sc1
    buffer_load_dwordx2 v[248:249], v239, s[56:59], s27 offen offset:512 sc1
    v_mfma_f32_32x32x16_bf16 v[48:63], v[212:215], v[184:187], v[48:63]
    ds_read_b128 v[168:171], v218 offset:43008
    ds_read_b128 v[172:175], v218 offset:44032
    s_waitcnt vmcnt(11)
    v_accvgpr_read_b32 v234, a241
    v_mfma_f32_32x32x16_bf16 v[64:79], v[208:211], v[188:191], v[64:79]
    v_xor_b32 v234, s83, v234
    v_accvgpr_read_b32 v235, a243
    v_xor_b32 v235, s83, v235
    v_or_b32 v234, v234, v235
    v_accvgpr_read_b32 v235, a245
    v_mfma_f32_32x32x16_bf16 v[80:95], v[212:215], v[188:191], v[80:95]
    v_xor_b32 v235, s83, v235
    v_or_b32 v234, v234, v235
    v_accvgpr_read_b32 v235, a247
    v_xor_b32 v235, s83, v235
    v_mfma_f32_32x32x16_bf16 v[96:111], v[208:211], v[192:195], v[96:111]
    v_or_b32 v234, v234, v235
    v_accvgpr_read_b32 v235, a249
    v_xor_b32 v235, s83, v235
    v_or_b32 v234, v234, v235
    v_mfma_f32_32x32x16_bf16 v[112:127], v[212:215], v[192:195], v[112:127]
    s_cmp_ge_u32 s78, 54
    s_cselect_b32 s73, 0, -1
    v_and_b32 v234, s73, v234
    v_cmp_ne_u32 vcc, 0, v234
    s_cbranch_vccnz L_slow_sum_g12
L_go_sum_g12:
    s_waitcnt lgkmcnt(0)
    v_mfma_f32_32x32x16_bf16 v[0:15], v[200:203], v[160:163], v[0:15]
    ds_read_b64_tr_b16 v[208:209], v220 offset:6144
    ds_read_b64_tr_b16 v[210:211], v220 offset:6400
    buffer_load_dwordx2 v[250:251], v239, s[56:59], s27 offen offset:768 sc1
    v_mfma_f32_32x32x16_bf16 v[16:31], v[204:207], v[160:163], v[16:31]
    ds_read_b64_tr_b16 v[212:213], v220 offset:14336
    ds_read_b64_tr_b16 v[214:215], v220 offset:14592
    s_add_u32 s100, s100, 4096
    buffer_load_dwordx4 a[76:79], v238, s[56:59], s100 offen offset:0 sc1
    v_mfma_f32_32x32x16_bf16 v[32:47], v[200:203], v[164:167], v[32:47]
    ds_read_b128 v[180:183], v219 offset:40960
    ds_read_b128 v[184:187], v219 offset:41984
    s_mul_i32 s100, s14, 160
    s_add_u32 s100, s100, s9
    buffer_load_dwordx4 a[80:83], v238, s[56:59], s100 offen offset:0 sc1
    v_mfma_f32_32x32x16_bf16 v[48:63], v[204:207], v[164:167], v[48:63]
    ds_read_b128 v[188:191], v219 offset:43008
    ds_read_b128 v[192:195], v219 offset:44032
    v_mfma_f32_32x32x16_bf16 v[64:79], v[200:203], v[168:171], v[64:79]
    buffer_load_dwordx4 a[84:87], v238, s[56:59], s100 offen offset:1024 sc1
    v_accvgpr_read_b32 v254, a240
    v_mfma_f32_32x32x16_bf16 v[80:95], v[204:207], v[168:171], v[80:95]
    v_accvgpr_read_b32 v234, a242
    v_add_f32 v254, v254, v234
    v_accvgpr_read_b32 v234, a244
    v_mfma_f32_32x32x16_bf16 v[96:111], v[200:203], v[172:175], v[96:111]
    buffer_load_dwordx4 a[88:91], v238, s[56:59], s100 offen offset:2048 sc1
    v_add_f32 v254, v254, v234
    v_accvgpr_read_b32 v234, a246
    v_mfma_f32_32x32x16_bf16 v[112:127], v[204:207], v[172:175], v[112:127]
    v_add_f32 v254, v254, v234
    v_accvgpr_read_b32 v234, a248
    v_add_f32 v254, v254, v234
    s_waitcnt lgkmcnt(0)
    v_mfma_f32_32x32x16_bf16 v[0:15], v[208:211], v[180:183], v[0:15]
    s_waitcnt vmcnt(13)
    s_barrier
    ds_read_b64_tr_b16 v[200:201], v220 offset:32768
    ds_read_b64_tr_b16 v[202:203], v220 offset:33024
    v_mfma_f32_32x32x16_bf16 v[16:31], v[212:215], v[180:183], v[16:31]
    ds_read_b64_tr_b16 v[204:205], v220 offset:40960
    ds_read_b64_tr_b16 v[206:207], v220 offset:41216
    buffer_load_dwordx4 a[92:95], v238, s[56:59], s100 offen offset:3072 sc1
    v_mfma_f32_32x32x16_bf16 v[32:47], v[208:211], v[184:187], v[32:47]
    ds_read_b128 v[160:163], v216 offset:0
    ds_read_b128 v[164:167], v216 offset:1024
    s_add_u32 s100, s100, 4096
    buffer_load_dwordx4 a[96:99], v238, s[56:59], s100 offen offset:0 sc1
    v_mfma_f32_32x32x16_bf16 v[48:63], v[212:215], v[184:187], v[48:63]
    ds_read_b128 v[168:171], v216 offset:2048
    ds_read_b128 v[172:175], v216 offset:3072
    v_mfma_f32_32x32x16_bf16 v[64:79], v[208:211], v[188:191], v[64:79]
    s_mul_i32 s100, s14, 160
    s_add_u32 s100, s100, s9
    s_add_u32 s100, s100, 10240
    buffer_load_dwordx4 a[100:103], v238, s[56:59], s100 offen offset:0 sc1
    v_mfma_f32_32x32x16_bf16 v[80:95], v[212:215], v[188:191], v[80:95]
    v_mfma_f32_32x32x16_bf16 v[96:111], v[208:211], v[192:195], v[96:111]
    buffer_load_dwordx4 a[104:107], v238, s[56:59], s100 offen offset:1024 sc1
    v_mfma_f32_32x32x16_bf16 v[112:127], v[212:215], v[192:195], v[112:127]
    s_waitcnt lgkmcnt(0)
    v_mfma_f32_32x32x16_bf16 v[0:15], v[200:203], v[160:163], v[0:15]
    ds_read_b64_tr_b16 v[208:209], v220 offset:34816
    ds_read_b64_tr_b16 v[210:211], v220 offset:35072
    s_lshl_b32 s73, s4, 1
    v_lshrrev_b32 v242, 5, v233
    v_add_u32_e64 v242, s73, v242
    v_mfma_f32_32x32x16_bf16 v[16:31], v[204:207], v[160:163], v[16:31]
    ds_read_b64_tr_b16 v[212:213], v220 offset:43008
    ds_read_b64_tr_b16 v[214:215], v220 offset:43264
    buffer_load_dwordx4 a[108:111], v238, s[56:59], s100 offen offset:2048 sc1
    v_mul_u32_u24 v242, 205, v242
    v_lshrrev_b32 v242, 10, v242
    v_and_b32 v241, 15, v233
    v_mfma_f32_32x32x16_bf16 v[32:47], v[200:203], v[164:167], v[32:47]
    ds_read_b128 v[180:183], v217 offset:0
    ds_read_b128 v[184:187], v217 offset:1024
    buffer_load_dwordx4 a[112:115], v238, s[56:59], s100 offen offset:3072 sc1
    v_lshl_add_u32 v242, v242, 6, v241
    s_lshl_b32 s75, s64, 4
    v_mfma_f32_32x32x16_bf16 v[48:63], v[204:207], v[164:167], v[48:63]
    ds_read_b128 v[188:191], v217 offset:2048
    ds_read_b128 v[192:195], v217 offset:3072
    v_add_u32 v242, s75, v242
    v_and_b32 v243, 14, v241
    s_and_b32 s74, s64, 2
    v_mfma_f32_32x32x16_bf16 v[64:79], v[200:203], v[168:171], v[64:79]
    s_add_u32 s100, s100, 4096
    buffer_load_dwordx4 a[116:119], v238, s[56:59], s100 offen offset:0 sc1
    s_lshr_b32 s73, s4, 1
    s_lshl_b32 s73, s73, 5
    s_add_u32 s74, s74, s73
    v_mfma_f32_32x32x16_bf16 v[80:95], v[204:207], v[168:171], v[80:95]
    s_add_u32 s74, s74, 1024
    v_add3_u32 v243, v243, v241, s74
    v_and_b32 v241, 16, v233
    v_cmp_eq_u32 vcc, 0, v241
    s_mov_b32 s28, 5046272
    s_nop 0
    v_mfma_f32_32x32x16_bf16 v[96:111], v[200:203], v[172:175], v[96:111]
    s_mul_i32 s100, s15, 160
    s_add_u32 s100, s100, s9
    buffer_load_dwordx4 a[120:123], v238, s[56:59], s100 offen offset:0 sc1
    v_cndmask_b32 v231, v243, v242, vcc
    v_lshlrev_b32 v231, 5, v231
    v_mfma_f32_32x32x16_bf16 v[112:127], v[204:207], v[172:175], v[112:127]
    s_cmp_ge_u32 s64, 2
    s_cselect_b32 s23, 0, 0x2000
    s_or_b32 s22, s23, 0x3ff0000
    s_mov_b32 s10, 0x1fff
    s_mov_b32 s11, 0x1fff
    s_waitcnt lgkmcnt(0)
    v_mfma_f32_32x32x16_bf16 v[0:15], v[208:211], v[180:183], v[0:15]
    ds_read_b64_tr_b16 v[200:201], v220 offset:36864
    ds_read_b64_tr_b16 v[202:203], v220 offset:37120
    s_waitcnt vmcnt(12)
    v_xor_b32 v241, s83, v245
    v_xor_b32 v242, s83, v247
    v_mfma_f32_32x32x16_bf16 v[16:31], v[212:215], v[180:183], v[16:31]
    ds_read_b64_tr_b16 v[204:205], v220 offset:45056
    ds_read_b64_tr_b16 v[206:207], v220 offset:45312
    buffer_load_dwordx4 a[124:127], v238, s[56:59], s100 offen offset:1024 sc1
    v_or_b32 v241, v241, v242
    v_xor_b32 v242, s83, v249
    v_or_b32 v241, v241, v242
    v_mfma_f32_32x32x16_bf16 v[32:47], v[208:211], v[184:187], v[32:47]
    ds_read_b128 v[160:163], v218 offset:0
    ds_read_b128 v[164:167], v218 offset:1024
    buffer_load_dwordx4 a[128:131], v238, s[56:59], s100 offen offset:2048 sc1
    v_xor_b32 v242, s83, v251
    v_or_b32 v241, v241, v242
    v_mfma_f32_32x32x16_bf16 v[48:63], v[212:215], v[184:187], v[48:63]
    ds_read_b128 v[168:171], v218 offset:2048
    ds_read_b128 v[172:175], v218 offset:3072
    buffer_load_dwordx4 a[132:135], v238, s[56:59], s100 offen offset:3072 sc1
    v_cmp_ne_u32 vcc, 0, v241
    s_cbranch_vccnz L_slow_epi_g12
L_go_epi_g12:
    v_mfma_f32_32x32x16_bf16 v[64:79], v[208:211], v[188:191], v[64:79]
    s_lshl_b32 s73, s64, 10
    s_add_u32 s73, s73, 159744
    v_lshrrev_b32 v239, 2, v238
    v_add_u32 v239, s73, v239
    v_lshrrev_b32_e64 v240, 5, v233
    v_mfma_f32_32x32x16_bf16 v[80:95], v[212:215], v[188:191], v[80:95]
    s_add_u32 s100, s100, 4096
    buffer_load_dwordx4 a[136:139], v238, s[56:59], s100 offen offset:0 sc1
    v_lshl_add_u32 v241, v240, 4, s73
    ds_write_b32 v239, v254
    v_and_b32 v228, 0xffff0000, v244
    v_lshlrev_b32 v244, 16, v244
    v_mfma_f32_32x32x16_bf16 v[96:111], v[208:211], v[192:195], v[96:111]
    s_mul_i32 s100, s15, 160
    s_add_u32 s100, s100, s9
    s_add_u32 s100, s100, 10240
    buffer_load_dwordx4 a[140:143], v238, s[56:59], s100 offen offset:0 sc1
    v_mfma_f32_32x32x16_bf16 v[112:127], v[212:215], v[192:195], v[112:127]
    v_rcp_f32 v245, v228
    v_and_b32 v229, 0xffff0000, v246
    v_lshlrev_b32 v246, 16, v246
    v_rcp_f32 v247, v229
    s_waitcnt lgkmcnt(1)
    v_mfma_f32_32x32x16_bf16 v[0:15], v[200:203], v[160:163], v[0:15]
    ds_read_b64_tr_b16 v[208:209], v220 offset:38912
    ds_read_b64_tr_b16 v[210:211], v220 offset:39168
    v_and_b32 v222, 0xffff0000, v248
    v_lshlrev_b32 v248, 16, v248
    v_mfma_f32_32x32x16_bf16 v[16:31], v[204:207], v[160:163], v[16:31]
    ds_read_b64_tr_b16 v[212:213], v220 offset:47104
    ds_read_b64_tr_b16 v[214:215], v220 offset:47360
    buffer_load_dwordx4 a[144:147], v238, s[56:59], s100 offen offset:1024 sc1
    v_rcp_f32 v249, v222
    v_mfma_f32_32x32x16_bf16 v[32:47], v[200:203], v[164:167], v[32:47]
    ds_read_b128 v[180:183], v219 offset:0
    ds_read_b128 v[184:187], v219 offset:1024
    buffer_load_dwordx4 a[148:151], v238, s[56:59], s100 offen offset:2048 sc1
    v_and_b32 v223, 0xffff0000, v250
    v_mfma_f32_32x32x16_bf16 v[48:63], v[204:207], v[164:167], v[48:63]
    ds_read_b128 v[188:191], v219 offset:2048
    ds_read_b128 v[192:195], v219 offset:3072
    v_lshlrev_b32 v250, 16, v250
    v_rcp_f32 v251, v223
    v_mfma_f32_32x32x16_bf16 v[64:79], v[200:203], v[168:171], v[64:79]
    buffer_load_dwordx4 a[152:155], v238, s[56:59], s100 offen offset:3072 sc1
    v_and_b32 v234, 0xffff0000, v252
    v_lshlrev_b32 v252, 16, v252
    v_mfma_f32_32x32x16_bf16 v[80:95], v[204:207], v[168:171], v[80:95]
    v_rcp_f32 v253, v234
    v_and_b32 v242, 0xf0, v238
    v_lshl_add_u32 v242, v240, 9, v242
    v_bfe_u32 v243, v233, 4, 1
    v_mfma_f32_32x32x16_bf16 v[96:111], v[200:203], v[172:175], v[96:111]
    s_add_u32 s100, s100, 4096
    buffer_load_dwordx4 a[156:159], v238, s[56:59], s100 offen offset:0 sc1
    v_lshl_add_u32 v221, v243, 10, v242
    v_mul_f32 v245, 0xbfb8aa3b, v245
    v_mfma_f32_32x32x16_bf16 v[112:127], v[204:207], v[172:175], v[112:127]
    v_mul_f32 v247, 0xbfb8aa3b, v247
    v_mul_f32 v249, 0xbfb8aa3b, v249
    v_mul_f32 v251, 0xbfb8aa3b, v251
    v_mul_f32 v253, 0xbfb8aa3b, v253
    s_waitcnt lgkmcnt(0)
    v_mfma_f32_32x32x16_bf16 v[0:15], v[208:211], v[180:183], v[0:15]
    ds_read_b128 v[160:163], v241 offset:0
    v_mfma_f32_32x32x16_bf16 v[16:31], v[212:215], v[180:183], v[16:31]
    s_mul_i32 s100, s30, 160
    s_add_u32 s100, s100, s9
    buffer_load_dwordx4 a[160:163], v238, s[56:59], s100 offen offset:0 sc1
    v_mfma_f32_32x32x16_bf16 v[32:47], v[208:211], v[184:187], v[32:47]
    buffer_load_dwordx4 a[164:167], v238, s[56:59], s100 offen offset:1024 sc1
    v_mfma_f32_32x32x16_bf16 v[48:63], v[212:215], v[184:187], v[48:63]
    ds_read_b128 v[164:167], v241 offset:32
    ds_read_b128 v[168:171], v241 offset:64
    v_mfma_f32_32x32x16_bf16 v[64:79], v[208:211], v[188:191], v[64:79]
    buffer_load_dwordx4 a[168:171], v238, s[56:59], s100 offen offset:2048 sc1
    v_mfma_f32_32x32x16_bf16 v[80:95], v[212:215], v[188:191], v[80:95]
    ds_read_b128 v[172:175], v241 offset:96
    ds_read_b128 v[176:179], v241 offset:128
    v_mfma_f32_32x32x16_bf16 v[96:111], v[208:211], v[192:195], v[96:111]
    buffer_load_dwordx4 a[172:175], v238, s[56:59], s100 offen offset:3072 sc1
    ds_read_b128 v[200:203], v241 offset:160
    v_mfma_f32_32x32x16_bf16 v[112:127], v[212:215], v[192:195], v[112:127]
    ds_read_b128 v[204:207], v241 offset:192
    ds_read_b128 v[224:227], v241 offset:224
    s_waitcnt lgkmcnt(0)
    s_barrier
    v_pk_fma_f32 v[0:1], v[160:161], v[244:245], v[0:1] op_sel_hi:[1,0,1]
    v_pk_fma_f32 v[2:3], v[162:163], v[244:245], v[2:3] op_sel_hi:[1,0,1]
    v_pk_fma_f32 v[4:5], v[164:165], v[244:245], v[4:5] op_sel_hi:[1,0,1]
    v_pk_fma_f32 v[6:7], v[166:167], v[244:245], v[6:7] op_sel_hi:[1,0,1]
    v_pk_mul_f32 v[0:1], v[0:1], v[244:245] op_sel:[0,1] op_sel_hi:[1,1]
    v_pk_mul_f32 v[2:3], v[2:3], v[244:245] op_sel:[0,1] op_sel_hi:[1,1]
    v_pk_mul_f32 v[4:5], v[4:5], v[244:245] op_sel:[0,1] op_sel_hi:[1,1]
    v_pk_mul_f32 v[6:7], v[6:7], v[244:245] op_sel:[0,1] op_sel_hi:[1,1]
    v_exp_f32 v0, v0
    v_exp_f32 v1, v1
    v_exp_f32 v2, v2
    v_exp_f32 v3, v3
    v_exp_f32 v4, v4
    v_exp_f32 v5, v5
    v_exp_f32 v6, v6
    v_exp_f32 v7, v7
    s_add_u32 s100, s100, 4096
    buffer_load_dwordx4 a[176:179], v238, s[56:59], s100 offen offset:0 sc1
    v_pk_fma_f32 v[16:17], v[176:177], v[244:245], v[16:17] op_sel_hi:[1,0,1]
    v_pk_fma_f32 v[18:19], v[178:179], v[244:245], v[18:19] op_sel_hi:[1,0,1]
    v_pk_fma_f32 v[20:21], v[200:201], v[244:245], v[20:21] op_sel_hi:[1,0,1]
    v_pk_fma_f32 v[22:23], v[202:203], v[244:245], v[22:23] op_sel_hi:[1,0,1]
    v_pk_fma_f32 v[0:1], v[0:1], v[228:229], v[228:229] op_sel:[0,0,0] op_sel_hi:[1,0,0]
    v_pk_fma_f32 v[2:3], v[2:3], v[228:229], v[228:229] op_sel:[0,0,0] op_sel_hi:[1,0,0]
    v_pk_fma_f32 v[4:5], v[4:5], v[228:229], v[228:229] op_sel:[0,0,0] op_sel_hi:[1,0,0]
    v_pk_fma_f32 v[6:7], v[6:7], v[228:229], v[228:229] op_sel:[0,0,0] op_sel_hi:[1,0,0]
    v_rcp_f32 v0, v0
    v_rcp_f32 v1, v1
    v_rcp_f32 v2, v2
    v_rcp_f32 v3, v3
    v_rcp_f32 v4, v4
    v_rcp_f32 v5, v5
    v_rcp_f32 v6, v6
    v_rcp_f32_e64 v7, v7
    s_add_u32 s100, s70, 0
    buffer_load_dwordx4 a[200:203], v238, s[56:59], s100 offen offset:0 sc1
    v_pk_mul_f32 v[16:17], v[16:17], v[0:1]
    v_pk_mul_f32 v[18:19], v[18:19], v[2:3]
    v_pk_mul_f32 v[20:21], v[20:21], v[4:5]
    v_pk_mul_f32 v[22:23], v[22:23], v[6:7]
    v_cvt_pk_bf16_f32 v180, v16, v17
    v_cvt_pk_bf16_f32 v181, v18, v19
    v_cvt_pk_bf16_f32 v182, v20, v21
    v_cvt_pk_bf16_f32 v183, v22, v23
    buffer_store_dwordx4 v[180:183], v221, s[52:55], s16 offen offset:0 sc1
    v_pk_fma_f32 v[8:9], v[168:169], v[244:245], v[8:9] op_sel_hi:[1,0,1]
    v_pk_fma_f32 v[10:11], v[170:171], v[244:245], v[10:11] op_sel_hi:[1,0,1]
    v_pk_fma_f32 v[12:13], v[172:173], v[244:245], v[12:13] op_sel_hi:[1,0,1]
    v_pk_fma_f32 v[14:15], v[174:175], v[244:245], v[14:15] op_sel_hi:[1,0,1]
    v_pk_mul_f32 v[8:9], v[8:9], v[244:245] op_sel:[0,1] op_sel_hi:[1,1]
    v_pk_mul_f32 v[10:11], v[10:11], v[244:245] op_sel:[0,1] op_sel_hi:[1,1]
    v_pk_mul_f32 v[12:13], v[12:13], v[244:245] op_sel:[0,1] op_sel_hi:[1,1]
    v_pk_mul_f32 v[14:15], v[14:15], v[244:245] op_sel:[0,1] op_sel_hi:[1,1]
    v_exp_f32 v8, v8
    v_exp_f32 v9, v9
    v_exp_f32 v10, v10
    v_exp_f32 v11, v11
    v_exp_f32 v12, v12
    v_exp_f32 v13, v13
    v_exp_f32 v14, v14
    v_exp_f32 v15, v15
    buffer_load_dwordx4 a[204:207], v238, s[56:59], s100 offen offset:1024 sc1
    v_pk_fma_f32 v[24:25], v[204:205], v[244:245], v[24:25] op_sel_hi:[1,0,1]
    v_pk_fma_f32 v[26:27], v[206:207], v[244:245], v[26:27] op_sel_hi:[1,0,1]
    v_pk_fma_f32 v[28:29], v[224:225], v[244:245], v[28:29] op_sel_hi:[1,0,1]
    v_pk_fma_f32 v[30:31], v[226:227], v[244:245], v[30:31] op_sel_hi:[1,0,1]
    v_pk_fma_f32 v[8:9], v[8:9], v[228:229], v[228:229] op_sel:[0,0,0] op_sel_hi:[1,0,0]
    v_pk_fma_f32 v[10:11], v[10:11], v[228:229], v[228:229] op_sel:[0,0,0] op_sel_hi:[1,0,0]
    v_pk_fma_f32 v[12:13], v[12:13], v[228:229], v[228:229] op_sel:[0,0,0] op_sel_hi:[1,0,0]
    v_pk_fma_f32 v[14:15], v[14:15], v[228:229], v[228:229] op_sel:[0,0,0] op_sel_hi:[1,0,0]
    v_rcp_f32 v8, v8
    v_rcp_f32 v9, v9
    v_rcp_f32 v10, v10
    v_rcp_f32 v11, v11
    v_rcp_f32 v12, v12
    v_rcp_f32 v13, v13
    v_rcp_f32 v14, v14
    v_rcp_f32 v15, v15
    buffer_load_dwordx4 a[208:211], v238, s[56:59], s100 offen offset:2048 sc1
    v_pk_mul_f32 v[24:25], v[24:25], v[8:9]
    v_pk_mul_f32 v[26:27], v[26:27], v[10:11]
    v_pk_mul_f32 v[28:29], v[28:29], v[12:13]
    v_pk_mul_f32 v[30:31], v[30:31], v[14:15]
    v_cvt_pk_bf16_f32 v184, v24, v25
    v_cvt_pk_bf16_f32 v185, v26, v27
    v_cvt_pk_bf16_f32 v186, v28, v29
    v_cvt_pk_bf16_f32 v187, v30, v31
    buffer_store_dwordx4 v[184:187], v221, s[52:55], s16 offen offset:256 sc1
    v_pk_fma_f32 v[32:33], v[160:161], v[246:247], v[32:33] op_sel_hi:[1,0,1]
    v_pk_fma_f32 v[34:35], v[162:163], v[246:247], v[34:35] op_sel_hi:[1,0,1]
    v_pk_fma_f32 v[36:37], v[164:165], v[246:247], v[36:37] op_sel_hi:[1,0,1]
    v_pk_fma_f32 v[38:39], v[166:167], v[246:247], v[38:39] op_sel_hi:[1,0,1]
    v_pk_mul_f32 v[32:33], v[32:33], v[246:247] op_sel:[0,1] op_sel_hi:[1,1]
    v_pk_mul_f32 v[34:35], v[34:35], v[246:247] op_sel:[0,1] op_sel_hi:[1,1]
    v_pk_mul_f32 v[36:37], v[36:37], v[246:247] op_sel:[0,1] op_sel_hi:[1,1]
    v_pk_mul_f32 v[38:39], v[38:39], v[246:247] op_sel:[0,1] op_sel_hi:[1,1]
    v_exp_f32 v32, v32
    v_exp_f32 v33, v33
    v_exp_f32 v34, v34
    v_exp_f32 v35, v35
    v_exp_f32 v36, v36
    v_exp_f32 v37, v37
    v_exp_f32 v38, v38
    v_exp_f32 v39, v39
    buffer_load_dwordx4 a[212:215], v238, s[56:59], s100 offen offset:3072 sc1
    v_pk_fma_f32 v[48:49], v[176:177], v[246:247], v[48:49] op_sel_hi:[1,0,1]
    v_pk_fma_f32 v[50:51], v[178:179], v[246:247], v[50:51] op_sel_hi:[1,0,1]
    v_pk_fma_f32 v[52:53], v[200:201], v[246:247], v[52:53] op_sel_hi:[1,0,1]
    v_pk_fma_f32 v[54:55], v[202:203], v[246:247], v[54:55] op_sel_hi:[1,0,1]
    v_pk_fma_f32 v[32:33], v[32:33], v[228:229], v[228:229] op_sel:[0,1,1] op_sel_hi:[1,1,1]
    v_pk_fma_f32 v[34:35], v[34:35], v[228:229], v[228:229] op_sel:[0,1,1] op_sel_hi:[1,1,1]
    v_pk_fma_f32 v[36:37], v[36:37], v[228:229], v[228:229] op_sel:[0,1,1] op_sel_hi:[1,1,1]
    v_pk_fma_f32 v[38:39], v[38:39], v[228:229], v[228:229] op_sel:[0,1,1] op_sel_hi:[1,1,1]
    v_rcp_f32 v32, v32
    v_rcp_f32 v33, v33
    v_rcp_f32 v34, v34
    v_rcp_f32 v35, v35
    v_rcp_f32 v36, v36
    v_rcp_f32 v37, v37
    v_rcp_f32 v38, v38
    v_rcp_f32 v39, v39
    s_add_u32 s100, s100, 4096
    buffer_load_dwordx4 a[216:219], v238, s[56:59], s100 offen offset:0 sc1
    v_pk_mul_f32 v[48:49], v[48:49], v[32:33]
    v_pk_mul_f32 v[50:51], v[50:51], v[34:35]
    v_pk_mul_f32 v[52:53], v[52:53], v[36:37]
    v_pk_mul_f32 v[54:55], v[54:55], v[38:39]
    v_cvt_pk_bf16_f32 v188, v48, v49
    v_cvt_pk_bf16_f32 v189, v50, v51
    v_cvt_pk_bf16_f32 v190, v52, v53
    v_cvt_pk_bf16_f32 v191, v54, v55
    buffer_store_dwordx4 v[188:191], v221, s[52:55], s17 offen offset:0 sc1
    v_pk_fma_f32 v[40:41], v[168:169], v[246:247], v[40:41] op_sel_hi:[1,0,1]
    v_pk_fma_f32 v[42:43], v[170:171], v[246:247], v[42:43] op_sel_hi:[1,0,1]
    v_pk_fma_f32 v[44:45], v[172:173], v[246:247], v[44:45] op_sel_hi:[1,0,1]
    v_pk_fma_f32 v[46:47], v[174:175], v[246:247], v[46:47] op_sel_hi:[1,0,1]
    v_pk_mul_f32 v[40:41], v[40:41], v[246:247] op_sel:[0,1] op_sel_hi:[1,1]
    v_pk_mul_f32 v[42:43], v[42:43], v[246:247] op_sel:[0,1] op_sel_hi:[1,1]
    v_pk_mul_f32 v[44:45], v[44:45], v[246:247] op_sel:[0,1] op_sel_hi:[1,1]
    v_pk_mul_f32 v[46:47], v[46:47], v[246:247] op_sel:[0,1] op_sel_hi:[1,1]
    v_exp_f32 v40, v40
    v_exp_f32 v41, v41
    v_exp_f32 v42, v42
    v_exp_f32 v43, v43
    v_exp_f32 v44, v44
    v_exp_f32 v45, v45
    v_exp_f32 v46, v46
    v_exp_f32 v47, v47
    s_add_u32 s100, s70, 20480
    buffer_load_dwordx4 a[220:223], v238, s[56:59], s100 offen offset:0 sc1
    v_pk_fma_f32 v[56:57], v[204:205], v[246:247], v[56:57] op_sel_hi:[1,0,1]
    v_pk_fma_f32 v[58:59], v[206:207], v[246:247], v[58:59] op_sel_hi:[1,0,1]
    v_pk_fma_f32 v[60:61], v[224:225], v[246:247], v[60:61] op_sel_hi:[1,0,1]
    v_pk_fma_f32 v[62:63], v[226:227], v[246:247], v[62:63] op_sel_hi:[1,0,1]
    v_pk_fma_f32 v[40:41], v[40:41], v[228:229], v[228:229] op_sel:[0,1,1] op_sel_hi:[1,1,1]
    v_pk_fma_f32 v[42:43], v[42:43], v[228:229], v[228:229] op_sel:[0,1,1] op_sel_hi:[1,1,1]
    v_pk_fma_f32 v[44:45], v[44:45], v[228:229], v[228:229] op_sel:[0,1,1] op_sel_hi:[1,1,1]
    v_pk_fma_f32 v[46:47], v[46:47], v[228:229], v[228:229] op_sel:[0,1,1] op_sel_hi:[1,1,1]
    v_rcp_f32 v40, v40
    v_rcp_f32 v41, v41
    v_rcp_f32 v42, v42
    v_rcp_f32 v43, v43
    v_rcp_f32 v44, v44
    v_rcp_f32 v45, v45
    v_rcp_f32 v46, v46
    v_rcp_f32 v47, v47
    buffer_load_dwordx4 a[224:227], v238, s[56:59], s100 offen offset:1024 sc1
    v_pk_mul_f32 v[56:57], v[56:57], v[40:41]
    v_pk_mul_f32 v[58:59], v[58:59], v[42:43]
    v_pk_mul_f32 v[60:61], v[60:61], v[44:45]
    v_pk_mul_f32 v[62:63], v[62:63], v[46:47]
    v_cvt_pk_bf16_f32 v192, v56, v57
    v_cvt_pk_bf16_f32 v193, v58, v59
    v_cvt_pk_bf16_f32 v194, v60, v61
    v_cvt_pk_bf16_f32 v195, v62, v63
    buffer_store_dwordx4 v[192:195], v221, s[52:55], s17 offen offset:256 sc1
    v_pk_fma_f32 v[64:65], v[160:161], v[248:249], v[64:65] op_sel_hi:[1,0,1]
    v_pk_fma_f32 v[66:67], v[162:163], v[248:249], v[66:67] op_sel_hi:[1,0,1]
    v_pk_fma_f32 v[68:69], v[164:165], v[248:249], v[68:69] op_sel_hi:[1,0,1]
    v_pk_fma_f32 v[70:71], v[166:167], v[248:249], v[70:71] op_sel_hi:[1,0,1]
    v_pk_mul_f32 v[64:65], v[64:65], v[248:249] op_sel:[0,1] op_sel_hi:[1,1]
    v_pk_mul_f32 v[66:67], v[66:67], v[248:249] op_sel:[0,1] op_sel_hi:[1,1]
    v_pk_mul_f32 v[68:69], v[68:69], v[248:249] op_sel:[0,1] op_sel_hi:[1,1]
    v_pk_mul_f32 v[70:71], v[70:71], v[248:249] op_sel:[0,1] op_sel_hi:[1,1]
    v_exp_f32 v64, v64
    v_exp_f32 v65, v65
    v_exp_f32 v66, v66
    v_exp_f32 v67, v67
    v_exp_f32 v68, v68
    v_exp_f32 v69, v69
    v_exp_f32 v70, v70
    v_exp_f32 v71, v71
    buffer_load_dwordx4 a[228:231], v238, s[56:59], s100 offen offset:2048 sc1
    v_pk_fma_f32 v[80:81], v[176:177], v[248:249], v[80:81] op_sel_hi:[1,0,1]
    v_pk_fma_f32 v[82:83], v[178:179], v[248:249], v[82:83] op_sel_hi:[1,0,1]
    v_pk_fma_f32 v[84:85], v[200:201], v[248:249], v[84:85] op_sel_hi:[1,0,1]
    v_pk_fma_f32 v[86:87], v[202:203], v[248:249], v[86:87] op_sel_hi:[1,0,1]
    v_pk_fma_f32 v[64:65], v[64:65], v[222:223], v[222:223] op_sel:[0,0,0] op_sel_hi:[1,0,0]
    v_pk_fma_f32 v[66:67], v[66:67], v[222:223], v[222:223] op_sel:[0,0,0] op_sel_hi:[1,0,0]
    v_pk_fma_f32 v[68:69], v[68:69], v[222:223], v[222:223] op_sel:[0,0,0] op_sel_hi:[1,0,0]
    v_pk_fma_f32 v[70:71], v[70:71], v[222:223], v[222:223] op_sel:[0,0,0] op_sel_hi:[1,0,0]
    v_rcp_f32 v64, v64
    v_rcp_f32 v65, v65
    v_rcp_f32 v66, v66
    v_rcp_f32 v67, v67
    v_rcp_f32 v68, v68
    v_rcp_f32 v69, v69
    v_rcp_f32 v70, v70
    v_rcp_f32 v71, v71
    buffer_load_dwordx4 a[232:235], v238, s[56:59], s100 offen offset:3072 sc1
    v_pk_mul_f32 v[80:81], v[80:81], v[64:65]
    v_pk_mul_f32 v[82:83], v[82:83], v[66:67]
    v_pk_mul_f32 v[84:85], v[84:85], v[68:69]
    v_pk_mul_f32 v[86:87], v[86:87], v[70:71]
    v_cvt_pk_bf16_f32 v180, v80, v81
    v_cvt_pk_bf16_f32 v181, v82, v83
    v_cvt_pk_bf16_f32 v182, v84, v85
    v_cvt_pk_bf16_f32 v183, v86, v87
    buffer_store_dwordx4 v[180:183], v221, s[52:55], s18 offen offset:0 sc1
    v_pk_fma_f32 v[72:73], v[168:169], v[248:249], v[72:73] op_sel_hi:[1,0,1]
    v_pk_fma_f32 v[74:75], v[170:171], v[248:249], v[74:75] op_sel_hi:[1,0,1]
    v_pk_fma_f32 v[76:77], v[172:173], v[248:249], v[76:77] op_sel_hi:[1,0,1]
    v_pk_fma_f32 v[78:79], v[174:175], v[248:249], v[78:79] op_sel_hi:[1,0,1]
    v_pk_mul_f32 v[72:73], v[72:73], v[248:249] op_sel:[0,1] op_sel_hi:[1,1]
    v_pk_mul_f32 v[74:75], v[74:75], v[248:249] op_sel:[0,1] op_sel_hi:[1,1]
    v_pk_mul_f32 v[76:77], v[76:77], v[248:249] op_sel:[0,1] op_sel_hi:[1,1]
    v_pk_mul_f32 v[78:79], v[78:79], v[248:249] op_sel:[0,1] op_sel_hi:[1,1]
    v_exp_f32 v72, v72
    v_exp_f32 v73, v73
    v_exp_f32 v74, v74
    v_exp_f32 v75, v75
    v_exp_f32 v76, v76
    v_exp_f32 v77, v77
    v_exp_f32 v78, v78
    v_exp_f32 v79, v79
    s_add_u32 s100, s100, 4096
    buffer_load_dwordx4 a[236:239], v238, s[56:59], s100 offen offset:0 sc1
    v_pk_fma_f32 v[88:89], v[204:205], v[248:249], v[88:89] op_sel_hi:[1,0,1]
    v_pk_fma_f32 v[90:91], v[206:207], v[248:249], v[90:91] op_sel_hi:[1,0,1]
    v_pk_fma_f32 v[92:93], v[224:225], v[248:249], v[92:93] op_sel_hi:[1,0,1]
    v_pk_fma_f32 v[94:95], v[226:227], v[248:249], v[94:95] op_sel_hi:[1,0,1]
    v_pk_fma_f32 v[72:73], v[72:73], v[222:223], v[222:223] op_sel:[0,0,0] op_sel_hi:[1,0,0]
    v_pk_fma_f32 v[74:75], v[74:75], v[222:223], v[222:223] op_sel:[0,0,0] op_sel_hi:[1,0,0]
    v_pk_fma_f32 v[76:77], v[76:77], v[222:223], v[222:223] op_sel:[0,0,0] op_sel_hi:[1,0,0]
    v_pk_fma_f32 v[78:79], v[78:79], v[222:223], v[222:223] op_sel:[0,0,0] op_sel_hi:[1,0,0]
    v_rcp_f32 v72, v72
    v_rcp_f32 v73, v73
    v_rcp_f32 v74, v74
    v_rcp_f32 v75, v75
    v_rcp_f32 v76, v76
    v_rcp_f32 v77, v77
    v_rcp_f32 v78, v78
    v_rcp_f32 v79, v79
    s_add_u32 m0, s6, 16384
    s_add_u32 s100, s70, 81920
    buffer_load_dwordx4 v238, s[56:59], s100 offen offset:0 sc1 lds
    v_pk_mul_f32 v[88:89], v[88:89], v[72:73]
    v_pk_mul_f32 v[90:91], v[90:91], v[74:75]
    v_pk_mul_f32 v[92:93], v[92:93], v[76:77]
    v_pk_mul_f32 v[94:95], v[94:95], v[78:79]
    v_cvt_pk_bf16_f32 v184, v88, v89
    v_cvt_pk_bf16_f32 v185, v90, v91
    v_cvt_pk_bf16_f32 v186, v92, v93
    v_cvt_pk_bf16_f32 v187, v94, v95
    buffer_store_dwordx4 v[184:187], v221, s[52:55], s18 offen offset:256 sc1
    v_pk_fma_f32 v[96:97], v[160:161], v[250:251], v[96:97] op_sel_hi:[1,0,1]
    v_pk_fma_f32 v[98:99], v[162:163], v[250:251], v[98:99] op_sel_hi:[1,0,1]
    v_pk_fma_f32 v[100:101], v[164:165], v[250:251], v[100:101] op_sel_hi:[1,0,1]
    v_pk_fma_f32 v[102:103], v[166:167], v[250:251], v[102:103] op_sel_hi:[1,0,1]
    v_pk_mul_f32 v[96:97], v[96:97], v[250:251] op_sel:[0,1] op_sel_hi:[1,1]
    v_pk_mul_f32 v[98:99], v[98:99], v[250:251] op_sel:[0,1] op_sel_hi:[1,1]
    v_pk_mul_f32 v[100:101], v[100:101], v[250:251] op_sel:[0,1] op_sel_hi:[1,1]
    v_pk_mul_f32 v[102:103], v[102:103], v[250:251] op_sel:[0,1] op_sel_hi:[1,1]
    v_exp_f32 v96, v96
    v_exp_f32 v97, v97
    v_exp_f32 v98, v98
    v_exp_f32 v99, v99
    v_exp_f32 v100, v100
    v_exp_f32 v101, v101
    v_exp_f32 v102, v102
    v_exp_f32 v103, v103
    buffer_load_dwordx4 v238, s[56:59], s100 offen offset:1024 sc1 lds
    v_pk_fma_f32 v[112:113], v[176:177], v[250:251], v[112:113] op_sel_hi:[1,0,1]
    v_pk_fma_f32 v[114:115], v[178:179], v[250:251], v[114:115] op_sel_hi:[1,0,1]
    v_pk_fma_f32 v[116:117], v[200:201], v[250:251], v[116:117] op_sel_hi:[1,0,1]
    v_pk_fma_f32 v[118:119], v[202:203], v[250:251], v[118:119] op_sel_hi:[1,0,1]
    v_pk_fma_f32 v[96:97], v[96:97], v[222:223], v[222:223] op_sel:[0,1,1] op_sel_hi:[1,1,1]
    v_pk_fma_f32 v[98:99], v[98:99], v[222:223], v[222:223] op_sel:[0,1,1] op_sel_hi:[1,1,1]
    v_pk_fma_f32 v[100:101], v[100:101], v[222:223], v[222:223] op_sel:[0,1,1] op_sel_hi:[1,1,1]
    v_pk_fma_f32 v[102:103], v[102:103], v[222:223], v[222:223] op_sel:[0,1,1] op_sel_hi:[1,1,1]
    v_rcp_f32 v96, v96
    v_rcp_f32 v97, v97
    v_rcp_f32 v98, v98
    v_rcp_f32 v99, v99
    v_rcp_f32 v100, v100
    v_rcp_f32 v101, v101
    v_rcp_f32 v102, v102
    v_rcp_f32 v103, v103
    buffer_load_dwordx4 v238, s[56:59], s100 offen offset:2048 sc1 lds
    v_pk_mul_f32 v[112:113], v[112:113], v[96:97]
    v_pk_mul_f32 v[114:115], v[114:115], v[98:99]
    v_pk_mul_f32 v[116:117], v[116:117], v[100:101]
    v_pk_mul_f32 v[118:119], v[118:119], v[102:103]
    v_cvt_pk_bf16_f32 v188, v112, v113
    v_cvt_pk_bf16_f32 v189, v114, v115
    v_cvt_pk_bf16_f32 v190, v116, v117
    v_cvt_pk_bf16_f32 v191, v118, v119
    buffer_store_dwordx4 v[188:191], v221, s[52:55], s19 offen offset:0 sc1
    v_pk_fma_f32 v[104:105], v[168:169], v[250:251], v[104:105] op_sel_hi:[1,0,1]
    v_pk_fma_f32 v[106:107], v[170:171], v[250:251], v[106:107] op_sel_hi:[1,0,1]
    v_pk_fma_f32 v[108:109], v[172:173], v[250:251], v[108:109] op_sel_hi:[1,0,1]
    v_pk_fma_f32 v[110:111], v[174:175], v[250:251], v[110:111] op_sel_hi:[1,0,1]
    v_pk_mul_f32 v[104:105], v[104:105], v[250:251] op_sel:[0,1] op_sel_hi:[1,1]
    v_pk_mul_f32 v[106:107], v[106:107], v[250:251] op_sel:[0,1] op_sel_hi:[1,1]
    v_pk_mul_f32 v[108:109], v[108:109], v[250:251] op_sel:[0,1] op_sel_hi:[1,1]
    v_pk_mul_f32 v[110:111], v[110:111], v[250:251] op_sel:[0,1] op_sel_hi:[1,1]
    v_exp_f32 v104, v104
    v_exp_f32 v105, v105
    v_exp_f32 v106, v106
    v_exp_f32 v107, v107
    v_exp_f32 v108, v108
    v_exp_f32 v109, v109
    v_exp_f32 v110, v110
    v_exp_f32 v111, v111
    buffer_load_dwordx4 v238, s[56:59], s100 offen offset:3072 sc1 lds
    v_pk_fma_f32 v[120:121], v[204:205], v[250:251], v[120:121] op_sel_hi:[1,0,1]
    v_pk_fma_f32 v[122:123], v[206:207], v[250:251], v[122:123] op_sel_hi:[1,0,1]
    v_pk_fma_f32 v[124:125], v[224:225], v[250:251], v[124:125] op_sel_hi:[1,0,1]
    v_pk_fma_f32 v[126:127], v[226:227], v[250:251], v[126:127] op_sel_hi:[1,0,1]
    v_pk_fma_f32 v[104:105], v[104:105], v[222:223], v[222:223] op_sel:[0,1,1] op_sel_hi:[1,1,1]
    v_pk_fma_f32 v[106:107], v[106:107], v[222:223], v[222:223] op_sel:[0,1,1] op_sel_hi:[1,1,1]
    v_pk_fma_f32 v[108:109], v[108:109], v[222:223], v[222:223] op_sel:[0,1,1] op_sel_hi:[1,1,1]
    v_pk_fma_f32 v[110:111], v[110:111], v[222:223], v[222:223] op_sel:[0,1,1] op_sel_hi:[1,1,1]
    v_rcp_f32 v104, v104
    v_rcp_f32 v105, v105
    v_rcp_f32 v106, v106
    v_rcp_f32 v107, v107
    v_rcp_f32 v108, v108
    v_rcp_f32 v109, v109
    v_rcp_f32 v110, v110
    v_rcp_f32 v111, v111
    s_add_u32 m0, s6, 20480
    s_add_u32 s100, s100, 4096
    buffer_load_dwordx4 v238, s[56:59], s100 offen offset:0 sc1 lds
    v_pk_mul_f32 v[120:121], v[120:121], v[104:105]
    v_pk_mul_f32 v[122:123], v[122:123], v[106:107]
    v_pk_mul_f32 v[124:125], v[124:125], v[108:109]
    v_pk_mul_f32 v[126:127], v[126:127], v[110:111]
    v_cvt_pk_bf16_f32 v192, v120, v121
    v_cvt_pk_bf16_f32 v193, v122, v123
    v_cvt_pk_bf16_f32 v194, v124, v125
    v_cvt_pk_bf16_f32 v195, v126, v127
    buffer_store_dwordx4 v[192:195], v221, s[52:55], s19 offen offset:256 sc1
    s_add_u32 s100, s70, 40960
    buffer_load_dwordx4 v[160:163], v238, s[56:59], s100 offen offset:0 sc1
    buffer_load_dwordx4 v[164:167], v238, s[56:59], s100 offen offset:1024 sc1
    buffer_load_dwordx4 v[168:171], v238, s[56:59], s100 offen offset:2048 sc1
    buffer_load_dwordx4 v[172:175], v238, s[56:59], s100 offen offset:3072 sc1
    v_mov_b32 v239, s83
    s_mov_b64 exec, 1
    s_waitcnt vmcnt(4)
    buffer_store_dword v239, off, s[56:59], s67 sc1
    s_mov_b64 exec, -1
    s_mov_b32 s48, s24
    s_mov_b32 s49, s25
    s_mov_b32 s50, 1280
    s_mov_b32 s51, 0x20000
    s_lshl_b32 s73, s4, 6
    s_lshl_b32 s75, s64, 2
    s_mul_i32 s74, s5, 20
    s_add_u32 s73, s73, s75
    s_mul_i32 s75, s64, 1344
    v_lshrrev_b32 v239, 4, v233
    v_and_b32 v240, 15, v233
    v_mul_u32_u24 v241, 336, v239
    v_lshl_add_u32 v241, v240, 4, v241
    v_add_u32 v222, s75, v241
    v_add_u32 v239, s73, v239
    v_add_u32 v240, s74, v240
    v_mul_u32_u24 v241, 160, v239
    v_add_u32 v241, v241, v240
    v_lshlrev_b32 v220, 4, v241
    v_lshlrev_b32 v241, 3, v241
    v_lshlrev_b32 v240, 3, v240
    s_mov_b32 s76, 0
    buffer_load_dwordx2 v[0:1], v241, s[40:43], s76 offen
    s_mov_b32 s76, 20480
    buffer_load_dwordx2 v[2:3], v241, s[40:43], s76 offen
    s_mov_b32 s76, 40960
    buffer_load_dwordx2 v[4:5], v241, s[40:43], s76 offen
    s_mov_b32 s76, 61440
    buffer_load_dwordx2 v[6:7], v241, s[40:43], s76 offen
    buffer_load_dwordx2 v[10:11], v240, s[48:51], 0 offen
    v_and_b32 v239, 48, v233
    v_bfe_u32 v240, v233, 2, 2
    v_add_u32 v239, v239, v240
    v_and_b32 v240, 3, v233
    v_add_u32 v240, 16, v240
    v_mul_u32_u24 v241, 336, v239
    v_lshl_add_u32 v241, v240, 4, v241
    v_add_u32 v224, s75, v241
    v_add_u32 v239, s73, v239
    v_add_u32 v240, s74, v240
    v_mul_u32_u24 v241, 160, v239
    v_add_u32 v241, v241, v240
    v_lshlrev_b32 v221, 4, v241
    v_lshlrev_b32 v241, 3, v241
    v_lshlrev_b32 v240, 3, v240
    buffer_load_dwordx2 v[8:9], v241, s[40:43], 0 offen
    v_lshlrev_b32 v239, 3, v239
    s_mov_b32 s76, 4194304
    buffer_load_dwordx2 v[14:15], v239, s[56:59], s76 offen sc1
    buffer_load_dwordx2 v[12:13], v240, s[48:51], 0 offen
    s_mov_b32 s44, s34
    s_mov_b32 s45, s35
    s_mov_b32 s46, 5242880
    s_mov_b32 s47, 0x20000
    v_add_u32 v223, 43008, v222
    s_mul_i32 s75, s64, 21504
    v_and_b32 v230, 15, v233
    v_mul_u32_u24 v230, 336, v230
    v_and_b32 v239, 48, v233
    v_add3_u32 v230, v230, v239, s75
    s_add_u32 s100, s100, 4096
    buffer_load_dwordx4 v[176:179], v238, s[56:59], s100 offen offset:0 sc1
    s_add_u32 s100, s70, 61440
    buffer_load_dwordx4 v[180:183], v238, s[56:59], s100 offen offset:0 sc1
    buffer_load_dwordx4 v[184:187], v238, s[56:59], s100 offen offset:1024 sc1
    buffer_load_dwordx4 v[188:191], v238, s[56:59], s100 offen offset:2048 sc1
    buffer_load_dwordx4 v[192:195], v238, s[56:59], s100 offen offset:3072 sc1
    s_add_u32 s100, s100, 4096
    buffer_load_dwordx4 v[196:199], v238, s[56:59], s100 offen offset:0 sc1
    s_add_u32 m0, s71, 20480
    s_add_u32 s100, s70, 102400
    buffer_load_dwordx4 v238, s[56:59], s100 offen offset:0 sc1 lds
    buffer_load_dwordx4 v238, s[56:59], s100 offen offset:1024 sc1 lds
    buffer_load_dwordx4 v238, s[56:59], s100 offen offset:2048 sc1 lds
    buffer_load_dwordx4 v238, s[56:59], s100 offen offset:3072 sc1 lds
    s_add_u32 m0, s71, 24576
    s_add_u32 s100, s100, 4096
    buffer_load_dwordx4 v238, s[56:59], s100 offen offset:0 sc1 lds
    s_add_u32 m0, s6, 0
    s_nop 0
    s_add_u32 s100, s70, 122880
    buffer_load_dwordx4 v238, s[56:59], s100 offen offset:0 sc1 lds
    buffer_load_dwordx4 v238, s[56:59], s100 offen offset:1024 sc1 lds
    buffer_load_dwordx4 v238, s[56:59], s100 offen offset:2048 sc1 lds
    buffer_load_dwordx4 v238, s[56:59], s100 offen offset:3072 sc1 lds
    s_add_u32 m0, s6, 4096
    s_add_u32 s100, s100, 4096
    buffer_load_dwordx4 v238, s[56:59], s100 offen offset:0 sc1 lds
    s_add_u32 m0, s71, 40960
    s_add_u32 s100, s70, 143360
    buffer_load_dwordx4 v238, s[56:59], s100 offen offset:0 sc1 lds
    buffer_load_dwordx4 v238, s[56:59], s100 offen offset:1024 sc1 lds
    buffer_load_dwordx4 v238, s[56:59], s100 offen offset:2048 sc1 lds
    buffer_load_dwordx4 v238, s[56:59], s100 offen offset:3072 sc1 lds
    s_add_u32 m0, s71, 45056
    s_add_u32 s100, s100, 4096
    buffer_load_dwordx4 v238, s[56:59], s100 offen offset:0 sc1 lds
    s_add_u32 m0, s6, 32768
    s_add_u32 s100, s70, 163840
    buffer_load_dwordx4 v238, s[56:59], s100 offen offset:0 sc1 lds
    buffer_load_dwordx4 v238, s[56:59], s100 offen offset:1024 sc1 lds
    buffer_load_dwordx4 v238, s[56:59], s100 offen offset:2048 sc1 lds
    buffer_load_dwordx4 v238, s[56:59], s100 offen offset:3072 sc1 lds
    s_add_u32 m0, s6, 36864
    s_add_u32 s100, s100, 4096
    buffer_load_dwordx4 v238, s[56:59], s100 offen offset:0 sc1 lds
    s_add_u32 m0, s71, 0
    s_nop 0
    s_add_u32 s100, s70, 184320
    buffer_load_dwordx4 v238, s[56:59], s100 offen offset:0 sc1 lds
    buffer_load_dwordx4 v238, s[56:59], s100 offen offset:1024 sc1 lds
    buffer_load_dwordx4 v238, s[56:59], s100 offen offset:2048 sc1 lds
    buffer_load_dwordx4 v238, s[56:59], s100 offen offset:3072 sc1 lds
    s_add_u32 m0, s71, 4096
    s_add_u32 s100, s100, 4096
    buffer_load_dwordx4 v238, s[56:59], s100 offen offset:0 sc1 lds
    s_add_u32 m0, s6, 21504
    s_add_u32 s100, s70, 204800
    buffer_load_dwordx4 v238, s[56:59], s100 offen offset:0 sc1 lds
    buffer_load_dwordx4 v238, s[56:59], s100 offen offset:1024 sc1 lds
    buffer_load_dwordx4 v238, s[56:59], s100 offen offset:2048 sc1 lds
    s_add_u32 m0, s6, 2048
    s_nop 0
    buffer_load_dwordx4 v238, s[56:59], s100 offen offset:3072 sc1 lds
    s_add_u32 m0, s6, 6144
    s_add_u32 s100, s100, 4096
    buffer_load_dwordx4 v238, s[56:59], s100 offen offset:0 sc1 lds
    s_mul_i32 s100, s30, 160
    s_add_u32 s100, s100, s9
    s_add_u32 s100, s100, 10240
    buffer_load_dwordx4 a[180:183], v238, s[56:59], s100 offen offset:0 sc1
    buffer_load_dwordx4 a[184:187], v238, s[56:59], s100 offen offset:1024 sc1
    buffer_load_dwordx4 a[188:191], v238, s[56:59], s100 offen offset:2048 sc1
    buffer_load_dwordx4 a[192:195], v238, s[56:59], s100 offen offset:3072 sc1
    s_add_u32 s100, s100, 4096
    buffer_load_dwordx4 a[196:199], v238, s[56:59], s100 offen offset:0 sc1
    s_branch L_p2_g
L_sum:
    s_waitcnt lgkmcnt(0)
    v_mfma_f32_32x32x16_bf16 v[0:15], v[200:203], v[160:163], v[0:15]
    ds_read_b64_tr_b16 v[208:209], v220 offset:2048
    ds_read_b64_tr_b16 v[210:211], v220 offset:2304
    v_lshlrev_b32 v234, 16, v200
    v_and_b32 v237, 0xffff0000, v200
    v_add_f32 v234, v234, v237
    v_mfma_f32_32x32x16_bf16 v[16:31], v[204:207], v[160:163], v[16:31]
    ds_read_b64_tr_b16 v[212:213], v220 offset:10240
    buffer_load_dwordx4 v231, s[44:47], s68 offen offset:2048 lds
    v_lshlrev_b32 v235, 16, v204
    v_and_b32 v237, 0xffff0000, v204
    v_mfma_f32_32x32x16_bf16 v[32:47], v[200:203], v[164:167], v[32:47]
    ds_read_b64_tr_b16 v[214:215], v220 offset:10496
    ds_read_b128 v[180:183], v217 offset:40960
    v_add_f32 v235, v235, v237
    v_lshlrev_b32 v236, 16, v201
    v_mfma_f32_32x32x16_bf16 v[48:63], v[204:207], v[164:167], v[48:63]
    ds_read_b128 v[184:187], v217 offset:41984
    buffer_load_dwordx4 v232, s[44:47], s68 offen offset:3072 lds
    v_and_b32 v237, 0xffff0000, v201
    v_add_f32 v234, v234, v236
    v_mfma_f32_32x32x16_bf16 v[64:79], v[200:203], v[168:171], v[64:79]
    ds_read_b128 v[188:191], v217 offset:43008
    ds_read_b128 v[192:195], v217 offset:44032
    v_add_f32 v234, v234, v237
    v_lshlrev_b32 v236, 16, v205
    v_and_b32 v237, 0xffff0000, v205
    v_mfma_f32_32x32x16_bf16 v[80:95], v[204:207], v[168:171], v[80:95]
    ds_read_b128 v[196:199], v217 offset:45056
    s_add_u32 m0, s72, 36864
    s_add_u32 s68, s26, 110592
    buffer_load_dwordx4 v229, s[44:47], s68 offen offset:0 lds
    v_add_f32 v235, v235, v236
    v_add_f32 v235, v235, v237
    v_mfma_f32_32x32x16_bf16 v[96:111], v[200:203], v[172:175], v[96:111]
    v_lshlrev_b32 v236, 16, v202
    v_and_b32 v237, 0xffff0000, v202
    v_add_f32 v234, v234, v236
    v_add_f32 v234, v234, v237
    v_lshlrev_b32 v236, 16, v206
    v_mfma_f32_32x32x16_bf16 v[112:127], v[204:207], v[172:175], v[112:127]
    buffer_load_dwordx4 v230, s[44:47], s68 offen offset:1024 lds
    v_and_b32 v237, 0xffff0000, v206
    v_add_f32 v235, v235, v236
    v_mfma_f32_32x32x16_bf16 v[128:143], v[200:203], v[176:179], v[128:143]
    v_add_f32 v235, v235, v237
    v_lshlrev_b32 v236, 16, v203
    v_and_b32 v237, 0xffff0000, v203
    v_add_f32 v234, v234, v236
    v_add_f32 v234, v234, v237
    v_mfma_f32_32x32x16_bf16 v[144:159], v[204:207], v[176:179], v[144:159]
    v_cmp_eq_u32 vcc, 0, v243
    s_cbranch_vccnz L_slow_non_glux
L_go_non_glux:
    v_readfirstlane_b32 s83, v243
    v_lshlrev_b32 v236, 16, v207
    v_and_b32 v237, 0xffff0000, v207
    v_add_f32 v235, v235, v236
    v_add_f32 v235, v235, v237
    s_waitcnt lgkmcnt(0)
    v_mfma_f32_32x32x16_bf16 v[0:15], v[208:211], v[180:183], v[0:15]
    ds_read_b64_tr_b16 v[200:201], v220 offset:4096
    ds_read_b64_tr_b16 v[202:203], v220 offset:4352
    s_waitcnt vmcnt(7)
    v_lshlrev_b32 v236, 16, v208
    v_and_b32 v237, 0xffff0000, v208
    v_add_f32 v234, v234, v236
    v_mfma_f32_32x32x16_bf16 v[16:31], v[212:215], v[180:183], v[16:31]
    ds_read_b64_tr_b16 v[204:205], v220 offset:12288
    buffer_load_dwordx4 v231, s[44:47], s68 offen offset:2048 lds
    v_add_f32 v234, v234, v237
    v_lshlrev_b32 v236, 16, v212
    v_and_b32 v237, 0xffff0000, v212
    v_mfma_f32_32x32x16_bf16 v[32:47], v[208:211], v[184:187], v[32:47]
    ds_read_b64_tr_b16 v[206:207], v220 offset:12544
    ds_read_b128 v[160:163], v218 offset:40960
    v_add_f32 v235, v235, v236
    v_add_f32 v235, v235, v237
    v_lshlrev_b32 v236, 16, v209
    v_and_b32 v237, 0xffff0000, v209
    v_mfma_f32_32x32x16_bf16 v[48:63], v[212:215], v[184:187], v[48:63]
    ds_read_b128 v[164:167], v218 offset:41984
    buffer_load_dwordx4 v232, s[44:47], s68 offen offset:3072 lds
    v_add_f32 v234, v234, v236
    v_add_f32 v234, v234, v237
    v_lshlrev_b32 v236, 16, v213
    v_mfma_f32_32x32x16_bf16 v[64:79], v[208:211], v[188:191], v[64:79]
    ds_read_b128 v[168:171], v218 offset:43008
    ds_read_b128 v[172:175], v218 offset:44032
    s_barrier
    v_and_b32 v237, 0xffff0000, v213
    v_add_f32 v235, v235, v236
    v_add_f32 v235, v235, v237
    v_mfma_f32_32x32x16_bf16 v[80:95], v[212:215], v[188:191], v[80:95]
    ds_read_b128 v[176:179], v218 offset:45056
    s_add_u32 m0, s71, 24576
    s_add_u32 s3, s3, 128
    s_cmp_eq_u32 s3, 1280
    s_cselect_b32 s3, 0, s3
    s_mul_i32 s26, s3, 1728
    s_add_u32 s68, s3, 0
    buffer_load_dwordx4 v228, s[40:43], s68 offen lds
    v_lshlrev_b32 v236, 16, v210
    v_and_b32 v237, 0xffff0000, v210
    v_mfma_f32_32x32x16_bf16 v[96:111], v[208:211], v[192:195], v[96:111]
    s_lshl_b32 s73, s2, 4
    s_add_u32 s73, s73, 4259840
    v_add_f32 v234, v234, v236
    v_add_f32 v234, v234, v237
    v_lshlrev_b32 v236, 16, v214
    v_and_b32 v237, 0xffff0000, v214
    v_mfma_f32_32x32x16_bf16 v[112:127], v[212:215], v[192:195], v[112:127]
    s_add_u32 m0, s71, 20480
    s_nop 0
    buffer_load_dwordx4 v224, s[40:43], s68 offen offset:0 lds
    v_add_f32 v235, v235, v236
    v_add_f32 v235, v235, v237
    v_lshlrev_b32 v236, 16, v211
    v_and_b32 v237, 0xffff0000, v211
    v_mfma_f32_32x32x16_bf16 v[128:143], v[208:211], v[196:199], v[128:143]
    s_cmp_eq_u32 s64, 0
    s_cselect_b32 s73, s73, 134217728
    v_mov_b32 v241, s83
    v_add_f32 v234, v234, v236
    v_add_f32 v234, v234, v237
    v_lshlrev_b32 v236, 16, v215
    v_mfma_f32_32x32x16_bf16 v[144:159], v[212:215], v[196:199], v[144:159]
    s_mov_b64 exec, 1
    buffer_store_dword v241, off, s[56:59], s73 sc1
    s_mov_b64 exec, -1
    v_and_b32 v237, 0xffff0000, v215
    v_add_f32 v235, v235, v236
    v_add_f32 v235, v235, v237
    s_waitcnt lgkmcnt(0)
    v_mfma_f32_32x32x16_bf16 v[0:15], v[200:203], v[160:163], v[0:15]
    ds_read_b64_tr_b16 v[208:209], v220 offset:6144
    ds_read_b64_tr_b16 v[210:211], v220 offset:6400
    v_lshlrev_b32 v236, 16, v200
    v_and_b32 v237, 0xffff0000, v200
    v_add_f32 v234, v234, v236
    v_mfma_f32_32x32x16_bf16 v[16:31], v[204:207], v[160:163], v[16:31]
    ds_read_b64_tr_b16 v[212:213], v220 offset:14336
    buffer_load_dwordx4 v225, s[40:43], s68 offen offset:1024 lds
    v_add_f32 v234, v234, v237
    v_mfma_f32_32x32x16_bf16 v[32:47], v[200:203], v[164:167], v[32:47]
    ds_read_b64_tr_b16 v[214:215], v220 offset:14592
    ds_read_b128 v[180:183], v219 offset:40960
    v_lshlrev_b32 v236, 16, v204
    v_and_b32 v237, 0xffff0000, v204
    v_add_f32 v235, v235, v236
    v_mfma_f32_32x32x16_bf16 v[48:63], v[204:207], v[164:167], v[48:63]
    ds_read_b128 v[184:187], v219 offset:41984
    v_add_f32 v235, v235, v237
    v_lshlrev_b32 v236, 16, v201
    v_and_b32 v237, 0xffff0000, v201
    v_add_f32 v234, v234, v236
    v_mfma_f32_32x32x16_bf16 v[64:79], v[200:203], v[168:171], v[64:79]
    ds_read_b128 v[188:191], v219 offset:43008
    ds_read_b128 v[192:195], v219 offset:44032
    buffer_load_dwordx4 v226, s[40:43], s68 offen offset:2048 lds
    v_add_f32 v234, v234, v237
    v_mfma_f32_32x32x16_bf16 v[80:95], v[204:207], v[168:171], v[80:95]
    ds_read_b128 v[196:199], v219 offset:45056
    v_lshlrev_b32 v236, 16, v205
    v_and_b32 v237, 0xffff0000, v205
    v_add_f32 v235, v235, v236
    v_mfma_f32_32x32x16_bf16 v[96:111], v[200:203], v[172:175], v[96:111]
    v_add_f32 v235, v235, v237
    v_lshlrev_b32 v236, 16, v202
    v_and_b32 v237, 0xffff0000, v202
    v_add_f32 v234, v234, v236
    v_add_f32 v234, v234, v237
    v_mfma_f32_32x32x16_bf16 v[112:127], v[204:207], v[172:175], v[112:127]
    buffer_load_dwordx4 v227, s[40:43], s68 offen offset:3072 lds
    v_lshlrev_b32 v236, 16, v206
    v_and_b32 v237, 0xffff0000, v206
    v_add_f32 v235, v235, v236
    v_mfma_f32_32x32x16_bf16 v[128:143], v[200:203], v[176:179], v[128:143]
    v_add_f32 v235, v235, v237
    v_lshlrev_b32 v236, 16, v203
    v_and_b32 v237, 0xffff0000, v203
    v_add_f32 v234, v234, v236
    v_mfma_f32_32x32x16_bf16 v[144:159], v[204:207], v[176:179], v[144:159]
    v_add_f32 v234, v234, v237
    v_lshlrev_b32 v236, 16, v207
    v_and_b32 v237, 0xffff0000, v207
    v_add_f32 v235, v235, v236
    v_add_f32 v235, v235, v237
    s_waitcnt lgkmcnt(0)
    v_mfma_f32_32x32x16_bf16 v[0:15], v[208:211], v[180:183], v[0:15]
    s_waitcnt vmcnt(6)
    s_barrier
    ds_read_b64_tr_b16 v[200:201], v220 offset:32768
    ds_read_b64_tr_b16 v[202:203], v220 offset:33024
    v_lshlrev_b32 v236, 16, v208
    v_and_b32 v237, 0xffff0000, v208
    v_mfma_f32_32x32x16_bf16 v[16:31], v[212:215], v[180:183], v[16:31]
    ds_read_b64_tr_b16 v[204:205], v220 offset:40960
    s_add_u32 m0, s72, 16384
    s_add_u32 s68, s26, 0
    buffer_load_dwordx4 v229, s[44:47], s68 offen offset:0 lds
    v_add_f32 v234, v234, v236
    v_add_f32 v234, v234, v237
    v_mfma_f32_32x32x16_bf16 v[32:47], v[208:211], v[184:187], v[32:47]
    ds_read_b64_tr_b16 v[206:207], v220 offset:41216
    ds_read_b128 v[160:163], v216 offset:0
    v_lshlrev_b32 v236, 16, v212
    v_and_b32 v237, 0xffff0000, v212
    v_add_f32 v235, v235, v236
    v_mfma_f32_32x32x16_bf16 v[48:63], v[212:215], v[184:187], v[48:63]
    ds_read_b128 v[164:167], v216 offset:1024
    buffer_load_dwordx4 v230, s[44:47], s68 offen offset:1024 lds
    v_add_f32 v235, v235, v237
    v_lshlrev_b32 v236, 16, v209
    v_mfma_f32_32x32x16_bf16 v[64:79], v[208:211], v[188:191], v[64:79]
    ds_read_b128 v[168:171], v216 offset:2048
    ds_read_b128 v[172:175], v216 offset:3072
    v_and_b32 v237, 0xffff0000, v209
    v_add_f32 v234, v234, v236
    v_add_f32 v234, v234, v237
    v_mfma_f32_32x32x16_bf16 v[80:95], v[212:215], v[188:191], v[80:95]
    ds_read_b128 v[176:179], v216 offset:4096
    buffer_load_dwordx4 v231, s[44:47], s68 offen offset:2048 lds
    v_lshlrev_b32 v236, 16, v213
    v_and_b32 v237, 0xffff0000, v213
    v_mfma_f32_32x32x16_bf16 v[96:111], v[208:211], v[192:195], v[96:111]
    v_add_f32 v235, v235, v236
    v_add_f32 v235, v235, v237
    v_lshlrev_b32 v236, 16, v210
    v_and_b32 v237, 0xffff0000, v210
    v_add_f32 v234, v234, v236
    v_mfma_f32_32x32x16_bf16 v[112:127], v[212:215], v[192:195], v[112:127]
    buffer_load_dwordx4 v232, s[44:47], s68 offen offset:3072 lds
    v_add_f32 v234, v234, v237
    v_lshlrev_b32 v236, 16, v214
    v_and_b32 v237, 0xffff0000, v214
    v_mfma_f32_32x32x16_bf16 v[128:143], v[208:211], v[196:199], v[128:143]
    v_add_f32 v235, v235, v236
    v_add_f32 v235, v235, v237
    v_lshlrev_b32 v236, 16, v211
    v_and_b32 v237, 0xffff0000, v211
    v_add_f32 v234, v234, v236
    v_mfma_f32_32x32x16_bf16 v[144:159], v[212:215], v[196:199], v[144:159]
    v_add_f32 v234, v234, v237
    v_lshlrev_b32 v236, 16, v215
    v_and_b32 v237, 0xffff0000, v215
    v_add_f32 v235, v235, v236
    v_add_f32 v235, v235, v237
    s_waitcnt lgkmcnt(0)
    v_mfma_f32_32x32x16_bf16 v[0:15], v[200:203], v[160:163], v[0:15]
    ds_read_b64_tr_b16 v[208:209], v220 offset:34816
    ds_read_b64_tr_b16 v[210:211], v220 offset:35072
    v_lshlrev_b32 v236, 16, v200
    v_and_b32 v237, 0xffff0000, v200
    v_add_f32 v234, v234, v236
    v_mfma_f32_32x32x16_bf16 v[16:31], v[204:207], v[160:163], v[16:31]
    ds_read_b64_tr_b16 v[212:213], v220 offset:43008
    s_add_u32 m0, s72, 20480
    s_add_u32 s68, s26, 110592
    buffer_load_dwordx4 v229, s[44:47], s68 offen offset:0 lds
    v_add_f32 v234, v234, v237
    v_mfma_f32_32x32x16_bf16 v[32:47], v[200:203], v[164:167], v[32:47]
    ds_read_b64_tr_b16 v[214:215], v220 offset:43264
    ds_read_b128 v[180:183], v217 offset:0
    v_lshlrev_b32 v236, 16, v204
    v_and_b32 v237, 0xffff0000, v204
    v_add_f32 v235, v235, v236
    v_mfma_f32_32x32x16_bf16 v[48:63], v[204:207], v[164:167], v[48:63]
    ds_read_b128 v[184:187], v217 offset:1024
    v_add_f32 v235, v235, v237
    v_lshlrev_b32 v236, 16, v201
    v_and_b32 v237, 0xffff0000, v201
    v_add_f32 v234, v234, v236
    v_mfma_f32_32x32x16_bf16 v[64:79], v[200:203], v[168:171], v[64:79]
    ds_read_b128 v[188:191], v217 offset:2048
    ds_read_b128 v[192:195], v217 offset:3072
    buffer_load_dwordx4 v230, s[44:47], s68 offen offset:1024 lds
    v_add_f32 v234, v234, v237
    v_mfma_f32_32x32x16_bf16 v[80:95], v[204:207], v[168:171], v[80:95]
    ds_read_b128 v[196:199], v217 offset:4096
    v_lshlrev_b32 v236, 16, v205
    v_and_b32 v237, 0xffff0000, v205
    v_add_f32 v235, v235, v236
    v_mfma_f32_32x32x16_bf16 v[96:111], v[200:203], v[172:175], v[96:111]
    v_add_f32 v235, v235, v237
    v_lshlrev_b32 v236, 16, v202
    v_and_b32 v237, 0xffff0000, v202
    v_add_f32 v234, v234, v236
    v_add_f32 v234, v234, v237
    v_mfma_f32_32x32x16_bf16 v[112:127], v[204:207], v[172:175], v[112:127]
    buffer_load_dwordx4 v231, s[44:47], s68 offen offset:2048 lds
    v_lshlrev_b32 v236, 16, v206
    v_and_b32 v237, 0xffff0000, v206
    v_add_f32 v235, v235, v236
    v_mfma_f32_32x32x16_bf16 v[128:143], v[200:203], v[176:179], v[128:143]
    v_add_f32 v235, v235, v237
    v_lshlrev_b32 v236, 16, v203
    v_and_b32 v237, 0xffff0000, v203
    v_add_f32 v234, v234, v236
    v_mfma_f32_32x32x16_bf16 v[144:159], v[204:207], v[176:179], v[144:159]
    v_add_f32 v234, v234, v237
    v_lshlrev_b32 v236, 16, v207
    v_and_b32 v237, 0xffff0000, v207
    v_add_f32 v235, v235, v236
    v_add_f32 v235, v235, v237
    s_waitcnt lgkmcnt(0)
    v_mfma_f32_32x32x16_bf16 v[0:15], v[208:211], v[180:183], v[0:15]
    ds_read_b64_tr_b16 v[200:201], v220 offset:36864
    ds_read_b64_tr_b16 v[202:203], v220 offset:37120
    s_lshr_b32 s73, s2, 3
    v_lshlrev_b32 v236, 16, v208
    v_and_b32 v237, 0xffff0000, v208
    v_add_f32 v234, v234, v236
    v_mfma_f32_32x32x16_bf16 v[16:31], v[212:215], v[180:183], v[16:31]
    ds_read_b64_tr_b16 v[204:205], v220 offset:45056
    buffer_load_dwordx4 v232, s[44:47], s68 offen offset:3072 lds
    v_add_f32 v234, v234, v237
    v_lshlrev_b32 v236, 16, v212
    v_and_b32 v237, 0xffff0000, v212
    v_mfma_f32_32x32x16_bf16 v[32:47], v[208:211], v[184:187], v[32:47]
    ds_read_b64_tr_b16 v[206:207], v220 offset:45312
    ds_read_b128 v[160:163], v218 offset:0
    v_add_f32 v235, v235, v236
    v_add_f32 v235, v235, v237
    v_lshlrev_b32_e64 v236, 16, v209
    v_mfma_f32_32x32x16_bf16 v[48:63], v[212:215], v[184:187], v[48:63]
    ds_read_b128 v[164:167], v218 offset:1024
    s_add_u32 m0, s71, 45056
    s_add_u32 s3, s3, 128
    s_cmp_eq_u32 s3, 1280
    s_cselect_b32 s3, 0, s3
    s_mul_i32 s26, s3, 1728
    s_add_u32 s68, s3, 0
    buffer_load_dwordx4 v228, s[40:43], s68 offen lds
    v_and_b32 v237, 0xffff0000, v209
    v_add_f32 v234, v234, v236
    v_add_f32 v234, v234, v237
    v_mfma_f32_32x32x16_bf16 v[64:79], v[208:211], v[188:191], v[64:79]
    ds_read_b128 v[168:171], v218 offset:2048
    ds_read_b128 v[172:175], v218 offset:3072
    v_lshlrev_b32 v236, 16, v213
    v_and_b32 v237, 0xffff0000, v213
    v_add_f32 v235, v235, v236
    v_add_f32 v235, v235, v237
    v_mfma_f32_32x32x16_bf16 v[80:95], v[212:215], v[188:191], v[80:95]
    ds_read_b128 v[176:179], v218 offset:4096
    s_add_u32 m0, s71, 40960
    s_nop 0
    buffer_load_dwordx4 v224, s[40:43], s68 offen offset:0 lds
    v_lshlrev_b32 v236, 16, v210
    v_and_b32 v237, 0xffff0000, v210
    v_add_f32 v234, v234, v236
    v_mfma_f32_32x32x16_bf16 v[96:111], v[208:211], v[192:195], v[96:111]
    s_mul_i32 s73, s73, 3072
    s_cmp_eq_u32 s64, 0
    s_cselect_b32 s73, s73, 134217728
    v_add_f32 v234, v234, v237
    v_lshlrev_b32 v236, 16, v214
    v_and_b32 v237, 0xffff0000, v214
    v_mfma_f32_32x32x16_bf16 v[112:127], v[212:215], v[192:195], v[112:127]
    buffer_load_dwordx4 v225, s[40:43], s68 offen offset:1024 lds
    v_add_f32 v235, v235, v236
    v_add_f32 v235, v235, v237
    v_lshlrev_b32 v236, 16, v211
    v_mfma_f32_32x32x16_bf16 v[128:143], v[208:211], v[196:199], v[128:143]
    v_lshl_add_u32 v243, v233, 7, s73
    v_and_b32 v237, 0xffff0000, v211
    v_add_f32 v234, v234, v236
    v_add_f32 v234, v234, v237
    v_lshlrev_b32 v236, 16, v215
    v_and_b32 v237, 0xffff0000, v215
    v_mfma_f32_32x32x16_bf16 v[144:159], v[212:215], v[196:199], v[144:159]
    s_mov_b32 exec_lo, 16777215
    s_mov_b32 exec_hi, 0
    buffer_load_dword a255, v243, s[84:87], 0 offen
    s_mov_b64 exec, -1
    v_add_f32 v235, v235, v236
    v_add_f32 v235, v235, v237
    s_waitcnt lgkmcnt(0)
    v_mfma_f32_32x32x16_bf16 v[0:15], v[200:203], v[160:163], v[0:15]
    ds_read_b64_tr_b16 v[208:209], v220 offset:38912
    ds_read_b64_tr_b16 v[210:211], v220 offset:39168
    v_lshlrev_b32 v236, 16, v200
    v_and_b32 v237, 0xffff0000, v200
    v_add_f32 v234, v234, v236
    v_mfma_f32_32x32x16_bf16 v[16:31], v[204:207], v[160:163], v[16:31]
    ds_read_b64_tr_b16 v[212:213], v220 offset:47104
    buffer_load_dwordx4 v226, s[40:43], s68 offen offset:2048 lds
    v_add_f32 v234, v234, v237
    v_lshlrev_b32 v236, 16, v204
    v_mfma_f32_32x32x16_bf16 v[32:47], v[200:203], v[164:167], v[32:47]
    ds_read_b64_tr_b16 v[214:215], v220 offset:47360
    ds_read_b128 v[180:183], v219 offset:0
    v_and_b32 v237, 0xffff0000, v204
    v_add_f32 v235, v235, v236
    v_add_f32 v235, v235, v237
    v_mfma_f32_32x32x16_bf16 v[48:63], v[204:207], v[164:167], v[48:63]
    ds_read_b128 v[184:187], v219 offset:1024
    buffer_load_dwordx4 v227, s[40:43], s68 offen offset:3072 lds
    v_lshlrev_b32 v236, 16, v201
    v_and_b32 v237, 0xffff0000, v201
    v_mfma_f32_32x32x16_bf16 v[64:79], v[200:203], v[168:171], v[64:79]
    ds_read_b128 v[188:191], v219 offset:2048
    ds_read_b128 v[192:195], v219 offset:3072
    v_add_f32 v234, v234, v236
    v_add_f32 v234, v234, v237
    v_lshlrev_b32 v236, 16, v205
    v_mfma_f32_32x32x16_bf16 v[80:95], v[204:207], v[168:171], v[80:95]
    ds_read_b128 v[196:199], v219 offset:4096
    s_add_u32 m0, s72, 0
    s_add_u32 s68, s26, 0
    buffer_load_dwordx4 v229, s[44:47], s68 offen offset:0 lds
    v_and_b32 v237, 0xffff0000, v205
    v_mfma_f32_32x32x16_bf16 v[96:111], v[200:203], v[172:175], v[96:111]
    v_add_f32 v235, v235, v236
    v_add_f32 v235, v235, v237
    v_lshlrev_b32 v236, 16, v202
    v_and_b32 v237, 0xffff0000, v202
    v_add_f32 v234, v234, v236
    v_mfma_f32_32x32x16_bf16 v[112:127], v[204:207], v[172:175], v[112:127]
    buffer_load_dwordx4 v230, s[44:47], s68 offen offset:1024 lds
    v_add_f32 v234, v234, v237
    v_lshlrev_b32 v236, 16, v206
    v_and_b32 v237, 0xffff0000, v206
    v_mfma_f32_32x32x16_bf16 v[128:143], v[200:203], v[176:179], v[128:143]
    v_add_f32 v235, v235, v236
    v_add_f32 v235, v235, v237
    v_lshlrev_b32 v236, 16, v203
    v_and_b32 v237, 0xffff0000, v203
    v_add_f32 v234, v234, v236
    v_mfma_f32_32x32x16_bf16 v[144:159], v[204:207], v[176:179], v[144:159]
    v_add_f32 v234, v234, v237
    v_lshlrev_b32 v236, 16, v207
    v_and_b32 v237, 0xffff0000, v207
    v_add_f32 v235, v235, v236
    v_add_f32 v235, v235, v237
    s_waitcnt lgkmcnt(0)
    v_mfma_f32_32x32x16_bf16 v[0:15], v[208:211], v[180:183], v[0:15]
    s_waitcnt vmcnt(8)
    s_barrier
    ds_read_b64_tr_b16 v[200:201], v220 offset:16384
    ds_read_b64_tr_b16 v[202:203], v220 offset:16640
    v_lshlrev_b32 v236, 16, v208
    v_and_b32 v237, 0xffff0000, v208
    v_mfma_f32_32x32x16_bf16 v[16:31], v[212:215], v[180:183], v[16:31]
    ds_read_b64_tr_b16 v[204:205], v220 offset:24576
    buffer_load_dwordx4 v231, s[44:47], s68 offen offset:2048 lds
    v_add_f32 v234, v234, v236
    v_add_f32 v234, v234, v237
    v_mfma_f32_32x32x16_bf16 v[32:47], v[208:211], v[184:187], v[32:47]
    ds_read_b64_tr_b16 v[206:207], v220 offset:24832
    ds_read_b128 v[160:163], v216 offset:20480
    v_lshlrev_b32 v236, 16, v212
    v_and_b32 v237, 0xffff0000, v212
    v_mfma_f32_32x32x16_bf16 v[48:63], v[212:215], v[184:187], v[48:63]
    ds_read_b128 v[164:167], v216 offset:21504
    v_add_f32 v235, v235, v236
    v_add_f32 v235, v235, v237
    v_lshlrev_b32 v236, 16, v209
    v_and_b32 v237, 0xffff0000, v209
    v_mfma_f32_32x32x16_bf16 v[64:79], v[208:211], v[188:191], v[64:79]
    ds_read_b128 v[168:171], v216 offset:22528
    ds_read_b128 v[172:175], v216 offset:23552
    buffer_load_dwordx4 v232, s[44:47], s68 offen offset:3072 lds
    v_add_f32 v234, v234, v236
    v_mfma_f32_32x32x16_bf16 v[80:95], v[212:215], v[188:191], v[80:95]
    ds_read_b128 v[176:179], v216 offset:24576
    v_add_f32 v234, v234, v237
    v_lshlrev_b32 v236, 16, v213
    v_and_b32 v237, 0xffff0000, v213
    v_add_f32 v235, v235, v236
    v_mfma_f32_32x32x16_bf16 v[96:111], v[208:211], v[192:195], v[96:111]
    v_add_f32 v235, v235, v237
    v_lshlrev_b32 v236, 16, v210
    v_and_b32 v237, 0xffff0000, v210
    v_add_f32 v234, v234, v236
    v_add_f32 v234, v234, v237
    v_mfma_f32_32x32x16_bf16 v[112:127], v[212:215], v[192:195], v[112:127]
    s_add_u32 m0, s72, 4096
    s_add_u32 s68, s26, 110592
    buffer_load_dwordx4 v229, s[44:47], s68 offen offset:0 lds
    v_lshlrev_b32 v236, 16, v214
    v_and_b32 v237, 0xffff0000, v214
    v_mfma_f32_32x32x16_bf16 v[128:143], v[208:211], v[196:199], v[128:143]
    v_add_f32 v235, v235, v236
    v_add_f32 v235, v235, v237
    v_lshlrev_b32 v236, 16, v211
    v_and_b32 v237, 0xffff0000, v211
    v_add_f32 v234, v234, v236
    v_mfma_f32_32x32x16_bf16 v[144:159], v[212:215], v[196:199], v[144:159]
    v_add_f32 v234, v234, v237
    v_lshlrev_b32 v236, 16, v215
    v_and_b32 v237, 0xffff0000, v215
    v_add_f32 v235, v235, v236
    v_add_f32 v235, v235, v237
    s_branch L_nosum
L_glu:
    ds_read_b64_tr_b16 v[200:201], v220 offset:0
    ds_read_b64_tr_b16 v[202:203], v220 offset:256
    ds_read_b64_tr_b16 v[204:205], v220 offset:8192
    ds_read_b64_tr_b16 v[206:207], v220 offset:8448
    ds_read_b128 v[160:163], v216 offset:0
    ds_read_b128 v[164:167], v216 offset:1024
    ds_read_b128 v[168:171], v216 offset:2048
    ds_read_b128 v[172:175], v216 offset:3072
    ds_read_b128 v[176:179], v216 offset:4096
    s_waitcnt lgkmcnt(0)
    v_mfma_f32_32x32x16_bf16 v[0:15], v[200:203], v[160:163], 0
    ds_read_b64_tr_b16 v[208:209], v220 offset:2048
    ds_read_b64_tr_b16 v[210:211], v220 offset:2304
    v_accvgpr_write_b32 a232, 0
    v_mfma_f32_32x32x16_bf16 v[16:31], v[204:207], v[160:163], 0
    ds_read_b64_tr_b16 v[212:213], v220 offset:10240
    v_accvgpr_write_b32 a233, 0
    v_mfma_f32_32x32x16_bf16 v[32:47], v[200:203], v[164:167], 0
    ds_read_b64_tr_b16 v[214:215], v220 offset:10496
    ds_read_b128 v[180:183], v217 offset:0
    s_add_u32 m0, s72, 32768
    s_add_u32 s68, s98, s12
    s_add_u32 s68, s68, 0
    buffer_load_dwordx4 v250, s[92:95], s68 offen offset:0 lds
    v_mfma_f32_32x32x16_bf16 v[48:63], v[204:207], v[164:167], 0
    ds_read_b128 v[184:187], v217 offset:1024
    buffer_load_dwordx4 v251, s[92:95], s68 offen offset:1024 lds
    v_mfma_f32_32x32x16_bf16 v[64:79], v[200:203], v[168:171], 0
    ds_read_b128 v[188:191], v217 offset:2048
    ds_read_b128 v[192:195], v217 offset:3072
    s_add_u32 m0, s72, 16384
    s_add_u32 s68, s26, 0
    buffer_load_dwordx4 v232, s[44:47], s68 offen offset:3072 lds
    v_mfma_f32_32x32x16_bf16 v[80:95], v[204:207], v[168:171], 0
    ds_read_b128 v[196:199], v217 offset:4096
    s_add_u32 m0, s72, 20480
    s_add_u32 s68, s26, 110592
    buffer_load_dwordx4 v229, s[44:47], s68 offen offset:0 lds
    v_mfma_f32_32x32x16_bf16 v[96:111], v[200:203], v[172:175], 0
    buffer_load_dwordx4 v230, s[44:47], s68 offen offset:1024 lds
    v_mfma_f32_32x32x16_bf16 v[112:127], v[204:207], v[172:175], 0
    buffer_load_dwordx4 v231, s[44:47], s68 offen offset:2048 lds
    v_mfma_f32_32x32x16_bf16 v[128:143], v[200:203], v[176:179], 0
    buffer_load_dwordx4 v232, s[44:47], s68 offen offset:3072 lds
    v_mfma_f32_32x32x16_bf16 v[144:159], v[204:207], v[176:179], 0
    v_accvgpr_write_b32 a234, 0
    v_accvgpr_write_b32 a235, 0
    s_waitcnt lgkmcnt(0)
    v_mfma_f32_32x32x16_bf16 v[0:15], v[208:211], v[180:183], v[0:15]
    ds_read_b64_tr_b16 v[200:201], v220 offset:4096
    ds_read_b64_tr_b16 v[202:203], v220 offset:4352
    v_mfma_f32_32x32x16_bf16 v[16:31], v[212:215], v[180:183], v[16:31]
    ds_read_b64_tr_b16 v[204:205], v220 offset:12288
    v_mfma_f32_32x32x16_bf16 v[32:47], v[208:211], v[184:187], v[32:47]
    ds_read_b64_tr_b16 v[206:207], v220 offset:12544
    ds_read_b128 v[160:163], v218 offset:0
    s_add_u32 m0, s72, 34816
    s_add_u32 s68, s98, s12
    s_add_u32 s68, s68, 20480
    buffer_load_dwordx4 v250, s[92:95], s68 offen offset:0 lds
    v_mfma_f32_32x32x16_bf16 v[48:63], v[212:215], v[184:187], v[48:63]
    ds_read_b128 v[164:167], v218 offset:1024
    v_mfma_f32_32x32x16_bf16 v[64:79], v[208:211], v[188:191], v[64:79]
    ds_read_b128 v[168:171], v218 offset:2048
    ds_read_b128 v[172:175], v218 offset:3072
    buffer_load_dwordx4 v251, s[92:95], s68 offen offset:1024 lds
    v_mfma_f32_32x32x16_bf16 v[80:95], v[212:215], v[188:191], v[80:95]
    ds_read_b128 v[176:179], v218 offset:4096
    s_add_u32 m0, s71, 40960
    s_add_u32 s68, s97, 0
    buffer_load_dwordx4 v249, s[88:91], s68 offen offset:0 nt lds
    v_mfma_f32_32x32x16_bf16 v[96:111], v[208:211], v[192:195], v[96:111]
    v_mfma_f32_32x32x16_bf16 v[112:127], v[212:215], v[192:195], v[112:127]
    s_add_u32 s68, s97, 9216
    buffer_load_dwordx4 v249, s[88:91], s68 offen offset:1024 nt lds
    v_mfma_f32_32x32x16_bf16 v[128:143], v[208:211], v[196:199], v[128:143]
    s_add_u32 s68, s97, 18432
    buffer_load_dwordx4 v249, s[88:91], s68 offen offset:2048 nt lds
    v_mfma_f32_32x32x16_bf16 v[144:159], v[212:215], v[196:199], v[144:159]
    s_waitcnt lgkmcnt(0)
    v_mfma_f32_32x32x16_bf16 v[0:15], v[200:203], v[160:163], v[0:15]
    ds_read_b64_tr_b16 v[208:209], v220 offset:6144
    ds_read_b64_tr_b16 v[210:211], v220 offset:6400
    v_mfma_f32_32x32x16_bf16 v[16:31], v[204:207], v[160:163], v[16:31]
    ds_read_b64_tr_b16 v[212:213], v220 offset:14336
    v_mfma_f32_32x32x16_bf16 v[32:47], v[200:203], v[164:167], v[32:47]
    ds_read_b64_tr_b16 v[214:215], v220 offset:14592
    ds_read_b128 v[180:183], v219 offset:0
    s_add_u32 m0, s72, 36864
    s_add_u32 s68, s98, s12
    s_add_u32 s68, s68, 40960
    buffer_load_dwordx4 v250, s[92:95], s68 offen offset:0 lds
    v_mfma_f32_32x32x16_bf16 v[48:63], v[204:207], v[164:167], v[48:63]
    ds_read_b128 v[184:187], v219 offset:1024
    v_mfma_f32_32x32x16_bf16 v[64:79], v[200:203], v[168:171], v[64:79]
    ds_read_b128 v[188:191], v219 offset:2048
    ds_read_b128 v[192:195], v219 offset:3072
    buffer_load_dwordx4 v251, s[92:95], s68 offen offset:1024 lds
    v_mfma_f32_32x32x16_bf16 v[80:95], v[204:207], v[168:171], v[80:95]
    ds_read_b128 v[196:199], v219 offset:4096
    v_mfma_f32_32x32x16_bf16 v[96:111], v[200:203], v[172:175], v[96:111]
    s_add_u32 m0, s71, 40960
    s_add_u32 s68, s97, 27648
    buffer_load_dwordx4 v249, s[88:91], s68 offen offset:3072 nt lds
    v_mfma_f32_32x32x16_bf16 v[112:127], v[204:207], v[172:175], v[112:127]
    s_waitcnt vmcnt(13)
    ds_read_b128 a[0:3], v252 offset:0
    v_mfma_f32_32x32x16_bf16 v[128:143], v[200:203], v[176:179], v[128:143]
    ds_read_b128 a[20:23], v253 offset:0
    s_add_u32 m0, s71, 45056
    s_add_u32 s3, s3, 128
    s_cmp_eq_u32 s3, 1280
    s_cselect_b32 s3, 0, s3
    s_mul_i32 s26, s3, 1728
    s_add_u32 s68, s3, 0
    buffer_load_dwordx4 v228, s[40:43], s68 offen lds
    v_mfma_f32_32x32x16_bf16 v[144:159], v[204:207], v[176:179], v[144:159]
    s_waitcnt lgkmcnt(2)
    v_mfma_f32_32x32x16_bf16 v[0:15], v[208:211], v[180:183], v[0:15]
    s_waitcnt vmcnt(9)
    s_barrier
    ds_read_b64_tr_b16 v[200:201], v220 offset:16384
    ds_read_b64_tr_b16 v[202:203], v220 offset:16640
    v_mfma_f32_32x32x16_bf16 v[16:31], v[212:215], v[180:183], v[16:31]
    ds_read_b64_tr_b16 v[204:205], v220 offset:24576
    s_and_b32 s74, s67, 0x7f
    s_cselect_b32 s74, 134217728, s67
    v_mfma_f32_32x32x16_bf16 v[32:47], v[208:211], v[184:187], v[32:47]
    ds_read_b64_tr_b16 v[206:207], v220 offset:24832
    ds_read_b128 v[160:163], v216 offset:20480
    s_add_u32 m0, s72, 38912
    s_add_u32 s68, s98, s12
    s_add_u32 s68, s68, 61440
    buffer_load_dwordx4 v250, s[92:95], s68 offen offset:0 lds
    v_mfma_f32_32x32x16_bf16 v[48:63], v[212:215], v[184:187], v[48:63]
    ds_read_b128 v[164:167], v216 offset:21504
    buffer_load_dwordx4 v251, s[92:95], s68 offen offset:1024 lds
    v_mfma_f32_32x32x16_bf16 v[64:79], v[208:211], v[188:191], v[64:79]
    ds_read_b128 v[168:171], v216 offset:22528
    ds_read_b128 v[172:175], v216 offset:23552
    s_add_u32 m0, s72, 0
    s_add_u32 s68, s26, 0
    buffer_load_dwordx4 v229, s[44:47], s68 offen offset:0 lds
    v_mfma_f32_32x32x16_bf16 v[80:95], v[212:215], v[188:191], v[80:95]
    ds_read_b128 v[176:179], v216 offset:24576
    buffer_load_dwordx4 v230, s[44:47], s68 offen offset:1024 lds
    v_mfma_f32_32x32x16_bf16 v[96:111], v[208:211], v[192:195], v[96:111]
    buffer_load_dwordx4 v231, s[44:47], s68 offen offset:2048 lds
    v_mfma_f32_32x32x16_bf16 v[112:127], v[212:215], v[192:195], v[112:127]
    s_waitcnt vmcnt(12)
    ds_read_b128 a[4:7], v252 offset:2048
    buffer_load_dwordx4 v232, s[44:47], s68 offen offset:3072 lds
    v_mfma_f32_32x32x16_bf16 v[128:143], v[208:211], v[196:199], v[128:143]
    ds_read_b128 a[24:27], v253 offset:2048
    s_add_u32 m0, s72, 4096
    s_add_u32 s68, s26, 110592
    buffer_load_dwordx4 v229, s[44:47], s68 offen offset:0 lds
    v_mfma_f32_32x32x16_bf16 v[144:159], v[212:215], v[196:199], v[144:159]
    s_mov_b64 exec, 0xff
    buffer_store_dwordx4 a[232:235], v238, s[56:59], s74 offen sc1
    s_mov_b64 exec, -1
    s_waitcnt lgkmcnt(2)
    v_mfma_f32_32x32x16_bf16 v[0:15], v[200:203], v[160:163], v[0:15]
    ds_read_b64_tr_b16 v[208:209], v220 offset:18432
    ds_read_b64_tr_b16 v[210:211], v220 offset:18688
    v_mfma_f32_32x32x16_bf16 v[16:31], v[204:207], v[160:163], v[16:31]
    ds_read_b64_tr_b16 v[212:213], v220 offset:26624
    v_mfma_f32_32x32x16_bf16 v[32:47], v[200:203], v[164:167], v[32:47]
    ds_read_b64_tr_b16 v[214:215], v220 offset:26880
    ds_read_b128 v[180:183], v217 offset:20480
    s_add_u32 m0, s72, 32768
    s_add_u32 s68, s98, s12
    s_add_u32 s68, s68, 81920
    buffer_load_dwordx4 v250, s[92:95], s68 offen offset:0 lds
    v_mfma_f32_32x32x16_bf16 v[48:63], v[204:207], v[164:167], v[48:63]
    ds_read_b128 v[184:187], v217 offset:21504
    v_mfma_f32_32x32x16_bf16 v[64:79], v[200:203], v[168:171], v[64:79]
    ds_read_b128 v[188:191], v217 offset:22528
    ds_read_b128 v[192:195], v217 offset:23552
    buffer_load_dwordx4 v251, s[92:95], s68 offen offset:1024 lds
    v_mfma_f32_32x32x16_bf16 v[80:95], v[204:207], v[168:171], v[80:95]
    ds_read_b128 v[196:199], v217 offset:24576
    s_add_u32 m0, s72, 4096
    s_add_u32 s68, s26, 110592
    buffer_load_dwordx4 v230, s[44:47], s68 offen offset:1024 lds
    v_mfma_f32_32x32x16_bf16 v[96:111], v[200:203], v[172:175], v[96:111]
    v_mfma_f32_32x32x16_bf16 v[112:127], v[204:207], v[172:175], v[112:127]
    s_waitcnt vmcnt(13)
    ds_read_b128 a[8:11], v252 offset:4096
    ds_read_b128 a[28:31], v253 offset:4096
    s_waitcnt vmcnt(12)
    ds_read_b64_tr_b16 a[200:201], v247 offset:40960
    ds_read_b64_tr_b16 a[202:203], v247 offset:41472
    buffer_load_dwordx4 v231, s[44:47], s68 offen offset:2048 lds
    v_mfma_f32_32x32x16_bf16 v[128:143], v[200:203], v[176:179], v[128:143]
    ds_read_b64_tr_b16 a[204:205], v247 offset:41984
    ds_read_b64_tr_b16 a[206:207], v247 offset:42496
    ds_read_b64_tr_b16 a[208:209], v247 offset:43008
    ds_read_b64_tr_b16 a[210:211], v247 offset:43520
    ds_read_b64_tr_b16 a[212:213], v247 offset:44032
    ds_read_b64_tr_b16 a[214:215], v247 offset:44544
    buffer_load_dwordx4 v232, s[44:47], s68 offen offset:3072 lds
    v_mfma_f32_32x32x16_bf16 v[144:159], v[204:207], v[176:179], v[144:159]
    s_waitcnt lgkmcnt(0)
    v_mfma_f32_32x32x16_bf16 v[0:15], v[208:211], v[180:183], v[0:15]
    ds_read_b64_tr_b16 v[200:201], v220 offset:20480
    ds_read_b64_tr_b16 v[202:203], v220 offset:20736
    buffer_load_dword v243, off, s[60:63], 0 sc1
    v_mfma_f32_32x32x16_bf16 v[16:31], v[212:215], v[180:183], v[16:31]
    ds_read_b64_tr_b16 v[204:205], v220 offset:28672
    s_add_u32 m0, s71, 40960
    s_add_u32 s68, s3, 0
    buffer_load_dwordx4 v224, s[40:43], s68 offen offset:0 lds
    v_mfma_f32_32x32x16_bf16 v[32:47], v[208:211], v[184:187], v[32:47]
    ds_read_b64_tr_b16 v[206:207], v220 offset:28928
    ds_read_b128 v[160:163], v218 offset:20480
    v_mfma_f32_32x32x16_bf16 v[48:63], v[212:215], v[184:187], v[48:63]
    ds_read_b128 v[164:167], v218 offset:21504
    buffer_load_dwordx4 v225, s[40:43], s68 offen offset:1024 lds
    v_mfma_f32_32x32x16_bf16 v[64:79], v[208:211], v[188:191], v[64:79]
    ds_read_b128 v[168:171], v218 offset:22528
    ds_read_b128 v[172:175], v218 offset:23552
    v_mfma_f32_32x32x16_bf16 v[80:95], v[212:215], v[188:191], v[80:95]
    ds_read_b128 v[176:179], v218 offset:24576
    buffer_load_dwordx4 v226, s[40:43], s68 offen offset:2048 lds
    v_mfma_f32_32x32x16_bf16 v[96:111], v[208:211], v[192:195], v[96:111]
    buffer_store_dwordx4 a[200:203], v248, s[56:59], s96 offen offset:0 sc1
    buffer_store_dwordx4 a[204:207], v248, s[56:59], s96 offen offset:256 sc1
    v_mfma_f32_32x32x16_bf16 v[112:127], v[212:215], v[192:195], v[112:127]
    s_waitcnt vmcnt(17)
    ds_read_b128 a[12:15], v252 offset:6144
    ds_read_b128 a[32:35], v253 offset:6144
    buffer_load_dwordx4 v227, s[40:43], s68 offen offset:3072 lds
    v_mfma_f32_32x32x16_bf16 v[128:143], v[208:211], v[196:199], v[128:143]
    s_waitcnt vmcnt(10)
    ds_read_b128 a[16:19], v252 offset:0
    ds_read_b128 a[36:39], v253 offset:0
    v_mfma_f32_32x32x16_bf16 v[144:159], v[212:215], v[196:199], v[144:159]
    s_waitcnt lgkmcnt(4)
    v_mfma_f32_32x32x16_bf16 v[0:15], v[200:203], v[160:163], v[0:15]
    ds_read_b64_tr_b16 v[208:209], v220 offset:22528
    ds_read_b64_tr_b16 v[210:211], v220 offset:22784
    v_mfma_f32_32x32x16_bf16 v[16:31], v[204:207], v[160:163], v[16:31]
    ds_read_b64_tr_b16 v[212:213], v220 offset:30720
    s_add_u32 m0, s71, 4096
    s_add_u32 s3, s3, 128
    s_cmp_eq_u32 s3, 1280
    s_cselect_b32 s3, 0, s3
    s_mul_i32 s26, s3, 1728
    s_add_u32 s68, s3, 0
    buffer_load_dwordx4 v228, s[40:43], s68 offen lds
    v_mfma_f32_32x32x16_bf16 v[32:47], v[200:203], v[164:167], v[32:47]
    ds_read_b64_tr_b16 v[214:215], v220 offset:30976
    ds_read_b128 v[180:183], v219 offset:20480
    v_mfma_f32_32x32x16_bf16 v[48:63], v[204:207], v[164:167], v[48:63]
    ds_read_b128 v[184:187], v219 offset:21504
    s_add_u32 m0, s71, 0
    s_nop 0
    buffer_load_dwordx4 v224, s[40:43], s68 offen offset:0 lds
    v_mfma_f32_32x32x16_bf16 v[64:79], v[200:203], v[168:171], v[64:79]
    ds_read_b128 v[188:191], v219 offset:22528
    ds_read_b128 v[192:195], v219 offset:23552
    v_mfma_f32_32x32x16_bf16 v[80:95], v[204:207], v[168:171], v[80:95]
    ds_read_b128 v[196:199], v219 offset:24576
    buffer_load_dwordx4 v225, s[40:43], s68 offen offset:1024 lds
    v_mfma_f32_32x32x16_bf16 v[96:111], v[200:203], v[172:175], v[96:111]
    v_mfma_f32_32x32x16_bf16 v[112:127], v[204:207], v[172:175], v[112:127]
    buffer_load_dwordx4 v226, s[40:43], s68 offen offset:2048 lds
    v_mfma_f32_32x32x16_bf16 v[128:143], v[200:203], v[176:179], v[128:143]
    v_mfma_f32_32x32x16_bf16 v[144:159], v[204:207], v[176:179], v[144:159]
    buffer_store_dwordx4 a[208:211], v248, s[56:59], s96 offen offset:512 sc1
    buffer_store_dwordx4 a[212:215], v248, s[56:59], s96 offen offset:768 sc1
    s_waitcnt lgkmcnt(0)
    v_mfma_f32_32x32x16_bf16 v[0:15], v[208:211], v[180:183], v[0:15]
    s_waitcnt vmcnt(6)
    s_barrier
    ds_read_b64_tr_b16 v[200:201], v220 offset:0
    ds_read_b64_tr_b16 v[202:203], v220 offset:256
    v_mfma_f32_32x32x16_bf16 v[16:31], v[212:215], v[180:183], v[16:31]
    ds_read_b64_tr_b16 v[204:205], v220 offset:8192
    buffer_load_dwordx4 v227, s[40:43], s68 offen offset:3072 lds
    v_mfma_f32_32x32x16_bf16 v[32:47], v[208:211], v[184:187], v[32:47]
    ds_read_b64_tr_b16 v[206:207], v220 offset:8448
    ds_read_b128 v[160:163], v216 offset:40960
    v_mfma_f32_32x32x16_bf16 v[48:63], v[212:215], v[184:187], v[48:63]
    ds_read_b128 v[164:167], v216 offset:41984
    v_mfma_f32_32x32x16_bf16 v[64:79], v[208:211], v[188:191], v[64:79]
    ds_read_b128 v[168:171], v216 offset:43008
    ds_read_b128 v[172:175], v216 offset:44032
    s_add_u32 m0, s72, 32768
    s_add_u32 s68, s26, 0
    buffer_load_dwordx4 v229, s[44:47], s68 offen offset:0 lds
    v_mfma_f32_32x32x16_bf16 v[80:95], v[212:215], v[188:191], v[80:95]
    ds_read_b128 v[176:179], v216 offset:45056
    v_mfma_f32_32x32x16_bf16 v[96:111], v[208:211], v[192:195], v[96:111]
    v_mfma_f32_32x32x16_bf16 v[112:127], v[212:215], v[192:195], v[112:127]
    buffer_load_dwordx4 v230, s[44:47], s68 offen offset:1024 lds
    v_mfma_f32_32x32x16_bf16 v[128:143], v[208:211], v[196:199], v[128:143]
    v_mfma_f32_32x32x16_bf16 v[144:159], v[212:215], v[196:199], v[144:159]
    s_cmp_lt_u32 s31, 134217728
    s_cbranch_scc1 L_sum
    s_waitcnt lgkmcnt(0)
    v_mfma_f32_32x32x16_bf16 v[0:15], v[200:203], v[160:163], v[0:15]
    ds_read_b64_tr_b16 v[208:209], v220 offset:2048
    ds_read_b64_tr_b16 v[210:211], v220 offset:2304
    v_mfma_f32_32x32x16_bf16 v[16:31], v[204:207], v[160:163], v[16:31]
    ds_read_b64_tr_b16 v[212:213], v220 offset:10240
    buffer_load_dwordx4 v231, s[44:47], s68 offen offset:2048 lds
    v_mfma_f32_32x32x16_bf16 v[32:47], v[200:203], v[164:167], v[32:47]
    ds_read_b64_tr_b16 v[214:215], v220 offset:10496
    ds_read_b128 v[180:183], v217 offset:40960
    v_mfma_f32_32x32x16_bf16 v[48:63], v[204:207], v[164:167], v[48:63]
    ds_read_b128 v[184:187], v217 offset:41984
    buffer_load_dwordx4 v232, s[44:47], s68 offen offset:3072 lds
    v_mfma_f32_32x32x16_bf16 v[64:79], v[200:203], v[168:171], v[64:79]
    ds_read_b128 v[188:191], v217 offset:43008
    ds_read_b128 v[192:195], v217 offset:44032
    v_mfma_f32_32x32x16_bf16 v[80:95], v[204:207], v[168:171], v[80:95]
    ds_read_b128 v[196:199], v217 offset:45056
    s_add_u32 m0, s72, 36864
    s_add_u32 s68, s26, 110592
    buffer_load_dwordx4 v229, s[44:47], s68 offen offset:0 lds
    v_mfma_f32_32x32x16_bf16 v[96:111], v[200:203], v[172:175], v[96:111]
    v_mfma_f32_32x32x16_bf16 v[112:127], v[204:207], v[172:175], v[112:127]
    buffer_load_dwordx4 v230, s[44:47], s68 offen offset:1024 lds
    v_mfma_f32_32x32x16_bf16 v[128:143], v[200:203], v[176:179], v[128:143]
    v_mfma_f32_32x32x16_bf16 v[144:159], v[204:207], v[176:179], v[144:159]
    v_cmp_eq_u32 vcc, 0, v243
    s_cbranch_vccnz L_slow_non_glu
L_go_non_glu:
    v_readfirstlane_b32 s83, v243
    s_waitcnt lgkmcnt(0)
    v_mfma_f32_32x32x16_bf16 v[0:15], v[208:211], v[180:183], v[0:15]
    ds_read_b64_tr_b16 v[200:201], v220 offset:4096
    ds_read_b64_tr_b16 v[202:203], v220 offset:4352
    s_waitcnt vmcnt(7)
    v_mfma_f32_32x32x16_bf16 v[16:31], v[212:215], v[180:183], v[16:31]
    ds_read_b64_tr_b16 v[204:205], v220 offset:12288
    buffer_load_dwordx4 v231, s[44:47], s68 offen offset:2048 lds
    v_mfma_f32_32x32x16_bf16 v[32:47], v[208:211], v[184:187], v[32:47]
    ds_read_b64_tr_b16 v[206:207], v220 offset:12544
    ds_read_b128 v[160:163], v218 offset:40960
    v_mfma_f32_32x32x16_bf16 v[48:63], v[212:215], v[184:187], v[48:63]
    ds_read_b128 v[164:167], v218 offset:41984
    buffer_load_dwordx4 v232, s[44:47], s68 offen offset:3072 lds
    v_mfma_f32_32x32x16_bf16 v[64:79], v[208:211], v[188:191], v[64:79]
    ds_read_b128 v[168:171], v218 offset:43008
    ds_read_b128 v[172:175], v218 offset:44032
    s_barrier
    v_mfma_f32_32x32x16_bf16 v[80:95], v[212:215], v[188:191], v[80:95]
    ds_read_b128 v[176:179], v218 offset:45056
    s_add_u32 m0, s71, 24576
    s_add_u32 s3, s3, 128
    s_cmp_eq_u32 s3, 1280
    s_cselect_b32 s3, 0, s3
    s_mul_i32 s26, s3, 1728
    s_add_u32 s68, s3, 0
    buffer_load_dwordx4 v228, s[40:43], s68 offen lds
    v_mfma_f32_32x32x16_bf16 v[96:111], v[208:211], v[192:195], v[96:111]
    s_lshl_b32 s73, s2, 4
    s_add_u32 s73, s73, 4259840
    v_mfma_f32_32x32x16_bf16 v[112:127], v[212:215], v[192:195], v[112:127]
    s_add_u32 m0, s71, 20480
    s_nop 0
    buffer_load_dwordx4 v224, s[40:43], s68 offen offset:0 lds
    v_mfma_f32_32x32x16_bf16 v[128:143], v[208:211], v[196:199], v[128:143]
    s_cmp_eq_u32 s64, 0
    s_cselect_b32 s73, s73, 134217728
    v_mov_b32 v241, s83
    v_mfma_f32_32x32x16_bf16 v[144:159], v[212:215], v[196:199], v[144:159]
    s_mov_b64 exec, 1
    buffer_store_dword v241, off, s[56:59], s73 sc1
    s_mov_b64 exec, -1
    s_waitcnt lgkmcnt(0)
    v_mfma_f32_32x32x16_bf16 v[0:15], v[200:203], v[160:163], v[0:15]
    ds_read_b64_tr_b16 v[208:209], v220 offset:6144
    ds_read_b64_tr_b16 v[210:211], v220 offset:6400
    v_mfma_f32_32x32x16_bf16 v[16:31], v[204:207], v[160:163], v[16:31]
    ds_read_b64_tr_b16 v[212:213], v220 offset:14336
    buffer_load_dwordx4 v225, s[40:43], s68 offen offset:1024 lds
    v_mfma_f32_32x32x16_bf16 v[32:47], v[200:203], v[164:167], v[32:47]
    ds_read_b64_tr_b16 v[214:215], v220 offset:14592
    ds_read_b128 v[180:183], v219 offset:40960
    v_mfma_f32_32x32x16_bf16 v[48:63], v[204:207], v[164:167], v[48:63]
    ds_read_b128 v[184:187], v219 offset:41984
    v_mfma_f32_32x32x16_bf16 v[64:79], v[200:203], v[168:171], v[64:79]
    ds_read_b128 v[188:191], v219 offset:43008
    ds_read_b128 v[192:195], v219 offset:44032
    buffer_load_dwordx4 v226, s[40:43], s68 offen offset:2048 lds
    v_mfma_f32_32x32x16_bf16 v[80:95], v[204:207], v[168:171], v[80:95]
    ds_read_b128 v[196:199], v219 offset:45056
    v_mfma_f32_32x32x16_bf16 v[96:111], v[200:203], v[172:175], v[96:111]
    v_mfma_f32_32x32x16_bf16 v[112:127], v[204:207], v[172:175], v[112:127]
    buffer_load_dwordx4 v227, s[40:43], s68 offen offset:3072 lds
    v_mfma_f32_32x32x16_bf16 v[128:143], v[200:203], v[176:179], v[128:143]
    v_mfma_f32_32x32x16_bf16 v[144:159], v[204:207], v[176:179], v[144:159]
    s_waitcnt lgkmcnt(0)
    v_mfma_f32_32x32x16_bf16 v[0:15], v[208:211], v[180:183], v[0:15]
    s_waitcnt vmcnt(6)
    s_barrier
    ds_read_b64_tr_b16 v[200:201], v220 offset:32768
    ds_read_b64_tr_b16 v[202:203], v220 offset:33024
    v_mfma_f32_32x32x16_bf16 v[16:31], v[212:215], v[180:183], v[16:31]
    ds_read_b64_tr_b16 v[204:205], v220 offset:40960
    s_add_u32 m0, s72, 16384
    s_add_u32 s68, s26, 0
    buffer_load_dwordx4 v229, s[44:47], s68 offen offset:0 lds
    v_mfma_f32_32x32x16_bf16 v[32:47], v[208:211], v[184:187], v[32:47]
    ds_read_b64_tr_b16 v[206:207], v220 offset:41216
    ds_read_b128 v[160:163], v216 offset:0
    v_mfma_f32_32x32x16_bf16 v[48:63], v[212:215], v[184:187], v[48:63]
    ds_read_b128 v[164:167], v216 offset:1024
    buffer_load_dwordx4 v230, s[44:47], s68 offen offset:1024 lds
    v_mfma_f32_32x32x16_bf16 v[64:79], v[208:211], v[188:191], v[64:79]
    ds_read_b128 v[168:171], v216 offset:2048
    ds_read_b128 v[172:175], v216 offset:3072
    v_mfma_f32_32x32x16_bf16 v[80:95], v[212:215], v[188:191], v[80:95]
    ds_read_b128 v[176:179], v216 offset:4096
    buffer_load_dwordx4 v231, s[44:47], s68 offen offset:2048 lds
    v_mfma_f32_32x32x16_bf16 v[96:111], v[208:211], v[192:195], v[96:111]
    v_mfma_f32_32x32x16_bf16 v[112:127], v[212:215], v[192:195], v[112:127]
    buffer_load_dwordx4 v232, s[44:47], s68 offen offset:3072 lds
    v_mfma_f32_32x32x16_bf16 v[128:143], v[208:211], v[196:199], v[128:143]
    v_mfma_f32_32x32x16_bf16 v[144:159], v[212:215], v[196:199], v[144:159]
    s_waitcnt lgkmcnt(0)
    v_mfma_f32_32x32x16_bf16 v[0:15], v[200:203], v[160:163], v[0:15]
    ds_read_b64_tr_b16 v[208:209], v220 offset:34816
    ds_read_b64_tr_b16 v[210:211], v220 offset:35072
    v_mfma_f32_32x32x16_bf16 v[16:31], v[204:207], v[160:163], v[16:31]
    ds_read_b64_tr_b16 v[212:213], v220 offset:43008
    s_add_u32 m0, s72, 20480
    s_add_u32 s68, s26, 110592
    buffer_load_dwordx4 v229, s[44:47], s68 offen offset:0 lds
    v_mfma_f32_32x32x16_bf16 v[32:47], v[200:203], v[164:167], v[32:47]
    ds_read_b64_tr_b16 v[214:215], v220 offset:43264
    ds_read_b128 v[180:183], v217 offset:0
    v_mfma_f32_32x32x16_bf16 v[48:63], v[204:207], v[164:167], v[48:63]
    ds_read_b128 v[184:187], v217 offset:1024
    v_mfma_f32_32x32x16_bf16 v[64:79], v[200:203], v[168:171], v[64:79]
    ds_read_b128 v[188:191], v217 offset:2048
    ds_read_b128 v[192:195], v217 offset:3072
    buffer_load_dwordx4 v230, s[44:47], s68 offen offset:1024 lds
    v_mfma_f32_32x32x16_bf16 v[80:95], v[204:207], v[168:171], v[80:95]
    ds_read_b128 v[196:199], v217 offset:4096
    v_mfma_f32_32x32x16_bf16 v[96:111], v[200:203], v[172:175], v[96:111]
    v_mfma_f32_32x32x16_bf16 v[112:127], v[204:207], v[172:175], v[112:127]
    buffer_load_dwordx4 v231, s[44:47], s68 offen offset:2048 lds
    v_mfma_f32_32x32x16_bf16 v[128:143], v[200:203], v[176:179], v[128:143]
    v_mfma_f32_32x32x16_bf16 v[144:159], v[204:207], v[176:179], v[144:159]
    s_waitcnt lgkmcnt(0)
    v_mfma_f32_32x32x16_bf16 v[0:15], v[208:211], v[180:183], v[0:15]
    ds_read_b64_tr_b16 v[200:201], v220 offset:36864
    ds_read_b64_tr_b16 v[202:203], v220 offset:37120
    s_lshr_b32 s73, s2, 3
    v_mfma_f32_32x32x16_bf16 v[16:31], v[212:215], v[180:183], v[16:31]
    ds_read_b64_tr_b16 v[204:205], v220 offset:45056
    buffer_load_dwordx4 v232, s[44:47], s68 offen offset:3072 lds
    v_mfma_f32_32x32x16_bf16 v[32:47], v[208:211], v[184:187], v[32:47]
    ds_read_b64_tr_b16 v[206:207], v220 offset:45312
    ds_read_b128 v[160:163], v218 offset:0
    v_mfma_f32_32x32x16_bf16 v[48:63], v[212:215], v[184:187], v[48:63]
    ds_read_b128 v[164:167], v218 offset:1024
    s_add_u32 m0, s71, 45056
    s_add_u32 s3, s3, 128
    s_cmp_eq_u32 s3, 1280
    s_cselect_b32 s3, 0, s3
    s_mul_i32 s26, s3, 1728
    s_add_u32 s68, s3, 0
    buffer_load_dwordx4 v228, s[40:43], s68 offen lds
    v_mfma_f32_32x32x16_bf16 v[64:79], v[208:211], v[188:191], v[64:79]
    ds_read_b128 v[168:171], v218 offset:2048
    ds_read_b128 v[172:175], v218 offset:3072
    v_mfma_f32_32x32x16_bf16 v[80:95], v[212:215], v[188:191], v[80:95]
    ds_read_b128 v[176:179], v218 offset:4096
    s_add_u32 m0, s71, 40960
    s_nop 0
    buffer_load_dwordx4 v224, s[40:43], s68 offen offset:0 lds
    v_mfma_f32_32x32x16_bf16 v[96:111], v[208:211], v[192:195], v[96:111]
    s_mul_i32 s73, s73, 3072
    s_cmp_eq_u32 s64, 0
    s_cselect_b32 s73, s73, 134217728
    v_mfma_f32_32x32x16_bf16 v[112:127], v[212:215], v[192:195], v[112:127]
    buffer_load_dwordx4 v225, s[40:43], s68 offen offset:1024 lds
    v_mfma_f32_32x32x16_bf16 v[128:143], v[208:211], v[196:199], v[128:143]
    v_lshl_add_u32 v243, v233, 7, s73
    v_mfma_f32_32x32x16_bf16 v[144:159], v[212:215], v[196:199], v[144:159]
    s_mov_b32 exec_lo, 16777215
    s_mov_b32 exec_hi, 0
    buffer_load_dword a255, v243, s[84:87], 0 offen
    s_mov_b64 exec, -1
    s_waitcnt lgkmcnt(0)
    v_mfma_f32_32x32x16_bf16 v[0:15], v[200:203], v[160:163], v[0:15]
    ds_read_b64_tr_b16 v[208:209], v220 offset:38912
    ds_read_b64_tr_b16 v[210:211], v220 offset:39168
    v_mfma_f32_32x32x16_bf16 v[16:31], v[204:207], v[160:163], v[16:31]
    ds_read_b64_tr_b16 v[212:213], v220 offset:47104
    buffer_load_dwordx4 v226, s[40:43], s68 offen offset:2048 lds
    v_mfma_f32_32x32x16_bf16 v[32:47], v[200:203], v[164:167], v[32:47]
    ds_read_b64_tr_b16 v[214:215], v220 offset:47360
    ds_read_b128 v[180:183], v219 offset:0
    v_mfma_f32_32x32x16_bf16 v[48:63], v[204:207], v[164:167], v[48:63]
    ds_read_b128 v[184:187], v219 offset:1024
    buffer_load_dwordx4 v227, s[40:43], s68 offen offset:3072 lds
    v_mfma_f32_32x32x16_bf16 v[64:79], v[200:203], v[168:171], v[64:79]
    ds_read_b128 v[188:191], v219 offset:2048
    ds_read_b128 v[192:195], v219 offset:3072
    v_mfma_f32_32x32x16_bf16 v[80:95], v[204:207], v[168:171], v[80:95]
    ds_read_b128 v[196:199], v219 offset:4096
    s_add_u32 m0, s72, 0
    s_add_u32 s68, s26, 0
    buffer_load_dwordx4 v229, s[44:47], s68 offen offset:0 lds
    v_mfma_f32_32x32x16_bf16 v[96:111], v[200:203], v[172:175], v[96:111]
    v_mfma_f32_32x32x16_bf16 v[112:127], v[204:207], v[172:175], v[112:127]
    buffer_load_dwordx4 v230, s[44:47], s68 offen offset:1024 lds
    v_mfma_f32_32x32x16_bf16 v[128:143], v[200:203], v[176:179], v[128:143]
    v_mfma_f32_32x32x16_bf16 v[144:159], v[204:207], v[176:179], v[144:159]
    s_waitcnt lgkmcnt(0)
    v_mfma_f32_32x32x16_bf16 v[0:15], v[208:211], v[180:183], v[0:15]
    s_waitcnt vmcnt(8)
    s_barrier
    ds_read_b64_tr_b16 v[200:201], v220 offset:16384
    ds_read_b64_tr_b16 v[202:203], v220 offset:16640
    v_mfma_f32_32x32x16_bf16 v[16:31], v[212:215], v[180:183], v[16:31]
    ds_read_b64_tr_b16 v[204:205], v220 offset:24576
    buffer_load_dwordx4 v231, s[44:47], s68 offen offset:2048 lds
    v_mfma_f32_32x32x16_bf16 v[32:47], v[208:211], v[184:187], v[32:47]
    ds_read_b64_tr_b16 v[206:207], v220 offset:24832
    ds_read_b128 v[160:163], v216 offset:20480
    v_mfma_f32_32x32x16_bf16 v[48:63], v[212:215], v[184:187], v[48:63]
    ds_read_b128 v[164:167], v216 offset:21504
    v_mfma_f32_32x32x16_bf16 v[64:79], v[208:211], v[188:191], v[64:79]
    ds_read_b128 v[168:171], v216 offset:22528
    ds_read_b128 v[172:175], v216 offset:23552
    buffer_load_dwordx4 v232, s[44:47], s68 offen offset:3072 lds
    v_mfma_f32_32x32x16_bf16 v[80:95], v[212:215], v[188:191], v[80:95]
    ds_read_b128 v[176:179], v216 offset:24576
    v_mfma_f32_32x32x16_bf16 v[96:111], v[208:211], v[192:195], v[96:111]
    v_mfma_f32_32x32x16_bf16 v[112:127], v[212:215], v[192:195], v[112:127]
    s_add_u32 m0, s72, 4096
    s_add_u32 s68, s26, 110592
    buffer_load_dwordx4 v229, s[44:47], s68 offen offset:0 lds
    v_mfma_f32_32x32x16_bf16 v[128:143], v[208:211], v[196:199], v[128:143]
    v_mfma_f32_32x32x16_bf16 v[144:159], v[212:215], v[196:199], v[144:159]
L_nosum:
    s_waitcnt lgkmcnt(0)
    v_mfma_f32_32x32x16_bf16 v[0:15], v[200:203], v[160:163], v[0:15]
    ds_read_b64_tr_b16 v[208:209], v220 offset:18432
    ds_read_b64_tr_b16 v[210:211], v220 offset:18688
    s_lshl_b32 s73, s64, 10
    v_mfma_f32_32x32x16_bf16 v[16:31], v[204:207], v[160:163], v[16:31]
    ds_read_b64_tr_b16 v[212:213], v220 offset:26624
    buffer_load_dwordx4 v230, s[44:47], s68 offen offset:1024 lds
    v_mfma_f32_32x32x16_bf16 v[32:47], v[200:203], v[164:167], v[32:47]
    ds_read_b64_tr_b16 v[214:215], v220 offset:26880
    ds_read_b128 v[180:183], v217 offset:20480
    s_add_u32 s73, s73, 4259840
    v_mfma_f32_32x32x16_bf16 v[48:63], v[204:207], v[164:167], v[48:63]
    ds_read_b128 v[184:187], v217 offset:21504
    buffer_load_dwordx4 v231, s[44:47], s68 offen offset:2048 lds
    v_mfma_f32_32x32x16_bf16 v[64:79], v[200:203], v[168:171], v[64:79]
    ds_read_b128 v[188:191], v217 offset:22528
    ds_read_b128 v[192:195], v217 offset:23552
    v_lshlrev_b32 v243, 4, v233
    v_mfma_f32_32x32x16_bf16 v[80:95], v[204:207], v[168:171], v[80:95]
    ds_read_b128 v[196:199], v217 offset:24576
    buffer_load_dwordx4 v232, s[44:47], s68 offen offset:3072 lds
    v_mfma_f32_32x32x16_bf16 v[96:111], v[200:203], v[172:175], v[96:111]
    buffer_load_dword v243, v243, s[56:59], s73 offen sc1
    v_permlane32_swap_b32 v234, v235
    v_mfma_f32_32x32x16_bf16 v[112:127], v[204:207], v[172:175], v[112:127]
    s_add_u32 m0, s71, 4096
    s_add_u32 s3, s3, 128
    s_cmp_eq_u32 s3, 1280
    s_cselect_b32 s3, 0, s3
    s_mul_i32 s26, s3, 1728
    s_add_u32 s68, s3, 0
    buffer_load_dwordx4 v228, s[40:43], s68 offen lds
    v_lshrrev_b32 v236, 1, v238
    v_mfma_f32_32x32x16_bf16 v[128:143], v[200:203], v[176:179], v[128:143]
    s_mul_i32 s101, s78, 2560
    s_add_u32 s101, s101, 4390912
    v_add_f32 v234, v234, v235
    v_mfma_f32_32x32x16_bf16 v[144:159], v[204:207], v[176:179], v[144:159]
    v_mov_b32 v235, s83
    s_add_u32 s73, s101, s31
    buffer_store_dwordx2 v[234:235], v236, s[56:59], s73 offen sc1
    s_waitcnt lgkmcnt(0)
    v_mfma_f32_32x32x16_bf16 v[0:15], v[208:211], v[180:183], v[0:15]
    ds_read_b64_tr_b16 v[200:201], v220 offset:20480
    ds_read_b64_tr_b16 v[202:203], v220 offset:20736
    v_mfma_f32_32x32x16_bf16 v[16:31], v[212:215], v[180:183], v[16:31]
    ds_read_b64_tr_b16 v[204:205], v220 offset:28672
    s_add_u32 m0, s71, 0
    s_nop 0
    buffer_load_dwordx4 v224, s[40:43], s68 offen offset:0 lds
    v_mfma_f32_32x32x16_bf16 v[32:47], v[208:211], v[184:187], v[32:47]
    ds_read_b64_tr_b16 v[206:207], v220 offset:28928
    ds_read_b128 v[160:163], v218 offset:20480
    v_mfma_f32_32x32x16_bf16 v[48:63], v[212:215], v[184:187], v[48:63]
    ds_read_b128 v[164:167], v218 offset:21504
    buffer_load_dwordx4 v225, s[40:43], s68 offen offset:1024 lds
    v_mfma_f32_32x32x16_bf16 v[64:79], v[208:211], v[188:191], v[64:79]
    ds_read_b128 v[168:171], v218 offset:22528
    ds_read_b128 v[172:175], v218 offset:23552
    v_mfma_f32_32x32x16_bf16 v[80:95], v[212:215], v[188:191], v[80:95]
    ds_read_b128 v[176:179], v218 offset:24576
    buffer_load_dwordx4 v226, s[40:43], s68 offen offset:2048 lds
    v_mfma_f32_32x32x16_bf16 v[96:111], v[208:211], v[192:195], v[96:111]
    v_mfma_f32_32x32x16_bf16 v[112:127], v[212:215], v[192:195], v[112:127]
    buffer_load_dwordx4 v227, s[40:43], s68 offen offset:3072 lds
    v_mfma_f32_32x32x16_bf16 v[128:143], v[208:211], v[196:199], v[128:143]
    v_mfma_f32_32x32x16_bf16 v[144:159], v[212:215], v[196:199], v[144:159]
    s_waitcnt lgkmcnt(0)
    v_mfma_f32_32x32x16_bf16 v[0:15], v[200:203], v[160:163], v[0:15]
    ds_read_b64_tr_b16 v[208:209], v220 offset:22528
    ds_read_b64_tr_b16 v[210:211], v220 offset:22784
    v_mfma_f32_32x32x16_bf16 v[16:31], v[204:207], v[160:163], v[16:31]
    ds_read_b64_tr_b16 v[212:213], v220 offset:30720
    s_add_u32 m0, s72, 32768
    s_add_u32 s68, s26, 0
    buffer_load_dwordx4 v229, s[44:47], s68 offen offset:0 lds
    v_mfma_f32_32x32x16_bf16 v[32:47], v[200:203], v[164:167], v[32:47]
    ds_read_b64_tr_b16 v[214:215], v220 offset:30976
    ds_read_b128 v[180:183], v219 offset:20480
    v_mfma_f32_32x32x16_bf16 v[48:63], v[204:207], v[164:167], v[48:63]
    ds_read_b128 v[184:187], v219 offset:21504
    v_mfma_f32_32x32x16_bf16 v[64:79], v[200:203], v[168:171], v[64:79]
    ds_read_b128 v[188:191], v219 offset:22528
    ds_read_b128 v[192:195], v219 offset:23552
    buffer_load_dwordx4 v230, s[44:47], s68 offen offset:1024 lds
    v_mfma_f32_32x32x16_bf16 v[80:95], v[204:207], v[168:171], v[80:95]
    ds_read_b128 v[196:199], v219 offset:24576
    v_mfma_f32_32x32x16_bf16 v[96:111], v[200:203], v[172:175], v[96:111]
    v_mfma_f32_32x32x16_bf16 v[112:127], v[204:207], v[172:175], v[112:127]
    buffer_load_dwordx4 v231, s[44:47], s68 offen offset:2048 lds
    v_mfma_f32_32x32x16_bf16 v[128:143], v[200:203], v[176:179], v[128:143]
    v_mfma_f32_32x32x16_bf16 v[144:159], v[204:207], v[176:179], v[144:159]
    s_waitcnt vmcnt(9)
    v_cmp_ne_u32 vcc, s83, v243
    s_cbranch_vccnz L_slow_f1_glu
L_go_f1_glu:
    s_barrier
    s_waitcnt lgkmcnt(0)
    v_mfma_f32_32x32x16_bf16 v[0:15], v[208:211], v[180:183], v[0:15]
    s_barrier
    ds_read_b64_tr_b16 v[200:201], v220 offset:0
    ds_read_b64_tr_b16 v[202:203], v220 offset:256
    v_mfma_f32_32x32x16_bf16 v[16:31], v[212:215], v[180:183], v[16:31]
    ds_read_b64_tr_b16 v[204:205], v220 offset:8192
    buffer_load_dwordx4 v232, s[44:47], s68 offen offset:3072 lds
    v_mfma_f32_32x32x16_bf16 v[32:47], v[208:211], v[184:187], v[32:47]
    ds_read_b64_tr_b16 v[206:207], v220 offset:8448
    ds_read_b128 v[160:163], v216 offset:40960
    s_add_u32 m0, s72, 36864
    s_add_u32 s68, s26, 110592
    buffer_load_dwordx4 v229, s[44:47], s68 offen offset:0 lds
    v_mfma_f32_32x32x16_bf16 v[48:63], v[212:215], v[184:187], v[48:63]
    ds_read_b128 v[164:167], v216 offset:41984
    v_mfma_f32_32x32x16_bf16 v[64:79], v[208:211], v[188:191], v[64:79]
    ds_read_b128 v[168:171], v216 offset:43008
    ds_read_b128 v[172:175], v216 offset:44032
    buffer_load_dwordx4 v230, s[44:47], s68 offen offset:1024 lds
    v_mfma_f32_32x32x16_bf16 v[80:95], v[212:215], v[188:191], v[80:95]
    ds_read_b128 v[176:179], v216 offset:45056
    v_mfma_f32_32x32x16_bf16 v[96:111], v[208:211], v[192:195], v[96:111]
    buffer_load_dwordx4 v231, s[44:47], s68 offen offset:2048 lds
    v_mfma_f32_32x32x16_bf16 v[112:127], v[212:215], v[192:195], v[112:127]
    v_mfma_f32_32x32x16_bf16 v[128:143], v[208:211], v[196:199], v[128:143]
    s_mul_i32 s100, s13, 160
    s_add_u32 s100, s100, s9
    buffer_load_dwordx4 a[40:43], v238, s[56:59], s100 offen offset:0 sc1
    v_mfma_f32_32x32x16_bf16 v[144:159], v[212:215], v[196:199], v[144:159]
    s_waitcnt lgkmcnt(0)
    v_mfma_f32_32x32x16_bf16 v[0:15], v[200:203], v[160:163], v[0:15]
    ds_read_b64_tr_b16 v[208:209], v220 offset:2048
    ds_read_b64_tr_b16 v[210:211], v220 offset:2304
    v_mfma_f32_32x32x16_bf16 v[16:31], v[204:207], v[160:163], v[16:31]
    ds_read_b64_tr_b16 v[212:213], v220 offset:10240
    buffer_load_dwordx4 v232, s[44:47], s68 offen offset:3072 lds
    v_mfma_f32_32x32x16_bf16 v[32:47], v[200:203], v[164:167], v[32:47]
    ds_read_b64_tr_b16 v[214:215], v220 offset:10496
    ds_read_b128 v[180:183], v217 offset:40960
    s_add_u32 m0, s71, 24576
    s_add_u32 s3, s3, 128
    s_cmp_eq_u32 s3, 1280
    s_cselect_b32 s3, 0, s3
    s_mul_i32 s26, s3, 1728
    s_add_u32 s68, s3, 0
    buffer_load_dwordx4 v228, s[40:43], s68 offen lds
    v_mfma_f32_32x32x16_bf16 v[48:63], v[204:207], v[164:167], v[48:63]
    ds_read_b128 v[184:187], v217 offset:41984
    v_mfma_f32_32x32x16_bf16 v[64:79], v[200:203], v[168:171], v[64:79]
    ds_read_b128 v[188:191], v217 offset:43008
    ds_read_b128 v[192:195], v217 offset:44032
    s_add_u32 m0, s71, 20480
    s_nop 0
    buffer_load_dwordx4 v224, s[40:43], s68 offen offset:0 lds
    v_mfma_f32_32x32x16_bf16 v[80:95], v[204:207], v[168:171], v[80:95]
    ds_read_b128 v[196:199], v217 offset:45056
    v_mfma_f32_32x32x16_bf16 v[96:111], v[200:203], v[172:175], v[96:111]
    buffer_load_dwordx4 v225, s[40:43], s68 offen offset:1024 lds
    v_mfma_f32_32x32x16_bf16 v[112:127], v[204:207], v[172:175], v[112:127]
    v_mfma_f32_32x32x16_bf16 v[128:143], v[200:203], v[176:179], v[128:143]
    buffer_load_dwordx4 a[44:47], v238, s[56:59], s100 offen offset:1024 sc1
    v_mfma_f32_32x32x16_bf16 v[144:159], v[204:207], v[176:179], v[144:159]
    s_waitcnt lgkmcnt(0)
    v_mfma_f32_32x32x16_bf16 v[0:15], v[208:211], v[180:183], v[0:15]
    ds_read_b64_tr_b16 v[200:201], v220 offset:4096
    ds_read_b64_tr_b16 v[202:203], v220 offset:4352
    v_mfma_f32_32x32x16_bf16 v[16:31], v[212:215], v[180:183], v[16:31]
    ds_read_b64_tr_b16 v[204:205], v220 offset:12288
    buffer_load_dwordx4 v226, s[40:43], s68 offen offset:2048 lds
    v_mfma_f32_32x32x16_bf16 v[32:47], v[208:211], v[184:187], v[32:47]
    ds_read_b64_tr_b16 v[206:207], v220 offset:12544
    ds_read_b128 v[160:163], v218 offset:40960
    buffer_load_dwordx4 v227, s[40:43], s68 offen offset:3072 lds
    v_mfma_f32_32x32x16_bf16 v[48:63], v[212:215], v[184:187], v[48:63]
    ds_read_b128 v[164:167], v218 offset:41984
    v_mfma_f32_32x32x16_bf16 v[64:79], v[208:211], v[188:191], v[64:79]
    ds_read_b128 v[168:171], v218 offset:43008
    ds_read_b128 v[172:175], v218 offset:44032
    s_add_u32 m0, s72, 16384
    s_add_u32 s68, s26, 0
    buffer_load_dwordx4 v229, s[44:47], s68 offen offset:0 lds
    v_mfma_f32_32x32x16_bf16 v[80:95], v[212:215], v[188:191], v[80:95]
    ds_read_b128 v[176:179], v218 offset:45056
    v_mfma_f32_32x32x16_bf16 v[96:111], v[208:211], v[192:195], v[96:111]
    buffer_load_dwordx4 a[48:51], v238, s[56:59], s100 offen offset:2048 sc1
    v_mfma_f32_32x32x16_bf16 v[112:127], v[212:215], v[192:195], v[112:127]
    v_mfma_f32_32x32x16_bf16 v[128:143], v[208:211], v[196:199], v[128:143]
    buffer_load_dwordx4 a[52:55], v238, s[56:59], s100 offen offset:3072 sc1
    v_mfma_f32_32x32x16_bf16 v[144:159], v[212:215], v[196:199], v[144:159]
    s_waitcnt lgkmcnt(0)
    v_mfma_f32_32x32x16_bf16 v[0:15], v[200:203], v[160:163], v[0:15]
    ds_read_b64_tr_b16 v[208:209], v220 offset:6144
    ds_read_b64_tr_b16 v[210:211], v220 offset:6400
    v_mfma_f32_32x32x16_bf16 v[16:31], v[204:207], v[160:163], v[16:31]
    ds_read_b64_tr_b16 v[212:213], v220 offset:14336
    buffer_load_dwordx4 v230, s[44:47], s68 offen offset:1024 lds
    v_mfma_f32_32x32x16_bf16 v[32:47], v[200:203], v[164:167], v[32:47]
    ds_read_b64_tr_b16 v[214:215], v220 offset:14592
    ds_read_b128 v[180:183], v219 offset:40960
    buffer_load_dwordx4 v231, s[44:47], s68 offen offset:2048 lds
    v_mfma_f32_32x32x16_bf16 v[48:63], v[204:207], v[164:167], v[48:63]
    ds_read_b128 v[184:187], v219 offset:41984
    v_mfma_f32_32x32x16_bf16 v[64:79], v[200:203], v[168:171], v[64:79]
    ds_read_b128 v[188:191], v219 offset:43008
    ds_read_b128 v[192:195], v219 offset:44032
    buffer_load_dwordx4 v232, s[44:47], s68 offen offset:3072 lds
    v_mfma_f32_32x32x16_bf16 v[80:95], v[204:207], v[168:171], v[80:95]
    ds_read_b128 v[196:199], v219 offset:45056
    v_mfma_f32_32x32x16_bf16 v[96:111], v[200:203], v[172:175], v[96:111]
    s_add_u32 m0, s72, 20480
    s_add_u32 s68, s26, 110592
    buffer_load_dwordx4 v229, s[44:47], s68 offen offset:0 lds
    v_mfma_f32_32x32x16_bf16 v[112:127], v[204:207], v[172:175], v[112:127]
    v_mfma_f32_32x32x16_bf16 v[128:143], v[200:203], v[176:179], v[128:143]
    s_add_u32 s100, s100, 4096
    buffer_load_dwordx4 a[56:59], v238, s[56:59], s100 offen offset:0 sc1
    v_mfma_f32_32x32x16_bf16 v[144:159], v[204:207], v[176:179], v[144:159]
    s_waitcnt lgkmcnt(0)
    v_mfma_f32_32x32x16_bf16 v[0:15], v[208:211], v[180:183], v[0:15]
    s_waitcnt vmcnt(14)
    s_barrier
    ds_read_b64_tr_b16 v[200:201], v220 offset:32768
    ds_read_b64_tr_b16 v[202:203], v220 offset:33024
    v_mfma_f32_32x32x16_bf16 v[16:31], v[212:215], v[180:183], v[16:31]
    ds_read_b64_tr_b16 v[204:205], v220 offset:40960
    buffer_load_dwordx4 v230, s[44:47], s68 offen offset:1024 lds
    v_mfma_f32_32x32x16_bf16 v[32:47], v[208:211], v[184:187], v[32:47]
    ds_read_b64_tr_b16 v[206:207], v220 offset:41216
    ds_read_b128 v[160:163], v216 offset:0
    buffer_load_dwordx4 v231, s[44:47], s68 offen offset:2048 lds
    v_mfma_f32_32x32x16_bf16 v[48:63], v[212:215], v[184:187], v[48:63]
    ds_read_b128 v[164:167], v216 offset:1024
    v_mfma_f32_32x32x16_bf16 v[64:79], v[208:211], v[188:191], v[64:79]
    ds_read_b128 v[168:171], v216 offset:2048
    ds_read_b128 v[172:175], v216 offset:3072
    buffer_load_dwordx4 v232, s[44:47], s68 offen offset:3072 lds
    v_mfma_f32_32x32x16_bf16 v[80:95], v[212:215], v[188:191], v[80:95]
    ds_read_b128 v[176:179], v216 offset:4096
    v_mfma_f32_32x32x16_bf16 v[96:111], v[208:211], v[192:195], v[96:111]
    s_add_u32 m0, s71, 45056
    s_add_u32 s3, s3, 128
    s_cmp_eq_u32 s3, 1280
    s_cselect_b32 s3, 0, s3
    s_mul_i32 s26, s3, 1728
    s_add_u32 s68, s3, 0
    buffer_load_dwordx4 v228, s[40:43], s68 offen lds
    v_mfma_f32_32x32x16_bf16 v[112:127], v[212:215], v[192:195], v[112:127]
    v_mfma_f32_32x32x16_bf16 v[128:143], v[208:211], v[196:199], v[128:143]
    s_mul_i32 s100, s13, 160
    s_add_u32 s100, s100, s9
    s_add_u32 s100, s100, 10240
    buffer_load_dwordx4 a[60:63], v238, s[56:59], s100 offen offset:0 sc1
    v_mfma_f32_32x32x16_bf16 v[144:159], v[212:215], v[196:199], v[144:159]
    s_waitcnt lgkmcnt(0)
    v_mfma_f32_32x32x16_bf16 v[0:15], v[200:203], v[160:163], v[0:15]
    ds_read_b64_tr_b16 v[208:209], v220 offset:34816
    ds_read_b64_tr_b16 v[210:211], v220 offset:35072
    v_mfma_f32_32x32x16_bf16 v[16:31], v[204:207], v[160:163], v[16:31]
    ds_read_b64_tr_b16 v[212:213], v220 offset:43008
    s_add_u32 m0, s71, 40960
    s_nop 0
    buffer_load_dwordx4 v224, s[40:43], s68 offen offset:0 lds
    v_mfma_f32_32x32x16_bf16 v[32:47], v[200:203], v[164:167], v[32:47]
    ds_read_b64_tr_b16 v[214:215], v220 offset:43264
    ds_read_b128 v[180:183], v217 offset:0
    v_mfma_f32_32x32x16_bf16 v[48:63], v[204:207], v[164:167], v[48:63]
    ds_read_b128 v[184:187], v217 offset:1024
    v_mfma_f32_32x32x16_bf16 v[64:79], v[200:203], v[168:171], v[64:79]
    ds_read_b128 v[188:191], v217 offset:2048
    ds_read_b128 v[192:195], v217 offset:3072
    buffer_load_dwordx4 v225, s[40:43], s68 offen offset:1024 lds
    v_mfma_f32_32x32x16_bf16 v[80:95], v[204:207], v[168:171], v[80:95]
    ds_read_b128 v[196:199], v217 offset:4096
    v_mfma_f32_32x32x16_bf16 v[96:111], v[200:203], v[172:175], v[96:111]
    v_mfma_f32_32x32x16_bf16 v[112:127], v[204:207], v[172:175], v[112:127]
    buffer_load_dwordx4 v226, s[40:43], s68 offen offset:2048 lds
    v_mfma_f32_32x32x16_bf16 v[128:143], v[200:203], v[176:179], v[128:143]
    buffer_load_dwordx2 a[240:241], v236, s[56:59], s101 offen offset:0 sc1
    v_mfma_f32_32x32x16_bf16 v[144:159], v[204:207], v[176:179], v[144:159]
    buffer_load_dwordx2 a[242:243], v236, s[56:59], s101 offen offset:512 sc1
    buffer_load_dwordx2 a[244:245], v236, s[56:59], s101 offen offset:1024 sc1
    s_waitcnt lgkmcnt(0)
    v_mfma_f32_32x32x16_bf16 v[0:15], v[208:211], v[180:183], v[0:15]
    ds_read_b64_tr_b16 v[200:201], v220 offset:36864
    ds_read_b64_tr_b16 v[202:203], v220 offset:37120
    v_mfma_f32_32x32x16_bf16 v[16:31], v[212:215], v[180:183], v[16:31]
    ds_read_b64_tr_b16 v[204:205], v220 offset:45056
    buffer_load_dwordx4 v227, s[40:43], s68 offen offset:3072 lds
    v_mfma_f32_32x32x16_bf16 v[32:47], v[208:211], v[184:187], v[32:47]
    ds_read_b64_tr_b16 v[206:207], v220 offset:45312
    ds_read_b128 v[160:163], v218 offset:0
    v_mfma_f32_32x32x16_bf16 v[48:63], v[212:215], v[184:187], v[48:63]
    ds_read_b128 v[164:167], v218 offset:1024
    s_add_u32 m0, s72, 0
    s_add_u32 s68, s26, 0
    buffer_load_dwordx4 v229, s[44:47], s68 offen offset:0 lds
    v_mfma_f32_32x32x16_bf16 v[64:79], v[208:211], v[188:191], v[64:79]
    ds_read_b128 v[168:171], v218 offset:2048
    ds_read_b128 v[172:175], v218 offset:3072
    v_mfma_f32_32x32x16_bf16 v[80:95], v[212:215], v[188:191], v[80:95]
    ds_read_b128 v[176:179], v218 offset:4096
    buffer_load_dwordx4 v230, s[44:47], s68 offen offset:1024 lds
    v_mfma_f32_32x32x16_bf16 v[96:111], v[208:211], v[192:195], v[96:111]
    v_mfma_f32_32x32x16_bf16 v[112:127], v[212:215], v[192:195], v[112:127]
    buffer_load_dwordx4 v231, s[44:47], s68 offen offset:2048 lds
    v_mfma_f32_32x32x16_bf16 v[128:143], v[208:211], v[196:199], v[128:143]
    v_mfma_f32_32x32x16_bf16 v[144:159], v[212:215], v[196:199], v[144:159]
    buffer_load_dwordx2 a[246:247], v236, s[56:59], s101 offen offset:1536 sc1
    buffer_load_dwordx2 a[248:249], v236, s[56:59], s101 offen offset:2048 sc1
    s_waitcnt lgkmcnt(0)
    v_mfma_f32_32x32x16_bf16 v[0:15], v[200:203], v[160:163], v[0:15]
    ds_read_b64_tr_b16 v[208:209], v220 offset:38912
    ds_read_b64_tr_b16 v[210:211], v220 offset:39168
    v_mfma_f32_32x32x16_bf16 v[16:31], v[204:207], v[160:163], v[16:31]
    ds_read_b64_tr_b16 v[212:213], v220 offset:47104
    buffer_load_dwordx4 v232, s[44:47], s68 offen offset:3072 lds
    v_mfma_f32_32x32x16_bf16 v[32:47], v[200:203], v[164:167], v[32:47]
    ds_read_b64_tr_b16 v[214:215], v220 offset:47360
    ds_read_b128 v[180:183], v219 offset:0
    v_mfma_f32_32x32x16_bf16 v[48:63], v[204:207], v[164:167], v[48:63]
    ds_read_b128 v[184:187], v219 offset:1024
    s_add_u32 m0, s72, 4096
    s_add_u32 s68, s26, 110592
    buffer_load_dwordx4 v229, s[44:47], s68 offen offset:0 lds
    v_mfma_f32_32x32x16_bf16 v[64:79], v[200:203], v[168:171], v[64:79]
    ds_read_b128 v[188:191], v219 offset:2048
    ds_read_b128 v[192:195], v219 offset:3072
    v_mfma_f32_32x32x16_bf16 v[80:95], v[204:207], v[168:171], v[80:95]
    ds_read_b128 v[196:199], v219 offset:4096
    buffer_load_dwordx4 v230, s[44:47], s68 offen offset:1024 lds
    v_mfma_f32_32x32x16_bf16 v[96:111], v[200:203], v[172:175], v[96:111]
    v_mfma_f32_32x32x16_bf16 v[112:127], v[204:207], v[172:175], v[112:127]
    buffer_load_dwordx4 v231, s[44:47], s68 offen offset:2048 lds
    v_mfma_f32_32x32x16_bf16 v[128:143], v[200:203], v[176:179], v[128:143]
    v_mfma_f32_32x32x16_bf16 v[144:159], v[204:207], v[176:179], v[144:159]
    s_waitcnt lgkmcnt(0)
    v_mfma_f32_32x32x16_bf16 v[0:15], v[208:211], v[180:183], v[0:15]
    s_waitcnt vmcnt(18)
    s_barrier
    ds_read_b64_tr_b16 v[200:201], v220 offset:16384
    ds_read_b64_tr_b16 v[202:203], v220 offset:16640
    v_mfma_f32_32x32x16_bf16 v[16:31], v[212:215], v[180:183], v[16:31]
    ds_read_b64_tr_b16 v[204:205], v220 offset:24576
    buffer_load_dwordx4 v232, s[44:47], s68 offen offset:3072 lds
    v_mfma_f32_32x32x16_bf16 v[32:47], v[208:211], v[184:187], v[32:47]
    ds_read_b64_tr_b16 v[206:207], v220 offset:24832
    ds_read_b128 v[160:163], v216 offset:20480
    v_mfma_f32_32x32x16_bf16 v[48:63], v[212:215], v[184:187], v[48:63]
    ds_read_b128 v[164:167], v216 offset:21504
    s_add_u32 m0, s71, 4096
    s_add_u32 s3, s3, 128
    s_cmp_eq_u32 s3, 1280
    s_cselect_b32 s3, 0, s3
    s_mul_i32 s26, s3, 1728
    s_add_u32 s68, s3, 0
    buffer_load_dwordx4 v228, s[40:43], s68 offen lds
    v_mfma_f32_32x32x16_bf16 v[64:79], v[208:211], v[188:191], v[64:79]
    ds_read_b128 v[168:171], v216 offset:22528
    ds_read_b128 v[172:175], v216 offset:23552
    v_mfma_f32_32x32x16_bf16 v[80:95], v[212:215], v[188:191], v[80:95]
    ds_read_b128 v[176:179], v216 offset:24576
    s_add_u32 m0, s71, 0
    s_nop 0
    buffer_load_dwordx4 v224, s[40:43], s68 offen offset:0 lds
    v_mfma_f32_32x32x16_bf16 v[96:111], v[208:211], v[192:195], v[96:111]
    v_mfma_f32_32x32x16_bf16 v[112:127], v[212:215], v[192:195], v[112:127]
    buffer_load_dwordx4 a[64:67], v238, s[56:59], s100 offen offset:1024 sc1
    v_mfma_f32_32x32x16_bf16 v[128:143], v[208:211], v[196:199], v[128:143]
    v_mfma_f32_32x32x16_bf16 v[144:159], v[212:215], v[196:199], v[144:159]
    s_waitcnt lgkmcnt(0)
    v_mfma_f32_32x32x16_bf16 v[0:15], v[200:203], v[160:163], v[0:15]
    ds_read_b64_tr_b16 v[208:209], v220 offset:18432
    ds_read_b64_tr_b16 v[210:211], v220 offset:18688
    s_waitcnt vmcnt(8)
    v_accvgpr_read_b32 v234, a241
    v_mfma_f32_32x32x16_bf16 v[16:31], v[204:207], v[160:163], v[16:31]
    ds_read_b64_tr_b16 v[212:213], v220 offset:26624
    buffer_load_dwordx4 v225, s[40:43], s68 offen offset:1024 lds
    v_mfma_f32_32x32x16_bf16 v[32:47], v[200:203], v[164:167], v[32:47]
    ds_read_b64_tr_b16 v[214:215], v220 offset:26880
    ds_read_b128 v[180:183], v217 offset:20480
    buffer_load_dwordx4 v226, s[40:43], s68 offen offset:2048 lds
    v_mfma_f32_32x32x16_bf16 v[48:63], v[204:207], v[164:167], v[48:63]
    ds_read_b128 v[184:187], v217 offset:21504
    v_xor_b32 v234, s83, v234
    v_accvgpr_read_b32 v235, a243
    v_mfma_f32_32x32x16_bf16 v[64:79], v[200:203], v[168:171], v[64:79]
    ds_read_b128 v[188:191], v217 offset:22528
    ds_read_b128 v[192:195], v217 offset:23552
    buffer_load_dwordx4 v227, s[40:43], s68 offen offset:3072 lds
    v_mfma_f32_32x32x16_bf16 v[80:95], v[204:207], v[168:171], v[80:95]
    ds_read_b128 v[196:199], v217 offset:24576
    v_xor_b32 v235, s83, v235
    v_or_b32 v234, v234, v235
    v_mfma_f32_32x32x16_bf16 v[96:111], v[200:203], v[172:175], v[96:111]
    s_add_u32 m0, s72, 32768
    s_add_u32 s68, s26, 0
    buffer_load_dwordx4 v229, s[44:47], s68 offen offset:0 lds
    v_accvgpr_read_b32 v235, a245
    v_xor_b32 v235, s83, v235
    v_mfma_f32_32x32x16_bf16 v[112:127], v[204:207], v[172:175], v[112:127]
    v_or_b32 v234, v234, v235
    v_accvgpr_read_b32 v235, a247
    v_xor_b32 v235, s83, v235
    v_mfma_f32_32x32x16_bf16 v[128:143], v[200:203], v[176:179], v[128:143]
    buffer_load_dwordx4 a[68:71], v238, s[56:59], s100 offen offset:2048 sc1
    v_or_b32 v234, v234, v235
    v_accvgpr_read_b32 v235, a249
    v_xor_b32 v235, s83, v235
    v_mfma_f32_32x32x16_bf16 v[144:159], v[204:207], v[176:179], v[144:159]
    v_or_b32 v234, v234, v235
    v_cmp_ne_u32 vcc, 0, v234
    s_cbranch_vccnz L_slow_sum_glu
L_go_sum_glu:
    s_waitcnt lgkmcnt(0)
    v_mfma_f32_32x32x16_bf16 v[0:15], v[208:211], v[180:183], v[0:15]
    ds_read_b64_tr_b16 v[200:201], v220 offset:20480
    ds_read_b64_tr_b16 v[202:203], v220 offset:20736
    s_lshr_b32 s73, s2, 3
    s_mul_i32 s73, s73, 3072
    v_mfma_f32_32x32x16_bf16 v[16:31], v[212:215], v[180:183], v[16:31]
    ds_read_b64_tr_b16 v[204:205], v220 offset:28672
    buffer_load_dwordx4 v230, s[44:47], s68 offen offset:1024 lds
    v_mfma_f32_32x32x16_bf16 v[32:47], v[208:211], v[184:187], v[32:47]
    ds_read_b64_tr_b16 v[206:207], v220 offset:28928
    ds_read_b128 v[160:163], v218 offset:20480
    s_cmp_eq_u32 s64, 0
    s_cselect_b32 s73, s73, 134217728
    v_mfma_f32_32x32x16_bf16 v[48:63], v[212:215], v[184:187], v[48:63]
    ds_read_b128 v[164:167], v218 offset:21504
    buffer_load_dwordx4 v231, s[44:47], s68 offen offset:2048 lds
    v_mfma_f32_32x32x16_bf16 v[64:79], v[208:211], v[188:191], v[64:79]
    ds_read_b128 v[168:171], v218 offset:22528
    ds_read_b128 v[172:175], v218 offset:23552
    v_lshl_add_u32 v243, v233, 7, s73
    v_mfma_f32_32x32x16_bf16 v[80:95], v[212:215], v[188:191], v[80:95]
    ds_read_b128 v[176:179], v218 offset:24576
    buffer_load_dwordx4 v232, s[44:47], s68 offen offset:3072 lds
    v_mfma_f32_32x32x16_bf16 v[96:111], v[208:211], v[192:195], v[96:111]
    s_mov_b32 exec_lo, 16777215
    s_mov_b32 exec_hi, 0
    buffer_load_dword a255, v243, s[84:87], 0 offen
    s_mov_b64 exec, -1
    v_accvgpr_read_b32 v254, a240
    v_mfma_f32_32x32x16_bf16 v[112:127], v[212:215], v[192:195], v[112:127]
    s_add_u32 m0, s72, 36864
    s_add_u32 s68, s26, 110592
    buffer_load_dwordx4 v229, s[44:47], s68 offen offset:0 lds
    v_accvgpr_read_b32 v234, a242
    v_mfma_f32_32x32x16_bf16 v[128:143], v[208:211], v[196:199], v[128:143]
    v_add_f32 v254, v254, v234
    v_accvgpr_read_b32 v234, a244
    v_add_f32 v254, v254, v234
    v_accvgpr_read_b32 v234, a246
    v_mfma_f32_32x32x16_bf16 v[144:159], v[212:215], v[196:199], v[144:159]
    v_add_f32 v254, v254, v234
    v_accvgpr_read_b32 v234, a248
    v_add_f32 v254, v254, v234
    s_waitcnt lgkmcnt(0)
    v_mfma_f32_32x32x16_bf16 v[0:15], v[200:203], v[160:163], v[0:15]
    ds_read_b64_tr_b16 v[208:209], v220 offset:22528
    ds_read_b64_tr_b16 v[210:211], v220 offset:22784
    s_lshl_b32 s75, s78, 12
    v_mfma_f32_32x32x16_bf16 v[16:31], v[204:207], v[160:163], v[16:31]
    ds_read_b64_tr_b16 v[212:213], v220 offset:30720
    buffer_load_dwordx4 v230, s[44:47], s68 offen offset:1024 lds
    s_cmp_ge_u32 s78, 54
    s_cselect_b32 s21, 134217728, s75
    v_mfma_f32_32x32x16_bf16 v[32:47], v[200:203], v[164:167], v[32:47]
    ds_read_b64_tr_b16 v[214:215], v220 offset:30976
    ds_read_b128 v[180:183], v219 offset:20480
    buffer_load_dwordx4 v231, s[44:47], s68 offen offset:2048 lds
    v_mfma_f32_32x32x16_bf16 v[48:63], v[204:207], v[164:167], v[48:63]
    ds_read_b128 v[184:187], v219 offset:21504
    s_mul_i32 s73, s65, 5
    v_mfma_f32_32x32x16_bf16 v[64:79], v[200:203], v[168:171], v[64:79]
    ds_read_b128 v[188:191], v219 offset:22528
    ds_read_b128 v[192:195], v219 offset:23552
    buffer_load_dwordx4 v232, s[44:47], s68 offen offset:3072 lds
    v_mfma_f32_32x32x16_bf16 v[80:95], v[204:207], v[168:171], v[80:95]
    ds_read_b128 v[196:199], v219 offset:24576
    s_add_u32 s73, s73, 0
    s_lshr_b32 s74, s73, 1
    v_mfma_f32_32x32x16_bf16 v[96:111], v[200:203], v[172:175], v[96:111]
    buffer_load_dwordx4 a[72:75], v238, s[56:59], s100 offen offset:3072 sc1
    s_mul_i32 s74, s74, 380928
    s_lshl_b32 s73, s73, 11
    s_add_u32 s74, s74, s73
    v_mfma_f32_32x32x16_bf16 v[112:127], v[204:207], v[172:175], v[112:127]
    s_add_u32 s16, s74, s21
    s_mul_i32 s73, s65, 5
    s_add_u32 s73, s73, 1
    v_mfma_f32_32x32x16_bf16 v[128:143], v[200:203], v[176:179], v[128:143]
    s_add_u32 s100, s100, 4096
    buffer_load_dwordx4 a[76:79], v238, s[56:59], s100 offen offset:0 sc1
    s_lshr_b32 s74, s73, 1
    s_mul_i32 s74, s74, 380928
    v_mfma_f32_32x32x16_bf16 v[144:159], v[204:207], v[176:179], v[144:159]
    s_lshl_b32 s73, s73, 11
    s_add_u32 s74, s74, s73
    s_add_u32 s17, s74, s21
    s_waitcnt lgkmcnt(0)
    v_mfma_f32_32x32x16_bf16 v[0:15], v[208:211], v[180:183], v[0:15]
    s_waitcnt vmcnt(18)
    s_barrier
    ds_read_b64_tr_b16 v[200:201], v220 offset:0
    ds_read_b64_tr_b16 v[202:203], v220 offset:256
    s_mul_i32 s73, s65, 5
    v_mfma_f32_32x32x16_bf16 v[16:31], v[212:215], v[180:183], v[16:31]
    ds_read_b64_tr_b16 v[204:205], v220 offset:8192
    s_mul_i32 s100, s14, 160
    s_add_u32 s100, s100, s9
    buffer_load_dwordx4 a[80:83], v238, s[56:59], s100 offen offset:0 sc1
    v_mfma_f32_32x32x16_bf16 v[32:47], v[208:211], v[184:187], v[32:47]
    ds_read_b64_tr_b16 v[206:207], v220 offset:8448
    ds_read_b128 v[160:163], v216 offset:40960
    buffer_load_dwordx4 a[84:87], v238, s[56:59], s100 offen offset:1024 sc1
    s_add_u32 s73, s73, 2
    v_mfma_f32_32x32x16_bf16 v[48:63], v[212:215], v[184:187], v[48:63]
    ds_read_b128 v[164:167], v216 offset:41984
    s_lshr_b32 s74, s73, 1
    s_mul_i32 s74, s74, 380928
    s_lshl_b32 s73, s73, 11
    v_mfma_f32_32x32x16_bf16 v[64:79], v[208:211], v[188:191], v[64:79]
    ds_read_b128 v[168:171], v216 offset:43008
    ds_read_b128 v[172:175], v216 offset:44032
    buffer_load_dwordx4 a[88:91], v238, s[56:59], s100 offen offset:2048 sc1
    s_add_u32 s74, s74, s73
    v_mfma_f32_32x32x16_bf16 v[80:95], v[212:215], v[188:191], v[80:95]
    ds_read_b128 v[176:179], v216 offset:45056
    s_add_u32 s18, s74, s21
    s_mul_i32 s73, s65, 5
    v_mfma_f32_32x32x16_bf16 v[96:111], v[208:211], v[192:195], v[96:111]
    buffer_load_dwordx4 a[92:95], v238, s[56:59], s100 offen offset:3072 sc1
    s_add_u32 s73, s73, 3
    s_lshr_b32 s74, s73, 1
    s_mul_i32 s74, s74, 380928
    v_mfma_f32_32x32x16_bf16 v[112:127], v[212:215], v[192:195], v[112:127]
    s_lshl_b32 s73, s73, 11
    s_add_u32 s74, s74, s73
    s_add_u32 s19, s74, s21
    s_mul_i32 s73, s65, 5
    v_mfma_f32_32x32x16_bf16 v[128:143], v[208:211], v[196:199], v[128:143]
    s_add_u32 s100, s100, 4096
    buffer_load_dwordx4 a[96:99], v238, s[56:59], s100 offen offset:0 sc1
    s_add_u32 s73, s73, 4
    s_lshr_b32 s74, s73, 1
    v_mfma_f32_32x32x16_bf16 v[144:159], v[212:215], v[196:199], v[144:159]
    s_mul_i32 s74, s74, 380928
    s_lshl_b32 s73, s73, 11
    s_add_u32 s74, s74, s73
    s_add_u32 s20, s74, s21
    s_waitcnt lgkmcnt(0)
    v_mfma_f32_32x32x16_bf16 v[0:15], v[200:203], v[160:163], v[0:15]
    ds_read_b64_tr_b16 v[208:209], v220 offset:2048
    ds_read_b64_tr_b16 v[210:211], v220 offset:2304
    v_mfma_f32_32x32x16_bf16 v[16:31], v[204:207], v[160:163], v[16:31]
    ds_read_b64_tr_b16 v[212:213], v220 offset:10240
    s_mul_i32 s100, s14, 160
    s_add_u32 s100, s100, s9
    s_add_u32 s100, s100, 10240
    buffer_load_dwordx4 a[100:103], v238, s[56:59], s100 offen offset:0 sc1
    v_mfma_f32_32x32x16_bf16 v[32:47], v[200:203], v[164:167], v[32:47]
    ds_read_b64_tr_b16 v[214:215], v220 offset:10496
    ds_read_b128 v[180:183], v217 offset:40960
    buffer_load_dwordx4 a[104:107], v238, s[56:59], s100 offen offset:1024 sc1
    v_mfma_f32_32x32x16_bf16 v[48:63], v[204:207], v[164:167], v[48:63]
    ds_read_b128 v[184:187], v217 offset:41984
    v_mfma_f32_32x32x16_bf16 v[64:79], v[200:203], v[168:171], v[64:79]
    ds_read_b128 v[188:191], v217 offset:43008
    ds_read_b128 v[192:195], v217 offset:44032
    buffer_load_dwordx4 a[108:111], v238, s[56:59], s100 offen offset:2048 sc1
    v_mfma_f32_32x32x16_bf16 v[80:95], v[204:207], v[168:171], v[80:95]
    ds_read_b128 v[196:199], v217 offset:45056
    v_mfma_f32_32x32x16_bf16 v[96:111], v[200:203], v[172:175], v[96:111]
    buffer_load_dwordx4 a[112:115], v238, s[56:59], s100 offen offset:3072 sc1
    v_mfma_f32_32x32x16_bf16 v[112:127], v[204:207], v[172:175], v[112:127]
    v_mfma_f32_32x32x16_bf16 v[128:143], v[200:203], v[176:179], v[128:143]
    s_add_u32 s100, s100, 4096
    buffer_load_dwordx4 a[116:119], v238, s[56:59], s100 offen offset:0 sc1
    v_mfma_f32_32x32x16_bf16 v[144:159], v[204:207], v[176:179], v[144:159]
    s_waitcnt lgkmcnt(0)
    v_mfma_f32_32x32x16_bf16 v[0:15], v[208:211], v[180:183], v[0:15]
    ds_read_b64_tr_b16 v[200:201], v220 offset:4096
    ds_read_b64_tr_b16 v[202:203], v220 offset:4352
    v_mfma_f32_32x32x16_bf16 v[16:31], v[212:215], v[180:183], v[16:31]
    ds_read_b64_tr_b16 v[204:205], v220 offset:12288
    s_mul_i32 s100, s15, 160
    s_add_u32 s100, s100, s9
    buffer_load_dwordx4 a[120:123], v238, s[56:59], s100 offen offset:0 sc1
    v_mfma_f32_32x32x16_bf16 v[32:47], v[208:211], v[184:187], v[32:47]
    ds_read_b64_tr_b16 v[206:207], v220 offset:12544
    ds_read_b128 v[160:163], v218 offset:40960
    v_mfma_f32_32x32x16_bf16 v[48:63], v[212:215], v[184:187], v[48:63]
    ds_read_b128 v[164:167], v218 offset:41984
    v_mfma_f32_32x32x16_bf16 v[64:79], v[208:211], v[188:191], v[64:79]
    ds_read_b128 v[168:171], v218 offset:43008
    ds_read_b128 v[172:175], v218 offset:44032
    v_mfma_f32_32x32x16_bf16 v[80:95], v[212:215], v[188:191], v[80:95]
    ds_read_b128 v[176:179], v218 offset:45056
    buffer_load_dwordx4 a[124:127], v238, s[56:59], s100 offen offset:1024 sc1
    v_mfma_f32_32x32x16_bf16 v[96:111], v[208:211], v[192:195], v[96:111]
    s_mul_i32 s27, s65, 1280
    v_mfma_f32_32x32x16_bf16 v[112:127], v[212:215], v[192:195], v[112:127]
    s_add_u32 s27, s27, 4194304
    v_lshrrev_b32 v240, 1, v238
    v_mfma_f32_32x32x16_bf16 v[128:143], v[208:211], v[196:199], v[128:143]
    v_and_b32 v239, 0xf8, v240
    buffer_load_dwordx2 v[244:245], v239, s[56:59], s27 offen offset:0 sc1
    v_mfma_f32_32x32x16_bf16 v[144:159], v[212:215], v[196:199], v[144:159]
    buffer_load_dwordx2 v[246:247], v239, s[56:59], s27 offen offset:256 sc1
    buffer_load_dwordx2 v[248:249], v239, s[56:59], s27 offen offset:512 sc1
    s_waitcnt lgkmcnt(0)
    v_mfma_f32_32x32x16_bf16 v[0:15], v[200:203], v[160:163], v[0:15]
    ds_read_b64_tr_b16 v[208:209], v220 offset:6144
    ds_read_b64_tr_b16 v[210:211], v220 offset:6400
    v_mfma_f32_32x32x16_bf16 v[16:31], v[204:207], v[160:163], v[16:31]
    ds_read_b64_tr_b16 v[212:213], v220 offset:14336
    buffer_load_dwordx4 a[128:131], v238, s[56:59], s100 offen offset:2048 sc1
    v_mfma_f32_32x32x16_bf16 v[32:47], v[200:203], v[164:167], v[32:47]
    ds_read_b64_tr_b16 v[214:215], v220 offset:14592
    ds_read_b128 v[180:183], v219 offset:40960
    v_mfma_f32_32x32x16_bf16 v[48:63], v[204:207], v[164:167], v[48:63]
    ds_read_b128 v[184:187], v219 offset:41984
    v_mfma_f32_32x32x16_bf16 v[64:79], v[200:203], v[168:171], v[64:79]
    ds_read_b128 v[188:191], v219 offset:43008
    ds_read_b128 v[192:195], v219 offset:44032
    buffer_load_dwordx4 a[132:135], v238, s[56:59], s100 offen offset:3072 sc1
    v_mfma_f32_32x32x16_bf16 v[80:95], v[204:207], v[168:171], v[80:95]
    ds_read_b128 v[196:199], v219 offset:45056
    v_mfma_f32_32x32x16_bf16 v[96:111], v[200:203], v[172:175], v[96:111]
    v_mfma_f32_32x32x16_bf16 v[112:127], v[204:207], v[172:175], v[112:127]
    s_add_u32 s100, s100, 4096
    buffer_load_dwordx4 a[136:139], v238, s[56:59], s100 offen offset:0 sc1
    v_mfma_f32_32x32x16_bf16 v[128:143], v[200:203], v[176:179], v[128:143]
    buffer_load_dwordx2 v[250:251], v239, s[56:59], s27 offen offset:768 sc1
    v_mfma_f32_32x32x16_bf16 v[144:159], v[204:207], v[176:179], v[144:159]
    buffer_load_dwordx2 v[252:253], v239, s[56:59], s27 offen offset:1024 sc1
    s_waitcnt lgkmcnt(0)
    v_mfma_f32_32x32x16_bf16 v[0:15], v[208:211], v[180:183], v[0:15]
    s_waitcnt vmcnt(22)
    s_barrier
    ds_read_b64_tr_b16 v[200:201], v220 offset:32768
    ds_read_b64_tr_b16 v[202:203], v220 offset:33024
    v_mfma_f32_32x32x16_bf16 v[16:31], v[212:215], v[180:183], v[16:31]
    ds_read_b64_tr_b16 v[204:205], v220 offset:40960
    s_mul_i32 s100, s15, 160
    s_add_u32 s100, s100, s9
    s_add_u32 s100, s100, 10240
    buffer_load_dwordx4 a[140:143], v238, s[56:59], s100 offen offset:0 sc1
    v_mfma_f32_32x32x16_bf16 v[32:47], v[208:211], v[184:187], v[32:47]
    ds_read_b64_tr_b16 v[206:207], v220 offset:41216
    ds_read_b128 v[160:163], v216 offset:0
    buffer_load_dwordx4 a[144:147], v238, s[56:59], s100 offen offset:1024 sc1
    v_mfma_f32_32x32x16_bf16 v[48:63], v[212:215], v[184:187], v[48:63]
    ds_read_b128 v[164:167], v216 offset:1024
    v_mfma_f32_32x32x16_bf16 v[64:79], v[208:211], v[188:191], v[64:79]
    ds_read_b128 v[168:171], v216 offset:2048
    ds_read_b128 v[172:175], v216 offset:3072
    buffer_load_dwordx4 a[148:151], v238, s[56:59], s100 offen offset:2048 sc1
    v_mfma_f32_32x32x16_bf16 v[80:95], v[212:215], v[188:191], v[80:95]
    ds_read_b128 v[176:179], v216 offset:4096
    v_mfma_f32_32x32x16_bf16 v[96:111], v[208:211], v[192:195], v[96:111]
    buffer_load_dwordx4 a[152:155], v238, s[56:59], s100 offen offset:3072 sc1
    v_mfma_f32_32x32x16_bf16 v[112:127], v[212:215], v[192:195], v[112:127]
    v_mfma_f32_32x32x16_bf16 v[128:143], v[208:211], v[196:199], v[128:143]
    s_add_u32 s100, s100, 4096
    buffer_load_dwordx4 a[156:159], v238, s[56:59], s100 offen offset:0 sc1
    v_mfma_f32_32x32x16_bf16 v[144:159], v[212:215], v[196:199], v[144:159]
    s_waitcnt lgkmcnt(0)
    v_mfma_f32_32x32x16_bf16 v[0:15], v[200:203], v[160:163], v[0:15]
    ds_read_b64_tr_b16 v[208:209], v220 offset:34816
    ds_read_b64_tr_b16 v[210:211], v220 offset:35072
    s_lshl_b32 s73, s4, 1
    v_lshrrev_b32 v242, 5, v233
    v_mfma_f32_32x32x16_bf16 v[16:31], v[204:207], v[160:163], v[16:31]
    ds_read_b64_tr_b16 v[212:213], v220 offset:43008
    s_mul_i32 s100, s30, 160
    s_add_u32 s100, s100, s9
    buffer_load_dwordx4 a[160:163], v238, s[56:59], s100 offen offset:0 sc1
    v_add_u32 v242, s73, v242
    v_mfma_f32_32x32x16_bf16 v[32:47], v[200:203], v[164:167], v[32:47]
    ds_read_b64_tr_b16 v[214:215], v220 offset:43264
    ds_read_b128 v[180:183], v217 offset:0
    buffer_load_dwordx4 a[164:167], v238, s[56:59], s100 offen offset:1024 sc1
    v_mul_u32_u24 v242, 205, v242
    v_mfma_f32_32x32x16_bf16 v[48:63], v[204:207], v[164:167], v[48:63]
    ds_read_b128 v[184:187], v217 offset:1024
    v_lshrrev_b32 v242, 10, v242
    v_and_b32 v241, 15, v233
    v_lshl_add_u32 v242, v242, 6, v241
    s_lshl_b32 s75, s64, 4
    v_mfma_f32_32x32x16_bf16 v[64:79], v[200:203], v[168:171], v[64:79]
    ds_read_b128 v[188:191], v217 offset:2048
    ds_read_b128 v[192:195], v217 offset:3072
    buffer_load_dwordx4 a[168:171], v238, s[56:59], s100 offen offset:2048 sc1
    v_add_u32 v242, s75, v242
    v_mfma_f32_32x32x16_bf16 v[80:95], v[204:207], v[168:171], v[80:95]
    ds_read_b128 v[196:199], v217 offset:4096
    v_and_b32 v243, 14, v241
    s_and_b32 s74, s64, 2
    s_lshr_b32 s73, s4, 1
    v_mfma_f32_32x32x16_bf16 v[96:111], v[200:203], v[172:175], v[96:111]
    buffer_load_dwordx4 a[172:175], v238, s[56:59], s100 offen offset:3072 sc1
    s_lshl_b32 s73, s73, 5
    s_add_u32 s74, s74, s73
    s_add_u32 s74, s74, 1024
    v_add3_u32 v243, v243, v241, s74
    v_mfma_f32_32x32x16_bf16 v[112:127], v[204:207], v[172:175], v[112:127]
    v_and_b32 v241, 16, v233
    v_cmp_eq_u32 vcc, 0, v241
    s_mov_b32 s28, 5046272
    s_nop 0
    v_mfma_f32_32x32x16_bf16 v[128:143], v[200:203], v[176:179], v[128:143]
    s_add_u32 s100, s100, 4096
    buffer_load_dwordx4 a[176:179], v238, s[56:59], s100 offen offset:0 sc1
    v_cndmask_b32 v231, v243, v242, vcc
    v_lshlrev_b32 v231, 5, v231
    v_mfma_f32_32x32x16_bf16 v[144:159], v[204:207], v[176:179], v[144:159]
    s_cmp_ge_u32 s64, 2
    s_cselect_b32 s23, 0, 0x2000
    s_or_b32 s22, s23, 0x3ff0000
    s_mov_b32 s10, 0x1fff
    s_mov_b32 s11, 0x1fff
    s_waitcnt lgkmcnt(0)
    v_mfma_f32_32x32x16_bf16 v[0:15], v[208:211], v[180:183], v[0:15]
    ds_read_b64_tr_b16 v[200:201], v220 offset:36864
    ds_read_b64_tr_b16 v[202:203], v220 offset:37120
    s_waitcnt vmcnt(10)
    v_xor_b32 v241, s83, v245
    v_xor_b32 v242, s83, v247
    v_mfma_f32_32x32x16_bf16 v[16:31], v[212:215], v[180:183], v[16:31]
    ds_read_b64_tr_b16 v[204:205], v220 offset:45056
    s_mul_i32 s100, s30, 160
    s_add_u32 s100, s100, s9
    s_add_u32 s100, s100, 10240
    buffer_load_dwordx4 a[180:183], v238, s[56:59], s100 offen offset:0 sc1
    v_mfma_f32_32x32x16_bf16 v[32:47], v[208:211], v[184:187], v[32:47]
    ds_read_b64_tr_b16 v[206:207], v220 offset:45312
    ds_read_b128 v[160:163], v218 offset:0
    buffer_load_dwordx4 a[184:187], v238, s[56:59], s100 offen offset:1024 sc1
    v_or_b32 v241, v241, v242
    v_mfma_f32_32x32x16_bf16 v[48:63], v[212:215], v[184:187], v[48:63]
    ds_read_b128 v[164:167], v218 offset:1024
    v_xor_b32 v242, s83, v249
    v_or_b32 v241, v241, v242
    v_xor_b32 v242, s83, v251
    v_mfma_f32_32x32x16_bf16 v[64:79], v[208:211], v[188:191], v[64:79]
    ds_read_b128 v[168:171], v218 offset:2048
    ds_read_b128 v[172:175], v218 offset:3072
    buffer_load_dwordx4 a[188:191], v238, s[56:59], s100 offen offset:2048 sc1
    v_or_b32 v241, v241, v242
    v_xor_b32 v242, s83, v253
    v_mfma_f32_32x32x16_bf16 v[80:95], v[212:215], v[188:191], v[80:95]
    ds_read_b128 v[176:179], v218 offset:4096
    v_or_b32 v241, v241, v242
    v_cmp_ne_u32 vcc, 0, v241
    s_cbranch_vccnz L_slow_epi_glu
L_go_epi_glu:
    v_mfma_f32_32x32x16_bf16 v[96:111], v[208:211], v[192:195], v[96:111]
    buffer_load_dwordx4 a[192:195], v238, s[56:59], s100 offen offset:3072 sc1
    s_lshl_b32 s73, s64, 10
    s_add_u32 s73, s73, 159744
    v_lshrrev_b32 v239, 2, v238
    v_add_u32 v239, s73, v239
    v_mfma_f32_32x32x16_bf16 v[112:127], v[212:215], v[192:195], v[112:127]
    v_lshrrev_b32_e64 v240, 5, v233
    v_lshl_add_u32 v241, v240, 4, s73
    ds_write_b32 v239, v254
    v_and_b32 v228, 0xffff0000, v244
    v_mfma_f32_32x32x16_bf16 v[128:143], v[208:211], v[196:199], v[128:143]
    s_add_u32 s100, s100, 4096
    buffer_load_dwordx4 a[196:199], v238, s[56:59], s100 offen offset:0 sc1
    v_lshlrev_b32 v244, 16, v244
    v_rcp_f32 v245, v228
    v_mfma_f32_32x32x16_bf16 v[144:159], v[212:215], v[196:199], v[144:159]
    v_and_b32 v229, 0xffff0000, v246
    v_lshlrev_b32 v246, 16, v246
    v_rcp_f32 v247, v229
    s_waitcnt lgkmcnt(1)
    v_mfma_f32_32x32x16_bf16 v[0:15], v[200:203], v[160:163], v[0:15]
    ds_read_b64_tr_b16 v[208:209], v220 offset:38912
    ds_read_b64_tr_b16 v[210:211], v220 offset:39168
    v_and_b32 v222, 0xffff0000, v248
    v_lshlrev_b32 v248, 16, v248
    v_mfma_f32_32x32x16_bf16 v[16:31], v[204:207], v[160:163], v[16:31]
    ds_read_b64_tr_b16 v[212:213], v220 offset:47104
    s_add_u32 s100, s70, 0
    buffer_load_dwordx4 a[200:203], v238, s[56:59], s100 offen offset:0 sc1
    v_mfma_f32_32x32x16_bf16 v[32:47], v[200:203], v[164:167], v[32:47]
    ds_read_b64_tr_b16 v[214:215], v220 offset:47360
    ds_read_b128 v[180:183], v219 offset:0
    buffer_load_dwordx4 a[204:207], v238, s[56:59], s100 offen offset:1024 sc1
    v_rcp_f32 v249, v222
    v_mfma_f32_32x32x16_bf16 v[48:63], v[204:207], v[164:167], v[48:63]
    ds_read_b128 v[184:187], v219 offset:1024
    v_and_b32 v223, 0xffff0000, v250
    v_lshlrev_b32_e64 v250, 16, v250
    v_mfma_f32_32x32x16_bf16 v[64:79], v[200:203], v[168:171], v[64:79]
    ds_read_b128 v[188:191], v219 offset:2048
    ds_read_b128 v[192:195], v219 offset:3072
    buffer_load_dwordx4 a[208:211], v238, s[56:59], s100 offen offset:2048 sc1
    v_mfma_f32_32x32x16_bf16 v[80:95], v[204:207], v[168:171], v[80:95]
    ds_read_b128 v[196:199], v219 offset:4096
    v_rcp_f32 v251, v223
    v_and_b32 v234, 0xffff0000, v252
    v_mfma_f32_32x32x16_bf16 v[96:111], v[200:203], v[172:175], v[96:111]
    buffer_load_dwordx4 a[212:215], v238, s[56:59], s100 offen offset:3072 sc1
    v_lshlrev_b32 v252, 16, v252
    v_rcp_f32_e64 v253, v234
    v_mfma_f32_32x32x16_bf16 v[112:127], v[204:207], v[172:175], v[112:127]
    v_and_b32 v242, 0xf0, v238
    v_lshl_add_u32 v242, v240, 9, v242
    v_bfe_u32 v243, v233, 4, 1
    v_lshl_add_u32 v221, v243, 10, v242
    v_mfma_f32_32x32x16_bf16 v[128:143], v[200:203], v[176:179], v[128:143]
    s_add_u32 s100, s100, 4096
    buffer_load_dwordx4 a[216:219], v238, s[56:59], s100 offen offset:0 sc1
    v_mul_f32 v245, 0xbfb8aa3b, v245
    v_mfma_f32_32x32x16_bf16 v[144:159], v[204:207], v[176:179], v[144:159]
    v_mul_f32 v247, 0xbfb8aa3b, v247
    v_mul_f32 v249, 0xbfb8aa3b, v249
    v_mul_f32 v251, 0xbfb8aa3b, v251
    v_mul_f32 v253, 0xbfb8aa3b, v253
    s_waitcnt lgkmcnt(0)
    v_mfma_f32_32x32x16_bf16 v[0:15], v[208:211], v[180:183], v[0:15]
    ds_read_b128 v[160:163], v241 offset:0
    v_mfma_f32_32x32x16_bf16 v[16:31], v[212:215], v[180:183], v[16:31]
    s_add_u32 s100, s70, 20480
    buffer_load_dwordx4 a[220:223], v238, s[56:59], s100 offen offset:0 sc1
    v_mfma_f32_32x32x16_bf16 v[32:47], v[208:211], v[184:187], v[32:47]
    buffer_load_dwordx4 a[224:227], v238, s[56:59], s100 offen offset:1024 sc1
    v_mfma_f32_32x32x16_bf16 v[48:63], v[212:215], v[184:187], v[48:63]
    ds_read_b128 v[164:167], v241 offset:32
    v_mfma_f32_32x32x16_bf16 v[64:79], v[208:211], v[188:191], v[64:79]
    buffer_load_dwordx4 a[228:231], v238, s[56:59], s100 offen offset:2048 sc1
    ds_read_b128 v[168:171], v241 offset:64
    v_mfma_f32_32x32x16_bf16 v[80:95], v[212:215], v[188:191], v[80:95]
    ds_read_b128 v[172:175], v241 offset:96
    ds_read_b128 v[176:179], v241 offset:128
    v_mfma_f32_32x32x16_bf16 v[96:111], v[208:211], v[192:195], v[96:111]
    buffer_load_dwordx4 a[232:235], v238, s[56:59], s100 offen offset:3072 sc1
    v_mfma_f32_32x32x16_bf16 v[112:127], v[212:215], v[192:195], v[112:127]
    ds_read_b128 v[200:203], v241 offset:160
    ds_read_b128 v[204:207], v241 offset:192
    v_mfma_f32_32x32x16_bf16 v[128:143], v[208:211], v[196:199], v[128:143]
    s_add_u32 s100, s100, 4096
    buffer_load_dwordx4 a[236:239], v238, s[56:59], s100 offen offset:0 sc1
    v_mfma_f32_32x32x16_bf16 v[144:159], v[212:215], v[196:199], v[144:159]
    ds_read_b128 v[224:227], v241 offset:224
    s_waitcnt lgkmcnt(0)
    s_barrier
L_gluepi:
    s_nop 0
    v_pk_fma_f32 v[0:1], v[160:161], v[244:245], v[0:1] op_sel_hi:[1,0,1]
    v_pk_fma_f32 v[2:3], v[162:163], v[244:245], v[2:3] op_sel_hi:[1,0,1]
    v_pk_fma_f32 v[4:5], v[164:165], v[244:245], v[4:5] op_sel_hi:[1,0,1]
    v_pk_fma_f32 v[6:7], v[166:167], v[244:245], v[6:7] op_sel_hi:[1,0,1]
    v_pk_mul_f32 v[0:1], v[0:1], v[244:245] op_sel:[0,1] op_sel_hi:[1,1]
    v_pk_mul_f32 v[2:3], v[2:3], v[244:245] op_sel:[0,1] op_sel_hi:[1,1]
    v_pk_mul_f32 v[4:5], v[4:5], v[244:245] op_sel:[0,1] op_sel_hi:[1,1]
    v_pk_mul_f32 v[6:7], v[6:7], v[244:245] op_sel:[0,1] op_sel_hi:[1,1]
    v_exp_f32 v0, v0
    v_exp_f32 v1, v1
    v_exp_f32 v2, v2
    v_exp_f32 v3, v3
    v_exp_f32 v4, v4
    v_exp_f32 v5, v5
    v_exp_f32 v6, v6
    v_exp_f32 v7, v7
    s_add_u32 m0, s6, 16384
    s_add_u32 s100, s70, 81920
    buffer_load_dwordx4 v238, s[56:59], s100 offen offset:0 sc1 lds
    v_pk_fma_f32 v[16:17], v[176:177], v[244:245], v[16:17] op_sel_hi:[1,0,1]
    v_pk_fma_f32 v[18:19], v[178:179], v[244:245], v[18:19] op_sel_hi:[1,0,1]
    v_pk_fma_f32 v[20:21], v[200:201], v[244:245], v[20:21] op_sel_hi:[1,0,1]
    v_pk_fma_f32 v[22:23], v[202:203], v[244:245], v[22:23] op_sel_hi:[1,0,1]
    v_pk_fma_f32 v[0:1], v[0:1], v[228:229], v[228:229] op_sel:[0,0,0] op_sel_hi:[1,0,0]
    v_pk_fma_f32 v[2:3], v[2:3], v[228:229], v[228:229] op_sel:[0,0,0] op_sel_hi:[1,0,0]
    v_pk_fma_f32 v[4:5], v[4:5], v[228:229], v[228:229] op_sel:[0,0,0] op_sel_hi:[1,0,0]
    v_pk_fma_f32 v[6:7], v[6:7], v[228:229], v[228:229] op_sel:[0,0,0] op_sel_hi:[1,0,0]
    v_rcp_f32 v0, v0
    v_rcp_f32 v1, v1
    v_rcp_f32 v2, v2
    v_rcp_f32 v3, v3
    v_rcp_f32 v4, v4
    v_rcp_f32 v5, v5
    v_rcp_f32 v6, v6
    v_rcp_f32 v7, v7
    buffer_load_dwordx4 v238, s[56:59], s100 offen offset:1024 sc1 lds
    v_pk_mul_f32 v[16:17], v[16:17], v[0:1]
    v_pk_mul_f32 v[18:19], v[18:19], v[2:3]
    v_pk_mul_f32 v[20:21], v[20:21], v[4:5]
    v_pk_mul_f32 v[22:23], v[22:23], v[6:7]
    v_cvt_pk_bf16_f32 v180, v16, v17
    v_cvt_pk_bf16_f32 v181, v18, v19
    v_cvt_pk_bf16_f32 v182, v20, v21
    v_cvt_pk_bf16_f32 v183, v22, v23
    buffer_store_dwordx4 v[180:183], v221, s[52:55], s16 offen offset:0 sc1
    v_pk_fma_f32 v[8:9], v[168:169], v[244:245], v[8:9] op_sel_hi:[1,0,1]
    v_pk_fma_f32 v[10:11], v[170:171], v[244:245], v[10:11] op_sel_hi:[1,0,1]
    v_pk_fma_f32 v[12:13], v[172:173], v[244:245], v[12:13] op_sel_hi:[1,0,1]
    v_pk_fma_f32 v[14:15], v[174:175], v[244:245], v[14:15] op_sel_hi:[1,0,1]
    v_pk_mul_f32 v[8:9], v[8:9], v[244:245] op_sel:[0,1] op_sel_hi:[1,1]
    v_pk_mul_f32 v[10:11], v[10:11], v[244:245] op_sel:[0,1] op_sel_hi:[1,1]
    v_pk_mul_f32 v[12:13], v[12:13], v[244:245] op_sel:[0,1] op_sel_hi:[1,1]
    v_pk_mul_f32 v[14:15], v[14:15], v[244:245] op_sel:[0,1] op_sel_hi:[1,1]
    v_exp_f32 v8, v8
    v_exp_f32 v9, v9
    v_exp_f32 v10, v10
    v_exp_f32 v11, v11
    v_exp_f32 v12, v12
    v_exp_f32 v13, v13
    v_exp_f32 v14, v14
    v_exp_f32 v15, v15
    buffer_load_dwordx4 v238, s[56:59], s100 offen offset:2048 sc1 lds
    v_pk_fma_f32 v[24:25], v[204:205], v[244:245], v[24:25] op_sel_hi:[1,0,1]
    v_pk_fma_f32 v[26:27], v[206:207], v[244:245], v[26:27] op_sel_hi:[1,0,1]
    v_pk_fma_f32 v[28:29], v[224:225], v[244:245], v[28:29] op_sel_hi:[1,0,1]
    v_pk_fma_f32 v[30:31], v[226:227], v[244:245], v[30:31] op_sel_hi:[1,0,1]
    v_pk_fma_f32 v[8:9], v[8:9], v[228:229], v[228:229] op_sel:[0,0,0] op_sel_hi:[1,0,0]
    v_pk_fma_f32 v[10:11], v[10:11], v[228:229], v[228:229] op_sel:[0,0,0] op_sel_hi:[1,0,0]
    v_pk_fma_f32 v[12:13], v[12:13], v[228:229], v[228:229] op_sel:[0,0,0] op_sel_hi:[1,0,0]
    v_pk_fma_f32 v[14:15], v[14:15], v[228:229], v[228:229] op_sel:[0,0,0] op_sel_hi:[1,0,0]
    v_rcp_f32 v8, v8
    v_rcp_f32 v9, v9
    v_rcp_f32 v10, v10
    v_rcp_f32 v11, v11
    v_rcp_f32 v12, v12
    v_rcp_f32 v13, v13
    v_rcp_f32 v14, v14
    v_rcp_f32 v15, v15
    buffer_load_dwordx4 v238, s[56:59], s100 offen offset:3072 sc1 lds
    v_pk_mul_f32 v[24:25], v[24:25], v[8:9]
    v_pk_mul_f32 v[26:27], v[26:27], v[10:11]
    v_pk_mul_f32 v[28:29], v[28:29], v[12:13]
    v_pk_mul_f32 v[30:31], v[30:31], v[14:15]
    v_cvt_pk_bf16_f32 v184, v24, v25
    v_cvt_pk_bf16_f32 v185, v26, v27
    v_cvt_pk_bf16_f32 v186, v28, v29
    v_cvt_pk_bf16_f32 v187, v30, v31
    buffer_store_dwordx4 v[184:187], v221, s[52:55], s16 offen offset:256 sc1
    v_pk_fma_f32 v[32:33], v[160:161], v[246:247], v[32:33] op_sel_hi:[1,0,1]
    v_pk_fma_f32 v[34:35], v[162:163], v[246:247], v[34:35] op_sel_hi:[1,0,1]
    v_pk_fma_f32 v[36:37], v[164:165], v[246:247], v[36:37] op_sel_hi:[1,0,1]
    v_pk_fma_f32 v[38:39], v[166:167], v[246:247], v[38:39] op_sel_hi:[1,0,1]
    v_pk_mul_f32 v[32:33], v[32:33], v[246:247] op_sel:[0,1] op_sel_hi:[1,1]
    v_pk_mul_f32 v[34:35], v[34:35], v[246:247] op_sel:[0,1] op_sel_hi:[1,1]
    v_pk_mul_f32 v[36:37], v[36:37], v[246:247] op_sel:[0,1] op_sel_hi:[1,1]
    v_pk_mul_f32 v[38:39], v[38:39], v[246:247] op_sel:[0,1] op_sel_hi:[1,1]
    v_exp_f32 v32, v32
    v_exp_f32 v33, v33
    v_exp_f32 v34, v34
    v_exp_f32 v35, v35
    v_exp_f32 v36, v36
    v_exp_f32 v37, v37
    v_exp_f32 v38, v38
    v_exp_f32 v39, v39
    s_add_u32 m0, s6, 20480
    s_add_u32 s100, s100, 4096
    buffer_load_dwordx4 v238, s[56:59], s100 offen offset:0 sc1 lds
    v_pk_fma_f32 v[48:49], v[176:177], v[246:247], v[48:49] op_sel_hi:[1,0,1]
    v_pk_fma_f32 v[50:51], v[178:179], v[246:247], v[50:51] op_sel_hi:[1,0,1]
    v_pk_fma_f32 v[52:53], v[200:201], v[246:247], v[52:53] op_sel_hi:[1,0,1]
    v_pk_fma_f32 v[54:55], v[202:203], v[246:247], v[54:55] op_sel_hi:[1,0,1]
    v_pk_fma_f32 v[32:33], v[32:33], v[228:229], v[228:229] op_sel:[0,1,1] op_sel_hi:[1,1,1]
    v_pk_fma_f32 v[34:35], v[34:35], v[228:229], v[228:229] op_sel:[0,1,1] op_sel_hi:[1,1,1]
    v_pk_fma_f32 v[36:37], v[36:37], v[228:229], v[228:229] op_sel:[0,1,1] op_sel_hi:[1,1,1]
    v_pk_fma_f32 v[38:39], v[38:39], v[228:229], v[228:229] op_sel:[0,1,1] op_sel_hi:[1,1,1]
    v_rcp_f32 v32, v32
    v_rcp_f32 v33, v33
    v_rcp_f32 v34, v34
    v_rcp_f32 v35, v35
    v_rcp_f32 v36, v36
    v_rcp_f32 v37, v37
    v_rcp_f32 v38, v38
    v_rcp_f32 v39, v39
    s_add_u32 m0, s71, 20480
    s_add_u32 s100, s70, 102400
    buffer_load_dwordx4 v238, s[56:59], s100 offen offset:0 sc1 lds
    v_pk_mul_f32 v[48:49], v[48:49], v[32:33]
    v_pk_mul_f32 v[50:51], v[50:51], v[34:35]
    v_pk_mul_f32 v[52:53], v[52:53], v[36:37]
    v_pk_mul_f32 v[54:55], v[54:55], v[38:39]
    v_cvt_pk_bf16_f32 v188, v48, v49
    v_cvt_pk_bf16_f32 v189, v50, v51
    v_cvt_pk_bf16_f32 v190, v52, v53
    v_cvt_pk_bf16_f32 v191, v54, v55
    buffer_store_dwordx4 v[188:191], v221, s[52:55], s17 offen offset:0 sc1
    v_pk_fma_f32 v[40:41], v[168:169], v[246:247], v[40:41] op_sel_hi:[1,0,1]
    v_pk_fma_f32 v[42:43], v[170:171], v[246:247], v[42:43] op_sel_hi:[1,0,1]
    v_pk_fma_f32 v[44:45], v[172:173], v[246:247], v[44:45] op_sel_hi:[1,0,1]
    v_pk_fma_f32 v[46:47], v[174:175], v[246:247], v[46:47] op_sel_hi:[1,0,1]
    v_pk_mul_f32 v[40:41], v[40:41], v[246:247] op_sel:[0,1] op_sel_hi:[1,1]
    v_pk_mul_f32 v[42:43], v[42:43], v[246:247] op_sel:[0,1] op_sel_hi:[1,1]
    v_pk_mul_f32 v[44:45], v[44:45], v[246:247] op_sel:[0,1] op_sel_hi:[1,1]
    v_pk_mul_f32 v[46:47], v[46:47], v[246:247] op_sel:[0,1] op_sel_hi:[1,1]
    v_exp_f32 v40, v40
    v_exp_f32 v41, v41
    v_exp_f32 v42, v42
    v_exp_f32 v43, v43
    v_exp_f32 v44, v44
    v_exp_f32 v45, v45
    v_exp_f32 v46, v46
    v_exp_f32 v47, v47
    buffer_load_dwordx4 v238, s[56:59], s100 offen offset:1024 sc1 lds
    v_pk_fma_f32 v[56:57], v[204:205], v[246:247], v[56:57] op_sel_hi:[1,0,1]
    v_pk_fma_f32 v[58:59], v[206:207], v[246:247], v[58:59] op_sel_hi:[1,0,1]
    v_pk_fma_f32 v[60:61], v[224:225], v[246:247], v[60:61] op_sel_hi:[1,0,1]
    v_pk_fma_f32 v[62:63], v[226:227], v[246:247], v[62:63] op_sel_hi:[1,0,1]
    v_pk_fma_f32 v[40:41], v[40:41], v[228:229], v[228:229] op_sel:[0,1,1] op_sel_hi:[1,1,1]
    v_pk_fma_f32 v[42:43], v[42:43], v[228:229], v[228:229] op_sel:[0,1,1] op_sel_hi:[1,1,1]
    v_pk_fma_f32 v[44:45], v[44:45], v[228:229], v[228:229] op_sel:[0,1,1] op_sel_hi:[1,1,1]
    v_pk_fma_f32 v[46:47], v[46:47], v[228:229], v[228:229] op_sel:[0,1,1] op_sel_hi:[1,1,1]
    v_rcp_f32 v40, v40
    v_rcp_f32 v41, v41
    v_rcp_f32 v42, v42
    v_rcp_f32 v43, v43
    v_rcp_f32 v44, v44
    v_rcp_f32 v45, v45
    v_rcp_f32 v46, v46
    v_rcp_f32 v47, v47
    buffer_load_dwordx4 v238, s[56:59], s100 offen offset:2048 sc1 lds
    v_pk_mul_f32 v[56:57], v[56:57], v[40:41]
    v_pk_mul_f32 v[58:59], v[58:59], v[42:43]
    v_pk_mul_f32 v[60:61], v[60:61], v[44:45]
    v_pk_mul_f32 v[62:63], v[62:63], v[46:47]
    v_cvt_pk_bf16_f32 v192, v56, v57
    v_cvt_pk_bf16_f32 v193, v58, v59
    v_cvt_pk_bf16_f32 v194, v60, v61
    v_cvt_pk_bf16_f32 v195, v62, v63
    buffer_store_dwordx4 v[192:195], v221, s[52:55], s17 offen offset:256 sc1
    v_pk_fma_f32 v[64:65], v[160:161], v[248:249], v[64:65] op_sel_hi:[1,0,1]
    v_pk_fma_f32 v[66:67], v[162:163], v[248:249], v[66:67] op_sel_hi:[1,0,1]
    v_pk_fma_f32 v[68:69], v[164:165], v[248:249], v[68:69] op_sel_hi:[1,0,1]
    v_pk_fma_f32 v[70:71], v[166:167], v[248:249], v[70:71] op_sel_hi:[1,0,1]
    v_pk_mul_f32 v[64:65], v[64:65], v[248:249] op_sel:[0,1] op_sel_hi:[1,1]
    v_pk_mul_f32 v[66:67], v[66:67], v[248:249] op_sel:[0,1] op_sel_hi:[1,1]
    v_pk_mul_f32 v[68:69], v[68:69], v[248:249] op_sel:[0,1] op_sel_hi:[1,1]
    v_pk_mul_f32 v[70:71], v[70:71], v[248:249] op_sel:[0,1] op_sel_hi:[1,1]
    v_exp_f32 v64, v64
    v_exp_f32 v65, v65
    v_exp_f32 v66, v66
    v_exp_f32 v67, v67
    v_exp_f32 v68, v68
    v_exp_f32 v69, v69
    v_exp_f32 v70, v70
    v_exp_f32 v71, v71
    buffer_load_dwordx4 v238, s[56:59], s100 offen offset:3072 sc1 lds
    v_pk_fma_f32 v[80:81], v[176:177], v[248:249], v[80:81] op_sel_hi:[1,0,1]
    v_pk_fma_f32 v[82:83], v[178:179], v[248:249], v[82:83] op_sel_hi:[1,0,1]
    v_pk_fma_f32 v[84:85], v[200:201], v[248:249], v[84:85] op_sel_hi:[1,0,1]
    v_pk_fma_f32 v[86:87], v[202:203], v[248:249], v[86:87] op_sel_hi:[1,0,1]
    v_pk_fma_f32 v[64:65], v[64:65], v[222:223], v[222:223] op_sel:[0,0,0] op_sel_hi:[1,0,0]
    v_pk_fma_f32 v[66:67], v[66:67], v[222:223], v[222:223] op_sel:[0,0,0] op_sel_hi:[1,0,0]
    v_pk_fma_f32 v[68:69], v[68:69], v[222:223], v[222:223] op_sel:[0,0,0] op_sel_hi:[1,0,0]
    v_pk_fma_f32 v[70:71], v[70:71], v[222:223], v[222:223] op_sel:[0,0,0] op_sel_hi:[1,0,0]
    v_rcp_f32 v64, v64
    v_rcp_f32 v65, v65
    v_rcp_f32 v66, v66
    v_rcp_f32 v67, v67
    v_rcp_f32 v68, v68
    v_rcp_f32 v69, v69
    v_rcp_f32 v70, v70
    v_rcp_f32 v71, v71
    s_add_u32 m0, s71, 24576
    s_add_u32 s100, s100, 4096
    buffer_load_dwordx4 v238, s[56:59], s100 offen offset:0 sc1 lds
    v_pk_mul_f32 v[80:81], v[80:81], v[64:65]
    v_pk_mul_f32 v[82:83], v[82:83], v[66:67]
    v_pk_mul_f32 v[84:85], v[84:85], v[68:69]
    v_pk_mul_f32 v[86:87], v[86:87], v[70:71]
    v_cvt_pk_bf16_f32 v180, v80, v81
    v_cvt_pk_bf16_f32 v181, v82, v83
    v_cvt_pk_bf16_f32 v182, v84, v85
    v_cvt_pk_bf16_f32 v183, v86, v87
    buffer_store_dwordx4 v[180:183], v221, s[52:55], s18 offen offset:0 sc1
    v_pk_fma_f32 v[72:73], v[168:169], v[248:249], v[72:73] op_sel_hi:[1,0,1]
    v_pk_fma_f32 v[74:75], v[170:171], v[248:249], v[74:75] op_sel_hi:[1,0,1]
    v_pk_fma_f32 v[76:77], v[172:173], v[248:249], v[76:77] op_sel_hi:[1,0,1]
    v_pk_fma_f32 v[78:79], v[174:175], v[248:249], v[78:79] op_sel_hi:[1,0,1]
    v_pk_mul_f32 v[72:73], v[72:73], v[248:249] op_sel:[0,1] op_sel_hi:[1,1]
    v_pk_mul_f32 v[74:75], v[74:75], v[248:249] op_sel:[0,1] op_sel_hi:[1,1]
    v_pk_mul_f32 v[76:77], v[76:77], v[248:249] op_sel:[0,1] op_sel_hi:[1,1]
    v_pk_mul_f32 v[78:79], v[78:79], v[248:249] op_sel:[0,1] op_sel_hi:[1,1]
    v_exp_f32 v72, v72
    v_exp_f32 v73, v73
    v_exp_f32 v74, v74
    v_exp_f32 v75, v75
    v_exp_f32 v76, v76
    v_exp_f32 v77, v77
    v_exp_f32 v78, v78
    v_exp_f32_e64 v79, v79
    s_add_u32 m0, s6, 0
    s_add_u32 s100, s70, 122880
    buffer_load_dwordx4 v238, s[56:59], s100 offen offset:0 sc1 lds
    v_pk_fma_f32 v[88:89], v[204:205], v[248:249], v[88:89] op_sel_hi:[1,0,1]
    v_pk_fma_f32 v[90:91], v[206:207], v[248:249], v[90:91] op_sel_hi:[1,0,1]
    v_pk_fma_f32 v[92:93], v[224:225], v[248:249], v[92:93] op_sel_hi:[1,0,1]
    v_pk_fma_f32 v[94:95], v[226:227], v[248:249], v[94:95] op_sel_hi:[1,0,1]
    v_pk_fma_f32 v[72:73], v[72:73], v[222:223], v[222:223] op_sel:[0,0,0] op_sel_hi:[1,0,0]
    v_pk_fma_f32 v[74:75], v[74:75], v[222:223], v[222:223] op_sel:[0,0,0] op_sel_hi:[1,0,0]
    v_pk_fma_f32 v[76:77], v[76:77], v[222:223], v[222:223] op_sel:[0,0,0] op_sel_hi:[1,0,0]
    v_pk_fma_f32 v[78:79], v[78:79], v[222:223], v[222:223] op_sel:[0,0,0] op_sel_hi:[1,0,0]
    v_rcp_f32 v72, v72
    v_rcp_f32 v73, v73
    v_rcp_f32 v74, v74
    v_rcp_f32 v75, v75
    v_rcp_f32 v76, v76
    v_rcp_f32 v77, v77
    v_rcp_f32 v78, v78
    v_rcp_f32 v79, v79
    buffer_load_dwordx4 v238, s[56:59], s100 offen offset:1024 sc1 lds
    v_pk_mul_f32 v[88:89], v[88:89], v[72:73]
    v_pk_mul_f32 v[90:91], v[90:91], v[74:75]
    v_pk_mul_f32 v[92:93], v[92:93], v[76:77]
    v_pk_mul_f32 v[94:95], v[94:95], v[78:79]
    v_cvt_pk_bf16_f32 v184, v88, v89
    v_cvt_pk_bf16_f32 v185, v90, v91
    v_cvt_pk_bf16_f32 v186, v92, v93
    v_cvt_pk_bf16_f32 v187, v94, v95
    buffer_store_dwordx4 v[184:187], v221, s[52:55], s18 offen offset:256 sc1
    v_pk_fma_f32 v[96:97], v[160:161], v[250:251], v[96:97] op_sel_hi:[1,0,1]
    v_pk_fma_f32 v[98:99], v[162:163], v[250:251], v[98:99] op_sel_hi:[1,0,1]
    v_pk_fma_f32 v[100:101], v[164:165], v[250:251], v[100:101] op_sel_hi:[1,0,1]
    v_pk_fma_f32 v[102:103], v[166:167], v[250:251], v[102:103] op_sel_hi:[1,0,1]
    v_pk_mul_f32 v[96:97], v[96:97], v[250:251] op_sel:[0,1] op_sel_hi:[1,1]
    v_pk_mul_f32 v[98:99], v[98:99], v[250:251] op_sel:[0,1] op_sel_hi:[1,1]
    v_pk_mul_f32 v[100:101], v[100:101], v[250:251] op_sel:[0,1] op_sel_hi:[1,1]
    v_pk_mul_f32 v[102:103], v[102:103], v[250:251] op_sel:[0,1] op_sel_hi:[1,1]
    v_exp_f32 v96, v96
    v_exp_f32 v97, v97
    v_exp_f32 v98, v98
    v_exp_f32 v99, v99
    v_exp_f32 v100, v100
    v_exp_f32 v101, v101
    v_exp_f32 v102, v102
    v_exp_f32 v103, v103
    buffer_load_dwordx4 v238, s[56:59], s100 offen offset:2048 sc1 lds
    v_pk_fma_f32 v[112:113], v[176:177], v[250:251], v[112:113] op_sel_hi:[1,0,1]
    v_pk_fma_f32 v[114:115], v[178:179], v[250:251], v[114:115] op_sel_hi:[1,0,1]
    v_pk_fma_f32 v[116:117], v[200:201], v[250:251], v[116:117] op_sel_hi:[1,0,1]
    v_pk_fma_f32 v[118:119], v[202:203], v[250:251], v[118:119] op_sel_hi:[1,0,1]
    v_pk_fma_f32 v[96:97], v[96:97], v[222:223], v[222:223] op_sel:[0,1,1] op_sel_hi:[1,1,1]
    v_pk_fma_f32 v[98:99], v[98:99], v[222:223], v[222:223] op_sel:[0,1,1] op_sel_hi:[1,1,1]
    v_pk_fma_f32 v[100:101], v[100:101], v[222:223], v[222:223] op_sel:[0,1,1] op_sel_hi:[1,1,1]
    v_pk_fma_f32 v[102:103], v[102:103], v[222:223], v[222:223] op_sel:[0,1,1] op_sel_hi:[1,1,1]
    v_rcp_f32 v96, v96
    v_rcp_f32 v97, v97
    v_rcp_f32 v98, v98
    v_rcp_f32 v99, v99
    v_rcp_f32 v100, v100
    v_rcp_f32 v101, v101
    v_rcp_f32 v102, v102
    v_rcp_f32 v103, v103
    buffer_load_dwordx4 v238, s[56:59], s100 offen offset:3072 sc1 lds
    v_pk_mul_f32 v[112:113], v[112:113], v[96:97]
    v_pk_mul_f32 v[114:115], v[114:115], v[98:99]
    v_pk_mul_f32 v[116:117], v[116:117], v[100:101]
    v_pk_mul_f32 v[118:119], v[118:119], v[102:103]
    v_cvt_pk_bf16_f32 v188, v112, v113
    v_cvt_pk_bf16_f32 v189, v114, v115
    v_cvt_pk_bf16_f32 v190, v116, v117
    v_cvt_pk_bf16_f32 v191, v118, v119
    buffer_store_dwordx4 v[188:191], v221, s[52:55], s19 offen offset:0 sc1
    v_pk_fma_f32 v[104:105], v[168:169], v[250:251], v[104:105] op_sel_hi:[1,0,1]
    v_pk_fma_f32 v[106:107], v[170:171], v[250:251], v[106:107] op_sel_hi:[1,0,1]
    v_pk_fma_f32 v[108:109], v[172:173], v[250:251], v[108:109] op_sel_hi:[1,0,1]
    v_pk_fma_f32 v[110:111], v[174:175], v[250:251], v[110:111] op_sel_hi:[1,0,1]
    v_pk_mul_f32 v[104:105], v[104:105], v[250:251] op_sel:[0,1] op_sel_hi:[1,1]
    v_pk_mul_f32 v[106:107], v[106:107], v[250:251] op_sel:[0,1] op_sel_hi:[1,1]
    v_pk_mul_f32 v[108:109], v[108:109], v[250:251] op_sel:[0,1] op_sel_hi:[1,1]
    v_pk_mul_f32 v[110:111], v[110:111], v[250:251] op_sel:[0,1] op_sel_hi:[1,1]
    v_exp_f32 v104, v104
    v_exp_f32 v105, v105
    v_exp_f32 v106, v106
    v_exp_f32 v107, v107
    v_exp_f32 v108, v108
    v_exp_f32 v109, v109
    v_exp_f32 v110, v110
    v_exp_f32 v111, v111
    s_add_u32 m0, s6, 4096
    s_add_u32 s100, s100, 4096
    buffer_load_dwordx4 v238, s[56:59], s100 offen offset:0 sc1 lds
    v_pk_fma_f32 v[120:121], v[204:205], v[250:251], v[120:121] op_sel_hi:[1,0,1]
    v_pk_fma_f32 v[122:123], v[206:207], v[250:251], v[122:123] op_sel_hi:[1,0,1]
    v_pk_fma_f32 v[124:125], v[224:225], v[250:251], v[124:125] op_sel_hi:[1,0,1]
    v_pk_fma_f32 v[126:127], v[226:227], v[250:251], v[126:127] op_sel_hi:[1,0,1]
    v_pk_fma_f32 v[104:105], v[104:105], v[222:223], v[222:223] op_sel:[0,1,1] op_sel_hi:[1,1,1]
    v_pk_fma_f32 v[106:107], v[106:107], v[222:223], v[222:223] op_sel:[0,1,1] op_sel_hi:[1,1,1]
    v_pk_fma_f32 v[108:109], v[108:109], v[222:223], v[222:223] op_sel:[0,1,1] op_sel_hi:[1,1,1]
    v_pk_fma_f32 v[110:111], v[110:111], v[222:223], v[222:223] op_sel:[0,1,1] op_sel_hi:[1,1,1]
    v_rcp_f32 v104, v104
    v_rcp_f32 v105, v105
    v_rcp_f32 v106, v106
    v_rcp_f32 v107, v107
    v_rcp_f32 v108, v108
    v_rcp_f32 v109, v109
    v_rcp_f32 v110, v110
    v_rcp_f32 v111, v111
    s_add_u32 m0, s71, 40960
    s_add_u32 s100, s70, 143360
    buffer_load_dwordx4 v238, s[56:59], s100 offen offset:0 sc1 lds
    v_pk_mul_f32 v[120:121], v[120:121], v[104:105]
    v_pk_mul_f32 v[122:123], v[122:123], v[106:107]
    v_pk_mul_f32 v[124:125], v[124:125], v[108:109]
    v_pk_mul_f32 v[126:127], v[126:127], v[110:111]
    v_cvt_pk_bf16_f32 v192, v120, v121
    v_cvt_pk_bf16_f32 v193, v122, v123
    v_cvt_pk_bf16_f32 v194, v124, v125
    v_cvt_pk_bf16_f32 v195, v126, v127
    buffer_store_dwordx4 v[192:195], v221, s[52:55], s19 offen offset:256 sc1
    v_pk_fma_f32 v[128:129], v[160:161], v[252:253], v[128:129] op_sel_hi:[1,0,1]
    v_pk_fma_f32 v[130:131], v[162:163], v[252:253], v[130:131] op_sel_hi:[1,0,1]
    v_pk_fma_f32 v[132:133], v[164:165], v[252:253], v[132:133] op_sel_hi:[1,0,1]
    v_pk_fma_f32 v[134:135], v[166:167], v[252:253], v[134:135] op_sel_hi:[1,0,1]
    v_pk_mul_f32 v[128:129], v[128:129], v[252:253] op_sel:[0,1] op_sel_hi:[1,1]
    v_pk_mul_f32 v[130:131], v[130:131], v[252:253] op_sel:[0,1] op_sel_hi:[1,1]
    v_pk_mul_f32 v[132:133], v[132:133], v[252:253] op_sel:[0,1] op_sel_hi:[1,1]
    v_pk_mul_f32 v[134:135], v[134:135], v[252:253] op_sel:[0,1] op_sel_hi:[1,1]
    v_exp_f32 v128, v128
    v_exp_f32 v129, v129
    v_exp_f32 v130, v130
    v_exp_f32 v131, v131
    v_exp_f32 v132, v132
    v_exp_f32 v133, v133
    v_exp_f32 v134, v134
    v_exp_f32 v135, v135
    buffer_load_dwordx4 v238, s[56:59], s100 offen offset:1024 sc1 lds
    v_pk_fma_f32 v[144:145], v[176:177], v[252:253], v[144:145] op_sel_hi:[1,0,1]
    v_pk_fma_f32 v[146:147], v[178:179], v[252:253], v[146:147] op_sel_hi:[1,0,1]
    v_pk_fma_f32 v[148:149], v[200:201], v[252:253], v[148:149] op_sel_hi:[1,0,1]
    v_pk_fma_f32 v[150:151], v[202:203], v[252:253], v[150:151] op_sel_hi:[1,0,1]
    v_pk_fma_f32 v[128:129], v[128:129], v[234:235], v[234:235] op_sel:[0,0,0] op_sel_hi:[1,0,0]
    v_pk_fma_f32 v[130:131], v[130:131], v[234:235], v[234:235] op_sel:[0,0,0] op_sel_hi:[1,0,0]
    v_pk_fma_f32 v[132:133], v[132:133], v[234:235], v[234:235] op_sel:[0,0,0] op_sel_hi:[1,0,0]
    v_pk_fma_f32 v[134:135], v[134:135], v[234:235], v[234:235] op_sel:[0,0,0] op_sel_hi:[1,0,0]
    v_rcp_f32 v128, v128
    v_rcp_f32 v129, v129
    v_rcp_f32 v130, v130
    v_rcp_f32 v131, v131
    v_rcp_f32 v132, v132
    v_rcp_f32 v133, v133
    v_rcp_f32 v134, v134
    v_rcp_f32 v135, v135
    buffer_load_dwordx4 v238, s[56:59], s100 offen offset:2048 sc1 lds
    v_pk_mul_f32 v[144:145], v[144:145], v[128:129]
    v_pk_mul_f32 v[146:147], v[146:147], v[130:131]
    v_pk_mul_f32 v[148:149], v[148:149], v[132:133]
    v_pk_mul_f32 v[150:151], v[150:151], v[134:135]
    v_cvt_pk_bf16_f32 v180, v144, v145
    v_cvt_pk_bf16_f32 v181, v146, v147
    v_cvt_pk_bf16_f32 v182, v148, v149
    v_cvt_pk_bf16_f32 v183, v150, v151
    buffer_store_dwordx4 v[180:183], v221, s[52:55], s20 offen offset:0 sc1
    v_pk_fma_f32 v[136:137], v[168:169], v[252:253], v[136:137] op_sel_hi:[1,0,1]
    v_pk_fma_f32 v[138:139], v[170:171], v[252:253], v[138:139] op_sel_hi:[1,0,1]
    v_pk_fma_f32 v[140:141], v[172:173], v[252:253], v[140:141] op_sel_hi:[1,0,1]
    v_pk_fma_f32 v[142:143], v[174:175], v[252:253], v[142:143] op_sel_hi:[1,0,1]
    v_pk_mul_f32 v[136:137], v[136:137], v[252:253] op_sel:[0,1] op_sel_hi:[1,1]
    v_pk_mul_f32 v[138:139], v[138:139], v[252:253] op_sel:[0,1] op_sel_hi:[1,1]
    v_pk_mul_f32 v[140:141], v[140:141], v[252:253] op_sel:[0,1] op_sel_hi:[1,1]
    v_pk_mul_f32 v[142:143], v[142:143], v[252:253] op_sel:[0,1] op_sel_hi:[1,1]
    v_exp_f32 v136, v136
    v_exp_f32 v137, v137
    v_exp_f32 v138, v138
    v_exp_f32 v139, v139
    v_exp_f32 v140, v140
    v_exp_f32 v141, v141
    v_exp_f32 v142, v142
    v_exp_f32 v143, v143
    buffer_load_dwordx4 v238, s[56:59], s100 offen offset:3072 sc1 lds
    v_pk_fma_f32 v[152:153], v[204:205], v[252:253], v[152:153] op_sel_hi:[1,0,1]
    v_pk_fma_f32 v[154:155], v[206:207], v[252:253], v[154:155] op_sel_hi:[1,0,1]
    v_pk_fma_f32 v[156:157], v[224:225], v[252:253], v[156:157] op_sel_hi:[1,0,1]
    v_pk_fma_f32 v[158:159], v[226:227], v[252:253], v[158:159] op_sel_hi:[1,0,1]
    v_pk_fma_f32 v[136:137], v[136:137], v[234:235], v[234:235] op_sel:[0,0,0] op_sel_hi:[1,0,0]
    v_pk_fma_f32 v[138:139], v[138:139], v[234:235], v[234:235] op_sel:[0,0,0] op_sel_hi:[1,0,0]
    v_pk_fma_f32 v[140:141], v[140:141], v[234:235], v[234:235] op_sel:[0,0,0] op_sel_hi:[1,0,0]
    v_pk_fma_f32 v[142:143], v[142:143], v[234:235], v[234:235] op_sel:[0,0,0] op_sel_hi:[1,0,0]
    v_rcp_f32 v136, v136
    v_rcp_f32 v137, v137
    v_rcp_f32 v138, v138
    v_rcp_f32 v139, v139
    v_rcp_f32 v140, v140
    v_rcp_f32 v141, v141
    v_rcp_f32 v142, v142
    v_rcp_f32 v143, v143
    s_add_u32 m0, s71, 45056
    s_add_u32 s100, s100, 4096
    buffer_load_dwordx4 v238, s[56:59], s100 offen offset:0 sc1 lds
    v_pk_mul_f32 v[152:153], v[152:153], v[136:137]
    v_pk_mul_f32 v[154:155], v[154:155], v[138:139]
    v_pk_mul_f32 v[156:157], v[156:157], v[140:141]
    v_pk_mul_f32 v[158:159], v[158:159], v[142:143]
    v_cvt_pk_bf16_f32 v184, v152, v153
    v_cvt_pk_bf16_f32 v185, v154, v155
    v_cvt_pk_bf16_f32 v186, v156, v157
    v_cvt_pk_bf16_f32 v187, v158, v159
    buffer_store_dwordx4 v[184:187], v221, s[52:55], s20 offen offset:256 sc1
    s_add_u32 s100, s70, 40960
    buffer_load_dwordx4 v[160:163], v238, s[56:59], s100 offen offset:0 sc1
    buffer_load_dwordx4 v[164:167], v238, s[56:59], s100 offen offset:1024 sc1
    buffer_load_dwordx4 v[168:171], v238, s[56:59], s100 offen offset:2048 sc1
    buffer_load_dwordx4 v[172:175], v238, s[56:59], s100 offen offset:3072 sc1
    v_mov_b32 v239, s83
    s_mov_b64 exec, 1
    s_waitcnt vmcnt(4)
    buffer_store_dword v239, off, s[56:59], s67 sc1
    s_mov_b64 exec, -1
    s_mov_b32 s48, s24
    s_mov_b32 s49, s25
    s_mov_b32 s50, 1280
    s_mov_b32 s51, 0x20000
    s_lshl_b32 s73, s4, 6
    s_lshl_b32 s75, s64, 2
    s_mul_i32 s74, s5, 20
    s_add_u32 s73, s73, s75
    s_mul_i32 s75, s64, 1344
    v_lshrrev_b32 v239, 4, v233
    v_and_b32 v240, 15, v233
    v_mul_u32_u24 v241, 336, v239
    v_lshl_add_u32 v241, v240, 4, v241
    v_add_u32 v222, s75, v241
    v_add_u32 v239, s73, v239
    v_add_u32 v240, s74, v240
    v_mul_u32_u24 v241, 160, v239
    v_add_u32 v241, v241, v240
    v_lshlrev_b32 v220, 4, v241
    v_lshlrev_b32 v241, 3, v241
    v_lshlrev_b32 v240, 3, v240
    s_mov_b32 s76, 0
    buffer_load_dwordx2 v[0:1], v241, s[40:43], s76 offen
    s_mov_b32 s76, 20480
    buffer_load_dwordx2 v[2:3], v241, s[40:43], s76 offen
    s_mov_b32 s76, 40960
    buffer_load_dwordx2 v[4:5], v241, s[40:43], s76 offen
    s_mov_b32 s76, 61440
    buffer_load_dwordx2 v[6:7], v241, s[40:43], s76 offen
    buffer_load_dwordx2 v[10:11], v240, s[48:51], 0 offen
    v_and_b32 v239, 48, v233
    v_bfe_u32 v240, v233, 2, 2
    v_add_u32 v239, v239, v240
    v_and_b32 v240, 3, v233
    v_add_u32 v240, 16, v240
    v_mul_u32_u24 v241, 336, v239
    v_lshl_add_u32 v241, v240, 4, v241
    v_add_u32 v224, s75, v241
    v_add_u32 v239, s73, v239
    v_add_u32 v240, s74, v240
    v_mul_u32_u24 v241, 160, v239
    v_add_u32 v241, v241, v240
    v_lshlrev_b32 v221, 4, v241
    v_lshlrev_b32 v241, 3, v241
    v_lshlrev_b32 v240, 3, v240
    buffer_load_dwordx2 v[8:9], v241, s[40:43], 0 offen
    v_lshlrev_b32 v239, 3, v239
    s_mov_b32 s76, 4194304
    buffer_load_dwordx2 v[14:15], v239, s[56:59], s76 offen sc1
    buffer_load_dwordx2 v[12:13], v240, s[48:51], 0 offen
    s_mov_b32 s44, s34
    s_mov_b32 s45, s35
    s_mov_b32 s46, 5242880
    s_mov_b32 s47, 0x20000
    v_add_u32 v223, 43008, v222
    s_mul_i32 s75, s64, 21504
    v_and_b32 v230, 15, v233
    v_mul_u32_u24 v230, 336, v230
    v_and_b32 v239, 48, v233
    v_add3_u32 v230, v230, v239, s75
    s_add_u32 s100, s100, 4096
    buffer_load_dwordx4 v[176:179], v238, s[56:59], s100 offen offset:0 sc1
    s_add_u32 s100, s70, 61440
    buffer_load_dwordx4 v[180:183], v238, s[56:59], s100 offen offset:0 sc1
    buffer_load_dwordx4 v[184:187], v238, s[56:59], s100 offen offset:1024 sc1
    buffer_load_dwordx4 v[188:191], v238, s[56:59], s100 offen offset:2048 sc1
    buffer_load_dwordx4 v[192:195], v238, s[56:59], s100 offen offset:3072 sc1
    s_add_u32 s100, s100, 4096
    buffer_load_dwordx4 v[196:199], v238, s[56:59], s100 offen offset:0 sc1
    s_add_u32 m0, s6, 32768
    s_add_u32 s100, s70, 163840
    buffer_load_dwordx4 v238, s[56:59], s100 offen offset:0 sc1 lds
    buffer_load_dwordx4 v238, s[56:59], s100 offen offset:1024 sc1 lds
    buffer_load_dwordx4 v238, s[56:59], s100 offen offset:2048 sc1 lds
    buffer_load_dwordx4 v238, s[56:59], s100 offen offset:3072 sc1 lds
    s_add_u32 m0, s6, 36864
    s_add_u32 s100, s100, 4096
    buffer_load_dwordx4 v238, s[56:59], s100 offen offset:0 sc1 lds
    s_add_u32 m0, s71, 0
    s_nop 0
    s_add_u32 s100, s70, 184320
    buffer_load_dwordx4 v238, s[56:59], s100 offen offset:0 sc1 lds
    buffer_load_dwordx4 v238, s[56:59], s100 offen offset:1024 sc1 lds
    buffer_load_dwordx4 v238, s[56:59], s100 offen offset:2048 sc1 lds
    buffer_load_dwordx4 v238, s[56:59], s100 offen offset:3072 sc1 lds
    s_add_u32 m0, s71, 4096
    s_add_u32 s100, s100, 4096
    buffer_load_dwordx4 v238, s[56:59], s100 offen offset:0 sc1 lds
    s_add_u32 m0, s6, 21504
    s_add_u32 s100, s70, 204800
    buffer_load_dwordx4 v238, s[56:59], s100 offen offset:0 sc1 lds
    buffer_load_dwordx4 v238, s[56:59], s100 offen offset:1024 sc1 lds
    buffer_load_dwordx4 v238, s[56:59], s100 offen offset:2048 sc1 lds
    s_add_u32 m0, s6, 2048
    s_nop 0
    buffer_load_dwordx4 v238, s[56:59], s100 offen offset:3072 sc1 lds
    s_add_u32 m0, s6, 6144
    s_add_u32 s100, s100, 4096
    buffer_load_dwordx4 v238, s[56:59], s100 offen offset:0 sc1 lds
L_p2_g:
    s_mov_b64 exec, s[10:11]
    buffer_load_dword v232, v231, s[56:59], s28 offen sc1
    s_mov_b64 exec, -1
    s_add_u32 m0, s6, 7168
    s_add_u32 s100, s70, 225280
    buffer_load_dwordx4 v238, s[56:59], s100 offen offset:0 sc1 lds
    s_add_u32 m0, s6, 36864
    s_nop 0
    buffer_load_dwordx4 v238, s[56:59], s100 offen offset:1024 sc1 lds
    buffer_load_dwordx4 v238, s[56:59], s100 offen offset:2048 sc1 lds
    buffer_load_dwordx4 v238, s[56:59], s100 offen offset:3072 sc1 lds
    s_add_u32 m0, s29, 159744
    s_add_u32 s100, s100, 4096
    buffer_load_dwordx4 v238, s[56:59], s100 offen offset:0 sc1 lds
    s_waitcnt vmcnt(5)
    v_cmp_ne_u32 vcc, s83, v232
    s_nop 0
    s_and_b64 vcc, vcc, s[10:11]
    s_cbranch_vccnz L_slow_gg
L_go_gg:
    s_add_u32 s101, s69, 0
    buffer_load_dwordx4 v[80:83], v238, s[52:55], s101 offen offset:0 sc1
    buffer_load_dwordx4 v[84:87], v238, s[52:55], s101 offen offset:1024 sc1
    buffer_load_dwordx4 v[88:91], v238, s[52:55], s101 offen offset:2048 sc1
    buffer_load_dwordx4 v[92:95], v238, s[52:55], s101 offen offset:3072 sc1
    s_add_u32 s101, s69, 16384
    buffer_load_dwordx4 v[96:99], v238, s[52:55], s101 offen offset:0 sc1
    buffer_load_dwordx4 v[100:103], v238, s[52:55], s101 offen offset:1024 sc1
    buffer_load_dwordx4 v[104:107], v238, s[52:55], s101 offen offset:2048 sc1
    buffer_load_dwordx4 v[108:111], v238, s[52:55], s101 offen offset:3072 sc1
    s_add_u32 s101, s69, 32768
    buffer_load_dwordx4 v[112:115], v238, s[52:55], s101 offen offset:0 sc1
    buffer_load_dwordx4 v[116:119], v238, s[52:55], s101 offen offset:1024 sc1
    buffer_load_dwordx4 v[120:123], v238, s[52:55], s101 offen offset:2048 sc1
    buffer_load_dwordx4 v[124:127], v238, s[52:55], s101 offen offset:3072 sc1
    s_add_u32 s101, s69, 49152
    buffer_load_dwordx4 v[128:131], v238, s[52:55], s101 offen offset:0 sc1
    buffer_load_dwordx4 v[132:135], v238, s[52:55], s101 offen offset:1024 sc1
    buffer_load_dwordx4 v[136:139], v238, s[52:55], s101 offen offset:2048 sc1
    buffer_load_dwordx4 v[140:143], v238, s[52:55], s101 offen offset:3072 sc1
    v_add_u32 v234, s71, v238
    v_add_u32 v236, s6, v238
    v_add_u32 v237, s29, v238
    v_add_u32 v237, 159744, v237
    v_cmp_ne_u32 vcc, s83, v15
    s_cbranch_vccnz L_slow_stg
L_go_stg:
    v_and_b32 v239, 48, v233
    ds_bpermute_b32 v16, v239, v14 offset:0
    ds_bpermute_b32 v18, v239, v14 offset:64
    ds_bpermute_b32 v20, v239, v14 offset:128
    ds_bpermute_b32 v22, v239, v14 offset:192
    v_lshlrev_b32 v24, 16, v10
    v_and_b32 v25, 0xffff0000, v10
    v_lshlrev_b32 v26, 16, v11
    v_and_b32 v27, 0xffff0000, v11
    v_lshlrev_b32 v28, 16, v12
    v_and_b32 v29, 0xffff0000, v12
    v_lshlrev_b32 v30, 16, v13
    v_and_b32 v31, 0xffff0000, v13
    v_and_b32 v15, 0xffff0000, v14
    v_lshlrev_b32 v14, 16, v14
    v_rcp_f32 v15, v15
    v_lshlrev_b32 v216, 16, v8
    v_and_b32 v217, 0xffff0000, v8
    v_lshlrev_b32 v218, 16, v9
    v_and_b32 v219, 0xffff0000, v9
    v_pk_add_f32 v[10:11], v[216:217], v[14:15] op_sel_hi:[1,0]
    v_pk_mul_f32 v[10:11], v[10:11], v[14:15] op_sel:[0,1] op_sel_hi:[1,1]
    v_pk_fma_f32 v[216:217], v[10:11], v[28:29], v[216:217]
    v_pk_add_f32 v[12:13], v[218:219], v[14:15] op_sel_hi:[1,0]
    v_pk_mul_f32 v[12:13], v[12:13], v[14:15] op_sel:[0,1] op_sel_hi:[1,1]
    v_pk_fma_f32 v[218:219], v[12:13], v[30:31], v[218:219]
    s_waitcnt lgkmcnt(0)
    v_and_b32 v17, 0xffff0000, v16
    v_lshlrev_b32 v16, 16, v16
    v_rcp_f32 v17, v17
    v_lshlrev_b32 v200, 16, v0
    v_and_b32 v201, 0xffff0000, v0
    v_lshlrev_b32_e64 v202, 16, v1
    v_and_b32 v203, 0xffff0000, v1
    v_pk_add_f32 v[10:11], v[200:201], v[16:17] op_sel_hi:[1,0]
    v_pk_mul_f32 v[10:11], v[10:11], v[16:17] op_sel:[0,1] op_sel_hi:[1,1]
    v_pk_fma_f32 v[200:201], v[10:11], v[24:25], v[200:201]
    v_pk_add_f32 v[12:13], v[202:203], v[16:17] op_sel_hi:[1,0]
    v_pk_mul_f32 v[12:13], v[12:13], v[16:17] op_sel:[0,1] op_sel_hi:[1,1]
    v_pk_fma_f32 v[202:203], v[12:13], v[26:27], v[202:203]
    v_and_b32 v19, 0xffff0000, v18
    v_lshlrev_b32 v18, 16, v18
    v_rcp_f32 v19, v19
    v_lshlrev_b32 v204, 16, v2
    v_and_b32 v205, 0xffff0000, v2
    v_lshlrev_b32 v206, 16, v3
    v_and_b32 v207, 0xffff0000, v3
    v_pk_add_f32 v[10:11], v[204:205], v[18:19] op_sel_hi:[1,0]
    v_pk_mul_f32 v[10:11], v[10:11], v[18:19] op_sel:[0,1] op_sel_hi:[1,1]
    v_pk_fma_f32 v[204:205], v[10:11], v[24:25], v[204:205]
    v_pk_add_f32 v[12:13], v[206:207], v[18:19] op_sel_hi:[1,0]
    v_pk_mul_f32 v[12:13], v[12:13], v[18:19] op_sel:[0,1] op_sel_hi:[1,1]
    v_pk_fma_f32 v[206:207], v[12:13], v[26:27], v[206:207]
    v_and_b32 v21, 0xffff0000, v20
    v_lshlrev_b32 v20, 16, v20
    v_rcp_f32 v21, v21
    v_lshlrev_b32 v208, 16, v4
    v_and_b32 v209, 0xffff0000, v4
    v_lshlrev_b32 v210, 16, v5
    v_and_b32 v211, 0xffff0000, v5
    v_pk_add_f32 v[10:11], v[208:209], v[20:21] op_sel_hi:[1,0]
    v_pk_mul_f32 v[10:11], v[10:11], v[20:21] op_sel:[0,1] op_sel_hi:[1,1]
    v_pk_fma_f32 v[208:209], v[10:11], v[24:25], v[208:209]
    v_pk_add_f32 v[12:13], v[210:211], v[20:21] op_sel_hi:[1,0]
    v_pk_mul_f32 v[12:13], v[12:13], v[20:21] op_sel:[0,1] op_sel_hi:[1,1]
    v_pk_fma_f32 v[210:211], v[12:13], v[26:27], v[210:211]
    v_and_b32 v23, 0xffff0000, v22
    v_lshlrev_b32 v22, 16, v22
    v_rcp_f32 v23, v23
    v_lshlrev_b32 v212, 16, v6
    v_and_b32 v213, 0xffff0000, v6
    v_lshlrev_b32 v214, 16, v7
    v_and_b32 v215, 0xffff0000, v7
    v_pk_add_f32 v[10:11], v[212:213], v[22:23] op_sel_hi:[1,0]
    v_pk_mul_f32 v[10:11], v[10:11], v[22:23] op_sel:[0,1] op_sel_hi:[1,1]
    v_pk_fma_f32 v[212:213], v[10:11], v[24:25], v[212:213]
    v_pk_add_f32 v[12:13], v[214:215], v[22:23] op_sel_hi:[1,0]
    v_pk_mul_f32 v[12:13], v[12:13], v[22:23] op_sel:[0,1] op_sel_hi:[1,1]
    v_pk_fma_f32 v[214:215], v[12:13], v[26:27], v[214:215]
    s_waitcnt vmcnt(12)
    v_mfma_f32_16x16x32_bf16 v[0:3], a[200:203], v[80:83], 0
    s_add_u32 s101, s69, 65536
    buffer_load_dwordx4 v[144:147], v238, s[52:55], s101 offen offset:0 sc1
    v_mfma_f32_16x16x32_bf16 v[4:7], a[204:207], v[80:83], 0
    v_mfma_f32_16x16x32_bf16 v[8:11], a[208:211], v[80:83], 0
    v_mfma_f32_16x16x32_bf16 v[12:15], a[212:215], v[80:83], 0
    v_mfma_f32_16x16x32_bf16 v[16:19], a[216:219], v[80:83], 0
    v_mfma_f32_16x16x32_bf16 v[20:23], a[200:203], v[84:87], 0
    buffer_load_dwordx4 v[148:151], v238, s[52:55], s101 offen offset:1024 sc1
    v_mfma_f32_16x16x32_bf16 v[24:27], a[204:207], v[84:87], 0
    v_mfma_f32_16x16x32_bf16 v[28:31], a[208:211], v[84:87], 0
    v_mfma_f32_16x16x32_bf16 v[32:35], a[212:215], v[84:87], 0
    v_mfma_f32_16x16x32_bf16 v[36:39], a[216:219], v[84:87], 0
    v_mfma_f32_16x16x32_bf16 v[40:43], a[200:203], v[88:91], 0
    buffer_load_dwordx4 v[152:155], v238, s[52:55], s101 offen offset:2048 sc1
    v_mfma_f32_16x16x32_bf16 v[44:47], a[204:207], v[88:91], 0
    v_mfma_f32_16x16x32_bf16 v[48:51], a[208:211], v[88:91], 0
    v_mfma_f32_16x16x32_bf16 v[52:55], a[212:215], v[88:91], 0
    v_mfma_f32_16x16x32_bf16 v[56:59], a[216:219], v[88:91], 0
    v_mfma_f32_16x16x32_bf16 v[60:63], a[200:203], v[92:95], 0
    buffer_load_dwordx4 v[156:159], v238, s[52:55], s101 offen offset:3072 sc1
    v_mfma_f32_16x16x32_bf16 v[64:67], a[204:207], v[92:95], 0
    v_mfma_f32_16x16x32_bf16 v[68:71], a[208:211], v[92:95], 0
    v_mfma_f32_16x16x32_bf16 v[72:75], a[212:215], v[92:95], 0
    v_mfma_f32_16x16x32_bf16 v[76:79], a[216:219], v[92:95], 0
    s_waitcnt vmcnt(12)
    v_mfma_f32_16x16x32_bf16 v[0:3], a[220:223], v[96:99], v[0:3]
    s_add_u32 s101, s69, 81920
    buffer_load_dwordx4 v[80:83], v238, s[52:55], s101 offen offset:0 sc1
    v_mfma_f32_16x16x32_bf16 v[4:7], a[224:227], v[96:99], v[4:7]
    v_mfma_f32_16x16x32_bf16 v[8:11], a[228:231], v[96:99], v[8:11]
    v_mfma_f32_16x16x32_bf16 v[12:15], a[232:235], v[96:99], v[12:15]
    v_mfma_f32_16x16x32_bf16 v[16:19], a[236:239], v[96:99], v[16:19]
    v_mfma_f32_16x16x32_bf16 v[20:23], a[220:223], v[100:103], v[20:23]
    buffer_load_dwordx4 v[84:87], v238, s[52:55], s101 offen offset:1024 sc1
    v_mfma_f32_16x16x32_bf16 v[24:27], a[224:227], v[100:103], v[24:27]
    v_mfma_f32_16x16x32_bf16 v[28:31], a[228:231], v[100:103], v[28:31]
    v_mfma_f32_16x16x32_bf16 v[32:35], a[232:235], v[100:103], v[32:35]
    v_mfma_f32_16x16x32_bf16 v[36:39], a[236:239], v[100:103], v[36:39]
    v_mfma_f32_16x16x32_bf16 v[40:43], a[220:223], v[104:107], v[40:43]
    buffer_load_dwordx4 v[88:91], v238, s[52:55], s101 offen offset:2048 sc1
    v_mfma_f32_16x16x32_bf16 v[44:47], a[224:227], v[104:107], v[44:47]
    v_mfma_f32_16x16x32_bf16 v[48:51], a[228:231], v[104:107], v[48:51]
    v_mfma_f32_16x16x32_bf16 v[52:55], a[232:235], v[104:107], v[52:55]
    v_mfma_f32_16x16x32_bf16 v[56:59], a[236:239], v[104:107], v[56:59]
    v_mfma_f32_16x16x32_bf16 v[60:63], a[220:223], v[108:111], v[60:63]
    buffer_load_dwordx4 v[92:95], v238, s[52:55], s101 offen offset:3072 sc1
    v_mfma_f32_16x16x32_bf16 v[64:67], a[224:227], v[108:111], v[64:67]
    v_mfma_f32_16x16x32_bf16 v[68:71], a[228:231], v[108:111], v[68:71]
    v_mfma_f32_16x16x32_bf16 v[72:75], a[232:235], v[108:111], v[72:75]
    v_mfma_f32_16x16x32_bf16 v[76:79], a[236:239], v[108:111], v[76:79]
    s_waitcnt vmcnt(12)
    v_mfma_f32_16x16x32_bf16 v[0:3], v[160:163], v[112:115], v[0:3]
    s_add_u32 s101, s69, 98304
    buffer_load_dwordx4 v[96:99], v238, s[52:55], s101 offen offset:0 sc1
    v_mfma_f32_16x16x32_bf16 v[4:7], v[164:167], v[112:115], v[4:7]
    v_mfma_f32_16x16x32_bf16 v[8:11], v[168:171], v[112:115], v[8:11]
    v_mfma_f32_16x16x32_bf16 v[12:15], v[172:175], v[112:115], v[12:15]
    buffer_load_dwordx4 v[100:103], v238, s[52:55], s101 offen offset:1024 sc1
    v_mfma_f32_16x16x32_bf16 v[16:19], v[176:179], v[112:115], v[16:19]
    v_mfma_f32_16x16x32_bf16 v[20:23], v[160:163], v[116:119], v[20:23]
    v_mfma_f32_16x16x32_bf16 v[24:27], v[164:167], v[116:119], v[24:27]
    buffer_load_dwordx4 v[104:107], v238, s[52:55], s101 offen offset:2048 sc1
    v_mfma_f32_16x16x32_bf16 v[28:31], v[168:171], v[116:119], v[28:31]
    v_mfma_f32_16x16x32_bf16 v[32:35], v[172:175], v[116:119], v[32:35]
    v_mfma_f32_16x16x32_bf16 v[36:39], v[176:179], v[116:119], v[36:39]
    v_mfma_f32_16x16x32_bf16 v[40:43], v[160:163], v[120:123], v[40:43]
    buffer_load_dwordx4 v[108:111], v238, s[52:55], s101 offen offset:3072 sc1
    v_mfma_f32_16x16x32_bf16 v[44:47], v[164:167], v[120:123], v[44:47]
    v_mfma_f32_16x16x32_bf16 v[48:51], v[168:171], v[120:123], v[48:51]
    v_mfma_f32_16x16x32_bf16 v[52:55], v[172:175], v[120:123], v[52:55]
    s_add_u32 s100, s70, 245760
    buffer_load_dwordx4 a[200:203], v238, s[56:59], s100 offen offset:0 sc1
    v_mfma_f32_16x16x32_bf16 v[56:59], v[176:179], v[120:123], v[56:59]
    v_mfma_f32_16x16x32_bf16 v[60:63], v[160:163], v[124:127], v[60:63]
    v_mfma_f32_16x16x32_bf16 v[64:67], v[164:167], v[124:127], v[64:67]
    buffer_load_dwordx4 a[204:207], v238, s[56:59], s100 offen offset:1024 sc1
    v_mfma_f32_16x16x32_bf16 v[68:71], v[168:171], v[124:127], v[68:71]
    v_mfma_f32_16x16x32_bf16 v[72:75], v[172:175], v[124:127], v[72:75]
    v_mfma_f32_16x16x32_bf16 v[76:79], v[176:179], v[124:127], v[76:79]
    s_waitcnt vmcnt(14)
    v_mfma_f32_16x16x32_bf16 v[0:3], v[180:183], v[128:131], v[0:3]
    v_mfma_f32_16x16x32_bf16 v[4:7], v[184:187], v[128:131], v[4:7]
    ds_read_b128 a[220:223], v236 offset:16384
    v_mfma_f32_16x16x32_bf16 v[8:11], v[188:191], v[128:131], v[8:11]
    v_mfma_f32_16x16x32_bf16 v[12:15], v[192:195], v[128:131], v[12:15]
    ds_read_b128 a[224:227], v236 offset:17408
    v_mfma_f32_16x16x32_bf16 v[16:19], v[196:199], v[128:131], v[16:19]
    v_mfma_f32_16x16x32_bf16 v[20:23], v[180:183], v[132:135], v[20:23]
    ds_read_b128 a[228:231], v236 offset:18432
    v_mfma_f32_16x16x32_bf16 v[24:27], v[184:187], v[132:135], v[24:27]
    ds_read_b128 a[232:235], v236 offset:19456
    v_mfma_f32_16x16x32_bf16 v[28:31], v[188:191], v[132:135], v[28:31]
    v_mfma_f32_16x16x32_bf16 v[32:35], v[192:195], v[132:135], v[32:35]
    ds_read_b128 a[236:239], v236 offset:20480
    v_mfma_f32_16x16x32_bf16 v[36:39], v[196:199], v[132:135], v[36:39]
    v_mfma_f32_16x16x32_bf16 v[40:43], v[180:183], v[136:139], v[40:43]
    s_add_u32 s101, s69, 114688
    buffer_load_dwordx4 v[112:115], v238, s[52:55], s101 offen offset:0 sc1
    v_mfma_f32_16x16x32_bf16 v[44:47], v[184:187], v[136:139], v[44:47]
    buffer_load_dwordx4 v[116:119], v238, s[52:55], s101 offen offset:1024 sc1
    v_mfma_f32_16x16x32_bf16 v[48:51], v[188:191], v[136:139], v[48:51]
    v_mfma_f32_16x16x32_bf16 v[52:55], v[192:195], v[136:139], v[52:55]
    buffer_load_dwordx4 v[120:123], v238, s[52:55], s101 offen offset:2048 sc1
    v_mfma_f32_16x16x32_bf16 v[56:59], v[196:199], v[136:139], v[56:59]
    v_mfma_f32_16x16x32_bf16 v[60:63], v[180:183], v[140:143], v[60:63]
    buffer_load_dwordx4 v[124:127], v238, s[52:55], s101 offen offset:3072 sc1
    v_mfma_f32_16x16x32_bf16 v[64:67], v[184:187], v[140:143], v[64:67]
    buffer_load_dwordx4 a[208:211], v238, s[56:59], s100 offen offset:2048 sc1
    v_mfma_f32_16x16x32_bf16 v[68:71], v[188:191], v[140:143], v[68:71]
    v_mfma_f32_16x16x32_bf16 v[72:75], v[192:195], v[140:143], v[72:75]
    buffer_load_dwordx4 a[212:215], v238, s[56:59], s100 offen offset:3072 sc1
    v_mfma_f32_16x16x32_bf16 v[76:79], v[196:199], v[140:143], v[76:79]
    s_waitcnt vmcnt(16) lgkmcnt(0)
    v_mfma_f32_16x16x32_bf16 v[0:3], a[220:223], v[144:147], v[0:3]
    v_mfma_f32_16x16x32_bf16 v[4:7], a[224:227], v[144:147], v[4:7]
    ds_read_b128 v[160:163], v234 offset:20480
    v_mfma_f32_16x16x32_bf16 v[8:11], a[228:231], v[144:147], v[8:11]
    v_mfma_f32_16x16x32_bf16 v[12:15], a[232:235], v[144:147], v[12:15]
    ds_read_b128 v[164:167], v234 offset:21504
    v_mfma_f32_16x16x32_bf16 v[16:19], a[236:239], v[144:147], v[16:19]
    v_mfma_f32_16x16x32_bf16 v[20:23], a[220:223], v[148:151], v[20:23]
    ds_read_b128 v[168:171], v234 offset:22528
    v_mfma_f32_16x16x32_bf16 v[24:27], a[224:227], v[148:151], v[24:27]
    ds_read_b128 v[172:175], v234 offset:23552
    v_mfma_f32_16x16x32_bf16 v[28:31], a[228:231], v[148:151], v[28:31]
    v_mfma_f32_16x16x32_bf16 v[32:35], a[232:235], v[148:151], v[32:35]
    ds_read_b128 v[176:179], v234 offset:24576
    v_mfma_f32_16x16x32_bf16 v[36:39], a[236:239], v[148:151], v[36:39]
    v_mfma_f32_16x16x32_bf16 v[40:43], a[220:223], v[152:155], v[40:43]
    s_add_u32 s101, s69, 131072
    buffer_load_dwordx4 v[128:131], v238, s[52:55], s101 offen offset:0 sc1
    v_mfma_f32_16x16x32_bf16 v[44:47], a[224:227], v[152:155], v[44:47]
    buffer_load_dwordx4 v[132:135], v238, s[52:55], s101 offen offset:1024 sc1
    v_mfma_f32_16x16x32_bf16 v[48:51], a[228:231], v[152:155], v[48:51]
    v_mfma_f32_16x16x32_bf16 v[52:55], a[232:235], v[152:155], v[52:55]
    buffer_load_dwordx4 v[136:139], v238, s[52:55], s101 offen offset:2048 sc1
    v_mfma_f32_16x16x32_bf16 v[56:59], a[236:239], v[152:155], v[56:59]
    v_mfma_f32_16x16x32_bf16 v[60:63], a[220:223], v[156:159], v[60:63]
    buffer_load_dwordx4 v[140:143], v238, s[52:55], s101 offen offset:3072 sc1
    v_mfma_f32_16x16x32_bf16 v[64:67], a[224:227], v[156:159], v[64:67]
    s_add_u32 s100, s100, 4096
    buffer_load_dwordx4 a[216:219], v238, s[56:59], s100 offen offset:0 sc1
    v_mfma_f32_16x16x32_bf16 v[68:71], a[228:231], v[156:159], v[68:71]
    v_mfma_f32_16x16x32_bf16 v[72:75], a[232:235], v[156:159], v[72:75]
    s_add_u32 s100, s70, 266240
    s_add_u32 s100, s100, s7
    buffer_load_dwordx4 v[180:183], v238, s[56:59], s100 offen offset:0 sc1
    v_mfma_f32_16x16x32_bf16 v[76:79], a[236:239], v[156:159], v[76:79]
    s_waitcnt vmcnt(18) lgkmcnt(0)
    v_mfma_f32_16x16x32_bf16 v[0:3], v[160:163], v[80:83], v[0:3]
    v_mfma_f32_16x16x32_bf16 v[4:7], v[164:167], v[80:83], v[4:7]
    ds_read_b128 a[220:223], v236 offset:0
    v_mfma_f32_16x16x32_bf16 v[8:11], v[168:171], v[80:83], v[8:11]
    v_mfma_f32_16x16x32_bf16 v[12:15], v[172:175], v[80:83], v[12:15]
    ds_read_b128 a[224:227], v236 offset:1024
    v_mfma_f32_16x16x32_bf16 v[16:19], v[176:179], v[80:83], v[16:19]
    v_mfma_f32_16x16x32_bf16 v[20:23], v[160:163], v[84:87], v[20:23]
    ds_read_b128 a[228:231], v236 offset:2048
    v_mfma_f32_16x16x32_bf16 v[24:27], v[164:167], v[84:87], v[24:27]
    ds_read_b128 a[232:235], v236 offset:3072
    v_mfma_f32_16x16x32_bf16 v[28:31], v[168:171], v[84:87], v[28:31]
    v_mfma_f32_16x16x32_bf16 v[32:35], v[172:175], v[84:87], v[32:35]
    ds_read_b128 a[236:239], v236 offset:4096
    v_mfma_f32_16x16x32_bf16 v[36:39], v[176:179], v[84:87], v[36:39]
    v_mfma_f32_16x16x32_bf16 v[40:43], v[160:163], v[88:91], v[40:43]
    s_add_u32 s101, s69, 147456
    buffer_load_dwordx4 v[144:147], v238, s[52:55], s101 offen offset:0 sc1
    v_mfma_f32_16x16x32_bf16 v[44:47], v[164:167], v[88:91], v[44:47]
    buffer_load_dwordx4 v[148:151], v238, s[52:55], s101 offen offset:1024 sc1
    v_mfma_f32_16x16x32_bf16 v[48:51], v[168:171], v[88:91], v[48:51]
    v_mfma_f32_16x16x32_bf16 v[52:55], v[172:175], v[88:91], v[52:55]
    buffer_load_dwordx4 v[152:155], v238, s[52:55], s101 offen offset:2048 sc1
    v_mfma_f32_16x16x32_bf16 v[56:59], v[176:179], v[88:91], v[56:59]
    v_mfma_f32_16x16x32_bf16 v[60:63], v[160:163], v[92:95], v[60:63]
    buffer_load_dwordx4 v[156:159], v238, s[52:55], s101 offen offset:3072 sc1
    v_mfma_f32_16x16x32_bf16 v[64:67], v[164:167], v[92:95], v[64:67]
    buffer_load_dwordx4 v[184:187], v238, s[56:59], s100 offen offset:1024 sc1
    v_mfma_f32_16x16x32_bf16 v[68:71], v[168:171], v[92:95], v[68:71]
    v_mfma_f32_16x16x32_bf16 v[72:75], v[172:175], v[92:95], v[72:75]
    buffer_load_dwordx4 v[188:191], v238, s[56:59], s100 offen offset:2048 sc1
    v_mfma_f32_16x16x32_bf16 v[76:79], v[176:179], v[92:95], v[76:79]
    s_waitcnt vmcnt(20) lgkmcnt(0)
    v_mfma_f32_16x16x32_bf16 v[0:3], a[220:223], v[96:99], v[0:3]
    v_mfma_f32_16x16x32_bf16 v[4:7], a[224:227], v[96:99], v[4:7]
    ds_read_b128 v[160:163], v234 offset:40960
    v_mfma_f32_16x16x32_bf16 v[8:11], a[228:231], v[96:99], v[8:11]
    v_mfma_f32_16x16x32_bf16 v[12:15], a[232:235], v[96:99], v[12:15]
    ds_read_b128 v[164:167], v234 offset:41984
    v_mfma_f32_16x16x32_bf16 v[16:19], a[236:239], v[96:99], v[16:19]
    v_mfma_f32_16x16x32_bf16 v[20:23], a[220:223], v[100:103], v[20:23]
    ds_read_b128 v[168:171], v234 offset:43008
    v_mfma_f32_16x16x32_bf16 v[24:27], a[224:227], v[100:103], v[24:27]
    ds_read_b128 v[172:175], v234 offset:44032
    v_mfma_f32_16x16x32_bf16 v[28:31], a[228:231], v[100:103], v[28:31]
    v_mfma_f32_16x16x32_bf16 v[32:35], a[232:235], v[100:103], v[32:35]
    ds_read_b128 v[176:179], v234 offset:45056
    v_mfma_f32_16x16x32_bf16 v[36:39], a[236:239], v[100:103], v[36:39]
    v_mfma_f32_16x16x32_bf16 v[40:43], a[220:223], v[104:107], v[40:43]
    s_add_u32 s101, s69, 163840
    buffer_load_dwordx4 v[80:83], v238, s[52:55], s101 offen offset:0 sc1
    v_mfma_f32_16x16x32_bf16 v[44:47], a[224:227], v[104:107], v[44:47]
    buffer_load_dwordx4 v[84:87], v238, s[52:55], s101 offen offset:1024 sc1
    v_mfma_f32_16x16x32_bf16 v[48:51], a[228:231], v[104:107], v[48:51]
    v_mfma_f32_16x16x32_bf16 v[52:55], a[232:235], v[104:107], v[52:55]
    buffer_load_dwordx4 v[88:91], v238, s[52:55], s101 offen offset:2048 sc1
    v_mfma_f32_16x16x32_bf16 v[56:59], a[236:239], v[104:107], v[56:59]
    v_mfma_f32_16x16x32_bf16 v[60:63], a[220:223], v[108:111], v[60:63]
    buffer_load_dwordx4 v[92:95], v238, s[52:55], s101 offen offset:3072 sc1
    v_mfma_f32_16x16x32_bf16 v[64:67], a[224:227], v[108:111], v[64:67]
    buffer_load_dwordx4 v[192:195], v238, s[56:59], s100 offen offset:3072 sc1
    v_mfma_f32_16x16x32_bf16 v[68:71], a[228:231], v[108:111], v[68:71]
    v_mfma_f32_16x16x32_bf16 v[72:75], a[232:235], v[108:111], v[72:75]
    s_add_u32 s100, s100, 4096
    buffer_load_dwordx4 v[196:199], v238, s[56:59], s100 offen offset:0 sc1
    v_mfma_f32_16x16x32_bf16 v[76:79], a[236:239], v[108:111], v[76:79]
    s_waitcnt vmcnt(20) lgkmcnt(0)
    v_mfma_f32_16x16x32_bf16 v[0:3], v[160:163], v[112:115], v[0:3]
    v_mfma_f32_16x16x32_bf16 v[4:7], v[164:167], v[112:115], v[4:7]
    v_mfma_f32_16x16x32_bf16 v[8:11], v[168:171], v[112:115], v[8:11]
    ds_read_b128 a[220:223], v236 offset:32768
    v_mfma_f32_16x16x32_bf16 v[12:15], v[172:175], v[112:115], v[12:15]
    v_mfma_f32_16x16x32_bf16 v[16:19], v[176:179], v[112:115], v[16:19]
    ds_read_b128 a[224:227], v236 offset:33792
    v_mfma_f32_16x16x32_bf16 v[20:23], v[160:163], v[116:119], v[20:23]
    v_mfma_f32_16x16x32_bf16 v[24:27], v[164:167], v[116:119], v[24:27]
    ds_read_b128 a[228:231], v236 offset:34816
    v_mfma_f32_16x16x32_bf16 v[28:31], v[168:171], v[116:119], v[28:31]
    v_mfma_f32_16x16x32_bf16 v[32:35], v[172:175], v[116:119], v[32:35]
    ds_read_b128 a[232:235], v236 offset:35840
    v_mfma_f32_16x16x32_bf16 v[36:39], v[176:179], v[116:119], v[36:39]
    v_mfma_f32_16x16x32_bf16 v[40:43], v[160:163], v[120:123], v[40:43]
    ds_read_b128 a[236:239], v236 offset:36864
    v_mfma_f32_16x16x32_bf16 v[44:47], v[164:167], v[120:123], v[44:47]
    v_mfma_f32_16x16x32_bf16 v[48:51], v[168:171], v[120:123], v[48:51]
    s_add_u32 s101, s69, 180224
    buffer_load_dwordx4 v[96:99], v238, s[52:55], s101 offen offset:0 sc1
    v_mfma_f32_16x16x32_bf16 v[52:55], v[172:175], v[120:123], v[52:55]
    v_mfma_f32_16x16x32_bf16 v[56:59], v[176:179], v[120:123], v[56:59]
    buffer_load_dwordx4 v[100:103], v238, s[52:55], s101 offen offset:1024 sc1
    v_mfma_f32_16x16x32_bf16 v[60:63], v[160:163], v[124:127], v[60:63]
    v_mfma_f32_16x16x32_bf16 v[64:67], v[164:167], v[124:127], v[64:67]
    buffer_load_dwordx4 v[104:107], v238, s[52:55], s101 offen offset:2048 sc1
    v_mfma_f32_16x16x32_bf16 v[68:71], v[168:171], v[124:127], v[68:71]
    v_mfma_f32_16x16x32_bf16 v[72:75], v[172:175], v[124:127], v[72:75]
    buffer_load_dwordx4 v[108:111], v238, s[52:55], s101 offen offset:3072 sc1
    v_mfma_f32_16x16x32_bf16 v[76:79], v[176:179], v[124:127], v[76:79]
    s_waitcnt vmcnt(18) lgkmcnt(0)
    v_mfma_f32_16x16x32_bf16 v[0:3], a[220:223], v[128:131], v[0:3]
    v_mfma_f32_16x16x32_bf16 v[4:7], a[224:227], v[128:131], v[4:7]
    ds_read_b128 v[160:163], v234 offset:0
    v_mfma_f32_16x16x32_bf16 v[8:11], a[228:231], v[128:131], v[8:11]
    v_mfma_f32_16x16x32_bf16 v[12:15], a[232:235], v[128:131], v[12:15]
    ds_read_b128 v[164:167], v234 offset:1024
    v_mfma_f32_16x16x32_bf16 v[16:19], a[236:239], v[128:131], v[16:19]
    v_mfma_f32_16x16x32_bf16 v[20:23], a[220:223], v[132:135], v[20:23]
    ds_read_b128 v[168:171], v234 offset:2048
    v_mfma_f32_16x16x32_bf16 v[24:27], a[224:227], v[132:135], v[24:27]
    v_mfma_f32_16x16x32_bf16 v[28:31], a[228:231], v[132:135], v[28:31]
    ds_read_b128 v[172:175], v234 offset:3072
    v_mfma_f32_16x16x32_bf16 v[32:35], a[232:235], v[132:135], v[32:35]
    v_mfma_f32_16x16x32_bf16 v[36:39], a[236:239], v[132:135], v[36:39]
    ds_read_b128 v[176:179], v234 offset:4096
    v_mfma_f32_16x16x32_bf16 v[40:43], a[220:223], v[136:139], v[40:43]
    s_mov_b64 exec, s[22:23]
    buffer_load_dword v232, v231, s[56:59], s28 offen sc1
    s_mov_b64 exec, -1
    v_mfma_f32_16x16x32_bf16 v[44:47], a[224:227], v[136:139], v[44:47]
    v_mfma_f32_16x16x32_bf16 v[48:51], a[228:231], v[136:139], v[48:51]
    s_add_u32 s101, s69, 196608
    buffer_load_dwordx4 v[112:115], v238, s[52:55], s101 offen offset:0 sc1
    v_mfma_f32_16x16x32_bf16 v[52:55], a[232:235], v[136:139], v[52:55]
    v_mfma_f32_16x16x32_bf16 v[56:59], a[236:239], v[136:139], v[56:59]
    buffer_load_dwordx4 v[116:119], v238, s[52:55], s101 offen offset:1024 sc1
    v_mfma_f32_16x16x32_bf16 v[60:63], a[220:223], v[140:143], v[60:63]
    v_mfma_f32_16x16x32_bf16 v[64:67], a[224:227], v[140:143], v[64:67]
    buffer_load_dwordx4 v[120:123], v238, s[52:55], s101 offen offset:2048 sc1
    v_mfma_f32_16x16x32_bf16 v[68:71], a[228:231], v[140:143], v[68:71]
    v_mfma_f32_16x16x32_bf16 v[72:75], a[232:235], v[140:143], v[72:75]
    buffer_load_dwordx4 v[124:127], v238, s[52:55], s101 offen offset:3072 sc1
    v_mfma_f32_16x16x32_bf16 v[76:79], a[236:239], v[140:143], v[76:79]
    s_waitcnt vmcnt(17) lgkmcnt(0)
    v_mfma_f32_16x16x32_bf16 v[0:3], v[160:163], v[144:147], v[0:3]
    v_mfma_f32_16x16x32_bf16 v[4:7], v[164:167], v[144:147], v[4:7]
    v_mfma_f32_16x16x32_bf16 v[8:11], v[168:171], v[144:147], v[8:11]
    v_mfma_f32_16x16x32_bf16 v[12:15], v[172:175], v[144:147], v[12:15]
    ds_read_b128 a[220:223], v236 offset:21504
    v_mfma_f32_16x16x32_bf16 v[16:19], v[176:179], v[144:147], v[16:19]
    v_mfma_f32_16x16x32_bf16 v[20:23], v[160:163], v[148:151], v[20:23]
    v_mfma_f32_16x16x32_bf16 v[24:27], v[164:167], v[148:151], v[24:27]
    ds_read_b128 a[224:227], v236 offset:22528
    v_mfma_f32_16x16x32_bf16 v[28:31], v[168:171], v[148:151], v[28:31]
    v_mfma_f32_16x16x32_bf16 v[32:35], v[172:175], v[148:151], v[32:35]
    v_mfma_f32_16x16x32_bf16 v[36:39], v[176:179], v[148:151], v[36:39]
    v_mfma_f32_16x16x32_bf16 v[40:43], v[160:163], v[152:155], v[40:43]
    ds_read_b128 a[228:231], v236 offset:23552
    v_mfma_f32_16x16x32_bf16 v[44:47], v[164:167], v[152:155], v[44:47]
    v_mfma_f32_16x16x32_bf16 v[48:51], v[168:171], v[152:155], v[48:51]
    v_mfma_f32_16x16x32_bf16 v[52:55], v[172:175], v[152:155], v[52:55]
    ds_read_b128 a[232:235], v236 offset:5120
    v_mfma_f32_16x16x32_bf16 v[56:59], v[176:179], v[152:155], v[56:59]
    v_mfma_f32_16x16x32_bf16 v[60:63], v[160:163], v[156:159], v[60:63]
    v_mfma_f32_16x16x32_bf16 v[64:67], v[164:167], v[156:159], v[64:67]
    ds_read_b128 a[236:239], v236 offset:6144
    v_mfma_f32_16x16x32_bf16 v[68:71], v[168:171], v[156:159], v[68:71]
    v_mfma_f32_16x16x32_bf16 v[72:75], v[172:175], v[156:159], v[72:75]
    v_mfma_f32_16x16x32_bf16 v[76:79], v[176:179], v[156:159], v[76:79]
    s_waitcnt vmcnt(11) lgkmcnt(0)
    v_mfma_f32_16x16x32_bf16 v[0:3], a[220:223], v[80:83], v[0:3]
    v_mfma_f32_16x16x32_bf16 v[4:7], a[224:227], v[80:83], v[4:7]
    ds_read_b128 v[160:163], v236 offset:7168
    v_mfma_f32_16x16x32_bf16 v[8:11], a[228:231], v[80:83], v[8:11]
    ds_read_b128 v[164:167], v236 offset:37888
    v_mfma_f32_16x16x32_bf16 v[12:15], a[232:235], v[80:83], v[12:15]
    v_mfma_f32_16x16x32_bf16 v[16:19], a[236:239], v[80:83], v[16:19]
    ds_read_b128 v[168:171], v236 offset:38912
    v_mfma_f32_16x16x32_bf16 v[20:23], a[220:223], v[84:87], v[20:23]
    ds_read_b128 v[172:175], v236 offset:39936
    v_mfma_f32_16x16x32_bf16 v[24:27], a[224:227], v[84:87], v[24:27]
    ds_read_b128 v[176:179], v237 offset:0
    v_mfma_f32_16x16x32_bf16 v[28:31], a[228:231], v[84:87], v[28:31]
    v_mfma_f32_16x16x32_bf16 v[32:35], a[232:235], v[84:87], v[32:35]
    s_waitcnt vmcnt(4)
    v_cmp_ne_u32 vcc, s83, v232
    s_nop 0
    s_and_b64 vcc, vcc, s[22:23]
    s_cbranch_vccnz L_slow_sg
L_go_sg:
    v_mfma_f32_16x16x32_bf16 v[36:39], a[236:239], v[84:87], v[36:39]
    s_add_u32 s101, s69, 212992
    s_add_u32 s101, s101, s7
    buffer_load_dwordx4 v[128:131], v238, s[52:55], s101 offen offset:0 sc1
    v_mfma_f32_16x16x32_bf16 v[40:43], a[220:223], v[88:91], v[40:43]
    buffer_load_dwordx4 v[132:135], v238, s[52:55], s101 offen offset:1024 sc1
    v_mfma_f32_16x16x32_bf16 v[44:47], a[224:227], v[88:91], v[44:47]
    v_mfma_f32_16x16x32_bf16 v[48:51], a[228:231], v[88:91], v[48:51]
    buffer_load_dwordx4 v[136:139], v238, s[52:55], s101 offen offset:2048 sc1
    v_mfma_f32_16x16x32_bf16 v[52:55], a[232:235], v[88:91], v[52:55]
    buffer_load_dwordx4 v[140:143], v238, s[52:55], s101 offen offset:3072 sc1
    v_mfma_f32_16x16x32_bf16 v[56:59], a[236:239], v[88:91], v[56:59]
    s_lshl_b32 s101, s12, 7
    s_add_u32 s101, s101, s99
    buffer_load_dwordx4 v[144:147], v238, s[52:55], s101 offen offset:0 sc1
    v_mfma_f32_16x16x32_bf16 v[60:63], a[220:223], v[92:95], v[60:63]
    v_mfma_f32_16x16x32_bf16 v[64:67], a[224:227], v[92:95], v[64:67]
    buffer_load_dwordx4 v[148:151], v238, s[52:55], s101 offen offset:1024 sc1
    v_mfma_f32_16x16x32_bf16 v[68:71], a[228:231], v[92:95], v[68:71]
    buffer_load_dwordx4 v[152:155], v238, s[52:55], s101 offen offset:2048 sc1
    v_mfma_f32_16x16x32_bf16 v[72:75], a[232:235], v[92:95], v[72:75]
    buffer_load_dwordx4 v[156:159], v238, s[52:55], s101 offen offset:3072 sc1
    v_mfma_f32_16x16x32_bf16 v[76:79], a[236:239], v[92:95], v[76:79]
    s_waitcnt lgkmcnt(0)
    v_mfma_f32_16x16x32_bf16 v[0:3], v[160:163], v[96:99], v[0:3]
    s_lshl_b32 s101, s12, 7
    s_add_u32 s101, s101, s99
    s_add_u32 s101, s101, 8192
    buffer_load_dwordx4 v[80:83], v238, s[52:55], s101 offen offset:0 sc1
    v_mfma_f32_16x16x32_bf16 v[4:7], v[164:167], v[96:99], v[4:7]
    v_mfma_f32_16x16x32_bf16 v[8:11], v[168:171], v[96:99], v[8:11]
    v_mfma_f32_16x16x32_bf16 v[12:15], v[172:175], v[96:99], v[12:15]
    v_mfma_f32_16x16x32_bf16 v[16:19], v[176:179], v[96:99], v[16:19]
    buffer_load_dwordx4 v[84:87], v238, s[52:55], s101 offen offset:1024 sc1
    v_mfma_f32_16x16x32_bf16 v[20:23], v[160:163], v[100:103], v[20:23]
    v_mfma_f32_16x16x32_bf16 v[24:27], v[164:167], v[100:103], v[24:27]
    v_mfma_f32_16x16x32_bf16 v[28:31], v[168:171], v[100:103], v[28:31]
    v_mfma_f32_16x16x32_bf16 v[32:35], v[172:175], v[100:103], v[32:35]
    buffer_load_dwordx4 v[88:91], v238, s[52:55], s101 offen offset:2048 sc1
    v_mfma_f32_16x16x32_bf16 v[36:39], v[176:179], v[100:103], v[36:39]
    v_mfma_f32_16x16x32_bf16 v[40:43], v[160:163], v[104:107], v[40:43]
    v_mfma_f32_16x16x32_bf16 v[44:47], v[164:167], v[104:107], v[44:47]
    v_mfma_f32_16x16x32_bf16 v[48:51], v[168:171], v[104:107], v[48:51]
    buffer_load_dwordx4 v[92:95], v238, s[52:55], s101 offen offset:3072 sc1
    v_mfma_f32_16x16x32_bf16 v[52:55], v[172:175], v[104:107], v[52:55]
    v_mfma_f32_16x16x32_bf16 v[56:59], v[176:179], v[104:107], v[56:59]
    v_mfma_f32_16x16x32_bf16 v[60:63], v[160:163], v[108:111], v[60:63]
    v_mfma_f32_16x16x32_bf16 v[64:67], v[164:167], v[108:111], v[64:67]
    s_barrier
    v_mfma_f32_16x16x32_bf16 v[68:71], v[168:171], v[108:111], v[68:71]
    v_mfma_f32_16x16x32_bf16 v[72:75], v[172:175], v[108:111], v[72:75]
    v_mfma_f32_16x16x32_bf16 v[76:79], v[176:179], v[108:111], v[76:79]
    s_waitcnt vmcnt(12)
    v_mfma_f32_16x16x32_bf16 v[0:3], a[200:203], v[112:115], v[0:3]
    s_lshl_b32 s101, s13, 7
    s_add_u32 s101, s101, s99
    buffer_load_dwordx4 v[96:99], v238, s[52:55], s101 offen offset:0 sc1
    v_mfma_f32_16x16x32_bf16 v[4:7], a[204:207], v[112:115], v[4:7]
    v_mfma_f32_16x16x32_bf16 v[8:11], a[208:211], v[112:115], v[8:11]
    v_mfma_f32_16x16x32_bf16 v[12:15], a[212:215], v[112:115], v[12:15]
    v_mfma_f32_16x16x32_bf16 v[16:19], a[216:219], v[112:115], v[16:19]
    v_mfma_f32_16x16x32_bf16 v[20:23], a[200:203], v[116:119], v[20:23]
    buffer_load_dwordx4 v[100:103], v238, s[52:55], s101 offen offset:1024 sc1
    v_mfma_f32_16x16x32_bf16 v[24:27], a[204:207], v[116:119], v[24:27]
    v_mfma_f32_16x16x32_bf16 v[28:31], a[208:211], v[116:119], v[28:31]
    v_mfma_f32_16x16x32_bf16 v[32:35], a[212:215], v[116:119], v[32:35]
    v_mfma_f32_16x16x32_bf16 v[36:39], a[216:219], v[116:119], v[36:39]
    v_mfma_f32_16x16x32_bf16 v[40:43], a[200:203], v[120:123], v[40:43]
    buffer_load_dwordx4 v[104:107], v238, s[52:55], s101 offen offset:2048 sc1
    v_mfma_f32_16x16x32_bf16 v[44:47], a[204:207], v[120:123], v[44:47]
    v_mfma_f32_16x16x32_bf16 v[48:51], a[208:211], v[120:123], v[48:51]
    v_mfma_f32_16x16x32_bf16 v[52:55], a[212:215], v[120:123], v[52:55]
    v_mfma_f32_16x16x32_bf16 v[56:59], a[216:219], v[120:123], v[56:59]
    v_mfma_f32_16x16x32_bf16 v[60:63], a[200:203], v[124:127], v[60:63]
    buffer_load_dwordx4 v[108:111], v238, s[52:55], s101 offen offset:3072 sc1
    v_mfma_f32_16x16x32_bf16 v[64:67], a[204:207], v[124:127], v[64:67]
    v_mfma_f32_16x16x32_bf16 v[68:71], a[208:211], v[124:127], v[68:71]
    v_mfma_f32_16x16x32_bf16 v[72:75], a[212:215], v[124:127], v[72:75]
    v_mfma_f32_16x16x32_bf16 v[76:79], a[216:219], v[124:127], v[76:79]
    s_waitcnt vmcnt(12)
    v_mfma_f32_16x16x32_bf16 v[0:3], v[180:183], v[128:131], v[0:3]
    s_lshl_b32 s101, s13, 7
    s_add_u32 s101, s101, s99
    s_add_u32 s101, s101, 8192
    buffer_load_dwordx4 v[112:115], v238, s[52:55], s101 offen offset:0 sc1
    v_mfma_f32_16x16x32_bf16 v[4:7], v[184:187], v[128:131], v[4:7]
    v_mfma_f32_16x16x32_bf16 v[8:11], v[188:191], v[128:131], v[8:11]
    v_mfma_f32_16x16x32_bf16 v[12:15], v[192:195], v[128:131], v[12:15]
    v_mfma_f32_16x16x32_bf16 v[16:19], v[196:199], v[128:131], v[16:19]
    v_mfma_f32_16x16x32_bf16 v[20:23], v[180:183], v[132:135], v[20:23]
    buffer_load_dwordx4 v[116:119], v238, s[52:55], s101 offen offset:1024 sc1
    v_mfma_f32_16x16x32_bf16 v[24:27], v[184:187], v[132:135], v[24:27]
    v_mfma_f32_16x16x32_bf16 v[28:31], v[188:191], v[132:135], v[28:31]
    v_mfma_f32_16x16x32_bf16 v[32:35], v[192:195], v[132:135], v[32:35]
    v_mfma_f32_16x16x32_bf16 v[36:39], v[196:199], v[132:135], v[36:39]
    v_mfma_f32_16x16x32_bf16 v[40:43], v[180:183], v[136:139], v[40:43]
    buffer_load_dwordx4 v[120:123], v238, s[52:55], s101 offen offset:2048 sc1
    v_mfma_f32_16x16x32_bf16 v[44:47], v[184:187], v[136:139], v[44:47]
    v_mfma_f32_16x16x32_bf16 v[48:51], v[188:191], v[136:139], v[48:51]
    v_mfma_f32_16x16x32_bf16 v[52:55], v[192:195], v[136:139], v[52:55]
    v_mfma_f32_16x16x32_bf16 v[56:59], v[196:199], v[136:139], v[56:59]
    v_mfma_f32_16x16x32_bf16 v[60:63], v[180:183], v[140:143], v[60:63]
    buffer_load_dwordx4 v[124:127], v238, s[52:55], s101 offen offset:3072 sc1
    v_mfma_f32_16x16x32_bf16 v[64:67], v[184:187], v[140:143], v[64:67]
    v_mfma_f32_16x16x32_bf16 v[68:71], v[188:191], v[140:143], v[68:71]
    v_mfma_f32_16x16x32_bf16 v[72:75], v[192:195], v[140:143], v[72:75]
    v_mfma_f32_16x16x32_bf16 v[76:79], v[196:199], v[140:143], v[76:79]
    s_waitcnt vmcnt(12)
    v_mfma_f32_16x16x32_bf16 v[0:3], a[0:3], v[144:147], v[0:3]
    s_lshl_b32 s101, s14, 7
    s_add_u32 s101, s101, s99
    buffer_load_dwordx4 v[128:131], v238, s[52:55], s101 offen offset:0 sc1
    v_mfma_f32_16x16x32_bf16 v[4:7], a[4:7], v[144:147], v[4:7]
    v_mfma_f32_16x16x32_bf16 v[8:11], a[8:11], v[144:147], v[8:11]
    v_mfma_f32_16x16x32_bf16 v[12:15], a[12:15], v[144:147], v[12:15]
    v_mfma_f32_16x16x32_bf16 v[16:19], a[16:19], v[144:147], v[16:19]
    v_mfma_f32_16x16x32_bf16 v[20:23], a[0:3], v[148:151], v[20:23]
    buffer_load_dwordx4 v[132:135], v238, s[52:55], s101 offen offset:1024 sc1
    v_mfma_f32_16x16x32_bf16 v[24:27], a[4:7], v[148:151], v[24:27]
    v_mfma_f32_16x16x32_bf16 v[28:31], a[8:11], v[148:151], v[28:31]
    v_mfma_f32_16x16x32_bf16 v[32:35], a[12:15], v[148:151], v[32:35]
    v_mfma_f32_16x16x32_bf16 v[36:39], a[16:19], v[148:151], v[36:39]
    v_mfma_f32_16x16x32_bf16 v[40:43], a[0:3], v[152:155], v[40:43]
    buffer_load_dwordx4 v[136:139], v238, s[52:55], s101 offen offset:2048 sc1
    v_mfma_f32_16x16x32_bf16 v[44:47], a[4:7], v[152:155], v[44:47]
    v_mfma_f32_16x16x32_bf16 v[48:51], a[8:11], v[152:155], v[48:51]
    v_mfma_f32_16x16x32_bf16 v[52:55], a[12:15], v[152:155], v[52:55]
    v_mfma_f32_16x16x32_bf16 v[56:59], a[16:19], v[152:155], v[56:59]
    v_mfma_f32_16x16x32_bf16 v[60:63], a[0:3], v[156:159], v[60:63]
    buffer_load_dwordx4 v[140:143], v238, s[52:55], s101 offen offset:3072 sc1
    v_mfma_f32_16x16x32_bf16 v[64:67], a[4:7], v[156:159], v[64:67]
    v_mfma_f32_16x16x32_bf16 v[68:71], a[8:11], v[156:159], v[68:71]
    v_mfma_f32_16x16x32_bf16 v[72:75], a[12:15], v[156:159], v[72:75]
    v_mfma_f32_16x16x32_bf16 v[76:79], a[16:19], v[156:159], v[76:79]
    s_waitcnt vmcnt(12)
    v_mfma_f32_16x16x32_bf16 v[0:3], a[20:23], v[80:83], v[0:3]
    s_lshl_b32 s101, s14, 7
    s_add_u32 s101, s101, s99
    s_add_u32 s101, s101, 8192
    buffer_load_dwordx4 v[144:147], v238, s[52:55], s101 offen offset:0 sc1
    v_mfma_f32_16x16x32_bf16 v[4:7], a[24:27], v[80:83], v[4:7]
    v_mfma_f32_16x16x32_bf16 v[8:11], a[28:31], v[80:83], v[8:11]
    v_mfma_f32_16x16x32_bf16 v[12:15], a[32:35], v[80:83], v[12:15]
    v_mfma_f32_16x16x32_bf16 v[16:19], a[36:39], v[80:83], v[16:19]
    v_mfma_f32_16x16x32_bf16 v[20:23], a[20:23], v[84:87], v[20:23]
    buffer_load_dwordx4 v[148:151], v238, s[52:55], s101 offen offset:1024 sc1
    v_mfma_f32_16x16x32_bf16 v[24:27], a[24:27], v[84:87], v[24:27]
    v_mfma_f32_16x16x32_bf16 v[28:31], a[28:31], v[84:87], v[28:31]
    v_mfma_f32_16x16x32_bf16 v[32:35], a[32:35], v[84:87], v[32:35]
    v_mfma_f32_16x16x32_bf16 v[36:39], a[36:39], v[84:87], v[36:39]
    v_mfma_f32_16x16x32_bf16 v[40:43], a[20:23], v[88:91], v[40:43]
    buffer_load_dwordx4 v[152:155], v238, s[52:55], s101 offen offset:2048 sc1
    v_mfma_f32_16x16x32_bf16 v[44:47], a[24:27], v[88:91], v[44:47]
    v_mfma_f32_16x16x32_bf16 v[48:51], a[28:31], v[88:91], v[48:51]
    v_mfma_f32_16x16x32_bf16 v[52:55], a[32:35], v[88:91], v[52:55]
    v_mfma_f32_16x16x32_bf16 v[56:59], a[36:39], v[88:91], v[56:59]
    v_mfma_f32_16x16x32_bf16 v[60:63], a[20:23], v[92:95], v[60:63]
    buffer_load_dwordx4 v[156:159], v238, s[52:55], s101 offen offset:3072 sc1
    v_mfma_f32_16x16x32_bf16 v[64:67], a[24:27], v[92:95], v[64:67]
    v_mfma_f32_16x16x32_bf16 v[68:71], a[28:31], v[92:95], v[68:71]
    v_mfma_f32_16x16x32_bf16 v[72:75], a[32:35], v[92:95], v[72:75]
    v_mfma_f32_16x16x32_bf16 v[76:79], a[36:39], v[92:95], v[76:79]
    s_waitcnt vmcnt(12)
    v_mfma_f32_16x16x32_bf16 v[0:3], a[40:43], v[96:99], v[0:3]
    s_lshl_b32 s101, s15, 7
    s_add_u32 s101, s101, s99
    buffer_load_dwordx4 v[80:83], v238, s[52:55], s101 offen offset:0 sc1
    v_mfma_f32_16x16x32_bf16 v[4:7], a[44:47], v[96:99], v[4:7]
    v_mfma_f32_16x16x32_bf16 v[8:11], a[48:51], v[96:99], v[8:11]
    v_mfma_f32_16x16x32_bf16 v[12:15], a[52:55], v[96:99], v[12:15]
    v_mfma_f32_16x16x32_bf16 v[16:19], a[56:59], v[96:99], v[16:19]
    v_mfma_f32_16x16x32_bf16 v[20:23], a[40:43], v[100:103], v[20:23]
    buffer_load_dwordx4 v[84:87], v238, s[52:55], s101 offen offset:1024 sc1
    v_mfma_f32_16x16x32_bf16 v[24:27], a[44:47], v[100:103], v[24:27]
    v_mfma_f32_16x16x32_bf16 v[28:31], a[48:51], v[100:103], v[28:31]
    v_mfma_f32_16x16x32_bf16 v[32:35], a[52:55], v[100:103], v[32:35]
    v_mfma_f32_16x16x32_bf16 v[36:39], a[56:59], v[100:103], v[36:39]
    v_mfma_f32_16x16x32_bf16 v[40:43], a[40:43], v[104:107], v[40:43]
    buffer_load_dwordx4 v[88:91], v238, s[52:55], s101 offen offset:2048 sc1
    v_mfma_f32_16x16x32_bf16 v[44:47], a[44:47], v[104:107], v[44:47]
    v_mfma_f32_16x16x32_bf16 v[48:51], a[48:51], v[104:107], v[48:51]
    v_mfma_f32_16x16x32_bf16 v[52:55], a[52:55], v[104:107], v[52:55]
    v_mfma_f32_16x16x32_bf16 v[56:59], a[56:59], v[104:107], v[56:59]
    v_mfma_f32_16x16x32_bf16 v[60:63], a[40:43], v[108:111], v[60:63]
    buffer_load_dwordx4 v[92:95], v238, s[52:55], s101 offen offset:3072 sc1
    v_mfma_f32_16x16x32_bf16 v[64:67], a[44:47], v[108:111], v[64:67]
    v_mfma_f32_16x16x32_bf16 v[68:71], a[48:51], v[108:111], v[68:71]
    v_mfma_f32_16x16x32_bf16 v[72:75], a[52:55], v[108:111], v[72:75]
    v_mfma_f32_16x16x32_bf16 v[76:79], a[56:59], v[108:111], v[76:79]
    s_waitcnt vmcnt(12)
    v_mfma_f32_16x16x32_bf16 v[0:3], a[60:63], v[112:115], v[0:3]
    s_lshl_b32 s101, s15, 7
    s_add_u32 s101, s101, s99
    s_add_u32 s101, s101, 8192
    buffer_load_dwordx4 v[96:99], v238, s[52:55], s101 offen offset:0 sc1
    v_mfma_f32_16x16x32_bf16 v[4:7], a[64:67], v[112:115], v[4:7]
    v_mfma_f32_16x16x32_bf16 v[8:11], a[68:71], v[112:115], v[8:11]
    v_mfma_f32_16x16x32_bf16 v[12:15], a[72:75], v[112:115], v[12:15]
    v_mfma_f32_16x16x32_bf16 v[16:19], a[76:79], v[112:115], v[16:19]
    v_mfma_f32_16x16x32_bf16 v[20:23], a[60:63], v[116:119], v[20:23]
    buffer_load_dwordx4 v[100:103], v238, s[52:55], s101 offen offset:1024 sc1
    v_mfma_f32_16x16x32_bf16 v[24:27], a[64:67], v[116:119], v[24:27]
    v_mfma_f32_16x16x32_bf16 v[28:31], a[68:71], v[116:119], v[28:31]
    v_mfma_f32_16x16x32_bf16 v[32:35], a[72:75], v[116:119], v[32:35]
    v_mfma_f32_16x16x32_bf16 v[36:39], a[76:79], v[116:119], v[36:39]
    v_mfma_f32_16x16x32_bf16 v[40:43], a[60:63], v[120:123], v[40:43]
    buffer_load_dwordx4 v[104:107], v238, s[52:55], s101 offen offset:2048 sc1
    v_mfma_f32_16x16x32_bf16 v[44:47], a[64:67], v[120:123], v[44:47]
    v_mfma_f32_16x16x32_bf16 v[48:51], a[68:71], v[120:123], v[48:51]
    v_mfma_f32_16x16x32_bf16 v[52:55], a[72:75], v[120:123], v[52:55]
    v_mfma_f32_16x16x32_bf16 v[56:59], a[76:79], v[120:123], v[56:59]
    v_mfma_f32_16x16x32_bf16 v[60:63], a[60:63], v[124:127], v[60:63]
    buffer_load_dwordx4 v[108:111], v238, s[52:55], s101 offen offset:3072 sc1
    v_mfma_f32_16x16x32_bf16 v[64:67], a[64:67], v[124:127], v[64:67]
    v_mfma_f32_16x16x32_bf16 v[68:71], a[68:71], v[124:127], v[68:71]
    v_mfma_f32_16x16x32_bf16 v[72:75], a[72:75], v[124:127], v[72:75]
    v_mfma_f32_16x16x32_bf16 v[76:79], a[76:79], v[124:127], v[76:79]
    s_waitcnt vmcnt(12)
    v_mfma_f32_16x16x32_bf16 v[0:3], a[80:83], v[128:131], v[0:3]
    s_lshl_b32 s101, s30, 7
    s_add_u32 s101, s101, s99
    buffer_load_dwordx4 v[112:115], v238, s[52:55], s101 offen offset:0 sc1
    v_mfma_f32_16x16x32_bf16 v[4:7], a[84:87], v[128:131], v[4:7]
    v_mfma_f32_16x16x32_bf16 v[8:11], a[88:91], v[128:131], v[8:11]
    v_mfma_f32_16x16x32_bf16 v[12:15], a[92:95], v[128:131], v[12:15]
    v_mfma_f32_16x16x32_bf16 v[16:19], a[96:99], v[128:131], v[16:19]
    v_mfma_f32_16x16x32_bf16 v[20:23], a[80:83], v[132:135], v[20:23]
    buffer_load_dwordx4 v[116:119], v238, s[52:55], s101 offen offset:1024 sc1
    v_mfma_f32_16x16x32_bf16 v[24:27], a[84:87], v[132:135], v[24:27]
    v_mfma_f32_16x16x32_bf16 v[28:31], a[88:91], v[132:135], v[28:31]
    v_mfma_f32_16x16x32_bf16 v[32:35], a[92:95], v[132:135], v[32:35]
    v_mfma_f32_16x16x32_bf16 v[36:39], a[96:99], v[132:135], v[36:39]
    v_mfma_f32_16x16x32_bf16 v[40:43], a[80:83], v[136:139], v[40:43]
    buffer_load_dwordx4 v[120:123], v238, s[52:55], s101 offen offset:2048 sc1
    v_mfma_f32_16x16x32_bf16 v[44:47], a[84:87], v[136:139], v[44:47]
    v_mfma_f32_16x16x32_bf16 v[48:51], a[88:91], v[136:139], v[48:51]
    v_mfma_f32_16x16x32_bf16 v[52:55], a[92:95], v[136:139], v[52:55]
    v_mfma_f32_16x16x32_bf16 v[56:59], a[96:99], v[136:139], v[56:59]
    v_mfma_f32_16x16x32_bf16 v[60:63], a[80:83], v[140:143], v[60:63]
    buffer_load_dwordx4 v[124:127], v238, s[52:55], s101 offen offset:3072 sc1
    v_mfma_f32_16x16x32_bf16 v[64:67], a[84:87], v[140:143], v[64:67]
    v_mfma_f32_16x16x32_bf16 v[68:71], a[88:91], v[140:143], v[68:71]
    v_mfma_f32_16x16x32_bf16 v[72:75], a[92:95], v[140:143], v[72:75]
    v_mfma_f32_16x16x32_bf16 v[76:79], a[96:99], v[140:143], v[76:79]
    s_waitcnt vmcnt(12)
    v_mfma_f32_16x16x32_bf16 v[0:3], a[100:103], v[144:147], v[0:3]
    s_lshl_b32 s101, s30, 7
    s_add_u32 s101, s101, s99
    s_add_u32 s101, s101, 8192
    buffer_load_dwordx4 v[128:131], v238, s[52:55], s101 offen offset:0 sc1
    v_mfma_f32_16x16x32_bf16 v[4:7], a[104:107], v[144:147], v[4:7]
    v_mfma_f32_16x16x32_bf16 v[8:11], a[108:111], v[144:147], v[8:11]
    v_mfma_f32_16x16x32_bf16 v[12:15], a[112:115], v[144:147], v[12:15]
    v_mfma_f32_16x16x32_bf16 v[16:19], a[116:119], v[144:147], v[16:19]
    v_mfma_f32_16x16x32_bf16 v[20:23], a[100:103], v[148:151], v[20:23]
    buffer_load_dwordx4 v[132:135], v238, s[52:55], s101 offen offset:1024 sc1
    v_mfma_f32_16x16x32_bf16 v[24:27], a[104:107], v[148:151], v[24:27]
    v_mfma_f32_16x16x32_bf16 v[28:31], a[108:111], v[148:151], v[28:31]
    v_mfma_f32_16x16x32_bf16 v[32:35], a[112:115], v[148:151], v[32:35]
    v_mfma_f32_16x16x32_bf16 v[36:39], a[116:119], v[148:151], v[36:39]
    v_mfma_f32_16x16x32_bf16 v[40:43], a[100:103], v[152:155], v[40:43]
    buffer_load_dwordx4 v[136:139], v238, s[52:55], s101 offen offset:2048 sc1
    v_mfma_f32_16x16x32_bf16 v[44:47], a[104:107], v[152:155], v[44:47]
    v_mfma_f32_16x16x32_bf16 v[48:51], a[108:111], v[152:155], v[48:51]
    v_mfma_f32_16x16x32_bf16 v[52:55], a[112:115], v[152:155], v[52:55]
    v_mfma_f32_16x16x32_bf16 v[56:59], a[116:119], v[152:155], v[56:59]
    v_mfma_f32_16x16x32_bf16 v[60:63], a[100:103], v[156:159], v[60:63]
    buffer_load_dwordx4 v[140:143], v238, s[52:55], s101 offen offset:3072 sc1
    v_mfma_f32_16x16x32_bf16 v[64:67], a[104:107], v[156:159], v[64:67]
    v_mfma_f32_16x16x32_bf16 v[68:71], a[108:111], v[156:159], v[68:71]
    v_mfma_f32_16x16x32_bf16 v[72:75], a[112:115], v[156:159], v[72:75]
    v_mfma_f32_16x16x32_bf16 v[76:79], a[116:119], v[156:159], v[76:79]
    s_waitcnt vmcnt(12)
    v_mfma_f32_16x16x32_bf16 v[0:3], a[120:123], v[80:83], v[0:3]
    v_mfma_f32_16x16x32_bf16 v[4:7], a[124:127], v[80:83], v[4:7]
    v_mfma_f32_16x16x32_bf16 v[8:11], a[128:131], v[80:83], v[8:11]
    v_mfma_f32_16x16x32_bf16 v[12:15], a[132:135], v[80:83], v[12:15]
    v_mfma_f32_16x16x32_bf16 v[16:19], a[136:139], v[80:83], v[16:19]
    v_mfma_f32_16x16x32_bf16 v[20:23], a[120:123], v[84:87], v[20:23]
    v_mfma_f32_16x16x32_bf16 v[24:27], a[124:127], v[84:87], v[24:27]
    v_mfma_f32_16x16x32_bf16 v[28:31], a[128:131], v[84:87], v[28:31]
    v_mfma_f32_16x16x32_bf16 v[32:35], a[132:135], v[84:87], v[32:35]
    v_mfma_f32_16x16x32_bf16 v[36:39], a[136:139], v[84:87], v[36:39]
    v_mfma_f32_16x16x32_bf16 v[40:43], a[120:123], v[88:91], v[40:43]
    v_mfma_f32_16x16x32_bf16 v[44:47], a[124:127], v[88:91], v[44:47]
    v_mfma_f32_16x16x32_bf16 v[48:51], a[128:131], v[88:91], v[48:51]
    v_mfma_f32_16x16x32_bf16 v[52:55], a[132:135], v[88:91], v[52:55]
    v_mfma_f32_16x16x32_bf16 v[56:59], a[136:139], v[88:91], v[56:59]
    v_mfma_f32_16x16x32_bf16 v[60:63], a[120:123], v[92:95], v[60:63]
    v_mfma_f32_16x16x32_bf16 v[64:67], a[124:127], v[92:95], v[64:67]
    v_mfma_f32_16x16x32_bf16 v[68:71], a[128:131], v[92:95], v[68:71]
    v_mfma_f32_16x16x32_bf16 v[72:75], a[132:135], v[92:95], v[72:75]
    v_mfma_f32_16x16x32_bf16 v[76:79], a[136:139], v[92:95], v[76:79]
    s_waitcnt vmcnt(8)
    v_mfma_f32_16x16x32_bf16 v[0:3], a[140:143], v[96:99], v[0:3]
    v_mfma_f32_16x16x32_bf16 v[4:7], a[144:147], v[96:99], v[4:7]
    v_mfma_f32_16x16x32_bf16 v[8:11], a[148:151], v[96:99], v[8:11]
    v_mfma_f32_16x16x32_bf16 v[12:15], a[152:155], v[96:99], v[12:15]
    v_mfma_f32_16x16x32_bf16 v[16:19], a[156:159], v[96:99], v[16:19]
    s_waitcnt vmcnt(4)
    v_mfma_f32_16x16x32_bf16 v[0:3], a[160:163], v[112:115], v[0:3]
    v_mfma_f32_16x16x32_bf16 v[4:7], a[164:167], v[112:115], v[4:7]
    v_mfma_f32_16x16x32_bf16 v[8:11], a[168:171], v[112:115], v[8:11]
    v_mfma_f32_16x16x32_bf16 v[12:15], a[172:175], v[112:115], v[12:15]
    v_mfma_f32_16x16x32_bf16 v[16:19], a[176:179], v[112:115], v[16:19]
    s_waitcnt vmcnt(0)
    v_mfma_f32_16x16x32_bf16 v[0:3], a[180:183], v[128:131], v[0:3]
    v_mfma_f32_16x16x32_bf16 v[4:7], a[184:187], v[128:131], v[4:7]
    v_mfma_f32_16x16x32_bf16 v[8:11], a[188:191], v[128:131], v[8:11]
    v_mfma_f32_16x16x32_bf16 v[12:15], a[192:195], v[128:131], v[12:15]
    v_mfma_f32_16x16x32_bf16 v[16:19], a[196:199], v[128:131], v[16:19]
    v_mfma_f32_16x16x32_bf16 v[20:23], a[140:143], v[100:103], v[20:23]
    v_mfma_f32_16x16x32_bf16 v[24:27], a[144:147], v[100:103], v[24:27]
    v_mfma_f32_16x16x32_bf16 v[28:31], a[148:151], v[100:103], v[28:31]
    s_nop 0
    ds_write_b128 v230, v[0:3] offset:0
    v_mfma_f32_16x16x32_bf16 v[32:35], a[152:155], v[100:103], v[32:35]
    v_mfma_f32_16x16x32_bf16 v[36:39], a[156:159], v[100:103], v[36:39]
    ds_write_b128 v230, v[4:7] offset:64
    v_mfma_f32_16x16x32_bf16 v[20:23], a[160:163], v[116:119], v[20:23]
    v_mfma_f32_16x16x32_bf16 v[24:27], a[164:167], v[116:119], v[24:27]
    ds_write_b128 v230, v[8:11] offset:128
    v_mfma_f32_16x16x32_bf16 v[28:31], a[168:171], v[116:119], v[28:31]
    v_mfma_f32_16x16x32_bf16 v[32:35], a[172:175], v[116:119], v[32:35]
    ds_write_b128 v230, v[12:15] offset:192
    v_mfma_f32_16x16x32_bf16 v[36:39], a[176:179], v[116:119], v[36:39]
    v_mfma_f32_16x16x32_bf16 v[20:23], a[180:183], v[132:135], v[20:23]
    ds_write_b128 v230, v[16:19] offset:256
    v_mfma_f32_16x16x32_bf16 v[24:27], a[184:187], v[132:135], v[24:27]
    v_mfma_f32_16x16x32_bf16 v[28:31], a[188:191], v[132:135], v[28:31]
    v_mfma_f32_16x16x32_bf16 v[32:35], a[192:195], v[132:135], v[32:35]
    v_mfma_f32_16x16x32_bf16 v[36:39], a[196:199], v[132:135], v[36:39]
    s_waitcnt lgkmcnt(0)
    s_barrier
    v_mfma_f32_16x16x32_bf16 v[40:43], a[140:143], v[104:107], v[40:43]
    ds_read_b128 v[80:83], v222 offset:0
    ds_read_b128 v[84:87], v222 offset:21504
    v_mfma_f32_16x16x32_bf16 v[44:47], a[144:147], v[104:107], v[44:47]
    ds_read_b128 v[88:91], v223 offset:0
    ds_read_b128 v[92:95], v223 offset:21504
    v_mfma_f32_16x16x32_bf16 v[48:51], a[148:151], v[104:107], v[48:51]
    ds_write_b128 v230, v[20:23] offset:5376
    v_mfma_f32_16x16x32_bf16 v[52:55], a[152:155], v[104:107], v[52:55]
    v_mfma_f32_16x16x32_bf16 v[56:59], a[156:159], v[104:107], v[56:59]
    ds_write_b128 v230, v[24:27] offset:5440
    v_mfma_f32_16x16x32_bf16 v[40:43], a[160:163], v[120:123], v[40:43]
    v_mfma_f32_16x16x32_bf16 v[44:47], a[164:167], v[120:123], v[44:47]
    ds_write_b128 v230, v[28:31] offset:5504
    v_mfma_f32_16x16x32_bf16 v[48:51], a[168:171], v[120:123], v[48:51]
    v_mfma_f32_16x16x32_bf16 v[52:55], a[172:175], v[120:123], v[52:55]
    ds_write_b128 v230, v[32:35] offset:5568
    v_mfma_f32_16x16x32_bf16 v[56:59], a[176:179], v[120:123], v[56:59]
    v_mfma_f32_16x16x32_bf16 v[40:43], a[180:183], v[136:139], v[40:43]
    ds_write_b128 v230, v[36:39] offset:5632
    v_mfma_f32_16x16x32_bf16 v[44:47], a[184:187], v[136:139], v[44:47]
    v_mfma_f32_16x16x32_bf16 v[48:51], a[188:191], v[136:139], v[48:51]
    v_mfma_f32_16x16x32_bf16 v[52:55], a[192:195], v[136:139], v[52:55]
    v_mfma_f32_16x16x32_bf16 v[56:59], a[196:199], v[136:139], v[56:59]
    s_waitcnt lgkmcnt(0)
    s_barrier
    v_mfma_f32_16x16x32_bf16 v[60:63], a[140:143], v[108:111], v[60:63]
    ds_read_b128 v[144:147], v222 offset:5376
    ds_read_b128 v[148:151], v222 offset:26880
    v_mfma_f32_16x16x32_bf16 v[64:67], a[144:147], v[108:111], v[64:67]
    ds_read_b128 v[152:155], v223 offset:5376
    ds_read_b128 v[156:159], v223 offset:26880
    v_mfma_f32_16x16x32_bf16 v[68:71], a[148:151], v[108:111], v[68:71]
    ds_write_b128 v230, v[40:43] offset:10752
    s_mov_b32 s73, 0
    v_mfma_f32_16x16x32_bf16 v[72:75], a[152:155], v[108:111], v[72:75]
    v_add_f32 v200, v200, v80
    v_mfma_f32_16x16x32_bf16 v[76:79], a[156:159], v[108:111], v[76:79]
    ds_write_b128 v230, v[44:47] offset:10816
    v_add_f32 v201, v201, v81
    v_add_f32 v202, v202, v82
    v_mfma_f32_16x16x32_bf16 v[60:63], a[160:163], v[124:127], v[60:63]
    v_add_f32 v203, v203, v83
    v_mfma_f32_16x16x32_bf16 v[64:67], a[164:167], v[124:127], v[64:67]
    ds_write_b128 v230, v[48:51] offset:10880
    v_add_f32 v200, v200, v84
    v_add_f32 v201, v201, v85
    v_mfma_f32_16x16x32_bf16 v[68:71], a[168:171], v[124:127], v[68:71]
    v_add_f32 v202, v202, v86
    v_mfma_f32_16x16x32_bf16 v[72:75], a[172:175], v[124:127], v[72:75]
    ds_write_b128 v230, v[52:55] offset:10944
    v_add_f32 v203, v203, v87
    v_add_f32 v200, v200, v88
    v_mfma_f32_16x16x32_bf16 v[76:79], a[176:179], v[124:127], v[76:79]
    v_add_f32 v201, v201, v89
    v_mfma_f32_16x16x32_bf16 v[60:63], a[180:183], v[140:143], v[60:63]
    ds_write_b128 v230, v[56:59] offset:11008
    v_add_f32 v202, v202, v90
    v_add_f32 v203, v203, v91
    v_mfma_f32_16x16x32_bf16 v[64:67], a[184:187], v[140:143], v[64:67]
    v_add_f32 v200, v200, v92
    v_mfma_f32_16x16x32_bf16 v[68:71], a[188:191], v[140:143], v[68:71]
    v_add_f32 v201, v201, v93
    v_add_f32 v202, v202, v94
    v_mfma_f32_16x16x32_bf16 v[72:75], a[192:195], v[140:143], v[72:75]
    v_add_f32 v203, v203, v95
    v_mfma_f32_16x16x32_bf16 v[76:79], a[196:199], v[140:143], v[76:79]
    buffer_store_dwordx4 v[200:203], v220, s[44:47], s73 offen nt
    s_waitcnt lgkmcnt(0)
    s_barrier
    ds_read_b128 v[0:3], v222 offset:10752
    ds_read_b128 v[4:7], v222 offset:32256
    ds_read_b128 v[8:11], v223 offset:10752
    ds_read_b128 v[12:15], v223 offset:32256
    ds_write_b128 v230, v[60:63] offset:16128
    ds_write_b128 v230, v[64:67] offset:16192
    ds_write_b128 v230, v[68:71] offset:16256
    ds_write_b128 v230, v[72:75] offset:16320
    ds_write_b128 v230, v[76:79] offset:16384
    s_mov_b32 s73, 40960
    v_pk_add_f32 v[204:205], v[204:205], v[144:145]
    v_pk_add_f32 v[206:207], v[206:207], v[146:147]
    v_pk_add_f32 v[204:205], v[204:205], v[148:149]
    v_pk_add_f32 v[206:207], v[206:207], v[150:151]
    v_pk_add_f32 v[204:205], v[204:205], v[152:153]
    v_pk_add_f32 v[206:207], v[206:207], v[154:155]
    v_pk_add_f32 v[204:205], v[204:205], v[156:157]
    v_pk_add_f32 v[206:207], v[206:207], v[158:159]
    buffer_store_dwordx4 v[204:207], v220, s[44:47], s73 offen nt
    s_mov_b32 s73, 81920
    s_waitcnt lgkmcnt(5)
    s_nop 0
    v_pk_add_f32 v[208:209], v[208:209], v[0:1]
    v_pk_add_f32 v[210:211], v[210:211], v[2:3]
    v_pk_add_f32 v[208:209], v[208:209], v[4:5]
    v_pk_add_f32 v[210:211], v[210:211], v[6:7]
    v_pk_add_f32 v[208:209], v[208:209], v[8:9]
    v_pk_add_f32 v[210:211], v[210:211], v[10:11]
    v_pk_add_f32 v[208:209], v[208:209], v[12:13]
    v_pk_add_f32 v[210:211], v[210:211], v[14:15]
    buffer_store_dwordx4 v[208:211], v220, s[44:47], s73 offen nt
    s_waitcnt lgkmcnt(0)
    s_barrier
    ds_read_b128 v[96:99], v222 offset:16128
    ds_read_b128 v[100:103], v222 offset:37632
    ds_read_b128 v[104:107], v223 offset:16128
    ds_read_b128 v[108:111], v223 offset:37632
    ds_read_b128 v[112:115], v224 offset:0
    ds_read_b128 v[116:119], v224 offset:21504
    ds_read_b128 v[120:123], v224 offset:43008
    ds_read_b128 v[124:127], v224 offset:64512
    s_mov_b32 s73, 122880
    s_waitcnt lgkmcnt(4)
    s_nop 0
    v_pk_add_f32 v[212:213], v[212:213], v[96:97]
    v_pk_add_f32 v[214:215], v[214:215], v[98:99]
    v_pk_add_f32 v[212:213], v[212:213], v[100:101]
    v_pk_add_f32 v[214:215], v[214:215], v[102:103]
    v_pk_add_f32 v[212:213], v[212:213], v[104:105]
    v_pk_add_f32 v[214:215], v[214:215], v[106:107]
    v_pk_add_f32 v[212:213], v[212:213], v[108:109]
    v_pk_add_f32 v[214:215], v[214:215], v[110:111]
    buffer_store_dwordx4 v[212:215], v220, s[44:47], s73 offen nt
    s_mov_b32 s73, 0
    s_waitcnt lgkmcnt(0)
    v_pk_add_f32 v[216:217], v[216:217], v[112:113]
    v_pk_add_f32 v[218:219], v[218:219], v[114:115]
    v_pk_add_f32 v[216:217], v[216:217], v[116:117]
    v_pk_add_f32 v[218:219], v[218:219], v[118:119]
    v_pk_add_f32 v[216:217], v[216:217], v[120:121]
    v_pk_add_f32 v[218:219], v[218:219], v[122:123]
    v_pk_add_f32 v[216:217], v[216:217], v[124:125]
    v_pk_add_f32 v[218:219], v[218:219], v[126:127]
    buffer_store_dwordx4 v[216:219], v221, s[44:47], s73 offen nt
    s_endpgm
L_slow_non_gld:
L_spin_non_gld:
    s_add_u32 s79, s79, 1
    s_cmp_gt_u32 s79, 100000
    s_cbranch_scc1 L_go_non_gld
    s_sleep 8
    buffer_load_dword v243, off, s[60:63], 0 sc1
    s_waitcnt vmcnt(0)
    v_cmp_eq_u32 vcc, 0, v243
    s_cbranch_vccnz L_spin_non_gld
    s_branch L_go_non_gld
L_slow_f1_gld:
L_spin_f1_gld:
    s_add_u32 s79, s79, 1
    s_cmp_gt_u32 s79, 100000
    s_cbranch_scc1 L_go_f1_gld
    s_sleep 8
    s_lshl_b32 s73, s64, 10
    s_add_u32 s73, s73, 4259840
    v_lshlrev_b32 v243, 4, v233
    buffer_load_dword v243, v243, s[56:59], s73 offen sc1
    s_waitcnt vmcnt(0)
    v_cmp_ne_u32 vcc, s83, v243
    s_cbranch_vccnz L_spin_f1_gld
    s_branch L_go_f1_gld
L_slow_sum_gld:
L_spin_sum_gld:
    s_add_u32 s79, s79, 1
    s_cmp_gt_u32 s79, 100000
    s_cbranch_scc1 L_go_sum_gld
    s_sleep 8
    buffer_load_dwordx2 a[240:241], v236, s[56:59], s101 offen offset:0 sc1
    buffer_load_dwordx2 a[242:243], v236, s[56:59], s101 offen offset:512 sc1
    buffer_load_dwordx2 a[244:245], v236, s[56:59], s101 offen offset:1024 sc1
    buffer_load_dwordx2 a[246:247], v236, s[56:59], s101 offen offset:1536 sc1
    buffer_load_dwordx2 a[248:249], v236, s[56:59], s101 offen offset:2048 sc1
    s_waitcnt vmcnt(0)
    v_accvgpr_read_b32 v234, a241
    v_xor_b32 v234, s83, v234
    v_accvgpr_read_b32 v235, a243
    v_xor_b32 v235, s83, v235
    v_or_b32 v234, v234, v235
    v_accvgpr_read_b32 v235, a245
    v_xor_b32 v235, s83, v235
    v_or_b32 v234, v234, v235
    v_accvgpr_read_b32 v235, a247
    v_xor_b32 v235, s83, v235
    v_or_b32 v234, v234, v235
    v_accvgpr_read_b32 v235, a249
    v_xor_b32 v235, s83, v235
    v_or_b32 v234, v234, v235
    v_cmp_ne_u32 vcc, 0, v234
    s_cbranch_vccnz L_spin_sum_gld
    s_branch L_go_sum_gld
L_slow_epi_gld:
L_spin_epi_gld:
    s_add_u32 s79, s79, 1
    s_cmp_gt_u32 s79, 100000
    s_cbranch_scc1 L_go_epi_gld
    s_sleep 8
    buffer_load_dwordx2 v[244:245], v239, s[56:59], s27 offen offset:0 sc1
    buffer_load_dwordx2 v[246:247], v239, s[56:59], s27 offen offset:256 sc1
    buffer_load_dwordx2 v[248:249], v239, s[56:59], s27 offen offset:512 sc1
    buffer_load_dwordx2 v[250:251], v239, s[56:59], s27 offen offset:768 sc1
    buffer_load_dwordx2 v[252:253], v239, s[56:59], s27 offen offset:1024 sc1
    s_waitcnt vmcnt(0)
    v_xor_b32 v241, s83, v245
    v_xor_b32 v242, s83, v247
    v_or_b32 v241, v241, v242
    v_xor_b32 v242, s83, v249
    v_or_b32 v241, v241, v242
    v_xor_b32 v242, s83, v251
    v_or_b32 v241, v241, v242
    v_xor_b32 v242, s83, v253
    v_or_b32 v241, v241, v242
    v_cmp_ne_u32 vcc, 0, v241
    s_cbranch_vccnz L_spin_epi_gld
    s_branch L_go_epi_gld
L_slow_non_ssm:
L_spin_non_ssm:
    s_add_u32 s79, s79, 1
    s_cmp_gt_u32 s79, 100000
    s_cbranch_scc1 L_go_non_ssm
    s_sleep 8
    buffer_load_dword v243, off, s[60:63], 0 sc1
    s_waitcnt vmcnt(0)
    v_cmp_eq_u32 vcc, 0, v243
    s_cbranch_vccnz L_spin_non_ssm
    s_branch L_go_non_ssm
L_slow_q:
L_spin_q:
    s_add_u32 s79, s79, 1
    s_cmp_gt_u32 s79, 100000
    s_cbranch_scc1 L_go_q
    s_sleep 8
    buffer_load_dwordx2 v[140:141], v159, s[56:59], s101 offen offset:0 sc1
    buffer_load_dwordx2 v[142:143], v159, s[56:59], s101 offen offset:512 sc1
    buffer_load_dwordx2 v[144:145], v159, s[56:59], s101 offen offset:1024 sc1
    buffer_load_dwordx2 v[146:147], v159, s[56:59], s101 offen offset:1536 sc1
    buffer_load_dwordx2 v[148:149], v159, s[56:59], s101 offen offset:2048 sc1
    s_waitcnt vmcnt(0)
    v_xor_b32 v152, s83, v141
    v_xor_b32 v153, s83, v143
    v_or_b32 v152, v152, v153
    v_xor_b32 v153, s83, v145
    v_or_b32 v152, v152, v153
    v_xor_b32 v153, s83, v147
    v_or_b32 v152, v152, v153
    v_xor_b32 v153, s83, v149
    v_or_b32 v152, v152, v153
    v_cmp_ne_u32 vcc, 0, v152
    s_cbranch_vccnz L_spin_q
    s_branch L_go_q
L_slow_f1_ssm:
L_spin_f1_ssm:
    s_add_u32 s79, s79, 1
    s_cmp_gt_u32 s79, 100000
    s_cbranch_scc1 L_go_f1_ssm
    s_sleep 8
    s_lshl_b32 s73, s64, 10
    s_add_u32 s73, s73, 4259840
    v_lshlrev_b32 v243, 4, v233
    buffer_load_dword v243, v243, s[56:59], s73 offen sc1
    s_waitcnt vmcnt(0)
    v_cmp_ne_u32 vcc, s83, v243
    s_cbranch_vccnz L_spin_f1_ssm
    s_branch L_go_f1_ssm
L_slow_sts:
L_spin_sts:
    s_add_u32 s79, s79, 1
    s_cmp_gt_u32 s79, 100000
    s_cbranch_scc1 L_go_sts
    s_sleep 8
    s_lshl_b32 s73, s4, 6
    s_lshl_b32 s75, s64, 2
    s_mul_i32 s74, s5, 20
    s_add_u32 s73, s73, s75
    s_mul_i32 s75, s64, 1344
    v_lshrrev_b32 v239, 4, v233
    v_and_b32 v240, 15, v233
    v_mul_u32_u24 v241, 336, v239
    v_lshl_add_u32 v241, v240, 4, v241
    v_add_u32 v222, s75, v241
    v_add_u32 v239, s73, v239
    v_add_u32 v240, s74, v240
    v_mul_u32_u24 v241, 160, v239
    v_add_u32 v241, v241, v240
    v_lshlrev_b32 v220, 4, v241
    v_lshlrev_b32 v241, 3, v241
    v_lshlrev_b32 v240, 3, v240
    s_mov_b32 s76, 0
    buffer_load_dwordx2 v[140:141], v241, s[40:43], s76 offen
    s_mov_b32 s76, 20480
    buffer_load_dwordx2 v[142:143], v241, s[40:43], s76 offen
    s_mov_b32 s76, 40960
    buffer_load_dwordx2 v[144:145], v241, s[40:43], s76 offen
    s_mov_b32 s76, 61440
    buffer_load_dwordx2 v[146:147], v241, s[40:43], s76 offen
    buffer_load_dwordx2 v[150:151], v240, s[48:51], 0 offen
    v_and_b32 v239, 48, v233
    v_bfe_u32 v240, v233, 2, 2
    v_add_u32 v239, v239, v240
    v_and_b32 v240, 3, v233
    v_add_u32 v240, 16, v240
    v_mul_u32_u24 v241, 336, v239
    v_lshl_add_u32 v241, v240, 4, v241
    v_add_u32 v224, s75, v241
    v_add_u32 v239, s73, v239
    v_add_u32 v240, s74, v240
    v_mul_u32_u24 v241, 160, v239
    v_add_u32 v241, v241, v240
    v_lshlrev_b32 v221, 4, v241
    v_lshlrev_b32 v241, 3, v241
    v_lshlrev_b32 v240, 3, v240
    buffer_load_dwordx2 v[148:149], v241, s[40:43], 0 offen
    v_lshlrev_b32 v239, 3, v239
    s_mov_b32 s76, 4194304
    buffer_load_dwordx2 v[154:155], v239, s[56:59], s76 offen sc1
    buffer_load_dwordx2 v[152:153], v240, s[48:51], 0 offen
    s_waitcnt vmcnt(0)
    v_cmp_ne_u32 vcc, s83, v155
    s_cbranch_vccnz L_spin_sts
    s_branch L_go_sts
L_slow_e:
L_spin_e:
    s_add_u32 s79, s79, 1
    s_cmp_gt_u32 s79, 100000
    s_cbranch_scc1 L_go_e
    s_sleep 2
    s_nop 0
    buffer_load_dwordx4 v[128:131], v160, s[56:59], s27 offen sc1
    buffer_load_dwordx4 v[132:135], v161, s[56:59], s27 offen sc1
    buffer_load_dwordx4 v[136:139], v162, s[56:59], s27 offen sc1
    buffer_load_dwordx4 v[140:143], v163, s[56:59], s27 offen sc1
    buffer_load_dwordx4 v[144:147], v164, s[56:59], s27 offen sc1
    buffer_load_dwordx4 v[148:151], v165, s[56:59], s27 offen sc1
    buffer_load_dwordx4 v[152:155], v166, s[56:59], s27 offen sc1
    buffer_load_dwordx4 v[156:159], v167, s[56:59], s27 offen sc1
    s_waitcnt vmcnt(0)
    v_xor_b32 v239, v130, v168
    v_xor_b32 v240, v134, v169
    v_or_b32 v239, v239, v240
    v_xor_b32 v240, v138, v170
    v_or_b32 v239, v239, v240
    v_xor_b32 v240, v142, v171
    v_or_b32 v239, v239, v240
    v_xor_b32 v240, v146, v172
    v_or_b32 v239, v239, v240
    v_xor_b32 v240, v150, v173
    v_or_b32 v239, v239, v240
    v_xor_b32 v240, v154, v174
    v_or_b32 v239, v239, v240
    v_xor_b32 v240, v158, v175
    v_or_b32 v239, v239, v240
    v_cmp_ne_u32 vcc, 0, v239
    s_cbranch_vccnz L_spin_e
    s_branch L_go_e
L_slow_gs:
    s_waitcnt vmcnt(0)
    v_mov_b32 v232, s83
    s_mov_b64 exec, 1
    buffer_store_dword v232, off, s[56:59], s67 sc1
    s_mov_b64 exec, -1
L_spin_gs:
    s_add_u32 s79, s79, 1
    s_cmp_gt_u32 s79, 100000
    s_cbranch_scc1 L_go_gs
    s_sleep 2
    s_mov_b64 exec, s[10:11]
    buffer_load_dword v232, v231, s[56:59], s28 offen sc1
    s_mov_b64 exec, -1
    s_waitcnt vmcnt(0)
    v_cmp_ne_u32 vcc, s83, v232
    s_nop 0
    s_and_b64 vcc, vcc, s[10:11]
    s_cbranch_vccnz L_spin_gs
    s_branch L_go_gs
L_slow_ss:
L_spin_ss:
    s_add_u32 s79, s79, 1
    s_cmp_gt_u32 s79, 100000
    s_cbranch_scc1 L_go_ss
    s_sleep 8
    s_mov_b64 exec, s[22:23]
    buffer_load_dword v232, v231, s[56:59], s28 offen sc1
    s_mov_b64 exec, -1
    s_waitcnt vmcnt(0)
    v_cmp_ne_u32 vcc, s83, v232
    s_nop 0
    s_and_b64 vcc, vcc, s[22:23]
    s_cbranch_vccnz L_spin_ss
    s_branch L_go_ss
L_slow_non_g12:
L_spin_non_g12:
    s_add_u32 s79, s79, 1
    s_cmp_gt_u32 s79, 100000
    s_cbranch_scc1 L_go_non_g12
    s_sleep 8
    buffer_load_dword v243, off, s[60:63], 0 sc1
    s_waitcnt vmcnt(0)
    v_cmp_eq_u32 vcc, 0, v243
    s_cbranch_vccnz L_spin_non_g12
    s_branch L_go_non_g12
L_slow_f1_g12:
L_spin_f1_g12:
    s_add_u32 s79, s79, 1
    s_cmp_gt_u32 s79, 100000
    s_cbranch_scc1 L_go_f1_g12
    s_sleep 8
    s_lshl_b32 s73, s64, 10
    s_add_u32 s73, s73, 4259840
    v_lshlrev_b32 v243, 4, v233
    buffer_load_dword v243, v243, s[56:59], s73 offen sc1
    s_waitcnt vmcnt(0)
    v_cmp_ne_u32 vcc, s83, v243
    s_cbranch_vccnz L_spin_f1_g12
    s_branch L_go_f1_g12
L_slow_sum_g12:
L_spin_sum_g12:
    s_add_u32 s79, s79, 1
    s_cmp_gt_u32 s79, 100000
    s_cbranch_scc1 L_go_sum_g12
    s_sleep 8
    buffer_load_dwordx2 a[240:241], v236, s[56:59], s101 offen offset:0 sc1
    buffer_load_dwordx2 a[242:243], v236, s[56:59], s101 offen offset:512 sc1
    buffer_load_dwordx2 a[244:245], v236, s[56:59], s101 offen offset:1024 sc1
    buffer_load_dwordx2 a[246:247], v236, s[56:59], s101 offen offset:1536 sc1
    buffer_load_dwordx2 a[248:249], v236, s[56:59], s101 offen offset:2048 sc1
    s_waitcnt vmcnt(0)
    v_accvgpr_read_b32 v234, a241
    v_xor_b32 v234, s83, v234
    v_accvgpr_read_b32 v235, a243
    v_xor_b32 v235, s83, v235
    v_or_b32 v234, v234, v235
    v_accvgpr_read_b32 v235, a245
    v_xor_b32 v235, s83, v235
    v_or_b32 v234, v234, v235
    v_accvgpr_read_b32 v235, a247
    v_xor_b32 v235, s83, v235
    v_or_b32 v234, v234, v235
    v_accvgpr_read_b32 v235, a249
    v_xor_b32 v235, s83, v235
    v_or_b32 v234, v234, v235
    s_cmp_ge_u32 s78, 54
    s_cselect_b32 s73, 0, -1
    v_and_b32 v234, s73, v234
    v_cmp_ne_u32 vcc, 0, v234
    s_cbranch_vccnz L_spin_sum_g12
    s_branch L_go_sum_g12
L_slow_epi_g12:
L_spin_epi_g12:
    s_add_u32 s79, s79, 1
    s_cmp_gt_u32 s79, 100000
    s_cbranch_scc1 L_go_epi_g12
    s_sleep 8
    buffer_load_dwordx2 v[244:245], v239, s[56:59], s27 offen offset:0 sc1
    buffer_load_dwordx2 v[246:247], v239, s[56:59], s27 offen offset:256 sc1
    buffer_load_dwordx2 v[248:249], v239, s[56:59], s27 offen offset:512 sc1
    buffer_load_dwordx2 v[250:251], v239, s[56:59], s27 offen offset:768 sc1
    s_waitcnt vmcnt(0)
    v_xor_b32 v241, s83, v245
    v_xor_b32 v242, s83, v247
    v_or_b32 v241, v241, v242
    v_xor_b32 v242, s83, v249
    v_or_b32 v241, v241, v242
    v_xor_b32 v242, s83, v251
    v_or_b32 v241, v241, v242
    v_cmp_ne_u32 vcc, 0, v241
    s_cbranch_vccnz L_spin_epi_g12
    s_branch L_go_epi_g12
L_slow_non_glux:
L_spin_non_glux:
    s_add_u32 s79, s79, 1
    s_cmp_gt_u32 s79, 100000
    s_cbranch_scc1 L_go_non_glux
    s_sleep 8
    buffer_load_dword v243, off, s[60:63], 0 sc1
    s_waitcnt vmcnt(0)
    v_cmp_eq_u32 vcc, 0, v243
    s_cbranch_vccnz L_spin_non_glux
    s_branch L_go_non_glux
L_slow_non_glu:
L_spin_non_glu:
    s_add_u32 s79, s79, 1
    s_cmp_gt_u32 s79, 100000
    s_cbranch_scc1 L_go_non_glu
    s_sleep 8
    buffer_load_dword v243, off, s[60:63], 0 sc1
    s_waitcnt vmcnt(0)
    v_cmp_eq_u32 vcc, 0, v243
    s_cbranch_vccnz L_spin_non_glu
    s_branch L_go_non_glu
L_slow_f1_glu:
L_spin_f1_glu:
    s_add_u32 s79, s79, 1
    s_cmp_gt_u32 s79, 100000
    s_cbranch_scc1 L_go_f1_glu
    s_sleep 8
    s_lshl_b32 s73, s64, 10
    s_add_u32 s73, s73, 4259840
    v_lshlrev_b32 v243, 4, v233
    buffer_load_dword v243, v243, s[56:59], s73 offen sc1
    s_waitcnt vmcnt(0)
    v_cmp_ne_u32 vcc, s83, v243
    s_cbranch_vccnz L_spin_f1_glu
    s_branch L_go_f1_glu
L_slow_sum_glu:
L_spin_sum_glu:
    s_add_u32 s79, s79, 1
    s_cmp_gt_u32 s79, 100000
    s_cbranch_scc1 L_go_sum_glu
    s_sleep 8
    buffer_load_dwordx2 a[240:241], v236, s[56:59], s101 offen offset:0 sc1
    buffer_load_dwordx2 a[242:243], v236, s[56:59], s101 offen offset:512 sc1
    buffer_load_dwordx2 a[244:245], v236, s[56:59], s101 offen offset:1024 sc1
    buffer_load_dwordx2 a[246:247], v236, s[56:59], s101 offen offset:1536 sc1
    buffer_load_dwordx2 a[248:249], v236, s[56:59], s101 offen offset:2048 sc1
    s_waitcnt vmcnt(0)
    v_accvgpr_read_b32 v234, a241
    v_xor_b32 v234, s83, v234
    v_accvgpr_read_b32 v235, a243
    v_xor_b32 v235, s83, v235
    v_or_b32 v234, v234, v235
    v_accvgpr_read_b32 v235, a245
    v_xor_b32 v235, s83, v235
    v_or_b32 v234, v234, v235
    v_accvgpr_read_b32 v235, a247
    v_xor_b32 v235, s83, v235
    v_or_b32 v234, v234, v235
    v_accvgpr_read_b32 v235, a249
    v_xor_b32 v235, s83, v235
    v_or_b32 v234, v234, v235
    v_cmp_ne_u32 vcc, 0, v234
    s_cbranch_vccnz L_spin_sum_glu
    s_branch L_go_sum_glu
L_slow_epi_glu:
L_spin_epi_glu:
    s_add_u32 s79, s79, 1
    s_cmp_gt_u32 s79, 100000
    s_cbranch_scc1 L_go_epi_glu
    s_sleep 8
    buffer_load_dwordx2 v[244:245], v239, s[56:59], s27 offen offset:0 sc1
    buffer_load_dwordx2 v[246:247], v239, s[56:59], s27 offen offset:256 sc1
    buffer_load_dwordx2 v[248:249], v239, s[56:59], s27 offen offset:512 sc1
    buffer_load_dwordx2 v[250:251], v239, s[56:59], s27 offen offset:768 sc1
    buffer_load_dwordx2 v[252:253], v239, s[56:59], s27 offen offset:1024 sc1
    s_waitcnt vmcnt(0)
    v_xor_b32 v241, s83, v245
    v_xor_b32 v242, s83, v247
    v_or_b32 v241, v241, v242
    v_xor_b32 v242, s83, v249
    v_or_b32 v241, v241, v242
    v_xor_b32 v242, s83, v251
    v_or_b32 v241, v241, v242
    v_xor_b32 v242, s83, v253
    v_or_b32 v241, v241, v242
    v_cmp_ne_u32 vcc, 0, v241
    s_cbranch_vccnz L_spin_epi_glu
    s_branch L_go_epi_glu
L_slow_gg:
L_spin_gg:
    s_add_u32 s79, s79, 1
    s_cmp_gt_u32 s79, 100000
    s_cbranch_scc1 L_go_gg
    s_sleep 2
    s_mov_b64 exec, s[10:11]
    buffer_load_dword v232, v231, s[56:59], s28 offen sc1
    s_mov_b64 exec, -1
    s_waitcnt vmcnt(0)
    v_cmp_ne_u32 vcc, s83, v232
    s_nop 0
    s_and_b64 vcc, vcc, s[10:11]
    s_cbranch_vccnz L_spin_gg
    s_branch L_go_gg
L_slow_stg:
L_spin_stg:
    s_add_u32 s79, s79, 1
    s_cmp_gt_u32 s79, 100000
    s_cbranch_scc1 L_go_stg
    s_sleep 8
    s_lshl_b32 s73, s4, 6
    s_lshl_b32 s75, s64, 2
    s_mul_i32 s74, s5, 20
    s_add_u32 s73, s73, s75
    s_mul_i32 s75, s64, 1344
    v_lshrrev_b32 v239, 4, v233
    v_and_b32 v240, 15, v233
    v_mul_u32_u24 v241, 336, v239
    v_lshl_add_u32 v241, v240, 4, v241
    v_add_u32 v222, s75, v241
    v_add_u32 v239, s73, v239
    v_add_u32 v240, s74, v240
    v_mul_u32_u24 v241, 160, v239
    v_add_u32 v241, v241, v240
    v_lshlrev_b32 v220, 4, v241
    v_lshlrev_b32 v241, 3, v241
    v_lshlrev_b32_e64 v240, 3, v240
    s_mov_b32 s76, 0
    buffer_load_dwordx2 v[0:1], v241, s[40:43], s76 offen
    s_mov_b32 s76, 20480
    buffer_load_dwordx2 v[2:3], v241, s[40:43], s76 offen
    s_mov_b32 s76, 40960
    buffer_load_dwordx2 v[4:5], v241, s[40:43], s76 offen
    s_mov_b32 s76, 61440
    buffer_load_dwordx2 v[6:7], v241, s[40:43], s76 offen
    buffer_load_dwordx2 v[10:11], v240, s[48:51], 0 offen
    v_and_b32 v239, 48, v233
    v_bfe_u32 v240, v233, 2, 2
    v_add_u32 v239, v239, v240
    v_and_b32 v240, 3, v233
    v_add_u32 v240, 16, v240
    v_mul_u32_u24 v241, 336, v239
    v_lshl_add_u32 v241, v240, 4, v241
    v_add_u32 v224, s75, v241
    v_add_u32 v239, s73, v239
    v_add_u32 v240, s74, v240
    v_mul_u32_u24 v241, 160, v239
    v_add_u32 v241, v241, v240
    v_lshlrev_b32 v221, 4, v241
    v_lshlrev_b32 v241, 3, v241
    v_lshlrev_b32 v240, 3, v240
    buffer_load_dwordx2 v[8:9], v241, s[40:43], 0 offen
    v_lshlrev_b32 v239, 3, v239
    s_mov_b32 s76, 4194304
    buffer_load_dwordx2 v[14:15], v239, s[56:59], s76 offen sc1
    buffer_load_dwordx2 v[12:13], v240, s[48:51], 0 offen
    s_waitcnt vmcnt(0)
    v_cmp_ne_u32 vcc, s83, v15
    s_cbranch_vccnz L_spin_stg
    s_branch L_go_stg
L_slow_sg:
L_spin_sg:
    s_add_u32 s79, s79, 1
    s_cmp_gt_u32 s79, 100000
    s_cbranch_scc1 L_go_sg
    s_sleep 8
    s_mov_b64 exec, s[22:23]
    buffer_load_dword v232, v231, s[56:59], s28 offen sc1
    s_mov_b64 exec, -1
    s_waitcnt vmcnt(0)
    v_cmp_ne_u32 vcc, s83, v232
    s_nop 0
    s_and_b64 vcc, vcc, s[22:23]
    s_cbranch_vccnz L_spin_sg
    s_branch L_go_sg
L_end:
    s_endpgm
.section .rodata,"a"
.p2align 6
.amdhsa_kernel parallel_sum__ssm_conv_s5__glu_gated_glu__prompt_kernel
  .amdhsa_next_free_vgpr 512
  .amdhsa_next_free_sgpr 102
  .amdhsa_accum_offset 256
  .amdhsa_group_segment_fixed_size 0
  .amdhsa_kernarg_size 128
  .amdhsa_user_sgpr_count 2
  .amdhsa_user_sgpr_kernarg_segment_ptr 1
  .amdhsa_system_sgpr_workgroup_id_x 1
.end_amdhsa_kernel
```
